```python
import torch

def _softmax(x, axis=-1):
    return torch.softmax(x, dim=axis)
def _gelu(x):
    return torch.nn.functional.gelu(x, approximate="tanh")
def _silu(x):
    return torch.nn.functional.silu(x)
def _sigmoid(x):
    return torch.sigmoid(x)
def _layernorm(x, axis=-1, eps=1e-5):
    m = x.mean(dim=axis, keepdim=True)
    v = x.var(dim=axis, keepdim=True, unbiased=False)
    return (x - m) / torch.sqrt(v + eps)
def _scatter_add(tgt, idx, src, axis=0):
    return tgt.clone().index_add_(axis, idx, src)
def _segment_sum(src, seg, n):
    out = torch.zeros((n,) + src.shape[1:], dtype=src.dtype)
    return out.index_add_(0, seg, src)
def _pad(x, pw):
    flat = tuple(v for pair in reversed(pw) for v in pair)
    return torch.nn.functional.pad(x, flat)

kernel_name = 'sequential_preLN__linear_attn_block__glu_gated_glu__prompt'

def setup_inputs():

    _w = (lambda a: (lambda t: t.to(torch.bfloat16) if t.is_floating_point() else t)(torch.as_tensor(a)))
    def _A_setup():
        B, S, D = 1, 2048, 1024
        return {
            "x": _w((lambda *s: torch.randn(*s, dtype=torch.bfloat16) * 0.05)(B, S, D)),
            "wqkv": _w((lambda *s: torch.randn(*s, dtype=torch.bfloat16) * 0.05)(D, 3 * D)),
            "wo": _w((lambda *s: torch.randn(*s, dtype=torch.bfloat16) * 0.05)(D, D)),
        }
    _A_in = _A_setup()

    def _B_setup():
        B, S, D, F = 1, 2048, 1024, 3584
        return {
            "x": _w((lambda *s: torch.randn(*s, dtype=torch.bfloat16) * 0.05)(B, S, D)),
            "w_gate": _w((lambda *s: torch.randn(*s, dtype=torch.bfloat16) * 0.05)(D, F)),
            "w_up": _w((lambda *s: torch.randn(*s, dtype=torch.bfloat16) * 0.05)(D, F)),
            "w_down": _w((lambda *s: torch.randn(*s, dtype=torch.bfloat16) * 0.05)(F, D)),
        }
    _B_in = _B_setup()

    return {
        "A_x": _A_in["x"],
        "A_wqkv": _A_in["wqkv"],
        "A_wo": _A_in["wo"],
        "B_x": _B_in["x"],
        "B_w_gate": _B_in["w_gate"],
        "B_w_up": _B_in["w_up"],
        "B_w_down": _B_in["w_down"],
    }

def reference(A_x, A_wqkv, A_wo, B_x, B_w_gate, B_w_up, B_w_down):
    def _A_ref(x, wqkv, wo):
        B, S, D = x.shape
        H = 32; Dh = D // H
        qkv = (lambda x, *d: x.permute(*d))((x @ wqkv).reshape(B, S, 3, H, Dh), 2, 0, 3, 1, 4)
        q, k, v = qkv[0], qkv[1], qkv[2]
        phi = lambda t: torch.where(t > 0, t + 1, torch.exp(t)) + 1e-6
        pq, pk = phi(q), phi(k)
        kv = torch.einsum("bhsd,bhse->bhde", pk, v)
        z = torch.einsum("bhsd->bhd", pk)
        num = torch.einsum("bhqd,bhde->bhqe", pq, kv)
        den = torch.einsum("bhqd,bhd->bhq", pq, z)[..., None] + 1e-6
        o = num / den
        return (lambda x, *d: x.permute(*d))(o, 0, 2, 1, 3).reshape(B, S, D) @ wo

    def _B_ref(x, w_gate, w_up, w_down):
        g = torch.einsum("bsd,df->bsf", x, w_gate)
        u = torch.einsum("bsd,df->bsf", x, w_up)
        h = _sigmoid(g) * u
        return torch.einsum("bsf,fd->bsd", h, w_down)

    x = A_x
    h = x + _A_ref(_layernorm(x, axis=-1), A_wqkv, A_wo)
    h2 = h + _B_ref(_layernorm(h, axis=-1), B_w_gate, B_w_up, B_w_down)
    return h2
```

```asm
; @launch grid=(256,1,1) block=(256,1,1) lds=163840
.amdgcn_target "amdgcn-amd-amdhsa--gfx950"
.text
.globl sequential_preLN__linear_attn_block__glu_gated_glu__prompt_kernel
.p2align 8
.type sequential_preLN__linear_attn_block__glu_gated_glu__prompt_kernel,@function
sequential_preLN__linear_attn_block__glu_gated_glu__prompt_kernel:
    s_cmp_ge_u32 s2, 256
    s_cbranch_scc1 L_end
    s_load_dwordx16 s[64:79], s[0:1], 0
    s_load_dwordx4 s[80:83], s[0:1], 64
    v_lshrrev_b32 v1, 6, v0
    v_and_b32 v255, 63, v0
    v_readfirstlane_b32 s3, v1
    v_lshlrev_b32 v254, 4, v255
    s_and_b32 s50, s2, 7
    s_lshr_b32 s51, s2, 3
    s_and_b32 s52, s50, 1
    s_lshr_b32 s53, s50, 1
    s_lshl_b32 s52, s52, 3
    s_and_b32 s54, s51, 7
    s_add_u32 s27, s52, s54
    s_lshl_b32 s53, s53, 2
    s_lshr_b32 s54, s51, 3
    s_add_u32 s28, s53, s54
    v_lshrrev_b32 v144, 3, v255
    v_and_b32 v145, 6, v144
    v_and_b32 v146, 7, v255
    v_xor_b32 v147, v145, v146
    v_lshlrev_b32 v148, 11, v144
    v_lshl_add_u32 v148, v147, 4, v148
    s_lshl_b32 s40, s27, 4
    s_add_u32 s40, s40, s28
    s_lshl_b32 s51, s40, 14
    s_lshl_b32 s52, s3, 9
    s_add_u32 s51, s51, s52
    s_lshl_b32 s22, s3, 12
    s_lshl_b32 s44, s2, 2
    s_add_u32 s44, s44, s3
    v_lshlrev_b32 v241, 7, v255
    s_waitcnt lgkmcnt(0)
    s_mov_b32 s12, s64
    s_mov_b32 s13, s65
    s_mov_b32 s14, 4194304
    s_mov_b32 s15, 0x20000
    s_add_u32 m0, s22, 147456
    s_nop 0
    buffer_load_dwordx4 v148, s[12:15], s51 offen offset:0 nt lds
    s_add_u32 m0, s22, 148352
    s_nop 0
    buffer_load_dwordx4 v148, s[12:15], s51 offen offset:128 nt lds
    s_add_u32 m0, s22, 149248
    s_nop 0
    buffer_load_dwordx4 v148, s[12:15], s51 offen offset:256 nt lds
    s_add_u32 m0, s22, 150144
    s_nop 0
    buffer_load_dwordx4 v148, s[12:15], s51 offen offset:384 nt lds
    s_add_u32 s56, s82, 34602752
    s_addc_u32 s57, s83, 0
    s_load_dword s33, s[56:57], 0
    s_mov_b32 s4, s66
    s_mov_b32 s5, s67
    s_mov_b32 s6, 6291456
    s_mov_b32 s7, 0x20000
    s_and_b32 s50, s3, 1
    s_lshl_b32 s45, s2, 1
    s_add_u32 s45, s45, s50
    s_mov_b32 s84, s68
    s_mov_b32 s85, s69
    s_mov_b32 s86, 2097152
    s_mov_b32 s87, 0x20000
    s_getpc_b64 s[52:53]
L_pc:
    s_sub_u32 s52, s52, L_pc-sequential_preLN__linear_attn_block__glu_gated_glu__prompt_kernel
    s_subb_u32 s53, s53, 0
    s_mov_b32 s54, L_end-sequential_preLN__linear_attn_block__glu_gated_glu__prompt_kernel
    s_mov_b32 s55, 0x20000
    s_lshr_b32 s56, s2, 3
    s_lshl_b32 s56, s56, 2
    s_add_u32 s56, s56, s3
    s_mul_i32 s56, s56, 640
    s_mov_b64 exec, 0x1f
    buffer_load_dword v150, v241, s[52:55], s56 offen
    s_mov_b64 exec, -1
    s_lshr_b32 s56, s44, 1
    s_mul_i32 s56, s56, 6144
    s_and_b32 s57, s3, 1
    s_lshl_b32 s57, s57, 11
    s_add_u32 s56, s56, s57
    s_add_u32 s56, s56, 2048
    s_mov_b64 exec, 0xffff
    buffer_load_dword v150, v241, s[4:7], s56 offen
    s_mov_b64 exec, -1
    s_lshr_b32 s57, s2, 3
    s_lshl_b32 s57, s57, 2
    s_add_u32 s57, s57, s3
    s_mul_i32 s57, s57, 49152
    s_and_b32 s56, s28, 8
    s_lshl_b32 s56, s56, 7
    s_add_u32 s56, s56, s57
    s_add_u32 s56, s56, 384
    s_bitcmp1_b32 s28, 2
    s_cselect_b32 s56, 0x7ff00000, s56
    v_mul_u32_u24 v151, 6144, v255
    s_add_u32 s56, s56, 2048
    s_mov_b64 exec, 0xff
    buffer_load_dword v150, v151, s[4:7], s56 offen offset:0
    buffer_load_dword v150, v151, s[4:7], s56 offen offset:2048
    s_mov_b64 exec, -1
    s_mov_b32 s8, s66
    s_mov_b32 s9, s67
    s_mov_b32 s10, 6291456
    s_mov_b32 s11, 0x20000
    s_mov_b32 s16, s82
    s_mov_b32 s17, s83
    s_mov_b32 s18, 134217728
    s_mov_b32 s19, 0x20000
    v_cmp_eq_u32 vcc, 3, v144
    v_add_u32 v240, 67108992, v254
    s_lshl_b32 s50, s27, 3
    v_cndmask_b32 v240, v254, v240, vcc
    s_lshl_b32 s51, s3, 1
    s_add_u32 s50, s50, s51
    s_lshl_b32 s50, s50, 15
    v_add_u32 v224, s50, v240
    v_add_u32 v225, 0x8000, v224
    v_lshrrev_b32 v242, 5, v255
    v_bfe_u32 v243, v255, 3, 2
    v_lshl_add_u32 v242, v242, 3, v243
    v_mul_u32_u24 v242, 6144, v242
    v_lshl_add_u32 v242, v147, 4, v242
    s_lshr_b32 s50, s3, 1
    s_lshl_b32 s50, s50, 5
    s_and_b32 s51, s3, 1
    s_lshl_b32 s51, s51, 2
    s_add_u32 s50, s50, s51
    s_mul_i32 s50, s50, 6144
    s_lshl_b32 s51, s28, 7
    s_add_u32 s50, s50, s51
    v_add_u32 v226, s50, v242
    v_add_u32 v227, 97280, v226
    v_add_u32 v228, 391168, v226
    v_add_u32 v229, 391168, v227
    v_lshrrev_b32 v242, 2, v255
    v_lshlrev_b32 v242, 7, v242
    v_and_b32 v243, 3, v255
    v_lshl_add_u32 v242, v243, 3, v242
    v_bfe_u32 v243, v255, 3, 2
    v_xor_b32 v244, 0, v243
    v_lshl_add_u32 v208, v244, 5, v242
    v_xor_b32 v244, 1, v243
    v_lshl_add_u32 v209, v244, 5, v242
    v_xor_b32 v244, 2, v243
    v_lshl_add_u32 v210, v244, 5, v242
    v_xor_b32 v244, 3, v243
    v_lshl_add_u32 v211, v244, 5, v242
    v_add_u32 v212, 0x10000, v208
    v_add_u32 v213, 0x10000, v209
    v_add_u32 v214, 0x10000, v210
    v_add_u32 v215, 0x10000, v211
    v_add_u32 v216, 0x10000, v212
    v_add_u32 v217, 0x10000, v213
    v_add_u32 v218, 0x10000, v214
    v_add_u32 v219, 0x10000, v215
    s_and_b32 s50, s2, 3
    s_lshl_b32 s50, s50, 2
    s_bfe_u32 s51, s2, 0x20003
    s_add_u32 s29, s50, s51
    s_lshr_b32 s50, s2, 5
    s_lshl_b32 s50, s50, 1
    s_bfe_u32 s51, s2, 0x10002
    s_add_u32 s30, s50, s51
    s_and_b32 s50, s2, 7
    s_lshr_b32 s51, s2, 3
    s_and_b32 s52, s50, 1
    s_lshr_b32 s53, s50, 1
    s_lshl_b32 s52, s52, 2
    s_and_b32 s54, s51, 3
    s_add_u32 s31, s52, s54
    s_lshl_b32 s53, s53, 3
    s_lshr_b32 s54, s51, 2
    s_add_u32 s32, s53, s54
    s_lshl_b32 s41, s29, 4
    s_add_u32 s41, s41, s30
    s_lshl_b32 s43, s29, 3
    s_lshl_b32 s50, s3, 1
    s_add_u32 s43, s43, s50
    s_lshl_b32 s42, s28, 4
    s_add_u32 s42, s42, s27
    s_mul_i32 s42, s42, 5120
    s_add_u32 s42, s42, 29360128
    s_lshl_b32 s48, s40, 5
    s_add_u32 s48, s48, 32636928
    v_mov_b32 v152, s48
    s_lshl_b32 s50, s40, 8
    s_lshl_b32 s51, s41, 8
    s_lshl_b32 s52, s31, 5
    s_add_u32 s52, s52, s32
    s_lshl_b32 s52, s52, 8
    s_add_u32 s53, s50, 33554432
    v_writelane_b32 v152, s53, 0
    s_add_u32 s53, s50, 33619968
    v_writelane_b32 v152, s53, 1
    s_add_u32 s53, s51, 33685504
    v_writelane_b32 v152, s53, 2
    s_add_u32 s53, s52, 33751040
    v_writelane_b32 v152, s53, 3
    s_add_u32 s53, s51, 33816576
    v_writelane_b32 v152, s53, 4
    s_add_u32 s53, s42, 4096
    v_writelane_b32 v152, s53, 5
    s_add_u32 s53, s42, 4224
    v_writelane_b32 v152, s53, 6
    s_add_u32 s53, s42, 4352
    v_writelane_b32 v152, s53, 7
    s_mov_b64 exec, 0x1ff
    buffer_load_dword v150, v152, s[16:19], 0 offen sc1
    s_mov_b64 exec, -1
    v_lshrrev_b32 v242, 3, v255
    v_and_b32 v243, 6, v242
    v_and_b32 v244, 7, v255
    v_xor_b32 v243, v243, v244
    v_lshlrev_b32 v242, 11, v242
    v_lshl_add_u32 v243, v243, 4, v242
    s_lshl_b32 s50, s3, 15
    s_lshl_b32 s51, s30, 7
    s_add_u32 s50, s50, s51
    v_add_u32 v220, s50, v243
    v_add_u32 v221, 15360, v220
    v_add_u32 v230, 129024, v220
    v_add_u32 v231, 129024, v221
    s_mov_b32 s34, 0x3fb8aa3b
    s_mov_b32 s35, 0x3fb8aa3b
    s_mov_b32 s36, 0x358637bd
    s_mov_b32 s37, 0x358637bd
    v_add_u32 v244, s22, v254
    v_add_u32 v251, 98304, v244
    v_add_u32 v244, 147456, v244
    s_lshr_b32 s50, s3, 1
    s_lshl_b32 s51, s50, 11
    s_add_u32 s51, s51, 147456
    v_add_u32 v245, s51, v254
    s_lshl_b32 s51, s3, 10
    v_add_u32 v247, s51, v254
    v_add_u32 v246, 98304, v247
    v_add_u32 v247, 98304, v247
    v_add_u32 v250, s51, v240
    v_lshrrev_b32 v253, 4, v255
    s_lshl_b32 s50, s50, 7
    s_add_u32 s50, s50, 4096
    v_lshl_add_u32 v248, v253, 5, s50
    v_mul_u32_u24 v253, 5120, v253
    v_add_u32 v253, 4352, v253
    v_and_b32 v252, 15, v255
    v_mul_u32_u24 v252, 5120, v252
    v_add_u32 v252, v252, v248
    s_lshl_b32 s51, s3, 2
    s_add_u32 s51, s51, 4352
    v_mov_b32 v249, s51
    v_mov_b32 v232, 0x3f803f80
    v_mov_b32 v233, 0x3f803f80
    v_mov_b32 v234, 0x3f803f80
    v_mov_b32 v235, 0x3f803f80
    v_and_b32 v145, 6, v146
    v_xor_b32 v145, v145, v144
    v_lshlrev_b32 v145, 4, v145
    v_lshl_add_u32 v145, v146, 7, v145
    s_add_u32 s51, s22, 147456
    v_add_u32 v145, s51, v145
    v_lshlrev_b32 v148, 8, v144
    v_lshl_add_u32 v148, v146, 4, v148
    v_and_b32 v149, 3, v144
    v_cmp_eq_u32 vcc, 1, v149
    s_and_b32 s50, s28, 1
    s_mul_i32 s50, s50, 67108992
    v_add_u32 v149, s50, v148
    v_cndmask_b32 v148, v148, v149, vcc
    v_lshl_add_u32 v149, v146, 3, s51
    v_lshlrev_b32 v154, 3, v146
    v_add_u32 v154, 147456, v154
    v_lshlrev_b32 v155, 2, v146
    s_lshr_b32 s46, s40, 1
    s_lshl_b32 s46, s46, 15
    s_lshl_b32 s50, s3, 13
    s_add_u32 s46, s46, s50
    s_and_b32 s50, s28, 1
    s_lshl_b32 s50, s50, 7
    s_add_u32 s46, s46, s50
    s_add_u32 s47, s46, 4096
    s_lshl_b32 s49, s3, 1
    s_lshl_b32 s49, 3, s49
    v_mov_b32 v48, 0
    v_mov_b32 v49, 0
    v_mov_b32 v50, 0
    v_mov_b32 v51, 0
    s_waitcnt vmcnt(5)
    ds_read_b128 v[0:3], v145 offset:0
    ds_read_b128 v[4:7], v145 offset:1024
    ds_read_b128 v[8:11], v145 offset:2048
    ds_read_b128 v[12:15], v145 offset:3072
    s_lshr_b32 s56, s44, 1
    s_mul_i32 s56, s56, 6144
    s_and_b32 s57, s3, 1
    s_lshl_b32 s57, s57, 11
    s_add_u32 s56, s56, s57
    s_add_u32 s56, s56, 3147776
    s_mov_b64 exec, 0xffff
    buffer_load_dword v150, v241, s[4:7], s56 offen
    s_mov_b64 exec, -1
    s_waitcnt lgkmcnt(0)
    s_add_u32 s33, s33, 0x9e3779b9
    v_dot2c_f32_bf16 v48, v232, v0
    v_dot2c_f32_bf16 v49, v0, v0
    v_dot2c_f32_bf16 v50, v232, v1
    v_dot2c_f32_bf16 v51, v1, v1
    v_dot2c_f32_bf16 v48, v232, v2
    v_dot2c_f32_bf16 v49, v2, v2
    v_dot2c_f32_bf16 v50, v232, v3
    v_dot2c_f32_bf16 v51, v3, v3
    v_dot2c_f32_bf16 v48, v232, v4
    v_dot2c_f32_bf16 v49, v4, v4
    v_dot2c_f32_bf16 v50, v232, v5
    v_dot2c_f32_bf16 v51, v5, v5
    v_dot2c_f32_bf16 v48, v232, v6
    v_dot2c_f32_bf16 v49, v6, v6
    v_dot2c_f32_bf16 v50, v232, v7
    v_dot2c_f32_bf16 v51, v7, v7
    v_dot2c_f32_bf16 v48, v232, v8
    v_dot2c_f32_bf16 v49, v8, v8
    v_dot2c_f32_bf16 v50, v232, v9
    v_dot2c_f32_bf16 v51, v9, v9
    v_dot2c_f32_bf16 v48, v232, v10
    v_dot2c_f32_bf16 v49, v10, v10
    v_dot2c_f32_bf16 v50, v232, v11
    v_dot2c_f32_bf16 v51, v11, v11
    v_dot2c_f32_bf16 v48, v232, v12
    v_dot2c_f32_bf16 v49, v12, v12
    v_dot2c_f32_bf16 v50, v232, v13
    v_dot2c_f32_bf16 v51, v13, v13
    v_dot2c_f32_bf16 v48, v232, v14
    v_dot2c_f32_bf16 v49, v14, v14
    v_dot2c_f32_bf16 v50, v232, v15
    v_dot2c_f32_bf16 v51, v15, v15
    v_lshlrev_b32 v16, 16, v0
    v_and_b32 v17, 0xffff0000, v0
    v_lshlrev_b32 v18, 16, v1
    v_pk_add_f32 v[48:49], v[48:49], v[50:51]
    v_and_b32 v19, 0xffff0000, v1
    v_lshlrev_b32 v20, 16, v2
    v_add_f32_dpp v48, v48, v48 row_ror:8 row_mask:0xf bank_mask:0xf
    v_add_f32_dpp v49, v49, v49 row_ror:8 row_mask:0xf bank_mask:0xf
    v_mov_b32 v50, v48
    v_mov_b32 v51, v49
    v_and_b32 v21, 0xffff0000, v2
    v_lshlrev_b32 v22, 16, v3
    v_permlane16_swap_b32 v48, v50
    v_permlane16_swap_b32 v49, v51
    v_and_b32 v23, 0xffff0000, v3
    v_pk_add_f32 v[48:49], v[48:49], v[50:51]
    v_mov_b32 v50, v48
    v_mov_b32 v51, v49
    v_lshlrev_b32 v24, 16, v4
    v_and_b32 v25, 0xffff0000, v4
    v_permlane32_swap_b32 v48, v50
    v_permlane32_swap_b32 v49, v51
    v_lshlrev_b32 v26, 16, v5
    v_pk_add_f32 v[48:49], v[48:49], v[50:51]
    ds_write_b64 v149, v[48:49]
    v_and_b32 v27, 0xffff0000, v5
    v_lshlrev_b32 v28, 16, v6
    v_and_b32 v29, 0xffff0000, v6
    v_lshlrev_b32 v30, 16, v7
    v_and_b32 v31, 0xffff0000, v7
    v_lshlrev_b32 v32, 16, v8
    v_and_b32 v33, 0xffff0000, v8
    v_lshlrev_b32 v34, 16, v9
    v_and_b32 v35, 0xffff0000, v9
    s_waitcnt lgkmcnt(0)
    s_barrier
    ds_read_b64 v[52:53], v154 offset:0
    ds_read_b64 v[54:55], v154 offset:4096
    ds_read_b64 v[56:57], v154 offset:8192
    ds_read_b64 v[58:59], v154 offset:12288
    v_lshlrev_b32 v36, 16, v10
    v_and_b32 v37, 0xffff0000, v10
    v_lshlrev_b32 v38, 16, v11
    v_and_b32 v39, 0xffff0000, v11
    v_lshlrev_b32 v40, 16, v12
    v_and_b32 v41, 0xffff0000, v12
    v_lshlrev_b32 v42, 16, v13
    v_and_b32 v43, 0xffff0000, v13
    v_lshlrev_b32 v44, 16, v14
    v_and_b32 v45, 0xffff0000, v14
    v_lshlrev_b32 v46, 16, v15
    v_and_b32 v47, 0xffff0000, v15
    s_waitcnt lgkmcnt(0)
    v_pk_add_f32 v[52:53], v[52:53], v[54:55]
    v_pk_add_f32 v[56:57], v[56:57], v[58:59]
    v_pk_add_f32 v[52:53], v[52:53], v[56:57]
    v_mul_f32 v52, 0x3a800000, v52
    v_mul_f32 v53, 0x3a800000, v53
    v_fma_f32 v53, -v52, v52, v53
    v_max_f32 v53, 0, v53
    v_add_f32 v53, 0x3727c5ac, v53
    v_rsq_f32 v54, v53
    s_mov_b32 exec_lo, s49
    s_mov_b32 exec_hi, 0
    buffer_store_dword v52, v155, s[16:19], s48 offen sc1
    s_mov_b64 exec, -1
    v_mul_f32 v56, -v52, v54
    v_pk_fma_f32 v[16:17], v[16:17], v[54:55], v[56:57] op_sel_hi:[1,0,0]
    v_cvt_pk_bf16_f32 v0, v16, v17
    v_pk_fma_f32 v[18:19], v[18:19], v[54:55], v[56:57] op_sel_hi:[1,0,0]
    v_cvt_pk_bf16_f32 v1, v18, v19
    v_pk_fma_f32 v[20:21], v[20:21], v[54:55], v[56:57] op_sel_hi:[1,0,0]
    v_cvt_pk_bf16_f32 v2, v20, v21
    v_pk_fma_f32 v[22:23], v[22:23], v[54:55], v[56:57] op_sel_hi:[1,0,0]
    v_cvt_pk_bf16_f32 v3, v22, v23
    buffer_store_dwordx4 v[0:3], v148, s[16:19], s46 offen offset:0 sc1
    v_pk_fma_f32 v[24:25], v[24:25], v[54:55], v[56:57] op_sel_hi:[1,0,0]
    v_cvt_pk_bf16_f32 v4, v24, v25
    v_pk_fma_f32 v[26:27], v[26:27], v[54:55], v[56:57] op_sel_hi:[1,0,0]
    v_cvt_pk_bf16_f32 v5, v26, v27
    v_pk_fma_f32 v[28:29], v[28:29], v[54:55], v[56:57] op_sel_hi:[1,0,0]
    v_cvt_pk_bf16_f32 v6, v28, v29
    v_pk_fma_f32 v[30:31], v[30:31], v[54:55], v[56:57] op_sel_hi:[1,0,0]
    v_cvt_pk_bf16_f32 v7, v30, v31
    buffer_store_dwordx4 v[4:7], v148, s[16:19], s46 offen offset:2048 sc1
    v_pk_fma_f32 v[32:33], v[32:33], v[54:55], v[56:57] op_sel_hi:[1,0,0]
    v_cvt_pk_bf16_f32 v8, v32, v33
    v_pk_fma_f32 v[34:35], v[34:35], v[54:55], v[56:57] op_sel_hi:[1,0,0]
    v_cvt_pk_bf16_f32 v9, v34, v35
    v_pk_fma_f32 v[36:37], v[36:37], v[54:55], v[56:57] op_sel_hi:[1,0,0]
    v_cvt_pk_bf16_f32 v10, v36, v37
    v_pk_fma_f32 v[38:39], v[38:39], v[54:55], v[56:57] op_sel_hi:[1,0,0]
    v_cvt_pk_bf16_f32 v11, v38, v39
    buffer_store_dwordx4 v[8:11], v148, s[16:19], s47 offen offset:0 sc1
    v_pk_fma_f32 v[40:41], v[40:41], v[54:55], v[56:57] op_sel_hi:[1,0,0]
    v_cvt_pk_bf16_f32 v12, v40, v41
    v_pk_fma_f32 v[42:43], v[42:43], v[54:55], v[56:57] op_sel_hi:[1,0,0]
    v_cvt_pk_bf16_f32 v13, v42, v43
    v_pk_fma_f32 v[44:45], v[44:45], v[54:55], v[56:57] op_sel_hi:[1,0,0]
    v_cvt_pk_bf16_f32 v14, v44, v45
    v_pk_fma_f32 v[46:47], v[46:47], v[54:55], v[56:57] op_sel_hi:[1,0,0]
    v_cvt_pk_bf16_f32 v15, v46, v47
    buffer_store_dwordx4 v[12:15], v148, s[16:19], s47 offen offset:2048 sc1
    s_add_u32 m0, s22, 0
    s_add_u32 s8, s66, 2048
    s_addc_u32 s9, s67, 0
    buffer_load_dwordx4 v226, s[8:11], 0 offen offset:0 lds
    buffer_load_dwordx4 v227, s[8:11], 0 offen offset:1024 lds
    buffer_load_dwordx4 v226, s[8:11], 0 offen offset:2048 lds
    buffer_load_dwordx4 v227, s[8:11], 0 offen offset:3072 lds
    s_add_u32 m0, s22, 16384
    s_add_u32 s8, s66, 395264
    s_addc_u32 s9, s67, 0
    buffer_load_dwordx4 v226, s[8:11], 0 offen offset:0 lds
    buffer_load_dwordx4 v227, s[8:11], 0 offen offset:1024 lds
    buffer_load_dwordx4 v226, s[8:11], 0 offen offset:2048 lds
    buffer_load_dwordx4 v227, s[8:11], 0 offen offset:3072 lds
    s_add_u32 m0, s22, 32768
    s_add_u32 s8, s66, 788480
    s_addc_u32 s9, s67, 0
    buffer_load_dwordx4 v226, s[8:11], 0 offen offset:0 lds
    buffer_load_dwordx4 v227, s[8:11], 0 offen offset:1024 lds
    buffer_load_dwordx4 v226, s[8:11], 0 offen offset:2048 lds
    buffer_load_dwordx4 v227, s[8:11], 0 offen offset:3072 lds
    s_lshl_b32 s50, s27, 4
    s_lshl_b32 s58, s50, 8
    s_lshl_b32 s59, s28, 2
    s_add_u32 s59, s58, s59
    s_add_u32 s59, s59, 33554432
    v_lshlrev_b32 v242, 8, v255
    v_mov_b32 v243, s33
    s_waitcnt vmcnt(12)
    s_barrier
    s_cmp_lg_u32 s3, 0
    s_cbranch_scc1 L_nosend0
    s_mov_b64 exec, 0xffff
    buffer_store_dword v243, v242, s[16:19], s59 offen sc1
    s_mov_b64 exec, -1
L_nosend0:
    s_lshl_b32 s56, s28, 6
    s_lshl_b32 s57, s27, 2
    s_add_u32 s56, s56, s57
    s_add_u32 s56, s56, s3
    s_lshl_b32 s56, s56, 11
    buffer_load_dwordx4 v[160:163], v254, s[84:87], s56 offen
    buffer_load_dwordx4 v[164:167], v254, s[84:87], s56 offen offset:1024
    s_mul_i32 s56, s44, 6144
    s_mov_b64 exec, 0xffff
    buffer_load_dword v150, v241, s[4:7], s56 offen
    s_mov_b64 exec, -1
    s_lshr_b32 s57, s2, 3
    s_lshl_b32 s57, s57, 2
    s_add_u32 s57, s57, s3
    s_mul_i32 s57, s57, 49152
    s_and_b32 s56, s28, 8
    s_lshl_b32 s56, s56, 7
    s_add_u32 s56, s56, s57
    s_add_u32 s56, s56, 384
    s_bitcmp1_b32 s28, 2
    s_cselect_b32 s56, 0x7ff00000, s56
    v_mul_u32_u24 v151, 6144, v255
    s_mov_b64 exec, 0xff
    buffer_load_dword v150, v151, s[4:7], s56 offen offset:0
    s_mov_b64 exec, -1
    s_add_u32 m0, s22, 49152
    s_add_u32 s8, s66, 1181696
    s_addc_u32 s9, s67, 0
    buffer_load_dwordx4 v226, s[8:11], 0 offen offset:0 lds
    buffer_load_dwordx4 v227, s[8:11], 0 offen offset:1024 lds
    buffer_load_dwordx4 v226, s[8:11], 0 offen offset:2048 lds
    buffer_load_dwordx4 v227, s[8:11], 0 offen offset:3072 lds
    s_add_u32 m0, s22, 65536
    s_add_u32 s8, s66, 1574912
    s_addc_u32 s9, s67, 0
    buffer_load_dwordx4 v226, s[8:11], 0 offen offset:0 lds
    buffer_load_dwordx4 v227, s[8:11], 0 offen offset:1024 lds
    buffer_load_dwordx4 v226, s[8:11], 0 offen offset:2048 lds
    buffer_load_dwordx4 v227, s[8:11], 0 offen offset:3072 lds
    s_mov_b32 s4, s82
    s_mov_b32 s5, s83
    s_mov_b32 s6, 134217728
    s_mov_b32 s7, 0x20000
    s_lshl_b32 s58, s40, 8
    s_add_u32 s58, s58, 33554432
    v_and_b32 v242, 15, v255
    v_lshlrev_b32 v242, 2, v242
    s_mov_b32 s59, 0x20000
L_poll0:
    buffer_load_dword v243, v242, s[16:19], s58 offen sc1
    s_sub_u32 s59, s59, 1
    s_cbranch_scc1 L_polldone0
    s_waitcnt vmcnt(0)
    v_cmp_ne_u32 vcc, s33, v243
    s_cmp_lg_u64 vcc, 0
    s_cbranch_scc1 L_poll0
L_polldone0:
    buffer_load_dwordx4 a[0:3], v224, s[4:7], 0 offen offset:0 sc1
    buffer_load_dwordx4 a[4:7], v224, s[4:7], 0 offen offset:1024 sc1
    buffer_load_dwordx4 a[8:11], v225, s[4:7], 0 offen offset:0 sc1
    buffer_load_dwordx4 a[12:15], v225, s[4:7], 0 offen offset:1024 sc1
    buffer_load_dwordx4 a[16:19], v224, s[4:7], 0 offen offset:2048 sc1
    buffer_load_dwordx4 a[20:23], v224, s[4:7], 0 offen offset:3072 sc1
    buffer_load_dwordx4 a[24:27], v225, s[4:7], 0 offen offset:2048 sc1
    buffer_load_dwordx4 a[28:31], v225, s[4:7], 0 offen offset:3072 sc1
    s_add_u32 s4, s82, 4096
    s_addc_u32 s5, s83, 0
    buffer_load_dwordx4 a[32:35], v224, s[4:7], 0 offen offset:0 sc1
    buffer_load_dwordx4 a[36:39], v224, s[4:7], 0 offen offset:1024 sc1
    buffer_load_dwordx4 a[40:43], v225, s[4:7], 0 offen offset:0 sc1
    buffer_load_dwordx4 a[44:47], v225, s[4:7], 0 offen offset:1024 sc1
    s_waitcnt vmcnt(32)
    s_barrier
    ds_read_b64_tr_b16 v[96:97], v208 offset:0
    ds_read_b64_tr_b16 v[98:99], v208 offset:4096
    ds_read_b64_tr_b16 v[100:101], v208 offset:8192
    ds_read_b64_tr_b16 v[102:103], v208 offset:12288
    ds_read_b64_tr_b16 v[104:105], v209 offset:0
    ds_read_b64_tr_b16 v[106:107], v209 offset:4096
    ds_read_b64_tr_b16 v[108:109], v209 offset:8192
    ds_read_b64_tr_b16 v[110:111], v209 offset:12288
    ds_read_b64_tr_b16 v[112:113], v210 offset:0
    ds_read_b64_tr_b16 v[114:115], v210 offset:4096
    ds_read_b64_tr_b16 v[116:117], v210 offset:8192
    ds_read_b64_tr_b16 v[118:119], v210 offset:12288
    ds_read_b64_tr_b16 v[120:121], v211 offset:0
    ds_read_b64_tr_b16 v[122:123], v211 offset:4096
    ds_read_b64_tr_b16 v[124:125], v211 offset:8192
    ds_read_b64_tr_b16 v[126:127], v211 offset:12288
    s_waitcnt vmcnt(22)
    v_lshlrev_b32 v168, 16, v160
    v_and_b32 v169, 0xffff0000, v160
    v_lshlrev_b32 v170, 16, v161
    v_and_b32 v171, 0xffff0000, v161
    v_lshlrev_b32 v172, 16, v162
    v_and_b32 v173, 0xffff0000, v162
    v_lshlrev_b32 v174, 16, v163
    v_and_b32 v175, 0xffff0000, v163
    v_lshlrev_b32 v176, 16, v164
    v_and_b32 v177, 0xffff0000, v164
    v_lshlrev_b32 v178, 16, v165
    v_and_b32 v179, 0xffff0000, v165
    v_lshlrev_b32 v180, 16, v166
    v_and_b32 v181, 0xffff0000, v166
    v_lshlrev_b32 v182, 16, v167
    v_and_b32 v183, 0xffff0000, v167
    v_pk_add_f32 v[168:169], v[168:169], v[170:171]
    v_pk_add_f32 v[168:169], v[168:169], v[172:173]
    v_pk_add_f32 v[168:169], v[168:169], v[174:175]
    v_pk_add_f32 v[168:169], v[168:169], v[176:177]
    v_pk_add_f32 v[168:169], v[168:169], v[178:179]
    v_pk_add_f32 v[168:169], v[168:169], v[180:181]
    v_pk_add_f32 v[168:169], v[168:169], v[182:183]
    v_add_f32 v168, v168, v169
    s_nop 1
    v_add_f32_dpp v168, v168, v168 row_ror:8 row_mask:0xf bank_mask:0xf
    s_nop 1
    v_add_f32_dpp v168, v168, v168 row_ror:4 row_mask:0xf bank_mask:0xf
    s_nop 1
    v_add_f32_dpp v168, v168, v168 row_ror:2 row_mask:0xf bank_mask:0xf
    s_nop 1
    v_add_f32_dpp v168, v168, v168 row_ror:1 row_mask:0xf bank_mask:0xf
    v_mov_b32 v169, v168
    s_nop 1
    v_permlane16_swap_b32 v168, v169
    s_nop 0
    v_add_f32 v168, v168, v169
    v_mov_b32 v169, v168
    s_nop 1
    v_permlane32_swap_b32 v168, v169
    s_nop 0
    v_add_f32 v168, v168, v169
    v_mul_f32 v223, 0x3a800000, v168
    v_lshrrev_b32 v237, 3, v255
    v_and_b32 v238, 7, v255
    v_lshlrev_b32 v238, 4, v238
    v_lshl_add_u32 v237, v237, 10, v238
    s_mul_i32 s46, s44, 7168
    s_add_u32 s47, s46, 41943040
    s_lshl_b32 s58, s28, 8
    s_lshl_b32 s59, s27, 2
    s_add_u32 s59, s58, s59
    s_add_u32 s59, s59, 33619968
    v_lshlrev_b32 v242, 12, v255
    v_mov_b32 v243, s33
    v_lshrrev_b32 v144, 3, v255
    v_lshrrev_b32 v145, 4, v255
    v_and_b32 v146, 7, v255
    v_xor_b32 v145, v145, v146
    v_xor_b32 v146, 4, v145
    v_lshlrev_b32 v144, 11, v144
    s_lshl_b32 s50, s43, 15
    s_lshl_b32 s51, s30, 7
    s_add_u32 s50, s50, s51
    v_add_u32 v144, s50, v144
    v_lshl_add_u32 v238, v145, 4, v144
    v_lshl_add_u32 v239, v146, 4, v144
    s_add_u32 s48, s22, 147456
    s_lshr_b32 s57, s2, 3
    s_lshl_b32 s57, s57, 2
    s_add_u32 s57, s57, s3
    s_mul_i32 s25, s57, 16384
    s_add_u32 s25, s25, 384
    s_bitcmp1_b32 s30, 0
    s_cselect_b32 s25, s25, 0x7ff00000
    v_lshlrev_b32 v236, 10, v255
    s_mul_i32 s26, s45, 4480
    s_mov_b32 s52, s76
    s_mov_b32 s53, s77
    s_mov_b32 s54, 7340032
    s_mov_b32 s55, 0x20000
    s_xor_b32 s24, s41, 1
    s_lshl_b32 s24, s24, 14
    s_add_u32 s24, s24, s22
    s_add_u32 s24, s24, 37748736
    v_mov_b32 v156, -1
    v_mov_b32 v157, -1
    v_mov_b32 v158, -1
    v_mov_b32 v159, -1
    s_waitcnt vmcnt(8) lgkmcnt(12)
    v_mfma_f32_16x16x32_bf16 v[0:3], a[0:3], v[96:99], 0
    ds_read_b64_tr_b16 v[128:129], v208 offset:2048
    buffer_load_dwordx4 a[48:51], v224, s[4:7], 0 offen offset:2048 sc1
    v_mfma_f32_16x16x32_bf16 v[0:3], a[4:7], v[100:103], v[0:3]
    ds_read_b64_tr_b16 v[130:131], v208 offset:6144
    s_add_u32 m0, s22, 81920
    v_mfma_f32_16x16x32_bf16 v[48:51], a[12:15], v[100:103], 0
    ds_read_b64_tr_b16 v[132:133], v208 offset:10240
    s_add_u32 s8, s66, 1968128
    v_mfma_f32_16x16x32_bf16 v[48:51], a[8:11], v[96:99], v[48:51]
    ds_read_b64_tr_b16 v[134:135], v208 offset:14336
    s_waitcnt lgkmcnt(12)
    v_mfma_f32_16x16x32_bf16 v[4:7], a[0:3], v[104:107], 0
    ds_read_b64_tr_b16 v[136:137], v209 offset:2048
    s_addc_u32 s9, s67, 0
    v_mfma_f32_16x16x32_bf16 v[4:7], a[4:7], v[108:111], v[4:7]
    ds_read_b64_tr_b16 v[138:139], v209 offset:6144
    buffer_load_dwordx4 v226, s[8:11], 0 offen offset:0 lds
    v_mfma_f32_16x16x32_bf16 v[52:55], a[12:15], v[108:111], 0
    ds_read_b64_tr_b16 v[140:141], v209 offset:10240
    buffer_load_dwordx4 a[52:55], v224, s[4:7], 0 offen offset:3072 sc1
    v_mfma_f32_16x16x32_bf16 v[52:55], a[8:11], v[104:107], v[52:55]
    ds_read_b64_tr_b16 v[142:143], v209 offset:14336
    s_waitcnt lgkmcnt(12)
    v_mfma_f32_16x16x32_bf16 v[8:11], a[0:3], v[112:115], 0
    ds_read_b64_tr_b16 v[96:97], v210 offset:2048
    v_mfma_f32_16x16x32_bf16 v[8:11], a[4:7], v[116:119], v[8:11]
    ds_read_b64_tr_b16 v[98:99], v210 offset:6144
    v_mfma_f32_16x16x32_bf16 v[56:59], a[12:15], v[116:119], 0
    ds_read_b64_tr_b16 v[100:101], v210 offset:10240
    buffer_load_dwordx4 v227, s[8:11], 0 offen offset:1024 lds
    v_mfma_f32_16x16x32_bf16 v[56:59], a[8:11], v[112:115], v[56:59]
    ds_read_b64_tr_b16 v[102:103], v210 offset:14336
    s_waitcnt lgkmcnt(12)
    v_mfma_f32_16x16x32_bf16 v[12:15], a[0:3], v[120:123], 0
    ds_read_b64_tr_b16 v[104:105], v211 offset:2048
    v_mfma_f32_16x16x32_bf16 v[12:15], a[4:7], v[124:127], v[12:15]
    ds_read_b64_tr_b16 v[106:107], v211 offset:6144
    v_mfma_f32_16x16x32_bf16 v[60:63], a[12:15], v[124:127], 0
    ds_read_b64_tr_b16 v[108:109], v211 offset:10240
    buffer_load_dwordx4 a[56:59], v225, s[4:7], 0 offen offset:2048 sc1
    v_mfma_f32_16x16x32_bf16 v[60:63], a[8:11], v[120:123], v[60:63]
    ds_read_b64_tr_b16 v[110:111], v211 offset:14336
    s_waitcnt lgkmcnt(12)
    v_mfma_f32_16x16x32_bf16 v[16:19], a[0:3], v[128:131], 0
    s_waitcnt vmcnt(33)
    s_barrier
    ds_read_b64_tr_b16 v[112:113], v208 offset:16384
    v_mfma_f32_16x16x32_bf16 v[16:19], a[4:7], v[132:135], v[16:19]
    ds_read_b64_tr_b16 v[114:115], v208 offset:20480
    v_mfma_f32_16x16x32_bf16 v[64:67], a[12:15], v[132:135], 0
    ds_read_b64_tr_b16 v[116:117], v208 offset:24576
    v_mfma_f32_16x16x32_bf16 v[64:67], a[8:11], v[128:131], v[64:67]
    ds_read_b64_tr_b16 v[118:119], v208 offset:28672
    s_waitcnt lgkmcnt(12)
    v_mfma_f32_16x16x32_bf16 v[20:23], a[0:3], v[136:139], 0
    ds_read_b64_tr_b16 v[120:121], v209 offset:16384
    buffer_load_dwordx4 v226, s[8:11], 0 offen offset:2048 lds
    v_mfma_f32_16x16x32_bf16 v[20:23], a[4:7], v[140:143], v[20:23]
    ds_read_b64_tr_b16 v[122:123], v209 offset:20480
    v_mfma_f32_16x16x32_bf16 v[68:71], a[12:15], v[140:143], 0
    ds_read_b64_tr_b16 v[124:125], v209 offset:24576
    v_mfma_f32_16x16x32_bf16 v[68:71], a[8:11], v[136:139], v[68:71]
    ds_read_b64_tr_b16 v[126:127], v209 offset:28672
    s_waitcnt lgkmcnt(12)
    v_mfma_f32_16x16x32_bf16 v[24:27], a[0:3], v[96:99], 0
    ds_read_b64_tr_b16 v[128:129], v210 offset:16384
    buffer_load_dwordx4 a[60:63], v225, s[4:7], 0 offen offset:3072 sc1
    v_mfma_f32_16x16x32_bf16 v[24:27], a[4:7], v[100:103], v[24:27]
    ds_read_b64_tr_b16 v[130:131], v210 offset:20480
    v_mfma_f32_16x16x32_bf16 v[72:75], a[12:15], v[100:103], 0
    ds_read_b64_tr_b16 v[132:133], v210 offset:24576
    v_mfma_f32_16x16x32_bf16 v[72:75], a[8:11], v[96:99], v[72:75]
    ds_read_b64_tr_b16 v[134:135], v210 offset:28672
    s_waitcnt lgkmcnt(12)
    v_mfma_f32_16x16x32_bf16 v[28:31], a[0:3], v[104:107], 0
    ds_read_b64_tr_b16 v[136:137], v211 offset:16384
    buffer_load_dwordx4 v227, s[8:11], 0 offen offset:3072 lds
    v_mfma_f32_16x16x32_bf16 v[28:31], a[4:7], v[108:111], v[28:31]
    ds_read_b64_tr_b16 v[138:139], v211 offset:20480
    v_mfma_f32_16x16x32_bf16 v[76:79], a[12:15], v[108:111], 0
    ds_read_b64_tr_b16 v[140:141], v211 offset:24576
    v_mfma_f32_16x16x32_bf16 v[76:79], a[8:11], v[104:107], v[76:79]
    ds_read_b64_tr_b16 v[142:143], v211 offset:28672
    s_waitcnt vmcnt(12) lgkmcnt(12)
    v_mfma_f32_16x16x32_bf16 v[0:3], a[16:19], v[112:115], v[0:3]
    ds_read_b64_tr_b16 v[96:97], v208 offset:18432
    s_add_u32 s4, s82, 8192
    v_mfma_f32_16x16x32_bf16 v[0:3], a[20:23], v[116:119], v[0:3]
    ds_read_b64_tr_b16 v[98:99], v208 offset:22528
    s_addc_u32 s5, s83, 0
    v_mfma_f32_16x16x32_bf16 v[48:51], a[28:31], v[116:119], v[48:51]
    ds_read_b64_tr_b16 v[100:101], v208 offset:26624
    buffer_load_dwordx4 a[64:67], v224, s[4:7], 0 offen offset:0 sc1
    v_mfma_f32_16x16x32_bf16 v[48:51], a[24:27], v[112:115], v[48:51]
    ds_read_b64_tr_b16 v[102:103], v208 offset:30720
    s_waitcnt lgkmcnt(12)
    v_mfma_f32_16x16x32_bf16 v[4:7], a[16:19], v[120:123], v[4:7]
    ds_read_b64_tr_b16 v[104:105], v209 offset:18432
    s_add_u32 m0, s22, 98304
    v_mfma_f32_16x16x32_bf16 v[4:7], a[20:23], v[124:127], v[4:7]
    ds_read_b64_tr_b16 v[106:107], v209 offset:22528
    s_add_u32 s8, s66, 2361344
    v_mfma_f32_16x16x32_bf16 v[52:55], a[28:31], v[124:127], v[52:55]
    ds_read_b64_tr_b16 v[108:109], v209 offset:26624
    s_addc_u32 s9, s67, 0
    v_mfma_f32_16x16x32_bf16 v[52:55], a[24:27], v[120:123], v[52:55]
    ds_read_b64_tr_b16 v[110:111], v209 offset:30720
    s_waitcnt lgkmcnt(12)
    v_mfma_f32_16x16x32_bf16 v[8:11], a[16:19], v[128:131], v[8:11]
    ds_read_b64_tr_b16 v[112:113], v210 offset:18432
    buffer_load_dwordx4 v226, s[8:11], 0 offen offset:0 lds
    v_mfma_f32_16x16x32_bf16 v[8:11], a[20:23], v[132:135], v[8:11]
    ds_read_b64_tr_b16 v[114:115], v210 offset:22528
    buffer_load_dwordx4 a[68:71], v224, s[4:7], 0 offen offset:1024 sc1
    v_mfma_f32_16x16x32_bf16 v[56:59], a[28:31], v[132:135], v[56:59]
    ds_read_b64_tr_b16 v[116:117], v210 offset:26624
    v_mfma_f32_16x16x32_bf16 v[56:59], a[24:27], v[128:131], v[56:59]
    ds_read_b64_tr_b16 v[118:119], v210 offset:30720
    s_waitcnt lgkmcnt(12)
    v_mfma_f32_16x16x32_bf16 v[12:15], a[16:19], v[136:139], v[12:15]
    ds_read_b64_tr_b16 v[120:121], v211 offset:18432
    buffer_load_dwordx4 v227, s[8:11], 0 offen offset:1024 lds
    v_mfma_f32_16x16x32_bf16 v[12:15], a[20:23], v[140:143], v[12:15]
    ds_read_b64_tr_b16 v[122:123], v211 offset:22528
    v_mfma_f32_16x16x32_bf16 v[60:63], a[28:31], v[140:143], v[60:63]
    ds_read_b64_tr_b16 v[124:125], v211 offset:26624
    v_mfma_f32_16x16x32_bf16 v[60:63], a[24:27], v[136:139], v[60:63]
    ds_read_b64_tr_b16 v[126:127], v211 offset:30720
    s_waitcnt lgkmcnt(12)
    v_mfma_f32_16x16x32_bf16 v[16:19], a[16:19], v[96:99], v[16:19]
    s_waitcnt vmcnt(36)
    s_barrier
    ds_read_b64_tr_b16 v[128:129], v208 offset:32768
    v_mfma_f32_16x16x32_bf16 v[16:19], a[20:23], v[100:103], v[16:19]
    ds_read_b64_tr_b16 v[130:131], v208 offset:36864
    buffer_load_dwordx4 a[72:75], v225, s[4:7], 0 offen offset:0 sc1
    v_mfma_f32_16x16x32_bf16 v[64:67], a[28:31], v[100:103], v[64:67]
    ds_read_b64_tr_b16 v[132:133], v208 offset:40960
    v_mfma_f32_16x16x32_bf16 v[64:67], a[24:27], v[96:99], v[64:67]
    ds_read_b64_tr_b16 v[134:135], v208 offset:45056
    s_waitcnt lgkmcnt(12)
    v_mfma_f32_16x16x32_bf16 v[20:23], a[16:19], v[104:107], v[20:23]
    ds_read_b64_tr_b16 v[136:137], v209 offset:32768
    v_mfma_f32_16x16x32_bf16 v[20:23], a[20:23], v[108:111], v[20:23]
    ds_read_b64_tr_b16 v[138:139], v209 offset:36864
    buffer_load_dwordx4 v226, s[8:11], 0 offen offset:2048 lds
    v_mfma_f32_16x16x32_bf16 v[68:71], a[28:31], v[108:111], v[68:71]
    ds_read_b64_tr_b16 v[140:141], v209 offset:40960
    v_mfma_f32_16x16x32_bf16 v[68:71], a[24:27], v[104:107], v[68:71]
    ds_read_b64_tr_b16 v[142:143], v209 offset:45056
    s_waitcnt lgkmcnt(12)
    v_mfma_f32_16x16x32_bf16 v[24:27], a[16:19], v[112:115], v[24:27]
    ds_read_b64_tr_b16 v[96:97], v210 offset:32768
    v_mfma_f32_16x16x32_bf16 v[24:27], a[20:23], v[116:119], v[24:27]
    ds_read_b64_tr_b16 v[98:99], v210 offset:36864
    buffer_load_dwordx4 a[76:79], v225, s[4:7], 0 offen offset:1024 sc1
    v_mfma_f32_16x16x32_bf16 v[72:75], a[28:31], v[116:119], v[72:75]
    ds_read_b64_tr_b16 v[100:101], v210 offset:40960
    v_mfma_f32_16x16x32_bf16 v[72:75], a[24:27], v[112:115], v[72:75]
    ds_read_b64_tr_b16 v[102:103], v210 offset:45056
    s_waitcnt lgkmcnt(12)
    v_mfma_f32_16x16x32_bf16 v[28:31], a[16:19], v[120:123], v[28:31]
    ds_read_b64_tr_b16 v[104:105], v211 offset:32768
    v_mfma_f32_16x16x32_bf16 v[28:31], a[20:23], v[124:127], v[28:31]
    ds_read_b64_tr_b16 v[106:107], v211 offset:36864
    buffer_load_dwordx4 v227, s[8:11], 0 offen offset:3072 lds
    v_mfma_f32_16x16x32_bf16 v[76:79], a[28:31], v[124:127], v[76:79]
    ds_read_b64_tr_b16 v[108:109], v211 offset:40960
    v_mfma_f32_16x16x32_bf16 v[76:79], a[24:27], v[120:123], v[76:79]
    ds_read_b64_tr_b16 v[110:111], v211 offset:45056
    s_waitcnt vmcnt(16) lgkmcnt(12)
    v_mfma_f32_16x16x32_bf16 v[0:3], a[32:35], v[128:131], v[0:3]
    ds_read_b64_tr_b16 v[112:113], v208 offset:34816
    buffer_store_dwordx4 v[156:159], v240, s[16:19], s24 offen offset:0 sc1
    v_mfma_f32_16x16x32_bf16 v[0:3], a[36:39], v[132:135], v[0:3]
    ds_read_b64_tr_b16 v[114:115], v208 offset:38912
    v_mfma_f32_16x16x32_bf16 v[48:51], a[44:47], v[132:135], v[48:51]
    ds_read_b64_tr_b16 v[116:117], v208 offset:43008
    buffer_load_dwordx4 a[80:83], v224, s[4:7], 0 offen offset:2048 sc1
    v_mfma_f32_16x16x32_bf16 v[48:51], a[40:43], v[128:131], v[48:51]
    ds_read_b64_tr_b16 v[118:119], v208 offset:47104
    s_waitcnt lgkmcnt(12)
    v_mfma_f32_16x16x32_bf16 v[4:7], a[32:35], v[136:139], v[4:7]
    ds_read_b64_tr_b16 v[120:121], v209 offset:34816
    s_add_u32 m0, s22, 114688
    v_mfma_f32_16x16x32_bf16 v[4:7], a[36:39], v[140:143], v[4:7]
    ds_read_b64_tr_b16 v[122:123], v209 offset:38912
    s_add_u32 s8, s66, 2754560
    v_mfma_f32_16x16x32_bf16 v[52:55], a[44:47], v[140:143], v[52:55]
    ds_read_b64_tr_b16 v[124:125], v209 offset:43008
    s_addc_u32 s9, s67, 0
    v_mfma_f32_16x16x32_bf16 v[52:55], a[40:43], v[136:139], v[52:55]
    ds_read_b64_tr_b16 v[126:127], v209 offset:47104
    s_waitcnt lgkmcnt(12)
    v_mfma_f32_16x16x32_bf16 v[8:11], a[32:35], v[96:99], v[8:11]
    ds_read_b64_tr_b16 v[128:129], v210 offset:34816
    buffer_load_dwordx4 v226, s[8:11], 0 offen offset:0 lds
    v_mfma_f32_16x16x32_bf16 v[8:11], a[36:39], v[100:103], v[8:11]
    ds_read_b64_tr_b16 v[130:131], v210 offset:38912
    buffer_load_dwordx4 a[84:87], v224, s[4:7], 0 offen offset:3072 sc1
    v_mfma_f32_16x16x32_bf16 v[56:59], a[44:47], v[100:103], v[56:59]
    ds_read_b64_tr_b16 v[132:133], v210 offset:43008
    v_mfma_f32_16x16x32_bf16 v[56:59], a[40:43], v[96:99], v[56:59]
    ds_read_b64_tr_b16 v[134:135], v210 offset:47104
    s_waitcnt lgkmcnt(12)
    v_mfma_f32_16x16x32_bf16 v[12:15], a[32:35], v[104:107], v[12:15]
    ds_read_b64_tr_b16 v[136:137], v211 offset:34816
    v_mfma_f32_16x16x32_bf16 v[12:15], a[36:39], v[108:111], v[12:15]
    ds_read_b64_tr_b16 v[138:139], v211 offset:38912
    buffer_load_dwordx4 v227, s[8:11], 0 offen offset:1024 lds
    v_mfma_f32_16x16x32_bf16 v[60:63], a[44:47], v[108:111], v[60:63]
    ds_read_b64_tr_b16 v[140:141], v211 offset:43008
    v_mfma_f32_16x16x32_bf16 v[60:63], a[40:43], v[104:107], v[60:63]
    ds_read_b64_tr_b16 v[142:143], v211 offset:47104
    s_waitcnt lgkmcnt(12)
    v_mfma_f32_16x16x32_bf16 v[16:19], a[32:35], v[112:115], v[16:19]
    s_waitcnt vmcnt(37)
    s_barrier
    ds_read_b64_tr_b16 v[96:97], v208 offset:49152
    v_mfma_f32_16x16x32_bf16 v[16:19], a[36:39], v[116:119], v[16:19]
    ds_read_b64_tr_b16 v[98:99], v208 offset:53248
    buffer_load_dwordx4 a[88:91], v225, s[4:7], 0 offen offset:2048 sc1
    v_mfma_f32_16x16x32_bf16 v[64:67], a[44:47], v[116:119], v[64:67]
    ds_read_b64_tr_b16 v[100:101], v208 offset:57344
    v_mfma_f32_16x16x32_bf16 v[64:67], a[40:43], v[112:115], v[64:67]
    ds_read_b64_tr_b16 v[102:103], v208 offset:61440
    s_waitcnt lgkmcnt(12)
    v_mfma_f32_16x16x32_bf16 v[20:23], a[32:35], v[120:123], v[20:23]
    ds_read_b64_tr_b16 v[104:105], v209 offset:49152
    v_mfma_f32_16x16x32_bf16 v[20:23], a[36:39], v[124:127], v[20:23]
    ds_read_b64_tr_b16 v[106:107], v209 offset:53248
    buffer_load_dwordx4 v226, s[8:11], 0 offen offset:2048 lds
    v_mfma_f32_16x16x32_bf16 v[68:71], a[44:47], v[124:127], v[68:71]
    ds_read_b64_tr_b16 v[108:109], v209 offset:57344
    v_mfma_f32_16x16x32_bf16 v[68:71], a[40:43], v[120:123], v[68:71]
    ds_read_b64_tr_b16 v[110:111], v209 offset:61440
    s_waitcnt lgkmcnt(12)
    v_mfma_f32_16x16x32_bf16 v[24:27], a[32:35], v[128:131], v[24:27]
    ds_read_b64_tr_b16 v[112:113], v210 offset:49152
    buffer_load_dwordx4 a[92:95], v225, s[4:7], 0 offen offset:3072 sc1
    v_mfma_f32_16x16x32_bf16 v[24:27], a[36:39], v[132:135], v[24:27]
    ds_read_b64_tr_b16 v[114:115], v210 offset:53248
    v_mfma_f32_16x16x32_bf16 v[72:75], a[44:47], v[132:135], v[72:75]
    ds_read_b64_tr_b16 v[116:117], v210 offset:57344
    v_mfma_f32_16x16x32_bf16 v[72:75], a[40:43], v[128:131], v[72:75]
    ds_read_b64_tr_b16 v[118:119], v210 offset:61440
    s_waitcnt lgkmcnt(12)
    v_mfma_f32_16x16x32_bf16 v[28:31], a[32:35], v[136:139], v[28:31]
    ds_read_b64_tr_b16 v[120:121], v211 offset:49152
    buffer_load_dwordx4 v227, s[8:11], 0 offen offset:3072 lds
    v_mfma_f32_16x16x32_bf16 v[28:31], a[36:39], v[140:143], v[28:31]
    ds_read_b64_tr_b16 v[122:123], v211 offset:53248
    v_mfma_f32_16x16x32_bf16 v[76:79], a[44:47], v[140:143], v[76:79]
    ds_read_b64_tr_b16 v[124:125], v211 offset:57344
    v_mfma_f32_16x16x32_bf16 v[76:79], a[40:43], v[136:139], v[76:79]
    ds_read_b64_tr_b16 v[126:127], v211 offset:61440
    s_waitcnt vmcnt(18) lgkmcnt(12)
    v_mfma_f32_16x16x32_bf16 v[0:3], a[48:51], v[96:99], v[0:3]
    ds_read_b64_tr_b16 v[128:129], v208 offset:51200
    s_add_u32 s4, s82, 12288
    v_mfma_f32_16x16x32_bf16 v[0:3], a[52:55], v[100:103], v[0:3]
    ds_read_b64_tr_b16 v[130:131], v208 offset:55296
    s_addc_u32 s5, s83, 0
    v_mfma_f32_16x16x32_bf16 v[48:51], a[60:63], v[100:103], v[48:51]
    ds_read_b64_tr_b16 v[132:133], v208 offset:59392
    buffer_load_dwordx4 a[96:99], v224, s[4:7], 0 offen offset:0 sc1
    v_mfma_f32_16x16x32_bf16 v[48:51], a[56:59], v[96:99], v[48:51]
    ds_read_b64_tr_b16 v[134:135], v208 offset:63488
    s_waitcnt lgkmcnt(12)
    v_mfma_f32_16x16x32_bf16 v[4:7], a[48:51], v[104:107], v[4:7]
    ds_read_b64_tr_b16 v[136:137], v209 offset:51200
    s_add_u32 m0, s22, 131072
    v_mfma_f32_16x16x32_bf16 v[4:7], a[52:55], v[108:111], v[4:7]
    ds_read_b64_tr_b16 v[138:139], v209 offset:55296
    s_add_u32 s8, s66, 3147776
    v_mfma_f32_16x16x32_bf16 v[52:55], a[60:63], v[108:111], v[52:55]
    ds_read_b64_tr_b16 v[140:141], v209 offset:59392
    s_addc_u32 s9, s67, 0
    v_mfma_f32_16x16x32_bf16 v[52:55], a[56:59], v[104:107], v[52:55]
    ds_read_b64_tr_b16 v[142:143], v209 offset:63488
    s_waitcnt lgkmcnt(12)
    v_mfma_f32_16x16x32_bf16 v[8:11], a[48:51], v[112:115], v[8:11]
    ds_read_b64_tr_b16 v[96:97], v210 offset:51200
    buffer_load_dwordx4 v226, s[8:11], 0 offen offset:0 lds
    v_mfma_f32_16x16x32_bf16 v[8:11], a[52:55], v[116:119], v[8:11]
    ds_read_b64_tr_b16 v[98:99], v210 offset:55296
    buffer_load_dwordx4 a[100:103], v224, s[4:7], 0 offen offset:1024 sc1
    v_mfma_f32_16x16x32_bf16 v[56:59], a[60:63], v[116:119], v[56:59]
    ds_read_b64_tr_b16 v[100:101], v210 offset:59392
    v_mfma_f32_16x16x32_bf16 v[56:59], a[56:59], v[112:115], v[56:59]
    ds_read_b64_tr_b16 v[102:103], v210 offset:63488
    s_waitcnt lgkmcnt(12)
    v_mfma_f32_16x16x32_bf16 v[12:15], a[48:51], v[120:123], v[12:15]
    ds_read_b64_tr_b16 v[104:105], v211 offset:51200
    buffer_load_dwordx4 v227, s[8:11], 0 offen offset:1024 lds
    v_mfma_f32_16x16x32_bf16 v[12:15], a[52:55], v[124:127], v[12:15]
    ds_read_b64_tr_b16 v[106:107], v211 offset:55296
    v_mfma_f32_16x16x32_bf16 v[60:63], a[60:63], v[124:127], v[60:63]
    ds_read_b64_tr_b16 v[108:109], v211 offset:59392
    v_mfma_f32_16x16x32_bf16 v[60:63], a[56:59], v[120:123], v[60:63]
    ds_read_b64_tr_b16 v[110:111], v211 offset:63488
    s_waitcnt lgkmcnt(12)
    v_mfma_f32_16x16x32_bf16 v[16:19], a[48:51], v[128:131], v[16:19]
    s_waitcnt vmcnt(41)
    s_barrier
    ds_read_b64_tr_b16 v[112:113], v212 offset:0
    v_mfma_f32_16x16x32_bf16 v[16:19], a[52:55], v[132:135], v[16:19]
    ds_read_b64_tr_b16 v[114:115], v212 offset:4096
    buffer_load_dwordx4 a[104:107], v225, s[4:7], 0 offen offset:0 sc1
    v_mfma_f32_16x16x32_bf16 v[64:67], a[60:63], v[132:135], v[64:67]
    ds_read_b64_tr_b16 v[116:117], v212 offset:8192
    v_mfma_f32_16x16x32_bf16 v[64:67], a[56:59], v[128:131], v[64:67]
    ds_read_b64_tr_b16 v[118:119], v212 offset:12288
    s_waitcnt lgkmcnt(12)
    v_mfma_f32_16x16x32_bf16 v[20:23], a[48:51], v[136:139], v[20:23]
    ds_read_b64_tr_b16 v[120:121], v213 offset:0
    v_mfma_f32_16x16x32_bf16 v[20:23], a[52:55], v[140:143], v[20:23]
    ds_read_b64_tr_b16 v[122:123], v213 offset:4096
    buffer_load_dwordx4 v226, s[8:11], 0 offen offset:2048 lds
    v_mfma_f32_16x16x32_bf16 v[68:71], a[60:63], v[140:143], v[68:71]
    ds_read_b64_tr_b16 v[124:125], v213 offset:8192
    v_mfma_f32_16x16x32_bf16 v[68:71], a[56:59], v[136:139], v[68:71]
    ds_read_b64_tr_b16 v[126:127], v213 offset:12288
    s_waitcnt lgkmcnt(12)
    v_mfma_f32_16x16x32_bf16 v[24:27], a[48:51], v[96:99], v[24:27]
    ds_read_b64_tr_b16 v[128:129], v214 offset:0
    v_mfma_f32_16x16x32_bf16 v[24:27], a[52:55], v[100:103], v[24:27]
    ds_read_b64_tr_b16 v[130:131], v214 offset:4096
    buffer_load_dwordx4 a[108:111], v225, s[4:7], 0 offen offset:1024 sc1
    v_mfma_f32_16x16x32_bf16 v[72:75], a[60:63], v[100:103], v[72:75]
    ds_read_b64_tr_b16 v[132:133], v214 offset:8192
    v_mfma_f32_16x16x32_bf16 v[72:75], a[56:59], v[96:99], v[72:75]
    ds_read_b64_tr_b16 v[134:135], v214 offset:12288
    s_waitcnt lgkmcnt(12)
    v_mfma_f32_16x16x32_bf16 v[28:31], a[48:51], v[104:107], v[28:31]
    ds_read_b64_tr_b16 v[136:137], v215 offset:0
    v_mfma_f32_16x16x32_bf16 v[28:31], a[52:55], v[108:111], v[28:31]
    ds_read_b64_tr_b16 v[138:139], v215 offset:4096
    buffer_load_dwordx4 v227, s[8:11], 0 offen offset:3072 lds
    v_mfma_f32_16x16x32_bf16 v[76:79], a[60:63], v[108:111], v[76:79]
    ds_read_b64_tr_b16 v[140:141], v215 offset:8192
    v_mfma_f32_16x16x32_bf16 v[76:79], a[56:59], v[104:107], v[76:79]
    ds_read_b64_tr_b16 v[142:143], v215 offset:12288
    s_waitcnt vmcnt(18) lgkmcnt(12)
    v_mfma_f32_16x16x32_bf16 v[0:3], a[64:67], v[112:115], v[0:3]
    ds_read_b64_tr_b16 v[96:97], v212 offset:2048
    buffer_load_dwordx4 a[112:115], v224, s[4:7], 0 offen offset:2048 sc1
    v_mfma_f32_16x16x32_bf16 v[0:3], a[68:71], v[116:119], v[0:3]
    ds_read_b64_tr_b16 v[98:99], v212 offset:6144
    v_mfma_f32_16x16x32_bf16 v[48:51], a[76:79], v[116:119], v[48:51]
    ds_read_b64_tr_b16 v[100:101], v212 offset:10240
    v_mfma_f32_16x16x32_bf16 v[48:51], a[72:75], v[112:115], v[48:51]
    ds_read_b64_tr_b16 v[102:103], v212 offset:14336
    s_waitcnt lgkmcnt(12)
    v_mfma_f32_16x16x32_bf16 v[4:7], a[64:67], v[120:123], v[4:7]
    ds_read_b64_tr_b16 v[104:105], v213 offset:2048
    v_mfma_f32_16x16x32_bf16 v[4:7], a[68:71], v[124:127], v[4:7]
    ds_read_b64_tr_b16 v[106:107], v213 offset:6144
    v_mfma_f32_16x16x32_bf16 v[52:55], a[76:79], v[124:127], v[52:55]
    ds_read_b64_tr_b16 v[108:109], v213 offset:10240
    buffer_load_dwordx4 a[116:119], v224, s[4:7], 0 offen offset:3072 sc1
    v_mfma_f32_16x16x32_bf16 v[52:55], a[72:75], v[120:123], v[52:55]
    ds_read_b64_tr_b16 v[110:111], v213 offset:14336
    s_waitcnt lgkmcnt(12)
    v_mfma_f32_16x16x32_bf16 v[8:11], a[64:67], v[128:131], v[8:11]
    ds_read_b64_tr_b16 v[112:113], v214 offset:2048
    v_mfma_f32_16x16x32_bf16 v[8:11], a[68:71], v[132:135], v[8:11]
    ds_read_b64_tr_b16 v[114:115], v214 offset:6144
    v_mfma_f32_16x16x32_bf16 v[56:59], a[76:79], v[132:135], v[56:59]
    ds_read_b64_tr_b16 v[116:117], v214 offset:10240
    v_mfma_f32_16x16x32_bf16 v[56:59], a[72:75], v[128:131], v[56:59]
    ds_read_b64_tr_b16 v[118:119], v214 offset:14336
    s_waitcnt lgkmcnt(12)
    v_mfma_f32_16x16x32_bf16 v[12:15], a[64:67], v[136:139], v[12:15]
    ds_read_b64_tr_b16 v[120:121], v215 offset:2048
    v_mfma_f32_16x16x32_bf16 v[12:15], a[68:71], v[140:143], v[12:15]
    ds_read_b64_tr_b16 v[122:123], v215 offset:6144
    v_mfma_f32_16x16x32_bf16 v[60:63], a[76:79], v[140:143], v[60:63]
    ds_read_b64_tr_b16 v[124:125], v215 offset:10240
    buffer_load_dwordx4 a[120:123], v225, s[4:7], 0 offen offset:2048 sc1
    v_mfma_f32_16x16x32_bf16 v[60:63], a[72:75], v[136:139], v[60:63]
    ds_read_b64_tr_b16 v[126:127], v215 offset:14336
    s_waitcnt lgkmcnt(12)
    v_mfma_f32_16x16x32_bf16 v[16:19], a[64:67], v[96:99], v[16:19]
    s_waitcnt vmcnt(28)
    s_barrier
    ds_read_b64_tr_b16 v[128:129], v212 offset:16384
    v_mfma_f32_16x16x32_bf16 v[16:19], a[68:71], v[100:103], v[16:19]
    ds_read_b64_tr_b16 v[130:131], v212 offset:20480
    v_mfma_f32_16x16x32_bf16 v[64:67], a[76:79], v[100:103], v[64:67]
    ds_read_b64_tr_b16 v[132:133], v212 offset:24576
    v_mfma_f32_16x16x32_bf16 v[64:67], a[72:75], v[96:99], v[64:67]
    ds_read_b64_tr_b16 v[134:135], v212 offset:28672
    s_waitcnt lgkmcnt(12)
    v_mfma_f32_16x16x32_bf16 v[20:23], a[64:67], v[104:107], v[20:23]
    ds_read_b64_tr_b16 v[136:137], v213 offset:16384
    v_mfma_f32_16x16x32_bf16 v[20:23], a[68:71], v[108:111], v[20:23]
    ds_read_b64_tr_b16 v[138:139], v213 offset:20480
    v_mfma_f32_16x16x32_bf16 v[68:71], a[76:79], v[108:111], v[68:71]
    ds_read_b64_tr_b16 v[140:141], v213 offset:24576
    v_mfma_f32_16x16x32_bf16 v[68:71], a[72:75], v[104:107], v[68:71]
    ds_read_b64_tr_b16 v[142:143], v213 offset:28672
    s_waitcnt lgkmcnt(12)
    v_mfma_f32_16x16x32_bf16 v[24:27], a[64:67], v[112:115], v[24:27]
    ds_read_b64_tr_b16 v[96:97], v214 offset:16384
    buffer_load_dwordx4 a[124:127], v225, s[4:7], 0 offen offset:3072 sc1
    v_mfma_f32_16x16x32_bf16 v[24:27], a[68:71], v[116:119], v[24:27]
    ds_read_b64_tr_b16 v[98:99], v214 offset:20480
    v_mfma_f32_16x16x32_bf16 v[72:75], a[76:79], v[116:119], v[72:75]
    ds_read_b64_tr_b16 v[100:101], v214 offset:24576
    v_mfma_f32_16x16x32_bf16 v[72:75], a[72:75], v[112:115], v[72:75]
    ds_read_b64_tr_b16 v[102:103], v214 offset:28672
    s_waitcnt lgkmcnt(12)
    v_mfma_f32_16x16x32_bf16 v[28:31], a[64:67], v[120:123], v[28:31]
    ds_read_b64_tr_b16 v[104:105], v215 offset:16384
    v_mfma_f32_16x16x32_bf16 v[28:31], a[68:71], v[124:127], v[28:31]
    ds_read_b64_tr_b16 v[106:107], v215 offset:20480
    v_mfma_f32_16x16x32_bf16 v[76:79], a[76:79], v[124:127], v[76:79]
    ds_read_b64_tr_b16 v[108:109], v215 offset:24576
    v_mfma_f32_16x16x32_bf16 v[76:79], a[72:75], v[120:123], v[76:79]
    ds_read_b64_tr_b16 v[110:111], v215 offset:28672
    s_waitcnt vmcnt(13) lgkmcnt(12)
    v_mfma_f32_16x16x32_bf16 v[0:3], a[80:83], v[128:131], v[0:3]
    ds_read_b64_tr_b16 v[112:113], v212 offset:18432
    buffer_store_dwordx4 v[156:159], v240, s[16:19], s24 offen offset:1024 sc1
    v_mfma_f32_16x16x32_bf16 v[0:3], a[84:87], v[132:135], v[0:3]
    ds_read_b64_tr_b16 v[114:115], v212 offset:22528
    s_add_u32 s4, s82, 16384
    v_mfma_f32_16x16x32_bf16 v[48:51], a[92:95], v[132:135], v[48:51]
    ds_read_b64_tr_b16 v[116:117], v212 offset:26624
    s_addc_u32 s5, s83, 0
    v_mfma_f32_16x16x32_bf16 v[48:51], a[88:91], v[128:131], v[48:51]
    ds_read_b64_tr_b16 v[118:119], v212 offset:30720
    s_waitcnt lgkmcnt(12)
    v_mfma_f32_16x16x32_bf16 v[4:7], a[80:83], v[136:139], v[4:7]
    ds_read_b64_tr_b16 v[120:121], v213 offset:18432
    buffer_load_dwordx4 a[128:131], v224, s[4:7], 0 offen offset:0 sc1
    v_mfma_f32_16x16x32_bf16 v[4:7], a[84:87], v[140:143], v[4:7]
    ds_read_b64_tr_b16 v[122:123], v213 offset:22528
    s_add_u32 m0, s22, 0
    v_mfma_f32_16x16x32_bf16 v[52:55], a[92:95], v[140:143], v[52:55]
    ds_read_b64_tr_b16 v[124:125], v213 offset:26624
    s_add_u32 s8, s66, 3540992
    v_mfma_f32_16x16x32_bf16 v[52:55], a[88:91], v[136:139], v[52:55]
    ds_read_b64_tr_b16 v[126:127], v213 offset:30720
    s_waitcnt lgkmcnt(12)
    v_mfma_f32_16x16x32_bf16 v[8:11], a[80:83], v[96:99], v[8:11]
    ds_read_b64_tr_b16 v[128:129], v214 offset:18432
    s_addc_u32 s9, s67, 0
    v_mfma_f32_16x16x32_bf16 v[8:11], a[84:87], v[100:103], v[8:11]
    ds_read_b64_tr_b16 v[130:131], v214 offset:22528
    buffer_load_dwordx4 v226, s[8:11], 0 offen offset:0 lds
    v_mfma_f32_16x16x32_bf16 v[56:59], a[92:95], v[100:103], v[56:59]
    ds_read_b64_tr_b16 v[132:133], v214 offset:26624
    buffer_load_dwordx4 a[132:135], v224, s[4:7], 0 offen offset:1024 sc1
    v_mfma_f32_16x16x32_bf16 v[56:59], a[88:91], v[96:99], v[56:59]
    ds_read_b64_tr_b16 v[134:135], v214 offset:30720
    s_waitcnt lgkmcnt(12)
    v_mfma_f32_16x16x32_bf16 v[12:15], a[80:83], v[104:107], v[12:15]
    ds_read_b64_tr_b16 v[136:137], v215 offset:18432
    v_mfma_f32_16x16x32_bf16 v[12:15], a[84:87], v[108:111], v[12:15]
    ds_read_b64_tr_b16 v[138:139], v215 offset:22528
    buffer_load_dwordx4 v227, s[8:11], 0 offen offset:1024 lds
    v_mfma_f32_16x16x32_bf16 v[60:63], a[92:95], v[108:111], v[60:63]
    ds_read_b64_tr_b16 v[140:141], v215 offset:26624
    v_mfma_f32_16x16x32_bf16 v[60:63], a[88:91], v[104:107], v[60:63]
    ds_read_b64_tr_b16 v[142:143], v215 offset:30720
    s_waitcnt lgkmcnt(12)
    v_mfma_f32_16x16x32_bf16 v[16:19], a[80:83], v[112:115], v[16:19]
    s_waitcnt vmcnt(26)
    s_barrier
    ds_read_b64_tr_b16 v[96:97], v212 offset:32768
    v_mfma_f32_16x16x32_bf16 v[16:19], a[84:87], v[116:119], v[16:19]
    ds_read_b64_tr_b16 v[98:99], v212 offset:36864
    buffer_load_dwordx4 a[136:139], v225, s[4:7], 0 offen offset:0 sc1
    v_mfma_f32_16x16x32_bf16 v[64:67], a[92:95], v[116:119], v[64:67]
    ds_read_b64_tr_b16 v[100:101], v212 offset:40960
    v_mfma_f32_16x16x32_bf16 v[64:67], a[88:91], v[112:115], v[64:67]
    ds_read_b64_tr_b16 v[102:103], v212 offset:45056
    s_waitcnt lgkmcnt(12)
    v_mfma_f32_16x16x32_bf16 v[20:23], a[80:83], v[120:123], v[20:23]
    ds_read_b64_tr_b16 v[104:105], v213 offset:32768
    v_mfma_f32_16x16x32_bf16 v[20:23], a[84:87], v[124:127], v[20:23]
    ds_read_b64_tr_b16 v[106:107], v213 offset:36864
    buffer_load_dwordx4 v226, s[8:11], 0 offen offset:2048 lds
    v_mfma_f32_16x16x32_bf16 v[68:71], a[92:95], v[124:127], v[68:71]
    ds_read_b64_tr_b16 v[108:109], v213 offset:40960
    v_mfma_f32_16x16x32_bf16 v[68:71], a[88:91], v[120:123], v[68:71]
    ds_read_b64_tr_b16 v[110:111], v213 offset:45056
    s_waitcnt lgkmcnt(12)
    v_mfma_f32_16x16x32_bf16 v[24:27], a[80:83], v[128:131], v[24:27]
    ds_read_b64_tr_b16 v[112:113], v214 offset:32768
    buffer_load_dwordx4 a[140:143], v225, s[4:7], 0 offen offset:1024 sc1
    v_mfma_f32_16x16x32_bf16 v[24:27], a[84:87], v[132:135], v[24:27]
    ds_read_b64_tr_b16 v[114:115], v214 offset:36864
    v_mfma_f32_16x16x32_bf16 v[72:75], a[92:95], v[132:135], v[72:75]
    ds_read_b64_tr_b16 v[116:117], v214 offset:40960
    v_mfma_f32_16x16x32_bf16 v[72:75], a[88:91], v[128:131], v[72:75]
    ds_read_b64_tr_b16 v[118:119], v214 offset:45056
    s_waitcnt lgkmcnt(12)
    v_mfma_f32_16x16x32_bf16 v[28:31], a[80:83], v[136:139], v[28:31]
    ds_read_b64_tr_b16 v[120:121], v215 offset:32768
    buffer_load_dwordx4 v227, s[8:11], 0 offen offset:3072 lds
    v_mfma_f32_16x16x32_bf16 v[28:31], a[84:87], v[140:143], v[28:31]
    ds_read_b64_tr_b16 v[122:123], v215 offset:36864
    v_mfma_f32_16x16x32_bf16 v[76:79], a[92:95], v[140:143], v[76:79]
    ds_read_b64_tr_b16 v[124:125], v215 offset:40960
    v_mfma_f32_16x16x32_bf16 v[76:79], a[88:91], v[136:139], v[76:79]
    ds_read_b64_tr_b16 v[126:127], v215 offset:45056
    s_waitcnt vmcnt(14) lgkmcnt(12)
    v_mfma_f32_16x16x32_bf16 v[0:3], a[96:99], v[96:99], v[0:3]
    ds_read_b64_tr_b16 v[128:129], v212 offset:34816
    buffer_load_dwordx4 a[144:147], v224, s[4:7], 0 offen offset:2048 sc1
    v_mfma_f32_16x16x32_bf16 v[0:3], a[100:103], v[100:103], v[0:3]
    ds_read_b64_tr_b16 v[130:131], v212 offset:38912
    s_add_u32 m0, s22, 16384
    v_mfma_f32_16x16x32_bf16 v[48:51], a[108:111], v[100:103], v[48:51]
    ds_read_b64_tr_b16 v[132:133], v212 offset:43008
    s_add_u32 s8, s66, 3934208
    v_mfma_f32_16x16x32_bf16 v[48:51], a[104:107], v[96:99], v[48:51]
    ds_read_b64_tr_b16 v[134:135], v212 offset:47104
    s_waitcnt lgkmcnt(12)
    v_mfma_f32_16x16x32_bf16 v[4:7], a[96:99], v[104:107], v[4:7]
    ds_read_b64_tr_b16 v[136:137], v213 offset:34816
    s_addc_u32 s9, s67, 0
    v_mfma_f32_16x16x32_bf16 v[4:7], a[100:103], v[108:111], v[4:7]
    ds_read_b64_tr_b16 v[138:139], v213 offset:38912
    buffer_load_dwordx4 v226, s[8:11], 0 offen offset:0 lds
    v_mfma_f32_16x16x32_bf16 v[52:55], a[108:111], v[108:111], v[52:55]
    ds_read_b64_tr_b16 v[140:141], v213 offset:43008
    buffer_load_dwordx4 a[148:151], v224, s[4:7], 0 offen offset:3072 sc1
    v_mfma_f32_16x16x32_bf16 v[52:55], a[104:107], v[104:107], v[52:55]
    ds_read_b64_tr_b16 v[142:143], v213 offset:47104
    s_waitcnt lgkmcnt(12)
    v_mfma_f32_16x16x32_bf16 v[8:11], a[96:99], v[112:115], v[8:11]
    ds_read_b64_tr_b16 v[96:97], v214 offset:34816
    v_mfma_f32_16x16x32_bf16 v[8:11], a[100:103], v[116:119], v[8:11]
    ds_read_b64_tr_b16 v[98:99], v214 offset:38912
    v_mfma_f32_16x16x32_bf16 v[56:59], a[108:111], v[116:119], v[56:59]
    ds_read_b64_tr_b16 v[100:101], v214 offset:43008
    buffer_load_dwordx4 v227, s[8:11], 0 offen offset:1024 lds
    v_mfma_f32_16x16x32_bf16 v[56:59], a[104:107], v[112:115], v[56:59]
    ds_read_b64_tr_b16 v[102:103], v214 offset:47104
    s_waitcnt lgkmcnt(12)
    v_mfma_f32_16x16x32_bf16 v[12:15], a[96:99], v[120:123], v[12:15]
    ds_read_b64_tr_b16 v[104:105], v215 offset:34816
    v_mfma_f32_16x16x32_bf16 v[12:15], a[100:103], v[124:127], v[12:15]
    ds_read_b64_tr_b16 v[106:107], v215 offset:38912
    v_mfma_f32_16x16x32_bf16 v[60:63], a[108:111], v[124:127], v[60:63]
    ds_read_b64_tr_b16 v[108:109], v215 offset:43008
    buffer_load_dwordx4 a[152:155], v225, s[4:7], 0 offen offset:2048 sc1
    v_mfma_f32_16x16x32_bf16 v[60:63], a[104:107], v[120:123], v[60:63]
    ds_read_b64_tr_b16 v[110:111], v215 offset:47104
    s_waitcnt lgkmcnt(12)
    v_mfma_f32_16x16x32_bf16 v[16:19], a[96:99], v[128:131], v[16:19]
    s_waitcnt vmcnt(26)
    s_barrier
    ds_read_b64_tr_b16 v[112:113], v212 offset:49152
    v_mfma_f32_16x16x32_bf16 v[16:19], a[100:103], v[132:135], v[16:19]
    ds_read_b64_tr_b16 v[114:115], v212 offset:53248
    v_mfma_f32_16x16x32_bf16 v[64:67], a[108:111], v[132:135], v[64:67]
    ds_read_b64_tr_b16 v[116:117], v212 offset:57344
    v_mfma_f32_16x16x32_bf16 v[64:67], a[104:107], v[128:131], v[64:67]
    ds_read_b64_tr_b16 v[118:119], v212 offset:61440
    s_waitcnt lgkmcnt(12)
    v_mfma_f32_16x16x32_bf16 v[20:23], a[96:99], v[136:139], v[20:23]
    ds_read_b64_tr_b16 v[120:121], v213 offset:49152
    buffer_load_dwordx4 v226, s[8:11], 0 offen offset:2048 lds
    v_mfma_f32_16x16x32_bf16 v[20:23], a[100:103], v[140:143], v[20:23]
    ds_read_b64_tr_b16 v[122:123], v213 offset:53248
    v_mfma_f32_16x16x32_bf16 v[68:71], a[108:111], v[140:143], v[68:71]
    ds_read_b64_tr_b16 v[124:125], v213 offset:57344
    v_mfma_f32_16x16x32_bf16 v[68:71], a[104:107], v[136:139], v[68:71]
    ds_read_b64_tr_b16 v[126:127], v213 offset:61440
    s_waitcnt lgkmcnt(12)
    v_mfma_f32_16x16x32_bf16 v[24:27], a[96:99], v[96:99], v[24:27]
    ds_read_b64_tr_b16 v[128:129], v214 offset:49152
    buffer_load_dwordx4 a[156:159], v225, s[4:7], 0 offen offset:3072 sc1
    v_mfma_f32_16x16x32_bf16 v[24:27], a[100:103], v[100:103], v[24:27]
    ds_read_b64_tr_b16 v[130:131], v214 offset:53248
    v_mfma_f32_16x16x32_bf16 v[72:75], a[108:111], v[100:103], v[72:75]
    ds_read_b64_tr_b16 v[132:133], v214 offset:57344
    v_mfma_f32_16x16x32_bf16 v[72:75], a[104:107], v[96:99], v[72:75]
    ds_read_b64_tr_b16 v[134:135], v214 offset:61440
    s_waitcnt lgkmcnt(12)
    v_mfma_f32_16x16x32_bf16 v[28:31], a[96:99], v[104:107], v[28:31]
    ds_read_b64_tr_b16 v[136:137], v215 offset:49152
    buffer_load_dwordx4 v227, s[8:11], 0 offen offset:3072 lds
    v_mfma_f32_16x16x32_bf16 v[28:31], a[100:103], v[108:111], v[28:31]
    ds_read_b64_tr_b16 v[138:139], v215 offset:53248
    v_mfma_f32_16x16x32_bf16 v[76:79], a[108:111], v[108:111], v[76:79]
    ds_read_b64_tr_b16 v[140:141], v215 offset:57344
    v_mfma_f32_16x16x32_bf16 v[76:79], a[104:107], v[104:107], v[76:79]
    ds_read_b64_tr_b16 v[142:143], v215 offset:61440
    s_waitcnt vmcnt(17) lgkmcnt(12)
    v_mfma_f32_16x16x32_bf16 v[0:3], a[112:115], v[112:115], v[0:3]
    ds_read_b64_tr_b16 v[96:97], v212 offset:51200
    s_add_u32 s4, s82, 20480
    v_mfma_f32_16x16x32_bf16 v[0:3], a[116:119], v[116:119], v[0:3]
    ds_read_b64_tr_b16 v[98:99], v212 offset:55296
    s_addc_u32 s5, s83, 0
    v_mfma_f32_16x16x32_bf16 v[48:51], a[124:127], v[116:119], v[48:51]
    ds_read_b64_tr_b16 v[100:101], v212 offset:59392
    buffer_load_dwordx4 a[160:163], v224, s[4:7], 0 offen offset:0 sc1
    v_mfma_f32_16x16x32_bf16 v[48:51], a[120:123], v[112:115], v[48:51]
    ds_read_b64_tr_b16 v[102:103], v212 offset:63488
    s_waitcnt lgkmcnt(12)
    v_mfma_f32_16x16x32_bf16 v[4:7], a[112:115], v[120:123], v[4:7]
    ds_read_b64_tr_b16 v[104:105], v213 offset:51200
    s_add_u32 m0, s22, 32768
    v_mfma_f32_16x16x32_bf16 v[4:7], a[116:119], v[124:127], v[4:7]
    ds_read_b64_tr_b16 v[106:107], v213 offset:55296
    s_add_u32 s8, s66, 4327424
    v_mfma_f32_16x16x32_bf16 v[52:55], a[124:127], v[124:127], v[52:55]
    ds_read_b64_tr_b16 v[108:109], v213 offset:59392
    s_addc_u32 s9, s67, 0
    v_mfma_f32_16x16x32_bf16 v[52:55], a[120:123], v[120:123], v[52:55]
    ds_read_b64_tr_b16 v[110:111], v213 offset:63488
    s_waitcnt lgkmcnt(12)
    v_mfma_f32_16x16x32_bf16 v[8:11], a[112:115], v[128:131], v[8:11]
    ds_read_b64_tr_b16 v[112:113], v214 offset:51200
    buffer_load_dwordx4 v226, s[8:11], 0 offen offset:0 lds
    v_mfma_f32_16x16x32_bf16 v[8:11], a[116:119], v[132:135], v[8:11]
    ds_read_b64_tr_b16 v[114:115], v214 offset:55296
    buffer_load_dwordx4 a[164:167], v224, s[4:7], 0 offen offset:1024 sc1
    v_mfma_f32_16x16x32_bf16 v[56:59], a[124:127], v[132:135], v[56:59]
    ds_read_b64_tr_b16 v[116:117], v214 offset:59392
    v_mfma_f32_16x16x32_bf16 v[56:59], a[120:123], v[128:131], v[56:59]
    ds_read_b64_tr_b16 v[118:119], v214 offset:63488
    s_waitcnt lgkmcnt(12)
    v_mfma_f32_16x16x32_bf16 v[12:15], a[112:115], v[136:139], v[12:15]
    ds_read_b64_tr_b16 v[120:121], v215 offset:51200
    buffer_load_dwordx4 v227, s[8:11], 0 offen offset:1024 lds
    v_mfma_f32_16x16x32_bf16 v[12:15], a[116:119], v[140:143], v[12:15]
    ds_read_b64_tr_b16 v[122:123], v215 offset:55296
    v_mfma_f32_16x16x32_bf16 v[60:63], a[124:127], v[140:143], v[60:63]
    ds_read_b64_tr_b16 v[124:125], v215 offset:59392
    v_mfma_f32_16x16x32_bf16 v[60:63], a[120:123], v[136:139], v[60:63]
    ds_read_b64_tr_b16 v[126:127], v215 offset:63488
    s_waitcnt lgkmcnt(12)
    v_mfma_f32_16x16x32_bf16 v[16:19], a[112:115], v[96:99], v[16:19]
    s_waitcnt vmcnt(25)
    s_barrier
    ds_read_b64_tr_b16 v[128:129], v216 offset:0
    v_mfma_f32_16x16x32_bf16 v[16:19], a[116:119], v[100:103], v[16:19]
    ds_read_b64_tr_b16 v[130:131], v216 offset:4096
    buffer_load_dwordx4 a[168:171], v225, s[4:7], 0 offen offset:0 sc1
    v_mfma_f32_16x16x32_bf16 v[64:67], a[124:127], v[100:103], v[64:67]
    ds_read_b64_tr_b16 v[132:133], v216 offset:8192
    v_mfma_f32_16x16x32_bf16 v[64:67], a[120:123], v[96:99], v[64:67]
    ds_read_b64_tr_b16 v[134:135], v216 offset:12288
    s_waitcnt lgkmcnt(12)
    v_mfma_f32_16x16x32_bf16 v[20:23], a[112:115], v[104:107], v[20:23]
    ds_read_b64_tr_b16 v[136:137], v217 offset:0
    v_mfma_f32_16x16x32_bf16 v[20:23], a[116:119], v[108:111], v[20:23]
    ds_read_b64_tr_b16 v[138:139], v217 offset:4096
    buffer_load_dwordx4 v226, s[8:11], 0 offen offset:2048 lds
    v_mfma_f32_16x16x32_bf16 v[68:71], a[124:127], v[108:111], v[68:71]
    ds_read_b64_tr_b16 v[140:141], v217 offset:8192
    v_mfma_f32_16x16x32_bf16 v[68:71], a[120:123], v[104:107], v[68:71]
    ds_read_b64_tr_b16 v[142:143], v217 offset:12288
    s_waitcnt lgkmcnt(12)
    v_mfma_f32_16x16x32_bf16 v[24:27], a[112:115], v[112:115], v[24:27]
    ds_read_b64_tr_b16 v[96:97], v218 offset:0
    v_mfma_f32_16x16x32_bf16 v[24:27], a[116:119], v[116:119], v[24:27]
    ds_read_b64_tr_b16 v[98:99], v218 offset:4096
    buffer_load_dwordx4 a[172:175], v225, s[4:7], 0 offen offset:1024 sc1
    v_mfma_f32_16x16x32_bf16 v[72:75], a[124:127], v[116:119], v[72:75]
    ds_read_b64_tr_b16 v[100:101], v218 offset:8192
    v_mfma_f32_16x16x32_bf16 v[72:75], a[120:123], v[112:115], v[72:75]
    ds_read_b64_tr_b16 v[102:103], v218 offset:12288
    s_waitcnt lgkmcnt(12)
    v_mfma_f32_16x16x32_bf16 v[28:31], a[112:115], v[120:123], v[28:31]
    ds_read_b64_tr_b16 v[104:105], v219 offset:0
    v_mfma_f32_16x16x32_bf16 v[28:31], a[116:119], v[124:127], v[28:31]
    ds_read_b64_tr_b16 v[106:107], v219 offset:4096
    buffer_load_dwordx4 v227, s[8:11], 0 offen offset:3072 lds
    v_mfma_f32_16x16x32_bf16 v[76:79], a[124:127], v[124:127], v[76:79]
    ds_read_b64_tr_b16 v[108:109], v219 offset:8192
    v_mfma_f32_16x16x32_bf16 v[76:79], a[120:123], v[120:123], v[76:79]
    ds_read_b64_tr_b16 v[110:111], v219 offset:12288
    s_waitcnt vmcnt(17) lgkmcnt(12)
    v_mfma_f32_16x16x32_bf16 v[0:3], a[128:131], v[128:131], v[0:3]
    ds_read_b64_tr_b16 v[112:113], v216 offset:2048
    buffer_store_dwordx4 v[156:159], v240, s[16:19], s24 offen offset:2048 sc1
    v_mfma_f32_16x16x32_bf16 v[0:3], a[132:135], v[132:135], v[0:3]
    ds_read_b64_tr_b16 v[114:115], v216 offset:6144
    v_mfma_f32_16x16x32_bf16 v[48:51], a[140:143], v[132:135], v[48:51]
    ds_read_b64_tr_b16 v[116:117], v216 offset:10240
    buffer_load_dwordx4 a[176:179], v224, s[4:7], 0 offen offset:2048 sc1
    v_mfma_f32_16x16x32_bf16 v[48:51], a[136:139], v[128:131], v[48:51]
    ds_read_b64_tr_b16 v[118:119], v216 offset:14336
    s_waitcnt lgkmcnt(12)
    v_mfma_f32_16x16x32_bf16 v[4:7], a[128:131], v[136:139], v[4:7]
    ds_read_b64_tr_b16 v[120:121], v217 offset:2048
    s_add_u32 m0, s22, 49152
    v_mfma_f32_16x16x32_bf16 v[4:7], a[132:135], v[140:143], v[4:7]
    ds_read_b64_tr_b16 v[122:123], v217 offset:6144
    s_add_u32 s8, s66, 4720640
    v_mfma_f32_16x16x32_bf16 v[52:55], a[140:143], v[140:143], v[52:55]
    ds_read_b64_tr_b16 v[124:125], v217 offset:10240
    s_addc_u32 s9, s67, 0
    v_mfma_f32_16x16x32_bf16 v[52:55], a[136:139], v[136:139], v[52:55]
    ds_read_b64_tr_b16 v[126:127], v217 offset:14336
    s_waitcnt lgkmcnt(12)
    v_mfma_f32_16x16x32_bf16 v[8:11], a[128:131], v[96:99], v[8:11]
    ds_read_b64_tr_b16 v[128:129], v218 offset:2048
    buffer_load_dwordx4 v226, s[8:11], 0 offen offset:0 lds
    v_mfma_f32_16x16x32_bf16 v[8:11], a[132:135], v[100:103], v[8:11]
    ds_read_b64_tr_b16 v[130:131], v218 offset:6144
    buffer_load_dwordx4 a[180:183], v224, s[4:7], 0 offen offset:3072 sc1
    v_mfma_f32_16x16x32_bf16 v[56:59], a[140:143], v[100:103], v[56:59]
    ds_read_b64_tr_b16 v[132:133], v218 offset:10240
    v_mfma_f32_16x16x32_bf16 v[56:59], a[136:139], v[96:99], v[56:59]
    ds_read_b64_tr_b16 v[134:135], v218 offset:14336
    s_waitcnt lgkmcnt(12)
    v_mfma_f32_16x16x32_bf16 v[12:15], a[128:131], v[104:107], v[12:15]
    ds_read_b64_tr_b16 v[136:137], v219 offset:2048
    v_mfma_f32_16x16x32_bf16 v[12:15], a[132:135], v[108:111], v[12:15]
    ds_read_b64_tr_b16 v[138:139], v219 offset:6144
    buffer_load_dwordx4 v227, s[8:11], 0 offen offset:1024 lds
    v_mfma_f32_16x16x32_bf16 v[60:63], a[140:143], v[108:111], v[60:63]
    ds_read_b64_tr_b16 v[140:141], v219 offset:10240
    v_mfma_f32_16x16x32_bf16 v[60:63], a[136:139], v[104:107], v[60:63]
    ds_read_b64_tr_b16 v[142:143], v219 offset:14336
    s_waitcnt lgkmcnt(12)
    v_mfma_f32_16x16x32_bf16 v[16:19], a[128:131], v[112:115], v[16:19]
    s_waitcnt vmcnt(21)
    s_barrier
    ds_read_b64_tr_b16 v[96:97], v208 offset:0
    v_mfma_f32_16x16x32_bf16 v[16:19], a[132:135], v[116:119], v[16:19]
    ds_read_b64_tr_b16 v[98:99], v208 offset:4096
    buffer_load_dwordx4 a[184:187], v225, s[4:7], 0 offen offset:2048 sc1
    v_mfma_f32_16x16x32_bf16 v[64:67], a[140:143], v[116:119], v[64:67]
    ds_read_b64_tr_b16 v[100:101], v208 offset:8192
    v_mfma_f32_16x16x32_bf16 v[64:67], a[136:139], v[112:115], v[64:67]
    ds_read_b64_tr_b16 v[102:103], v208 offset:12288
    s_waitcnt lgkmcnt(12)
    v_mfma_f32_16x16x32_bf16 v[20:23], a[128:131], v[120:123], v[20:23]
    ds_read_b64_tr_b16 v[104:105], v209 offset:0
    v_mfma_f32_16x16x32_bf16 v[20:23], a[132:135], v[124:127], v[20:23]
    ds_read_b64_tr_b16 v[106:107], v209 offset:4096
    buffer_load_dwordx4 v226, s[8:11], 0 offen offset:2048 lds
    v_mfma_f32_16x16x32_bf16 v[68:71], a[140:143], v[124:127], v[68:71]
    ds_read_b64_tr_b16 v[108:109], v209 offset:8192
    v_mfma_f32_16x16x32_bf16 v[68:71], a[136:139], v[120:123], v[68:71]
    ds_read_b64_tr_b16 v[110:111], v209 offset:12288
    s_waitcnt lgkmcnt(12)
    v_mfma_f32_16x16x32_bf16 v[24:27], a[128:131], v[128:131], v[24:27]
    ds_read_b64_tr_b16 v[112:113], v210 offset:0
    buffer_load_dwordx4 a[188:191], v225, s[4:7], 0 offen offset:3072 sc1
    v_mfma_f32_16x16x32_bf16 v[24:27], a[132:135], v[132:135], v[24:27]
    ds_read_b64_tr_b16 v[114:115], v210 offset:4096
    v_mfma_f32_16x16x32_bf16 v[72:75], a[140:143], v[132:135], v[72:75]
    ds_read_b64_tr_b16 v[116:117], v210 offset:8192
    v_mfma_f32_16x16x32_bf16 v[72:75], a[136:139], v[128:131], v[72:75]
    ds_read_b64_tr_b16 v[118:119], v210 offset:12288
    s_waitcnt lgkmcnt(12)
    v_mfma_f32_16x16x32_bf16 v[28:31], a[128:131], v[136:139], v[28:31]
    ds_read_b64_tr_b16 v[120:121], v211 offset:0
    buffer_load_dwordx4 v227, s[8:11], 0 offen offset:3072 lds
    v_mfma_f32_16x16x32_bf16 v[28:31], a[132:135], v[140:143], v[28:31]
    ds_read_b64_tr_b16 v[122:123], v211 offset:4096
    v_mfma_f32_16x16x32_bf16 v[76:79], a[140:143], v[140:143], v[76:79]
    ds_read_b64_tr_b16 v[124:125], v211 offset:8192
    v_mfma_f32_16x16x32_bf16 v[76:79], a[136:139], v[136:139], v[76:79]
    ds_read_b64_tr_b16 v[126:127], v211 offset:12288
    s_waitcnt vmcnt(18) lgkmcnt(12)
    v_mfma_f32_16x16x32_bf16 v[0:3], a[144:147], v[96:99], v[0:3]
    ds_read_b64_tr_b16 v[128:129], v208 offset:2048
    s_add_u32 s4, s82, 24576
    v_mfma_f32_16x16x32_bf16 v[0:3], a[148:151], v[100:103], v[0:3]
    ds_read_b64_tr_b16 v[130:131], v208 offset:6144
    s_addc_u32 s5, s83, 0
    v_mfma_f32_16x16x32_bf16 v[48:51], a[156:159], v[100:103], v[48:51]
    ds_read_b64_tr_b16 v[132:133], v208 offset:10240
    buffer_load_dwordx4 a[192:195], v224, s[4:7], 0 offen offset:0 sc1
    v_mfma_f32_16x16x32_bf16 v[48:51], a[152:155], v[96:99], v[48:51]
    ds_read_b64_tr_b16 v[134:135], v208 offset:14336
    s_waitcnt lgkmcnt(12)
    v_mfma_f32_16x16x32_bf16 v[4:7], a[144:147], v[104:107], v[4:7]
    ds_read_b64_tr_b16 v[136:137], v209 offset:2048
    v_mfma_f32_16x16x32_bf16 v[4:7], a[148:151], v[108:111], v[4:7]
    ds_read_b64_tr_b16 v[138:139], v209 offset:6144
    v_mfma_f32_16x16x32_bf16 v[52:55], a[156:159], v[108:111], v[52:55]
    ds_read_b64_tr_b16 v[140:141], v209 offset:10240
    v_mfma_f32_16x16x32_bf16 v[52:55], a[152:155], v[104:107], v[52:55]
    ds_read_b64_tr_b16 v[142:143], v209 offset:14336
    s_waitcnt lgkmcnt(12)
    v_mfma_f32_16x16x32_bf16 v[8:11], a[144:147], v[112:115], v[8:11]
    ds_read_b64_tr_b16 v[96:97], v210 offset:2048
    v_mfma_f32_16x16x32_bf16 v[8:11], a[148:151], v[116:119], v[8:11]
    ds_read_b64_tr_b16 v[98:99], v210 offset:6144
    buffer_load_dwordx4 a[196:199], v224, s[4:7], 0 offen offset:1024 sc1
    v_mfma_f32_16x16x32_bf16 v[56:59], a[156:159], v[116:119], v[56:59]
    ds_read_b64_tr_b16 v[100:101], v210 offset:10240
    v_mfma_f32_16x16x32_bf16 v[56:59], a[152:155], v[112:115], v[56:59]
    ds_read_b64_tr_b16 v[102:103], v210 offset:14336
    s_waitcnt lgkmcnt(12)
    v_mfma_f32_16x16x32_bf16 v[12:15], a[144:147], v[120:123], v[12:15]
    ds_read_b64_tr_b16 v[104:105], v211 offset:2048
    v_mfma_f32_16x16x32_bf16 v[12:15], a[148:151], v[124:127], v[12:15]
    ds_read_b64_tr_b16 v[106:107], v211 offset:6144
    v_mfma_f32_16x16x32_bf16 v[60:63], a[156:159], v[124:127], v[60:63]
    ds_read_b64_tr_b16 v[108:109], v211 offset:10240
    v_mfma_f32_16x16x32_bf16 v[60:63], a[152:155], v[120:123], v[60:63]
    ds_read_b64_tr_b16 v[110:111], v211 offset:14336
    s_waitcnt lgkmcnt(12)
    v_mfma_f32_16x16x32_bf16 v[16:19], a[144:147], v[128:131], v[16:19]
    s_waitcnt vmcnt(19)
    s_barrier
    ds_read_b64_tr_b16 v[112:113], v208 offset:16384
    v_mfma_f32_16x16x32_bf16 v[16:19], a[148:151], v[132:135], v[16:19]
    ds_read_b64_tr_b16 v[114:115], v208 offset:20480
    v_mfma_f32_16x16x32_bf16 v[64:67], a[156:159], v[132:135], v[64:67]
    ds_read_b64_tr_b16 v[116:117], v208 offset:24576
    buffer_load_dwordx4 a[200:203], v225, s[4:7], 0 offen offset:0 sc1
    v_mfma_f32_16x16x32_bf16 v[64:67], a[152:155], v[128:131], v[64:67]
    ds_read_b64_tr_b16 v[118:119], v208 offset:28672
    s_waitcnt lgkmcnt(12)
    v_mfma_f32_16x16x32_bf16 v[20:23], a[144:147], v[136:139], v[20:23]
    ds_read_b64_tr_b16 v[120:121], v209 offset:16384
    v_mfma_f32_16x16x32_bf16 v[20:23], a[148:151], v[140:143], v[20:23]
    ds_read_b64_tr_b16 v[122:123], v209 offset:20480
    v_mfma_f32_16x16x32_bf16 v[68:71], a[156:159], v[140:143], v[68:71]
    ds_read_b64_tr_b16 v[124:125], v209 offset:24576
    v_mfma_f32_16x16x32_bf16 v[68:71], a[152:155], v[136:139], v[68:71]
    ds_read_b64_tr_b16 v[126:127], v209 offset:28672
    s_waitcnt lgkmcnt(12)
    v_mfma_f32_16x16x32_bf16 v[24:27], a[144:147], v[96:99], v[24:27]
    ds_read_b64_tr_b16 v[128:129], v210 offset:16384
    v_mfma_f32_16x16x32_bf16 v[24:27], a[148:151], v[100:103], v[24:27]
    ds_read_b64_tr_b16 v[130:131], v210 offset:20480
    v_mfma_f32_16x16x32_bf16 v[72:75], a[156:159], v[100:103], v[72:75]
    ds_read_b64_tr_b16 v[132:133], v210 offset:24576
    buffer_load_dwordx4 a[204:207], v225, s[4:7], 0 offen offset:1024 sc1
    v_mfma_f32_16x16x32_bf16 v[72:75], a[152:155], v[96:99], v[72:75]
    ds_read_b64_tr_b16 v[134:135], v210 offset:28672
    s_waitcnt lgkmcnt(12)
    v_mfma_f32_16x16x32_bf16 v[28:31], a[144:147], v[104:107], v[28:31]
    ds_read_b64_tr_b16 v[136:137], v211 offset:16384
    v_mfma_f32_16x16x32_bf16 v[28:31], a[148:151], v[108:111], v[28:31]
    ds_read_b64_tr_b16 v[138:139], v211 offset:20480
    v_mfma_f32_16x16x32_bf16 v[76:79], a[156:159], v[108:111], v[76:79]
    ds_read_b64_tr_b16 v[140:141], v211 offset:24576
    v_mfma_f32_16x16x32_bf16 v[76:79], a[152:155], v[104:107], v[76:79]
    ds_read_b64_tr_b16 v[142:143], v211 offset:28672
    s_waitcnt vmcnt(14) lgkmcnt(12)
    v_mfma_f32_16x16x32_bf16 v[0:3], a[160:163], v[112:115], v[0:3]
    ds_read_b64_tr_b16 v[96:97], v208 offset:18432
    buffer_load_dwordx4 a[208:211], v224, s[4:7], 0 offen offset:2048 sc1
    v_mfma_f32_16x16x32_bf16 v[0:3], a[164:167], v[116:119], v[0:3]
    ds_read_b64_tr_b16 v[98:99], v208 offset:22528
    s_add_u32 m0, s22, 65536
    v_mfma_f32_16x16x32_bf16 v[48:51], a[172:175], v[116:119], v[48:51]
    ds_read_b64_tr_b16 v[100:101], v208 offset:26624
    s_add_u32 s8, s66, 5113856
    v_mfma_f32_16x16x32_bf16 v[48:51], a[168:171], v[112:115], v[48:51]
    ds_read_b64_tr_b16 v[102:103], v208 offset:30720
    s_waitcnt lgkmcnt(12)
    v_mfma_f32_16x16x32_bf16 v[4:7], a[160:163], v[120:123], v[4:7]
    ds_read_b64_tr_b16 v[104:105], v209 offset:18432
    s_addc_u32 s9, s67, 0
    v_mfma_f32_16x16x32_bf16 v[4:7], a[164:167], v[124:127], v[4:7]
    ds_read_b64_tr_b16 v[106:107], v209 offset:22528
    buffer_load_dwordx4 v226, s[8:11], 0 offen offset:0 lds
    v_mfma_f32_16x16x32_bf16 v[52:55], a[172:175], v[124:127], v[52:55]
    ds_read_b64_tr_b16 v[108:109], v209 offset:26624
    buffer_load_dwordx4 a[212:215], v224, s[4:7], 0 offen offset:3072 sc1
    v_mfma_f32_16x16x32_bf16 v[52:55], a[168:171], v[120:123], v[52:55]
    ds_read_b64_tr_b16 v[110:111], v209 offset:30720
    s_waitcnt lgkmcnt(12)
    v_mfma_f32_16x16x32_bf16 v[8:11], a[160:163], v[128:131], v[8:11]
    ds_read_b64_tr_b16 v[112:113], v210 offset:18432
    v_mfma_f32_16x16x32_bf16 v[8:11], a[164:167], v[132:135], v[8:11]
    ds_read_b64_tr_b16 v[114:115], v210 offset:22528
    v_mfma_f32_16x16x32_bf16 v[56:59], a[172:175], v[132:135], v[56:59]
    ds_read_b64_tr_b16 v[116:117], v210 offset:26624
    buffer_load_dwordx4 v227, s[8:11], 0 offen offset:1024 lds
    v_mfma_f32_16x16x32_bf16 v[56:59], a[168:171], v[128:131], v[56:59]
    ds_read_b64_tr_b16 v[118:119], v210 offset:30720
    s_waitcnt lgkmcnt(12)
    v_mfma_f32_16x16x32_bf16 v[12:15], a[160:163], v[136:139], v[12:15]
    ds_read_b64_tr_b16 v[120:121], v211 offset:18432
    v_mfma_f32_16x16x32_bf16 v[12:15], a[164:167], v[140:143], v[12:15]
    ds_read_b64_tr_b16 v[122:123], v211 offset:22528
    v_mfma_f32_16x16x32_bf16 v[60:63], a[172:175], v[140:143], v[60:63]
    ds_read_b64_tr_b16 v[124:125], v211 offset:26624
    buffer_load_dwordx4 a[216:219], v225, s[4:7], 0 offen offset:2048 sc1
    v_mfma_f32_16x16x32_bf16 v[60:63], a[168:171], v[136:139], v[60:63]
    ds_read_b64_tr_b16 v[126:127], v211 offset:30720
    s_waitcnt lgkmcnt(12)
    v_mfma_f32_16x16x32_bf16 v[16:19], a[160:163], v[96:99], v[16:19]
    s_waitcnt vmcnt(18)
    s_barrier
    ds_read_b64_tr_b16 v[128:129], v208 offset:32768
    v_mfma_f32_16x16x32_bf16 v[16:19], a[164:167], v[100:103], v[16:19]
    ds_read_b64_tr_b16 v[130:131], v208 offset:36864
    v_mfma_f32_16x16x32_bf16 v[64:67], a[172:175], v[100:103], v[64:67]
    ds_read_b64_tr_b16 v[132:133], v208 offset:40960
    v_mfma_f32_16x16x32_bf16 v[64:67], a[168:171], v[96:99], v[64:67]
    ds_read_b64_tr_b16 v[134:135], v208 offset:45056
    s_waitcnt lgkmcnt(12)
    v_mfma_f32_16x16x32_bf16 v[20:23], a[160:163], v[104:107], v[20:23]
    ds_read_b64_tr_b16 v[136:137], v209 offset:32768
    buffer_load_dwordx4 v226, s[8:11], 0 offen offset:2048 lds
    v_mfma_f32_16x16x32_bf16 v[20:23], a[164:167], v[108:111], v[20:23]
    ds_read_b64_tr_b16 v[138:139], v209 offset:36864
    v_mfma_f32_16x16x32_bf16 v[68:71], a[172:175], v[108:111], v[68:71]
    ds_read_b64_tr_b16 v[140:141], v209 offset:40960
    v_mfma_f32_16x16x32_bf16 v[68:71], a[168:171], v[104:107], v[68:71]
    ds_read_b64_tr_b16 v[142:143], v209 offset:45056
    s_waitcnt lgkmcnt(12)
    v_mfma_f32_16x16x32_bf16 v[24:27], a[160:163], v[112:115], v[24:27]
    ds_read_b64_tr_b16 v[96:97], v210 offset:32768
    buffer_load_dwordx4 a[220:223], v225, s[4:7], 0 offen offset:3072 sc1
    v_mfma_f32_16x16x32_bf16 v[24:27], a[164:167], v[116:119], v[24:27]
    ds_read_b64_tr_b16 v[98:99], v210 offset:36864
    v_mfma_f32_16x16x32_bf16 v[72:75], a[172:175], v[116:119], v[72:75]
    ds_read_b64_tr_b16 v[100:101], v210 offset:40960
    v_mfma_f32_16x16x32_bf16 v[72:75], a[168:171], v[112:115], v[72:75]
    ds_read_b64_tr_b16 v[102:103], v210 offset:45056
    s_waitcnt lgkmcnt(12)
    v_mfma_f32_16x16x32_bf16 v[28:31], a[160:163], v[120:123], v[28:31]
    ds_read_b64_tr_b16 v[104:105], v211 offset:32768
    buffer_load_dwordx4 v227, s[8:11], 0 offen offset:3072 lds
    v_mfma_f32_16x16x32_bf16 v[28:31], a[164:167], v[124:127], v[28:31]
    ds_read_b64_tr_b16 v[106:107], v211 offset:36864
    v_mfma_f32_16x16x32_bf16 v[76:79], a[172:175], v[124:127], v[76:79]
    ds_read_b64_tr_b16 v[108:109], v211 offset:40960
    v_mfma_f32_16x16x32_bf16 v[76:79], a[168:171], v[120:123], v[76:79]
    ds_read_b64_tr_b16 v[110:111], v211 offset:45056
    s_waitcnt vmcnt(13) lgkmcnt(12)
    v_mfma_f32_16x16x32_bf16 v[0:3], a[176:179], v[128:131], v[0:3]
    ds_read_b64_tr_b16 v[112:113], v208 offset:34816
    buffer_store_dwordx4 v[156:159], v240, s[16:19], s24 offen offset:3072 sc1
    v_mfma_f32_16x16x32_bf16 v[0:3], a[180:183], v[132:135], v[0:3]
    ds_read_b64_tr_b16 v[114:115], v208 offset:38912
    s_add_u32 s4, s82, 28672
    v_mfma_f32_16x16x32_bf16 v[48:51], a[188:191], v[132:135], v[48:51]
    ds_read_b64_tr_b16 v[116:117], v208 offset:43008
    s_addc_u32 s5, s83, 0
    v_mfma_f32_16x16x32_bf16 v[48:51], a[184:187], v[128:131], v[48:51]
    ds_read_b64_tr_b16 v[118:119], v208 offset:47104
    s_waitcnt lgkmcnt(12)
    v_mfma_f32_16x16x32_bf16 v[4:7], a[176:179], v[136:139], v[4:7]
    ds_read_b64_tr_b16 v[120:121], v209 offset:34816
    buffer_load_dwordx4 a[224:227], v224, s[4:7], 0 offen offset:0 sc1
    v_mfma_f32_16x16x32_bf16 v[4:7], a[180:183], v[140:143], v[4:7]
    ds_read_b64_tr_b16 v[122:123], v209 offset:38912
    s_add_u32 m0, s22, 81920
    v_mfma_f32_16x16x32_bf16 v[52:55], a[188:191], v[140:143], v[52:55]
    ds_read_b64_tr_b16 v[124:125], v209 offset:43008
    s_add_u32 s8, s66, 5507072
    v_mfma_f32_16x16x32_bf16 v[52:55], a[184:187], v[136:139], v[52:55]
    ds_read_b64_tr_b16 v[126:127], v209 offset:47104
    s_waitcnt lgkmcnt(12)
    v_mfma_f32_16x16x32_bf16 v[8:11], a[176:179], v[96:99], v[8:11]
    ds_read_b64_tr_b16 v[128:129], v210 offset:34816
    s_addc_u32 s9, s67, 0
    v_mfma_f32_16x16x32_bf16 v[8:11], a[180:183], v[100:103], v[8:11]
    ds_read_b64_tr_b16 v[130:131], v210 offset:38912
    buffer_load_dwordx4 v226, s[8:11], 0 offen offset:0 lds
    v_mfma_f32_16x16x32_bf16 v[56:59], a[188:191], v[100:103], v[56:59]
    ds_read_b64_tr_b16 v[132:133], v210 offset:43008
    buffer_load_dwordx4 a[228:231], v224, s[4:7], 0 offen offset:1024 sc1
    v_mfma_f32_16x16x32_bf16 v[56:59], a[184:187], v[96:99], v[56:59]
    ds_read_b64_tr_b16 v[134:135], v210 offset:47104
    s_waitcnt lgkmcnt(12)
    v_mfma_f32_16x16x32_bf16 v[12:15], a[176:179], v[104:107], v[12:15]
    ds_read_b64_tr_b16 v[136:137], v211 offset:34816
    v_mfma_f32_16x16x32_bf16 v[12:15], a[180:183], v[108:111], v[12:15]
    ds_read_b64_tr_b16 v[138:139], v211 offset:38912
    buffer_load_dwordx4 v227, s[8:11], 0 offen offset:1024 lds
    v_mfma_f32_16x16x32_bf16 v[60:63], a[188:191], v[108:111], v[60:63]
    ds_read_b64_tr_b16 v[140:141], v211 offset:43008
    v_mfma_f32_16x16x32_bf16 v[60:63], a[184:187], v[104:107], v[60:63]
    ds_read_b64_tr_b16 v[142:143], v211 offset:47104
    s_waitcnt lgkmcnt(12)
    v_mfma_f32_16x16x32_bf16 v[16:19], a[176:179], v[112:115], v[16:19]
    s_waitcnt vmcnt(17)
    s_barrier
    ds_read_b64_tr_b16 v[96:97], v208 offset:49152
    v_mfma_f32_16x16x32_bf16 v[16:19], a[180:183], v[116:119], v[16:19]
    ds_read_b64_tr_b16 v[98:99], v208 offset:53248
    buffer_load_dwordx4 a[232:235], v225, s[4:7], 0 offen offset:0 sc1
    v_mfma_f32_16x16x32_bf16 v[64:67], a[188:191], v[116:119], v[64:67]
    ds_read_b64_tr_b16 v[100:101], v208 offset:57344
    v_mfma_f32_16x16x32_bf16 v[64:67], a[184:187], v[112:115], v[64:67]
    ds_read_b64_tr_b16 v[102:103], v208 offset:61440
    s_waitcnt lgkmcnt(12)
    v_mfma_f32_16x16x32_bf16 v[20:23], a[176:179], v[120:123], v[20:23]
    ds_read_b64_tr_b16 v[104:105], v209 offset:49152
    v_mfma_f32_16x16x32_bf16 v[20:23], a[180:183], v[124:127], v[20:23]
    ds_read_b64_tr_b16 v[106:107], v209 offset:53248
    buffer_load_dwordx4 v226, s[8:11], 0 offen offset:2048 lds
    v_mfma_f32_16x16x32_bf16 v[68:71], a[188:191], v[124:127], v[68:71]
    ds_read_b64_tr_b16 v[108:109], v209 offset:57344
    v_mfma_f32_16x16x32_bf16 v[68:71], a[184:187], v[120:123], v[68:71]
    ds_read_b64_tr_b16 v[110:111], v209 offset:61440
    s_waitcnt lgkmcnt(12)
    v_mfma_f32_16x16x32_bf16 v[24:27], a[176:179], v[128:131], v[24:27]
    ds_read_b64_tr_b16 v[112:113], v210 offset:49152
    buffer_load_dwordx4 a[236:239], v225, s[4:7], 0 offen offset:1024 sc1
    v_mfma_f32_16x16x32_bf16 v[24:27], a[180:183], v[132:135], v[24:27]
    ds_read_b64_tr_b16 v[114:115], v210 offset:53248
    v_mfma_f32_16x16x32_bf16 v[72:75], a[188:191], v[132:135], v[72:75]
    ds_read_b64_tr_b16 v[116:117], v210 offset:57344
    v_mfma_f32_16x16x32_bf16 v[72:75], a[184:187], v[128:131], v[72:75]
    ds_read_b64_tr_b16 v[118:119], v210 offset:61440
    s_waitcnt lgkmcnt(12)
    v_mfma_f32_16x16x32_bf16 v[28:31], a[176:179], v[136:139], v[28:31]
    ds_read_b64_tr_b16 v[120:121], v211 offset:49152
    buffer_load_dwordx4 v227, s[8:11], 0 offen offset:3072 lds
    v_mfma_f32_16x16x32_bf16 v[28:31], a[180:183], v[140:143], v[28:31]
    ds_read_b64_tr_b16 v[122:123], v211 offset:53248
    v_mfma_f32_16x16x32_bf16 v[76:79], a[188:191], v[140:143], v[76:79]
    ds_read_b64_tr_b16 v[124:125], v211 offset:57344
    v_mfma_f32_16x16x32_bf16 v[76:79], a[184:187], v[136:139], v[76:79]
    ds_read_b64_tr_b16 v[126:127], v211 offset:61440
    s_waitcnt vmcnt(17) lgkmcnt(12)
    v_mfma_f32_16x16x32_bf16 v[0:3], a[192:195], v[96:99], v[0:3]
    ds_read_b64_tr_b16 v[128:129], v208 offset:51200
    buffer_load_dwordx4 a[240:243], v224, s[4:7], 0 offen offset:2048 sc1
    v_mfma_f32_16x16x32_bf16 v[0:3], a[196:199], v[100:103], v[0:3]
    ds_read_b64_tr_b16 v[130:131], v208 offset:55296
    s_add_u32 m0, s22, 98304
    v_mfma_f32_16x16x32_bf16 v[48:51], a[204:207], v[100:103], v[48:51]
    ds_read_b64_tr_b16 v[132:133], v208 offset:59392
    s_add_u32 s8, s66, 5900288
    v_mfma_f32_16x16x32_bf16 v[48:51], a[200:203], v[96:99], v[48:51]
    ds_read_b64_tr_b16 v[134:135], v208 offset:63488
    s_waitcnt lgkmcnt(12)
    v_mfma_f32_16x16x32_bf16 v[4:7], a[192:195], v[104:107], v[4:7]
    ds_read_b64_tr_b16 v[136:137], v209 offset:51200
    s_addc_u32 s9, s67, 0
    v_mfma_f32_16x16x32_bf16 v[4:7], a[196:199], v[108:111], v[4:7]
    ds_read_b64_tr_b16 v[138:139], v209 offset:55296
    buffer_load_dwordx4 v226, s[8:11], 0 offen offset:0 lds
    v_mfma_f32_16x16x32_bf16 v[52:55], a[204:207], v[108:111], v[52:55]
    ds_read_b64_tr_b16 v[140:141], v209 offset:59392
    buffer_load_dwordx4 a[244:247], v224, s[4:7], 0 offen offset:3072 sc1
    v_mfma_f32_16x16x32_bf16 v[52:55], a[200:203], v[104:107], v[52:55]
    ds_read_b64_tr_b16 v[142:143], v209 offset:63488
    s_waitcnt lgkmcnt(12)
    v_mfma_f32_16x16x32_bf16 v[8:11], a[192:195], v[112:115], v[8:11]
    ds_read_b64_tr_b16 v[96:97], v210 offset:51200
    v_mfma_f32_16x16x32_bf16 v[8:11], a[196:199], v[116:119], v[8:11]
    ds_read_b64_tr_b16 v[98:99], v210 offset:55296
    v_mfma_f32_16x16x32_bf16 v[56:59], a[204:207], v[116:119], v[56:59]
    ds_read_b64_tr_b16 v[100:101], v210 offset:59392
    buffer_load_dwordx4 v227, s[8:11], 0 offen offset:1024 lds
    v_mfma_f32_16x16x32_bf16 v[56:59], a[200:203], v[112:115], v[56:59]
    ds_read_b64_tr_b16 v[102:103], v210 offset:63488
    s_waitcnt lgkmcnt(12)
    v_mfma_f32_16x16x32_bf16 v[12:15], a[192:195], v[120:123], v[12:15]
    ds_read_b64_tr_b16 v[104:105], v211 offset:51200
    v_mfma_f32_16x16x32_bf16 v[12:15], a[196:199], v[124:127], v[12:15]
    ds_read_b64_tr_b16 v[106:107], v211 offset:55296
    v_mfma_f32_16x16x32_bf16 v[60:63], a[204:207], v[124:127], v[60:63]
    ds_read_b64_tr_b16 v[108:109], v211 offset:59392
    buffer_load_dwordx4 a[248:251], v225, s[4:7], 0 offen offset:2048 sc1
    v_mfma_f32_16x16x32_bf16 v[60:63], a[200:203], v[120:123], v[60:63]
    ds_read_b64_tr_b16 v[110:111], v211 offset:63488
    s_waitcnt lgkmcnt(12)
    v_mfma_f32_16x16x32_bf16 v[16:19], a[192:195], v[128:131], v[16:19]
    s_waitcnt vmcnt(14)
    s_barrier
    ds_read_b64_tr_b16 v[112:113], v212 offset:0
    v_mfma_f32_16x16x32_bf16 v[16:19], a[196:199], v[132:135], v[16:19]
    ds_read_b64_tr_b16 v[114:115], v212 offset:4096
    v_mfma_f32_16x16x32_bf16 v[64:67], a[204:207], v[132:135], v[64:67]
    ds_read_b64_tr_b16 v[116:117], v212 offset:8192
    v_mfma_f32_16x16x32_bf16 v[64:67], a[200:203], v[128:131], v[64:67]
    ds_read_b64_tr_b16 v[118:119], v212 offset:12288
    s_waitcnt lgkmcnt(12)
    v_mfma_f32_16x16x32_bf16 v[20:23], a[192:195], v[136:139], v[20:23]
    ds_read_b64_tr_b16 v[120:121], v213 offset:0
    buffer_load_dwordx4 v226, s[8:11], 0 offen offset:2048 lds
    v_mfma_f32_16x16x32_bf16 v[20:23], a[196:199], v[140:143], v[20:23]
    ds_read_b64_tr_b16 v[122:123], v213 offset:4096
    v_mfma_f32_16x16x32_bf16 v[68:71], a[204:207], v[140:143], v[68:71]
    ds_read_b64_tr_b16 v[124:125], v213 offset:8192
    v_mfma_f32_16x16x32_bf16 v[68:71], a[200:203], v[136:139], v[68:71]
    ds_read_b64_tr_b16 v[126:127], v213 offset:12288
    s_waitcnt lgkmcnt(12)
    v_mfma_f32_16x16x32_bf16 v[24:27], a[192:195], v[96:99], v[24:27]
    ds_read_b64_tr_b16 v[128:129], v214 offset:0
    buffer_load_dwordx4 a[252:255], v225, s[4:7], 0 offen offset:3072 sc1
    v_mfma_f32_16x16x32_bf16 v[24:27], a[196:199], v[100:103], v[24:27]
    ds_read_b64_tr_b16 v[130:131], v214 offset:4096
    v_mfma_f32_16x16x32_bf16 v[72:75], a[204:207], v[100:103], v[72:75]
    ds_read_b64_tr_b16 v[132:133], v214 offset:8192
    v_mfma_f32_16x16x32_bf16 v[72:75], a[200:203], v[96:99], v[72:75]
    ds_read_b64_tr_b16 v[134:135], v214 offset:12288
    s_waitcnt lgkmcnt(12)
    v_mfma_f32_16x16x32_bf16 v[28:31], a[192:195], v[104:107], v[28:31]
    ds_read_b64_tr_b16 v[136:137], v215 offset:0
    buffer_load_dwordx4 v227, s[8:11], 0 offen offset:3072 lds
    v_mfma_f32_16x16x32_bf16 v[28:31], a[196:199], v[108:111], v[28:31]
    ds_read_b64_tr_b16 v[138:139], v215 offset:4096
    v_mfma_f32_16x16x32_bf16 v[76:79], a[204:207], v[108:111], v[76:79]
    ds_read_b64_tr_b16 v[140:141], v215 offset:8192
    v_mfma_f32_16x16x32_bf16 v[76:79], a[200:203], v[104:107], v[76:79]
    ds_read_b64_tr_b16 v[142:143], v215 offset:12288
    s_waitcnt vmcnt(18) lgkmcnt(12)
    v_mfma_f32_16x16x32_bf16 v[0:3], a[208:211], v[112:115], v[0:3]
    ds_read_b64_tr_b16 v[96:97], v212 offset:2048
    s_add_u32 m0, s22, 114688
    v_mfma_f32_16x16x32_bf16 v[0:3], a[212:215], v[116:119], v[0:3]
    ds_read_b64_tr_b16 v[98:99], v212 offset:6144
    s_add_u32 s8, s66, 0
    v_mfma_f32_16x16x32_bf16 v[48:51], a[220:223], v[116:119], v[48:51]
    ds_read_b64_tr_b16 v[100:101], v212 offset:10240
    s_addc_u32 s9, s67, 0
    v_mfma_f32_16x16x32_bf16 v[48:51], a[216:219], v[112:115], v[48:51]
    ds_read_b64_tr_b16 v[102:103], v212 offset:14336
    s_waitcnt lgkmcnt(12)
    v_mfma_f32_16x16x32_bf16 v[4:7], a[208:211], v[120:123], v[4:7]
    ds_read_b64_tr_b16 v[104:105], v213 offset:2048
    buffer_load_dwordx4 v226, s[8:11], 0 offen offset:0 lds
    v_mfma_f32_16x16x32_bf16 v[4:7], a[212:215], v[124:127], v[4:7]
    ds_read_b64_tr_b16 v[106:107], v213 offset:6144
    v_mfma_f32_16x16x32_bf16 v[52:55], a[220:223], v[124:127], v[52:55]
    ds_read_b64_tr_b16 v[108:109], v213 offset:10240
    v_mfma_f32_16x16x32_bf16 v[52:55], a[216:219], v[120:123], v[52:55]
    ds_read_b64_tr_b16 v[110:111], v213 offset:14336
    s_waitcnt lgkmcnt(12)
    v_mfma_f32_16x16x32_bf16 v[8:11], a[208:211], v[128:131], v[8:11]
    ds_read_b64_tr_b16 v[112:113], v214 offset:2048
    v_mfma_f32_16x16x32_bf16 v[8:11], a[212:215], v[132:135], v[8:11]
    ds_read_b64_tr_b16 v[114:115], v214 offset:6144
    v_mfma_f32_16x16x32_bf16 v[56:59], a[220:223], v[132:135], v[56:59]
    ds_read_b64_tr_b16 v[116:117], v214 offset:10240
    buffer_load_dwordx4 v227, s[8:11], 0 offen offset:1024 lds
    v_mfma_f32_16x16x32_bf16 v[56:59], a[216:219], v[128:131], v[56:59]
    ds_read_b64_tr_b16 v[118:119], v214 offset:14336
    s_waitcnt lgkmcnt(12)
    v_mfma_f32_16x16x32_bf16 v[12:15], a[208:211], v[136:139], v[12:15]
    ds_read_b64_tr_b16 v[120:121], v215 offset:2048
    v_mfma_f32_16x16x32_bf16 v[12:15], a[212:215], v[140:143], v[12:15]
    ds_read_b64_tr_b16 v[122:123], v215 offset:6144
    v_mfma_f32_16x16x32_bf16 v[60:63], a[220:223], v[140:143], v[60:63]
    ds_read_b64_tr_b16 v[124:125], v215 offset:10240
    v_mfma_f32_16x16x32_bf16 v[60:63], a[216:219], v[136:139], v[60:63]
    ds_read_b64_tr_b16 v[126:127], v215 offset:14336
    s_waitcnt lgkmcnt(12)
    v_mfma_f32_16x16x32_bf16 v[16:19], a[208:211], v[96:99], v[16:19]
    s_waitcnt vmcnt(10)
    s_barrier
    ds_read_b64_tr_b16 v[128:129], v212 offset:16384
    v_mfma_f32_16x16x32_bf16 v[16:19], a[212:215], v[100:103], v[16:19]
    ds_read_b64_tr_b16 v[130:131], v212 offset:20480
    v_mfma_f32_16x16x32_bf16 v[64:67], a[220:223], v[100:103], v[64:67]
    ds_read_b64_tr_b16 v[132:133], v212 offset:24576
    v_mfma_f32_16x16x32_bf16 v[64:67], a[216:219], v[96:99], v[64:67]
    ds_read_b64_tr_b16 v[134:135], v212 offset:28672
    s_waitcnt lgkmcnt(12)
    v_mfma_f32_16x16x32_bf16 v[20:23], a[208:211], v[104:107], v[20:23]
    ds_read_b64_tr_b16 v[136:137], v213 offset:16384
    buffer_load_dwordx4 v228, s[8:11], 0 offen offset:2048 lds
    v_mfma_f32_16x16x32_bf16 v[20:23], a[212:215], v[108:111], v[20:23]
    ds_read_b64_tr_b16 v[138:139], v213 offset:20480
    v_mfma_f32_16x16x32_bf16 v[68:71], a[220:223], v[108:111], v[68:71]
    ds_read_b64_tr_b16 v[140:141], v213 offset:24576
    v_mfma_f32_16x16x32_bf16 v[68:71], a[216:219], v[104:107], v[68:71]
    ds_read_b64_tr_b16 v[142:143], v213 offset:28672
    s_waitcnt lgkmcnt(12)
    v_mfma_f32_16x16x32_bf16 v[24:27], a[208:211], v[112:115], v[24:27]
    ds_read_b64_tr_b16 v[96:97], v214 offset:16384
    v_mfma_f32_16x16x32_bf16 v[24:27], a[212:215], v[116:119], v[24:27]
    ds_read_b64_tr_b16 v[98:99], v214 offset:20480
    v_mfma_f32_16x16x32_bf16 v[72:75], a[220:223], v[116:119], v[72:75]
    ds_read_b64_tr_b16 v[100:101], v214 offset:24576
    v_mfma_f32_16x16x32_bf16 v[72:75], a[216:219], v[112:115], v[72:75]
    ds_read_b64_tr_b16 v[102:103], v214 offset:28672
    s_waitcnt lgkmcnt(12)
    v_mfma_f32_16x16x32_bf16 v[28:31], a[208:211], v[120:123], v[28:31]
    ds_read_b64_tr_b16 v[104:105], v215 offset:16384
    buffer_load_dwordx4 v229, s[8:11], 0 offen offset:3072 lds
    v_mfma_f32_16x16x32_bf16 v[28:31], a[212:215], v[124:127], v[28:31]
    ds_read_b64_tr_b16 v[106:107], v215 offset:20480
    v_mfma_f32_16x16x32_bf16 v[76:79], a[220:223], v[124:127], v[76:79]
    ds_read_b64_tr_b16 v[108:109], v215 offset:24576
    v_mfma_f32_16x16x32_bf16 v[76:79], a[216:219], v[120:123], v[76:79]
    ds_read_b64_tr_b16 v[110:111], v215 offset:28672
    s_waitcnt vmcnt(13) lgkmcnt(12)
    v_mfma_f32_16x16x32_bf16 v[0:3], a[224:227], v[128:131], v[0:3]
    ds_read_b64_tr_b16 v[112:113], v212 offset:18432
    s_add_u32 m0, s22, 131072
    v_mfma_f32_16x16x32_bf16 v[0:3], a[228:231], v[132:135], v[0:3]
    ds_read_b64_tr_b16 v[114:115], v212 offset:22528
    s_add_u32 s8, s66, 786432
    v_mfma_f32_16x16x32_bf16 v[48:51], a[236:239], v[132:135], v[48:51]
    ds_read_b64_tr_b16 v[116:117], v212 offset:26624
    s_addc_u32 s9, s67, 0
    v_mfma_f32_16x16x32_bf16 v[48:51], a[232:235], v[128:131], v[48:51]
    ds_read_b64_tr_b16 v[118:119], v212 offset:30720
    s_waitcnt lgkmcnt(12)
    v_mfma_f32_16x16x32_bf16 v[4:7], a[224:227], v[136:139], v[4:7]
    ds_read_b64_tr_b16 v[120:121], v213 offset:18432
    buffer_load_dwordx4 v226, s[8:11], 0 offen offset:0 lds
    v_mfma_f32_16x16x32_bf16 v[4:7], a[228:231], v[140:143], v[4:7]
    ds_read_b64_tr_b16 v[122:123], v213 offset:22528
    v_mfma_f32_16x16x32_bf16 v[52:55], a[236:239], v[140:143], v[52:55]
    ds_read_b64_tr_b16 v[124:125], v213 offset:26624
    v_mfma_f32_16x16x32_bf16 v[52:55], a[232:235], v[136:139], v[52:55]
    ds_read_b64_tr_b16 v[126:127], v213 offset:30720
    s_waitcnt lgkmcnt(12)
    v_mfma_f32_16x16x32_bf16 v[8:11], a[224:227], v[96:99], v[8:11]
    ds_read_b64_tr_b16 v[128:129], v214 offset:18432
    v_mfma_f32_16x16x32_bf16 v[8:11], a[228:231], v[100:103], v[8:11]
    ds_read_b64_tr_b16 v[130:131], v214 offset:22528
    v_mfma_f32_16x16x32_bf16 v[56:59], a[236:239], v[100:103], v[56:59]
    ds_read_b64_tr_b16 v[132:133], v214 offset:26624
    buffer_load_dwordx4 v227, s[8:11], 0 offen offset:1024 lds
    v_mfma_f32_16x16x32_bf16 v[56:59], a[232:235], v[96:99], v[56:59]
    ds_read_b64_tr_b16 v[134:135], v214 offset:30720
    s_waitcnt lgkmcnt(12)
    v_mfma_f32_16x16x32_bf16 v[12:15], a[224:227], v[104:107], v[12:15]
    ds_read_b64_tr_b16 v[136:137], v215 offset:18432
    v_mfma_f32_16x16x32_bf16 v[12:15], a[228:231], v[108:111], v[12:15]
    ds_read_b64_tr_b16 v[138:139], v215 offset:22528
    v_mfma_f32_16x16x32_bf16 v[60:63], a[236:239], v[108:111], v[60:63]
    ds_read_b64_tr_b16 v[140:141], v215 offset:26624
    v_mfma_f32_16x16x32_bf16 v[60:63], a[232:235], v[104:107], v[60:63]
    ds_read_b64_tr_b16 v[142:143], v215 offset:30720
    s_waitcnt lgkmcnt(12)
    v_mfma_f32_16x16x32_bf16 v[16:19], a[224:227], v[112:115], v[16:19]
    s_waitcnt vmcnt(6)
    s_barrier
    ds_read_b64_tr_b16 v[96:97], v212 offset:32768
    v_mfma_f32_16x16x32_bf16 v[16:19], a[228:231], v[116:119], v[16:19]
    ds_read_b64_tr_b16 v[98:99], v212 offset:36864
    v_mfma_f32_16x16x32_bf16 v[64:67], a[236:239], v[116:119], v[64:67]
    ds_read_b64_tr_b16 v[100:101], v212 offset:40960
    v_mfma_f32_16x16x32_bf16 v[64:67], a[232:235], v[112:115], v[64:67]
    ds_read_b64_tr_b16 v[102:103], v212 offset:45056
    s_waitcnt lgkmcnt(12)
    v_mfma_f32_16x16x32_bf16 v[20:23], a[224:227], v[120:123], v[20:23]
    ds_read_b64_tr_b16 v[104:105], v213 offset:32768
    buffer_load_dwordx4 v228, s[8:11], 0 offen offset:2048 lds
    v_mfma_f32_16x16x32_bf16 v[20:23], a[228:231], v[124:127], v[20:23]
    ds_read_b64_tr_b16 v[106:107], v213 offset:36864
    v_mfma_f32_16x16x32_bf16 v[68:71], a[236:239], v[124:127], v[68:71]
    ds_read_b64_tr_b16 v[108:109], v213 offset:40960
    v_mfma_f32_16x16x32_bf16 v[68:71], a[232:235], v[120:123], v[68:71]
    ds_read_b64_tr_b16 v[110:111], v213 offset:45056
    s_waitcnt lgkmcnt(12)
    v_mfma_f32_16x16x32_bf16 v[24:27], a[224:227], v[128:131], v[24:27]
    ds_read_b64_tr_b16 v[112:113], v214 offset:32768
    v_mfma_f32_16x16x32_bf16 v[24:27], a[228:231], v[132:135], v[24:27]
    ds_read_b64_tr_b16 v[114:115], v214 offset:36864
    v_mfma_f32_16x16x32_bf16 v[72:75], a[236:239], v[132:135], v[72:75]
    ds_read_b64_tr_b16 v[116:117], v214 offset:40960
    v_mfma_f32_16x16x32_bf16 v[72:75], a[232:235], v[128:131], v[72:75]
    ds_read_b64_tr_b16 v[118:119], v214 offset:45056
    s_waitcnt lgkmcnt(12)
    v_mfma_f32_16x16x32_bf16 v[28:31], a[224:227], v[136:139], v[28:31]
    ds_read_b64_tr_b16 v[120:121], v215 offset:32768
    buffer_load_dwordx4 v229, s[8:11], 0 offen offset:3072 lds
    v_mfma_f32_16x16x32_bf16 v[28:31], a[228:231], v[140:143], v[28:31]
    ds_read_b64_tr_b16 v[122:123], v215 offset:36864
    v_mfma_f32_16x16x32_bf16 v[76:79], a[236:239], v[140:143], v[76:79]
    ds_read_b64_tr_b16 v[124:125], v215 offset:40960
    v_mfma_f32_16x16x32_bf16 v[76:79], a[232:235], v[136:139], v[76:79]
    ds_read_b64_tr_b16 v[126:127], v215 offset:45056
    s_waitcnt vmcnt(9) lgkmcnt(12)
    v_mfma_f32_16x16x32_bf16 v[0:3], a[240:243], v[96:99], v[0:3]
    ds_read_b64_tr_b16 v[128:129], v212 offset:34816
    s_cmp_ge_u32 s3, 2
    v_mfma_f32_16x16x32_bf16 v[0:3], a[244:247], v[100:103], v[0:3]
    ds_read_b64_tr_b16 v[130:131], v212 offset:38912
    s_cselect_b32 s4, s74, s72
    v_mfma_f32_16x16x32_bf16 v[48:51], a[252:255], v[100:103], v[48:51]
    ds_read_b64_tr_b16 v[132:133], v212 offset:43008
    s_cselect_b32 s5, s75, s73
    v_mfma_f32_16x16x32_bf16 v[48:51], a[248:251], v[96:99], v[48:51]
    ds_read_b64_tr_b16 v[134:135], v212 offset:47104
    s_waitcnt lgkmcnt(12)
    v_mfma_f32_16x16x32_bf16 v[4:7], a[240:243], v[104:107], v[4:7]
    ds_read_b64_tr_b16 v[136:137], v213 offset:34816
    s_mov_b32 s6, 7340032
    v_mfma_f32_16x16x32_bf16 v[4:7], a[244:247], v[108:111], v[4:7]
    ds_read_b64_tr_b16 v[138:139], v213 offset:38912
    s_add_u32 m0, s22, 0
    v_mfma_f32_16x16x32_bf16 v[52:55], a[252:255], v[108:111], v[52:55]
    ds_read_b64_tr_b16 v[140:141], v213 offset:43008
    s_add_u32 s8, s66, 1572864
    v_mfma_f32_16x16x32_bf16 v[52:55], a[248:251], v[104:107], v[52:55]
    ds_read_b64_tr_b16 v[142:143], v213 offset:47104
    s_waitcnt lgkmcnt(12)
    v_mfma_f32_16x16x32_bf16 v[8:11], a[240:243], v[112:115], v[8:11]
    ds_read_b64_tr_b16 v[96:97], v214 offset:34816
    s_addc_u32 s9, s67, 0
    v_mfma_f32_16x16x32_bf16 v[8:11], a[244:247], v[116:119], v[8:11]
    ds_read_b64_tr_b16 v[98:99], v214 offset:38912
    buffer_load_dwordx4 v226, s[8:11], 0 offen offset:0 lds
    v_mfma_f32_16x16x32_bf16 v[56:59], a[252:255], v[116:119], v[56:59]
    ds_read_b64_tr_b16 v[100:101], v214 offset:43008
    v_mfma_f32_16x16x32_bf16 v[56:59], a[248:251], v[112:115], v[56:59]
    ds_read_b64_tr_b16 v[102:103], v214 offset:47104
    s_waitcnt lgkmcnt(12)
    v_mfma_f32_16x16x32_bf16 v[12:15], a[240:243], v[120:123], v[12:15]
    ds_read_b64_tr_b16 v[104:105], v215 offset:34816
    buffer_load_dwordx4 v227, s[8:11], 0 offen offset:1024 lds
    v_mfma_f32_16x16x32_bf16 v[12:15], a[244:247], v[124:127], v[12:15]
    ds_read_b64_tr_b16 v[106:107], v215 offset:38912
    v_mfma_f32_16x16x32_bf16 v[60:63], a[252:255], v[124:127], v[60:63]
    ds_read_b64_tr_b16 v[108:109], v215 offset:43008
    v_mfma_f32_16x16x32_bf16 v[60:63], a[248:251], v[120:123], v[60:63]
    ds_read_b64_tr_b16 v[110:111], v215 offset:47104
    s_waitcnt lgkmcnt(12)
    v_mfma_f32_16x16x32_bf16 v[16:19], a[240:243], v[128:131], v[16:19]
    s_waitcnt vmcnt(6)
    s_barrier
    ds_read_b64_tr_b16 v[112:113], v212 offset:49152
    v_mfma_f32_16x16x32_bf16 v[16:19], a[244:247], v[132:135], v[16:19]
    ds_read_b64_tr_b16 v[114:115], v212 offset:53248
    v_mfma_f32_16x16x32_bf16 v[64:67], a[252:255], v[132:135], v[64:67]
    ds_read_b64_tr_b16 v[116:117], v212 offset:57344
    v_mfma_f32_16x16x32_bf16 v[64:67], a[248:251], v[128:131], v[64:67]
    ds_read_b64_tr_b16 v[118:119], v212 offset:61440
    s_waitcnt lgkmcnt(12)
    v_mfma_f32_16x16x32_bf16 v[20:23], a[240:243], v[136:139], v[20:23]
    ds_read_b64_tr_b16 v[120:121], v213 offset:49152
    v_mfma_f32_16x16x32_bf16 v[20:23], a[244:247], v[140:143], v[20:23]
    ds_read_b64_tr_b16 v[122:123], v213 offset:53248
    buffer_load_dwordx4 v228, s[8:11], 0 offen offset:2048 lds
    v_mfma_f32_16x16x32_bf16 v[68:71], a[252:255], v[140:143], v[68:71]
    ds_read_b64_tr_b16 v[124:125], v213 offset:57344
    v_mfma_f32_16x16x32_bf16 v[68:71], a[248:251], v[136:139], v[68:71]
    ds_read_b64_tr_b16 v[126:127], v213 offset:61440
    s_waitcnt lgkmcnt(12)
    v_mfma_f32_16x16x32_bf16 v[24:27], a[240:243], v[96:99], v[24:27]
    ds_read_b64_tr_b16 v[128:129], v214 offset:49152
    v_mfma_f32_16x16x32_bf16 v[24:27], a[244:247], v[100:103], v[24:27]
    ds_read_b64_tr_b16 v[130:131], v214 offset:53248
    v_mfma_f32_16x16x32_bf16 v[72:75], a[252:255], v[100:103], v[72:75]
    ds_read_b64_tr_b16 v[132:133], v214 offset:57344
    v_mfma_f32_16x16x32_bf16 v[72:75], a[248:251], v[96:99], v[72:75]
    ds_read_b64_tr_b16 v[134:135], v214 offset:61440
    s_waitcnt lgkmcnt(12)
    v_mfma_f32_16x16x32_bf16 v[28:31], a[240:243], v[104:107], v[28:31]
    ds_read_b64_tr_b16 v[136:137], v215 offset:49152
    v_mfma_f32_16x16x32_bf16 v[28:31], a[244:247], v[108:111], v[28:31]
    ds_read_b64_tr_b16 v[138:139], v215 offset:53248
    buffer_load_dwordx4 v229, s[8:11], 0 offen offset:3072 lds
    v_mfma_f32_16x16x32_bf16 v[76:79], a[252:255], v[108:111], v[76:79]
    ds_read_b64_tr_b16 v[140:141], v215 offset:57344
    v_mfma_f32_16x16x32_bf16 v[76:79], a[248:251], v[104:107], v[76:79]
    ds_read_b64_tr_b16 v[142:143], v215 offset:61440
    s_mov_b32 exec_hi, 0xffffff
    buffer_load_dwordx4 v[168:171], v237, s[52:55], s46 offen offset:384
    s_mov_b64 exec, -1
    s_add_u32 m0, s22, 16384
    s_add_u32 s8, s66, 2359296
    s_addc_u32 s9, s67, 0
    buffer_load_dwordx4 v226, s[8:11], 0 offen offset:0 lds
    v_pk_mul_f32 v[144:145], v[0:1], s[34:35]
    v_pk_mul_f32 v[146:147], v[2:3], s[34:35]
    v_pk_mul_f32 v[148:149], v[48:49], s[34:35]
    v_pk_mul_f32 v[150:151], v[50:51], s[34:35]
    v_exp_f32_e64 v144, v144 clamp
    v_exp_f32_e64 v145, v145 clamp
    v_pk_add_f32 v[0:1], v[0:1], 1.0 op_sel_hi:[1,0]
    v_exp_f32_e64 v146, v146 clamp
    buffer_load_dwordx4 v227, s[8:11], 0 offen offset:1024 lds
    v_exp_f32_e64 v147, v147 clamp
    v_pk_add_f32 v[2:3], v[2:3], 1.0 op_sel_hi:[1,0]
    v_exp_f32_e64 v148, v148 clamp
    v_exp_f32_e64 v149, v149 clamp
    v_pk_add_f32 v[48:49], v[48:49], 1.0 op_sel_hi:[1,0]
    v_exp_f32_e64 v150, v150 clamp
    v_exp_f32_e64 v151, v151 clamp
    v_pk_add_f32 v[50:51], v[50:51], 1.0 op_sel_hi:[1,0]
    buffer_load_dwordx4 v228, s[8:11], 0 offen offset:2048 lds
    v_max_f32 v0, v0, v144
    v_max_f32 v1, v1, v145
    v_max_f32 v2, v2, v146
    v_max_f32 v3, v3, v147
    v_max_f32 v48, v48, v148
    v_max_f32 v49, v49, v149
    v_max_f32 v50, v50, v150
    v_max_f32 v51, v51, v151
    buffer_load_dwordx4 v229, s[8:11], 0 offen offset:3072 lds
    v_pk_add_f32 v[0:1], v[0:1], s[36:37]
    v_pk_add_f32 v[2:3], v[2:3], s[36:37]
    v_pk_add_f32 v[48:49], v[48:49], s[36:37]
    v_pk_add_f32 v[50:51], v[50:51], s[36:37]
    v_cvt_pk_bf16_f32 v176, v0, v1
    v_cvt_pk_bf16_f32 v177, v2, v3
    v_cvt_pk_bf16_f32 v178, v48, v49
    v_cvt_pk_bf16_f32 v179, v50, v51
    s_add_u32 m0, s22, 32768
    s_add_u32 s8, s66, 3145728
    s_addc_u32 s9, s67, 0
    buffer_load_dwordx4 v226, s[8:11], 0 offen offset:0 lds
    ds_write_b128 v244, v[176:179] offset:0
    s_barrier
    v_cvt_pk_bf16_f32 v192, v16, v17
    v_cvt_pk_bf16_f32 v193, v18, v19
    v_cvt_pk_bf16_f32 v194, v64, v65
    v_cvt_pk_bf16_f32 v195, v66, v67
    ds_write_b128 v251, v[192:195] offset:0
    v_cvt_pk_bf16_f32 v196, v20, v21
    buffer_load_dwordx4 v227, s[8:11], 0 offen offset:1024 lds
    v_cvt_pk_bf16_f32 v197, v22, v23
    v_cvt_pk_bf16_f32 v198, v68, v69
    v_cvt_pk_bf16_f32 v199, v70, v71
    ds_write_b128 v251, v[196:199] offset:1024
    v_cvt_pk_bf16_f32 v200, v24, v25
    v_cvt_pk_bf16_f32 v201, v26, v27
    v_cvt_pk_bf16_f32 v202, v72, v73
    v_cvt_pk_bf16_f32 v203, v74, v75
    buffer_load_dwordx4 v228, s[8:11], 0 offen offset:2048 lds
    ds_write_b128 v251, v[200:203] offset:2048
    v_cvt_pk_bf16_f32 v204, v28, v29
    v_cvt_pk_bf16_f32 v205, v30, v31
    v_cvt_pk_bf16_f32 v206, v76, v77
    v_cvt_pk_bf16_f32 v207, v78, v79
    ds_write_b128 v251, v[204:207] offset:3072
    v_pk_mul_f32 v[144:145], v[4:5], s[34:35]
    v_pk_mul_f32 v[146:147], v[6:7], s[34:35]
    buffer_load_dwordx4 v229, s[8:11], 0 offen offset:3072 lds
    v_pk_mul_f32 v[148:149], v[52:53], s[34:35]
    v_pk_mul_f32 v[150:151], v[54:55], s[34:35]
    v_exp_f32_e64 v144, v144 clamp
    v_exp_f32_e64 v145, v145 clamp
    v_pk_add_f32 v[4:5], v[4:5], 1.0 op_sel_hi:[1,0]
    v_exp_f32_e64 v146, v146 clamp
    v_exp_f32_e64 v147, v147 clamp
    v_pk_add_f32 v[6:7], v[6:7], 1.0 op_sel_hi:[1,0]
    s_add_u32 m0, s22, 49152
    s_add_u32 s8, s66, 3932160
    s_addc_u32 s9, s67, 0
    buffer_load_dwordx4 v226, s[8:11], 0 offen offset:0 lds
    v_exp_f32_e64 v148, v148 clamp
    v_exp_f32_e64 v149, v149 clamp
    v_pk_add_f32 v[52:53], v[52:53], 1.0 op_sel_hi:[1,0]
    v_exp_f32_e64 v150, v150 clamp
    v_exp_f32_e64 v151, v151 clamp
    v_pk_add_f32 v[54:55], v[54:55], 1.0 op_sel_hi:[1,0]
    v_max_f32 v4, v4, v144
    v_max_f32 v5, v5, v145
    buffer_load_dwordx4 v227, s[8:11], 0 offen offset:1024 lds
    v_max_f32 v6, v6, v146
    v_max_f32 v7, v7, v147
    v_max_f32 v52, v52, v148
    v_max_f32 v53, v53, v149
    v_max_f32 v54, v54, v150
    v_max_f32 v55, v55, v151
    v_pk_add_f32 v[4:5], v[4:5], s[36:37]
    v_pk_add_f32 v[6:7], v[6:7], s[36:37]
    buffer_load_dwordx4 v228, s[8:11], 0 offen offset:2048 lds
    v_pk_add_f32 v[52:53], v[52:53], s[36:37]
    v_pk_add_f32 v[54:55], v[54:55], s[36:37]
    v_cvt_pk_bf16_f32 v180, v4, v5
    v_cvt_pk_bf16_f32 v181, v6, v7
    v_cvt_pk_bf16_f32 v182, v52, v53
    v_cvt_pk_bf16_f32 v183, v54, v55
    ds_write_b128 v244, v[180:183] offset:1024
    v_pk_mul_f32 v[144:145], v[8:9], s[34:35]
    buffer_load_dwordx4 v229, s[8:11], 0 offen offset:3072 lds
    v_pk_mul_f32 v[146:147], v[10:11], s[34:35]
    v_pk_mul_f32 v[148:149], v[56:57], s[34:35]
    v_pk_mul_f32 v[150:151], v[58:59], s[34:35]
    v_exp_f32_e64 v144, v144 clamp
    v_exp_f32_e64 v145, v145 clamp
    v_pk_add_f32 v[8:9], v[8:9], 1.0 op_sel_hi:[1,0]
    v_exp_f32_e64 v146, v146 clamp
    v_exp_f32_e64 v147, v147 clamp
    s_add_u32 m0, s22, 65536
    s_add_u32 s8, s66, 4718592
    s_addc_u32 s9, s67, 0
    buffer_load_dwordx4 v226, s[8:11], 0 offen offset:0 lds
    v_pk_add_f32 v[10:11], v[10:11], 1.0 op_sel_hi:[1,0]
    v_exp_f32_e64 v148, v148 clamp
    v_exp_f32_e64 v149, v149 clamp
    v_pk_add_f32 v[56:57], v[56:57], 1.0 op_sel_hi:[1,0]
    v_exp_f32_e64 v150, v150 clamp
    v_exp_f32_e64 v151, v151 clamp
    v_pk_add_f32 v[58:59], v[58:59], 1.0 op_sel_hi:[1,0]
    v_max_f32 v8, v8, v144
    buffer_load_dwordx4 v227, s[8:11], 0 offen offset:1024 lds
    v_max_f32 v9, v9, v145
    v_max_f32 v10, v10, v146
    v_max_f32 v11, v11, v147
    v_max_f32 v56, v56, v148
    v_max_f32 v57, v57, v149
    v_max_f32 v58, v58, v150
    v_max_f32 v59, v59, v151
    v_pk_add_f32 v[8:9], v[8:9], s[36:37]
    buffer_load_dwordx4 v228, s[8:11], 0 offen offset:2048 lds
    v_pk_add_f32 v[10:11], v[10:11], s[36:37]
    v_pk_add_f32 v[56:57], v[56:57], s[36:37]
    v_pk_add_f32 v[58:59], v[58:59], s[36:37]
    v_cvt_pk_bf16_f32 v184, v8, v9
    v_cvt_pk_bf16_f32 v185, v10, v11
    v_cvt_pk_bf16_f32 v186, v56, v57
    v_cvt_pk_bf16_f32 v187, v58, v59
    ds_write_b128 v244, v[184:187] offset:2048
    buffer_load_dwordx4 v229, s[8:11], 0 offen offset:3072 lds
    v_pk_mul_f32 v[144:145], v[12:13], s[34:35]
    v_pk_mul_f32 v[146:147], v[14:15], s[34:35]
    v_pk_mul_f32 v[148:149], v[60:61], s[34:35]
    v_pk_mul_f32 v[150:151], v[62:63], s[34:35]
    v_exp_f32_e64 v144, v144 clamp
    v_exp_f32_e64 v145, v145 clamp
    v_pk_add_f32 v[12:13], v[12:13], 1.0 op_sel_hi:[1,0]
    v_exp_f32_e64 v146, v146 clamp
    s_add_u32 m0, s22, 81920
    s_add_u32 s8, s66, 5505024
    s_addc_u32 s9, s67, 0
    buffer_load_dwordx4 v226, s[8:11], 0 offen offset:0 lds
    v_exp_f32_e64 v147, v147 clamp
    v_pk_add_f32 v[14:15], v[14:15], 1.0 op_sel_hi:[1,0]
    v_exp_f32_e64 v148, v148 clamp
    v_exp_f32_e64 v149, v149 clamp
    v_pk_add_f32 v[60:61], v[60:61], 1.0 op_sel_hi:[1,0]
    v_exp_f32_e64 v150, v150 clamp
    v_exp_f32_e64 v151, v151 clamp
    v_pk_add_f32 v[62:63], v[62:63], 1.0 op_sel_hi:[1,0]
    buffer_load_dwordx4 v227, s[8:11], 0 offen offset:1024 lds
    v_max_f32 v12, v12, v144
    v_max_f32 v13, v13, v145
    v_max_f32 v14, v14, v146
    v_max_f32 v15, v15, v147
    v_max_f32 v60, v60, v148
    v_max_f32 v61, v61, v149
    v_max_f32 v62, v62, v150
    v_max_f32 v63, v63, v151
    buffer_load_dwordx4 v228, s[8:11], 0 offen offset:2048 lds
    v_pk_add_f32 v[12:13], v[12:13], s[36:37]
    v_pk_add_f32 v[14:15], v[14:15], s[36:37]
    v_pk_add_f32 v[60:61], v[60:61], s[36:37]
    v_pk_add_f32 v[62:63], v[62:63], s[36:37]
    v_cvt_pk_bf16_f32 v188, v12, v13
    v_cvt_pk_bf16_f32 v189, v14, v15
    v_cvt_pk_bf16_f32 v190, v60, v61
    v_cvt_pk_bf16_f32 v191, v62, v63
    buffer_load_dwordx4 v229, s[8:11], 0 offen offset:3072 lds
    ds_write_b128 v244, v[188:191] offset:3072
    s_waitcnt lgkmcnt(0)
    s_barrier
    ds_read_b128 v[0:3], v245 offset:0
    ds_read_b128 v[4:7], v245 offset:1024
    ds_read_b128 v[8:11], v246 offset:0
    ds_read_b128 v[12:15], v245 offset:4096
    ds_read_b128 v[16:19], v245 offset:5120
    ds_read_b128 v[20:23], v246 offset:4096
    ds_read_b128 v[48:51], v245 offset:8192
    ds_read_b128 v[52:55], v245 offset:9216
    ds_read_b128 v[56:59], v246 offset:8192
    ds_read_b128 v[60:63], v245 offset:12288
    ds_read_b128 v[64:67], v245 offset:13312
    ds_read_b128 v[68:71], v246 offset:12288
    s_mov_b64 exec, 1
    buffer_store_dword v223, v249, s[16:19], s42 offen sc1
    s_mov_b64 exec, -1
    s_waitcnt lgkmcnt(9)
    v_mfma_f32_16x16x32_bf16 v[148:151], v[0:3], v[8:11], 0
    v_mfma_f32_16x16x32_bf16 v[152:155], v[4:7], v[8:11], 0
    s_waitcnt lgkmcnt(6)
    v_mfma_f32_16x16x32_bf16 v[148:151], v[12:15], v[20:23], v[148:151]
    v_mfma_f32_16x16x32_bf16 v[152:155], v[16:19], v[20:23], v[152:155]
    s_waitcnt lgkmcnt(3)
    v_mfma_f32_16x16x32_bf16 v[148:151], v[48:51], v[56:59], v[148:151]
    v_mfma_f32_16x16x32_bf16 v[152:155], v[52:55], v[56:59], v[152:155]
    s_waitcnt lgkmcnt(0)
    v_mfma_f32_16x16x32_bf16 v[148:151], v[60:63], v[68:71], v[148:151]
    v_mfma_f32_16x16x32_bf16 v[152:155], v[64:67], v[68:71], v[152:155]
    v_mfma_f32_16x16x32_bf16 v[156:159], v[0:3], v[232:235], 0
    v_mfma_f32_16x16x32_bf16 v[160:163], v[4:7], v[232:235], 0
    v_mfma_f32_16x16x32_bf16 v[156:159], v[12:15], v[232:235], v[156:159]
    v_mfma_f32_16x16x32_bf16 v[160:163], v[16:19], v[232:235], v[160:163]
    v_mfma_f32_16x16x32_bf16 v[156:159], v[48:51], v[232:235], v[156:159]
    v_mfma_f32_16x16x32_bf16 v[160:163], v[52:55], v[232:235], v[160:163]
    v_mfma_f32_16x16x32_bf16 v[156:159], v[60:63], v[232:235], v[156:159]
    v_mfma_f32_16x16x32_bf16 v[160:163], v[64:67], v[232:235], v[160:163]
    v_cvt_pk_bf16_f32 v164, v148, v149
    v_cvt_pk_bf16_f32 v165, v150, v151
    v_cvt_pk_bf16_f32 v166, v152, v153
    v_cvt_pk_bf16_f32 v167, v154, v155
    buffer_store_dwordx4 v[164:167], v250, s[16:19], s42 offen sc1
    s_mov_b32 exec_lo, 0x00010001
    s_mov_b32 exec_hi, 0x00010001
    s_nop 0
    buffer_store_dwordx4 v[156:159], v248, s[16:19], s42 offen sc1
    buffer_store_dwordx4 v[160:163], v248, s[16:19], s42 offen offset:16 sc1
    s_mov_b64 exec, -1
    s_waitcnt vmcnt(24)
    s_mov_b32 exec_hi, 0xffffff
    buffer_store_dwordx4 v[168:171], v237, s[16:19], s47 offen offset:512 sc1
    s_mov_b64 exec, -1
    s_mov_b64 exec, 0xffff
    buffer_load_dword v222, v236, s[84:87], s25 offen
    s_mov_b64 exec, -1
    s_mov_b32 exec_hi, 0x7
    buffer_load_dword v222, v241, s[4:7], s26 offen
    s_mov_b64 exec, -1
    s_waitcnt lgkmcnt(15)
    v_mfma_f32_16x16x32_bf16 v[32:35], v[112:115], a[0:3], 0
    ds_read_b64_tr_b16 v[96:97], v212 offset:51200
    v_mfma_f32_16x16x32_bf16 v[32:35], v[116:119], a[4:7], v[32:35]
    ds_read_b64_tr_b16 v[98:99], v212 offset:55296
    v_mfma_f32_16x16x32_bf16 v[80:83], v[116:119], a[12:15], 0
    ds_read_b64_tr_b16 v[100:101], v212 offset:59392
    v_mfma_f32_16x16x32_bf16 v[80:83], v[112:115], a[8:11], v[80:83]
    ds_read_b64_tr_b16 v[102:103], v212 offset:63488
    s_waitcnt lgkmcnt(15)
    v_mfma_f32_16x16x32_bf16 v[36:39], v[120:123], a[0:3], 0
    ds_read_b64_tr_b16 v[104:105], v213 offset:51200
    v_mfma_f32_16x16x32_bf16 v[36:39], v[124:127], a[4:7], v[36:39]
    ds_read_b64_tr_b16 v[106:107], v213 offset:55296
    v_mfma_f32_16x16x32_bf16 v[84:87], v[124:127], a[12:15], 0
    ds_read_b64_tr_b16 v[108:109], v213 offset:59392
    v_mfma_f32_16x16x32_bf16 v[84:87], v[120:123], a[8:11], v[84:87]
    ds_read_b64_tr_b16 v[110:111], v213 offset:63488
    s_waitcnt lgkmcnt(15)
    v_mfma_f32_16x16x32_bf16 v[40:43], v[128:131], a[0:3], 0
    ds_read_b64_tr_b16 v[112:113], v214 offset:51200
    v_mfma_f32_16x16x32_bf16 v[40:43], v[132:135], a[4:7], v[40:43]
    ds_read_b64_tr_b16 v[114:115], v214 offset:55296
    v_mfma_f32_16x16x32_bf16 v[88:91], v[132:135], a[12:15], 0
    ds_read_b64_tr_b16 v[116:117], v214 offset:59392
    v_mfma_f32_16x16x32_bf16 v[88:91], v[128:131], a[8:11], v[88:91]
    ds_read_b64_tr_b16 v[118:119], v214 offset:63488
    s_waitcnt lgkmcnt(15)
    v_mfma_f32_16x16x32_bf16 v[44:47], v[136:139], a[0:3], 0
    ds_read_b64_tr_b16 v[120:121], v215 offset:51200
    v_mfma_f32_16x16x32_bf16 v[44:47], v[140:143], a[4:7], v[44:47]
    ds_read_b64_tr_b16 v[122:123], v215 offset:55296
    v_mfma_f32_16x16x32_bf16 v[92:95], v[140:143], a[12:15], 0
    ds_read_b64_tr_b16 v[124:125], v215 offset:59392
    v_mfma_f32_16x16x32_bf16 v[92:95], v[136:139], a[8:11], v[92:95]
    ds_read_b64_tr_b16 v[126:127], v215 offset:63488
    s_waitcnt lgkmcnt(12)
    v_mfma_f32_16x16x32_bf16 v[32:35], v[96:99], a[16:19], v[32:35]
    s_waitcnt vmcnt(32)
    s_barrier
    ds_read_b64_tr_b16 v[128:129], v216 offset:0
    v_mfma_f32_16x16x32_bf16 v[32:35], v[100:103], a[20:23], v[32:35]
    ds_read_b64_tr_b16 v[130:131], v216 offset:4096
    v_mfma_f32_16x16x32_bf16 v[80:83], v[100:103], a[28:31], v[80:83]
    ds_read_b64_tr_b16 v[132:133], v216 offset:8192
    v_mfma_f32_16x16x32_bf16 v[80:83], v[96:99], a[24:27], v[80:83]
    ds_read_b64_tr_b16 v[134:135], v216 offset:12288
    s_waitcnt lgkmcnt(12)
    v_mfma_f32_16x16x32_bf16 v[36:39], v[104:107], a[16:19], v[36:39]
    ds_read_b64_tr_b16 v[136:137], v217 offset:0
    v_mfma_f32_16x16x32_bf16 v[36:39], v[108:111], a[20:23], v[36:39]
    ds_read_b64_tr_b16 v[138:139], v217 offset:4096
    v_mfma_f32_16x16x32_bf16 v[84:87], v[108:111], a[28:31], v[84:87]
    ds_read_b64_tr_b16 v[140:141], v217 offset:8192
    v_mfma_f32_16x16x32_bf16 v[84:87], v[104:107], a[24:27], v[84:87]
    ds_read_b64_tr_b16 v[142:143], v217 offset:12288
    s_waitcnt lgkmcnt(12)
    v_mfma_f32_16x16x32_bf16 v[40:43], v[112:115], a[16:19], v[40:43]
    ds_read_b64_tr_b16 v[96:97], v218 offset:0
    v_mfma_f32_16x16x32_bf16 v[40:43], v[116:119], a[20:23], v[40:43]
    ds_read_b64_tr_b16 v[98:99], v218 offset:4096
    v_mfma_f32_16x16x32_bf16 v[88:91], v[116:119], a[28:31], v[88:91]
    ds_read_b64_tr_b16 v[100:101], v218 offset:8192
    v_mfma_f32_16x16x32_bf16 v[88:91], v[112:115], a[24:27], v[88:91]
    ds_read_b64_tr_b16 v[102:103], v218 offset:12288
    s_waitcnt lgkmcnt(12)
    v_mfma_f32_16x16x32_bf16 v[44:47], v[120:123], a[16:19], v[44:47]
    ds_read_b64_tr_b16 v[104:105], v219 offset:0
    v_mfma_f32_16x16x32_bf16 v[44:47], v[124:127], a[20:23], v[44:47]
    ds_read_b64_tr_b16 v[106:107], v219 offset:4096
    v_mfma_f32_16x16x32_bf16 v[92:95], v[124:127], a[28:31], v[92:95]
    ds_read_b64_tr_b16 v[108:109], v219 offset:8192
    v_mfma_f32_16x16x32_bf16 v[92:95], v[120:123], a[24:27], v[92:95]
    ds_read_b64_tr_b16 v[110:111], v219 offset:12288
    s_waitcnt lgkmcnt(12)
    v_mfma_f32_16x16x32_bf16 v[32:35], v[128:131], a[32:35], v[32:35]
    ds_read_b64_tr_b16 v[112:113], v216 offset:2048
    s_add_u32 m0, s48, 0
    v_mfma_f32_16x16x32_bf16 v[32:35], v[132:135], a[36:39], v[32:35]
    ds_read_b64_tr_b16 v[114:115], v216 offset:6144
    s_mov_b32 s53, 0
    v_mfma_f32_16x16x32_bf16 v[80:83], v[132:135], a[44:47], v[80:83]
    ds_read_b64_tr_b16 v[116:117], v216 offset:10240
    buffer_load_dwordx4 v238, s[12:15], s53 offen nt lds
    v_mfma_f32_16x16x32_bf16 v[80:83], v[128:131], a[40:43], v[80:83]
    ds_read_b64_tr_b16 v[118:119], v216 offset:14336
    s_waitcnt lgkmcnt(12)
    v_mfma_f32_16x16x32_bf16 v[36:39], v[136:139], a[32:35], v[36:39]
    ds_read_b64_tr_b16 v[120:121], v217 offset:2048
    s_add_u32 m0, s48, 1024
    v_mfma_f32_16x16x32_bf16 v[36:39], v[140:143], a[36:39], v[36:39]
    ds_read_b64_tr_b16 v[122:123], v217 offset:6144
    s_mov_b32 s53, 16384
    v_mfma_f32_16x16x32_bf16 v[84:87], v[140:143], a[44:47], v[84:87]
    ds_read_b64_tr_b16 v[124:125], v217 offset:10240
    v_mfma_f32_16x16x32_bf16 v[84:87], v[136:139], a[40:43], v[84:87]
    ds_read_b64_tr_b16 v[126:127], v217 offset:14336
    s_waitcnt lgkmcnt(12)
    v_mfma_f32_16x16x32_bf16 v[40:43], v[96:99], a[32:35], v[40:43]
    ds_read_b64_tr_b16 v[128:129], v218 offset:2048
    v_mfma_f32_16x16x32_bf16 v[40:43], v[100:103], a[36:39], v[40:43]
    ds_read_b64_tr_b16 v[130:131], v218 offset:6144
    buffer_load_dwordx4 v239, s[12:15], s53 offen nt lds
    v_mfma_f32_16x16x32_bf16 v[88:91], v[100:103], a[44:47], v[88:91]
    ds_read_b64_tr_b16 v[132:133], v218 offset:10240
    s_add_u32 m0, s48, 2048
    v_mfma_f32_16x16x32_bf16 v[88:91], v[96:99], a[40:43], v[88:91]
    ds_read_b64_tr_b16 v[134:135], v218 offset:14336
    s_waitcnt lgkmcnt(12)
    v_mfma_f32_16x16x32_bf16 v[44:47], v[104:107], a[32:35], v[44:47]
    ds_read_b64_tr_b16 v[136:137], v219 offset:2048
    s_mov_b32 s53, 32768
    v_mfma_f32_16x16x32_bf16 v[44:47], v[108:111], a[36:39], v[44:47]
    ds_read_b64_tr_b16 v[138:139], v219 offset:6144
    v_mfma_f32_16x16x32_bf16 v[92:95], v[108:111], a[44:47], v[92:95]
    ds_read_b64_tr_b16 v[140:141], v219 offset:10240
    v_mfma_f32_16x16x32_bf16 v[92:95], v[104:107], a[40:43], v[92:95]
    ds_read_b64_tr_b16 v[142:143], v219 offset:14336
    s_waitcnt lgkmcnt(12)
    v_mfma_f32_16x16x32_bf16 v[32:35], v[112:115], a[48:51], v[32:35]
    s_waitcnt vmcnt(30)
    s_barrier
    ds_read_b64_tr_b16 v[96:97], v208 offset:0
    v_mfma_f32_16x16x32_bf16 v[32:35], v[116:119], a[52:55], v[32:35]
    ds_read_b64_tr_b16 v[98:99], v208 offset:4096
    v_mfma_f32_16x16x32_bf16 v[80:83], v[116:119], a[60:63], v[80:83]
    ds_read_b64_tr_b16 v[100:101], v208 offset:8192
    buffer_load_dwordx4 v238, s[12:15], s53 offen nt lds
    v_mfma_f32_16x16x32_bf16 v[80:83], v[112:115], a[56:59], v[80:83]
    ds_read_b64_tr_b16 v[102:103], v208 offset:12288
    s_waitcnt lgkmcnt(12)
    v_mfma_f32_16x16x32_bf16 v[36:39], v[120:123], a[48:51], v[36:39]
    ds_read_b64_tr_b16 v[104:105], v209 offset:0
    s_add_u32 m0, s48, 3072
    v_mfma_f32_16x16x32_bf16 v[36:39], v[124:127], a[52:55], v[36:39]
    ds_read_b64_tr_b16 v[106:107], v209 offset:4096
    s_mov_b32 s53, 49152
    v_mfma_f32_16x16x32_bf16 v[84:87], v[124:127], a[60:63], v[84:87]
    ds_read_b64_tr_b16 v[108:109], v209 offset:8192
    v_mfma_f32_16x16x32_bf16 v[84:87], v[120:123], a[56:59], v[84:87]
    ds_read_b64_tr_b16 v[110:111], v209 offset:12288
    s_waitcnt lgkmcnt(12)
    v_mfma_f32_16x16x32_bf16 v[40:43], v[128:131], a[48:51], v[40:43]
    ds_read_b64_tr_b16 v[112:113], v210 offset:0
    v_mfma_f32_16x16x32_bf16 v[40:43], v[132:135], a[52:55], v[40:43]
    ds_read_b64_tr_b16 v[114:115], v210 offset:4096
    v_mfma_f32_16x16x32_bf16 v[88:91], v[132:135], a[60:63], v[88:91]
    ds_read_b64_tr_b16 v[116:117], v210 offset:8192
    buffer_load_dwordx4 v239, s[12:15], s53 offen nt lds
    v_mfma_f32_16x16x32_bf16 v[88:91], v[128:131], a[56:59], v[88:91]
    ds_read_b64_tr_b16 v[118:119], v210 offset:12288
    s_waitcnt lgkmcnt(12)
    v_mfma_f32_16x16x32_bf16 v[44:47], v[136:139], a[48:51], v[44:47]
    ds_read_b64_tr_b16 v[120:121], v211 offset:0
    v_mfma_f32_16x16x32_bf16 v[44:47], v[140:143], a[52:55], v[44:47]
    ds_read_b64_tr_b16 v[122:123], v211 offset:4096
    v_mfma_f32_16x16x32_bf16 v[92:95], v[140:143], a[60:63], v[92:95]
    ds_read_b64_tr_b16 v[124:125], v211 offset:8192
    v_mfma_f32_16x16x32_bf16 v[92:95], v[136:139], a[56:59], v[92:95]
    ds_read_b64_tr_b16 v[126:127], v211 offset:12288
    s_waitcnt lgkmcnt(12)
    v_mfma_f32_16x16x32_bf16 v[32:35], v[96:99], a[64:67], v[32:35]
    ds_read_b64_tr_b16 v[128:129], v208 offset:2048
    v_mfma_f32_16x16x32_bf16 v[32:35], v[100:103], a[68:71], v[32:35]
    ds_read_b64_tr_b16 v[130:131], v208 offset:6144
    v_mfma_f32_16x16x32_bf16 v[80:83], v[100:103], a[76:79], v[80:83]
    ds_read_b64_tr_b16 v[132:133], v208 offset:10240
    v_mfma_f32_16x16x32_bf16 v[80:83], v[96:99], a[72:75], v[80:83]
    ds_read_b64_tr_b16 v[134:135], v208 offset:14336
    s_waitcnt lgkmcnt(12)
    v_mfma_f32_16x16x32_bf16 v[36:39], v[104:107], a[64:67], v[36:39]
    ds_read_b64_tr_b16 v[136:137], v209 offset:2048
    v_mfma_f32_16x16x32_bf16 v[36:39], v[108:111], a[68:71], v[36:39]
    ds_read_b64_tr_b16 v[138:139], v209 offset:6144
    v_mfma_f32_16x16x32_bf16 v[84:87], v[108:111], a[76:79], v[84:87]
    ds_read_b64_tr_b16 v[140:141], v209 offset:10240
    v_mfma_f32_16x16x32_bf16 v[84:87], v[104:107], a[72:75], v[84:87]
    ds_read_b64_tr_b16 v[142:143], v209 offset:14336
    s_waitcnt lgkmcnt(12)
    v_mfma_f32_16x16x32_bf16 v[40:43], v[112:115], a[64:67], v[40:43]
    ds_read_b64_tr_b16 v[96:97], v210 offset:2048
    v_mfma_f32_16x16x32_bf16 v[40:43], v[116:119], a[68:71], v[40:43]
    ds_read_b64_tr_b16 v[98:99], v210 offset:6144
    v_mfma_f32_16x16x32_bf16 v[88:91], v[116:119], a[76:79], v[88:91]
    ds_read_b64_tr_b16 v[100:101], v210 offset:10240
    v_mfma_f32_16x16x32_bf16 v[88:91], v[112:115], a[72:75], v[88:91]
    ds_read_b64_tr_b16 v[102:103], v210 offset:14336
    s_waitcnt lgkmcnt(12)
    v_mfma_f32_16x16x32_bf16 v[44:47], v[120:123], a[64:67], v[44:47]
    ds_read_b64_tr_b16 v[104:105], v211 offset:2048
    v_mfma_f32_16x16x32_bf16 v[44:47], v[124:127], a[68:71], v[44:47]
    ds_read_b64_tr_b16 v[106:107], v211 offset:6144
    v_mfma_f32_16x16x32_bf16 v[92:95], v[124:127], a[76:79], v[92:95]
    ds_read_b64_tr_b16 v[108:109], v211 offset:10240
    v_mfma_f32_16x16x32_bf16 v[92:95], v[120:123], a[72:75], v[92:95]
    ds_read_b64_tr_b16 v[110:111], v211 offset:14336
    s_waitcnt lgkmcnt(12)
    v_mfma_f32_16x16x32_bf16 v[32:35], v[128:131], a[80:83], v[32:35]
    s_waitcnt vmcnt(6)
    s_barrier
    ds_read_b64_tr_b16 v[112:113], v208 offset:16384
    s_cmp_lg_u32 s3, 0
    s_cbranch_scc1 L_nosend1
    s_mov_b64 exec, 0xffff
    buffer_store_dword v243, v242, s[16:19], s59 offen sc1
    s_mov_b64 exec, -1
L_nosend1:
    v_mfma_f32_16x16x32_bf16 v[32:35], v[132:135], a[84:87], v[32:35]
    ds_read_b64_tr_b16 v[114:115], v208 offset:20480
    v_mfma_f32_16x16x32_bf16 v[80:83], v[132:135], a[92:95], v[80:83]
    ds_read_b64_tr_b16 v[116:117], v208 offset:24576
    v_mfma_f32_16x16x32_bf16 v[80:83], v[128:131], a[88:91], v[80:83]
    ds_read_b64_tr_b16 v[118:119], v208 offset:28672
    s_waitcnt lgkmcnt(12)
    v_mfma_f32_16x16x32_bf16 v[36:39], v[136:139], a[80:83], v[36:39]
    ds_read_b64_tr_b16 v[120:121], v209 offset:16384
    v_mfma_f32_16x16x32_bf16 v[36:39], v[140:143], a[84:87], v[36:39]
    ds_read_b64_tr_b16 v[122:123], v209 offset:20480
    v_mfma_f32_16x16x32_bf16 v[84:87], v[140:143], a[92:95], v[84:87]
    ds_read_b64_tr_b16 v[124:125], v209 offset:24576
    v_mfma_f32_16x16x32_bf16 v[84:87], v[136:139], a[88:91], v[84:87]
    ds_read_b64_tr_b16 v[126:127], v209 offset:28672
    s_waitcnt lgkmcnt(12)
    v_mfma_f32_16x16x32_bf16 v[40:43], v[96:99], a[80:83], v[40:43]
    ds_read_b64_tr_b16 v[128:129], v210 offset:16384
    v_mfma_f32_16x16x32_bf16 v[40:43], v[100:103], a[84:87], v[40:43]
    ds_read_b64_tr_b16 v[130:131], v210 offset:20480
    v_mfma_f32_16x16x32_bf16 v[88:91], v[100:103], a[92:95], v[88:91]
    ds_read_b64_tr_b16 v[132:133], v210 offset:24576
    v_mfma_f32_16x16x32_bf16 v[88:91], v[96:99], a[88:91], v[88:91]
    ds_read_b64_tr_b16 v[134:135], v210 offset:28672
    s_waitcnt lgkmcnt(12)
    v_mfma_f32_16x16x32_bf16 v[44:47], v[104:107], a[80:83], v[44:47]
    ds_read_b64_tr_b16 v[136:137], v211 offset:16384
    v_mfma_f32_16x16x32_bf16 v[44:47], v[108:111], a[84:87], v[44:47]
    ds_read_b64_tr_b16 v[138:139], v211 offset:20480
    v_mfma_f32_16x16x32_bf16 v[92:95], v[108:111], a[92:95], v[92:95]
    ds_read_b64_tr_b16 v[140:141], v211 offset:24576
    v_mfma_f32_16x16x32_bf16 v[92:95], v[104:107], a[88:91], v[92:95]
    ds_read_b64_tr_b16 v[142:143], v211 offset:28672
    s_waitcnt lgkmcnt(12)
    v_mfma_f32_16x16x32_bf16 v[32:35], v[112:115], a[96:99], v[32:35]
    ds_read_b64_tr_b16 v[96:97], v208 offset:18432
    v_mfma_f32_16x16x32_bf16 v[32:35], v[116:119], a[100:103], v[32:35]
    ds_read_b64_tr_b16 v[98:99], v208 offset:22528
    v_mfma_f32_16x16x32_bf16 v[80:83], v[116:119], a[108:111], v[80:83]
    ds_read_b64_tr_b16 v[100:101], v208 offset:26624
    v_mfma_f32_16x16x32_bf16 v[80:83], v[112:115], a[104:107], v[80:83]
    ds_read_b64_tr_b16 v[102:103], v208 offset:30720
    s_waitcnt lgkmcnt(12)
    v_mfma_f32_16x16x32_bf16 v[36:39], v[120:123], a[96:99], v[36:39]
    ds_read_b64_tr_b16 v[104:105], v209 offset:18432
    v_mfma_f32_16x16x32_bf16 v[36:39], v[124:127], a[100:103], v[36:39]
    ds_read_b64_tr_b16 v[106:107], v209 offset:22528
    v_mfma_f32_16x16x32_bf16 v[84:87], v[124:127], a[108:111], v[84:87]
    ds_read_b64_tr_b16 v[108:109], v209 offset:26624
    v_mfma_f32_16x16x32_bf16 v[84:87], v[120:123], a[104:107], v[84:87]
    ds_read_b64_tr_b16 v[110:111], v209 offset:30720
    s_waitcnt lgkmcnt(12)
    v_mfma_f32_16x16x32_bf16 v[40:43], v[128:131], a[96:99], v[40:43]
    ds_read_b64_tr_b16 v[112:113], v210 offset:18432
    v_mfma_f32_16x16x32_bf16 v[40:43], v[132:135], a[100:103], v[40:43]
    ds_read_b64_tr_b16 v[114:115], v210 offset:22528
    v_mfma_f32_16x16x32_bf16 v[88:91], v[132:135], a[108:111], v[88:91]
    ds_read_b64_tr_b16 v[116:117], v210 offset:26624
    v_mfma_f32_16x16x32_bf16 v[88:91], v[128:131], a[104:107], v[88:91]
    ds_read_b64_tr_b16 v[118:119], v210 offset:30720
    s_waitcnt lgkmcnt(12)
    v_mfma_f32_16x16x32_bf16 v[44:47], v[136:139], a[96:99], v[44:47]
    ds_read_b64_tr_b16 v[120:121], v211 offset:18432
    v_mfma_f32_16x16x32_bf16 v[44:47], v[140:143], a[100:103], v[44:47]
    ds_read_b64_tr_b16 v[122:123], v211 offset:22528
    v_mfma_f32_16x16x32_bf16 v[92:95], v[140:143], a[108:111], v[92:95]
    ds_read_b64_tr_b16 v[124:125], v211 offset:26624
    v_mfma_f32_16x16x32_bf16 v[92:95], v[136:139], a[104:107], v[92:95]
    ds_read_b64_tr_b16 v[126:127], v211 offset:30720
    s_waitcnt lgkmcnt(12)
    v_mfma_f32_16x16x32_bf16 v[32:35], v[96:99], a[112:115], v[32:35]
    s_waitcnt vmcnt(23)
    s_barrier
    ds_read_b64_tr_b16 v[128:129], v208 offset:32768
    v_mfma_f32_16x16x32_bf16 v[32:35], v[100:103], a[116:119], v[32:35]
    ds_read_b64_tr_b16 v[130:131], v208 offset:36864
    v_mfma_f32_16x16x32_bf16 v[80:83], v[100:103], a[124:127], v[80:83]
    ds_read_b64_tr_b16 v[132:133], v208 offset:40960
    v_mfma_f32_16x16x32_bf16 v[80:83], v[96:99], a[120:123], v[80:83]
    ds_read_b64_tr_b16 v[134:135], v208 offset:45056
    s_waitcnt lgkmcnt(12)
    v_mfma_f32_16x16x32_bf16 v[36:39], v[104:107], a[112:115], v[36:39]
    ds_read_b64_tr_b16 v[136:137], v209 offset:32768
    v_mfma_f32_16x16x32_bf16 v[36:39], v[108:111], a[116:119], v[36:39]
    ds_read_b64_tr_b16 v[138:139], v209 offset:36864
    v_mfma_f32_16x16x32_bf16 v[84:87], v[108:111], a[124:127], v[84:87]
    ds_read_b64_tr_b16 v[140:141], v209 offset:40960
    v_mfma_f32_16x16x32_bf16 v[84:87], v[104:107], a[120:123], v[84:87]
    ds_read_b64_tr_b16 v[142:143], v209 offset:45056
    s_waitcnt lgkmcnt(12)
    v_mfma_f32_16x16x32_bf16 v[40:43], v[112:115], a[112:115], v[40:43]
    ds_read_b64_tr_b16 v[96:97], v210 offset:32768
    v_mfma_f32_16x16x32_bf16 v[40:43], v[116:119], a[116:119], v[40:43]
    ds_read_b64_tr_b16 v[98:99], v210 offset:36864
    v_mfma_f32_16x16x32_bf16 v[88:91], v[116:119], a[124:127], v[88:91]
    ds_read_b64_tr_b16 v[100:101], v210 offset:40960
    v_mfma_f32_16x16x32_bf16 v[88:91], v[112:115], a[120:123], v[88:91]
    ds_read_b64_tr_b16 v[102:103], v210 offset:45056
    s_waitcnt lgkmcnt(12)
    v_mfma_f32_16x16x32_bf16 v[44:47], v[120:123], a[112:115], v[44:47]
    ds_read_b64_tr_b16 v[104:105], v211 offset:32768
    v_mfma_f32_16x16x32_bf16 v[44:47], v[124:127], a[116:119], v[44:47]
    ds_read_b64_tr_b16 v[106:107], v211 offset:36864
    v_mfma_f32_16x16x32_bf16 v[92:95], v[124:127], a[124:127], v[92:95]
    ds_read_b64_tr_b16 v[108:109], v211 offset:40960
    v_mfma_f32_16x16x32_bf16 v[92:95], v[120:123], a[120:123], v[92:95]
    ds_read_b64_tr_b16 v[110:111], v211 offset:45056
    s_waitcnt lgkmcnt(12)
    v_mfma_f32_16x16x32_bf16 v[32:35], v[128:131], a[128:131], v[32:35]
    ds_read_b64_tr_b16 v[112:113], v208 offset:34816
    s_lshl_b32 s58, s40, 8
    v_mfma_f32_16x16x32_bf16 v[32:35], v[132:135], a[132:135], v[32:35]
    ds_read_b64_tr_b16 v[114:115], v208 offset:38912
    s_add_u32 s58, s58, 33619968
    v_mfma_f32_16x16x32_bf16 v[80:83], v[132:135], a[140:143], v[80:83]
    ds_read_b64_tr_b16 v[116:117], v208 offset:43008
    v_and_b32 v242, 15, v255
    v_mfma_f32_16x16x32_bf16 v[80:83], v[128:131], a[136:139], v[80:83]
    ds_read_b64_tr_b16 v[118:119], v208 offset:47104
    s_waitcnt lgkmcnt(12)
    v_mfma_f32_16x16x32_bf16 v[36:39], v[136:139], a[128:131], v[36:39]
    ds_read_b64_tr_b16 v[120:121], v209 offset:34816
    v_lshlrev_b32 v242, 2, v242
    v_mfma_f32_16x16x32_bf16 v[36:39], v[140:143], a[132:135], v[36:39]
    ds_read_b64_tr_b16 v[122:123], v209 offset:38912
    buffer_load_dword v243, v242, s[16:19], s58 offen sc1
    v_mfma_f32_16x16x32_bf16 v[84:87], v[140:143], a[140:143], v[84:87]
    ds_read_b64_tr_b16 v[124:125], v209 offset:43008
    v_mfma_f32_16x16x32_bf16 v[84:87], v[136:139], a[136:139], v[84:87]
    ds_read_b64_tr_b16 v[126:127], v209 offset:47104
    s_waitcnt lgkmcnt(12)
    v_mfma_f32_16x16x32_bf16 v[40:43], v[96:99], a[128:131], v[40:43]
    ds_read_b64_tr_b16 v[128:129], v210 offset:34816
    v_mfma_f32_16x16x32_bf16 v[40:43], v[100:103], a[132:135], v[40:43]
    ds_read_b64_tr_b16 v[130:131], v210 offset:38912
    v_mfma_f32_16x16x32_bf16 v[88:91], v[100:103], a[140:143], v[88:91]
    ds_read_b64_tr_b16 v[132:133], v210 offset:43008
    v_mfma_f32_16x16x32_bf16 v[88:91], v[96:99], a[136:139], v[88:91]
    ds_read_b64_tr_b16 v[134:135], v210 offset:47104
    s_waitcnt lgkmcnt(12)
    v_mfma_f32_16x16x32_bf16 v[44:47], v[104:107], a[128:131], v[44:47]
    ds_read_b64_tr_b16 v[136:137], v211 offset:34816
    v_mfma_f32_16x16x32_bf16 v[44:47], v[108:111], a[132:135], v[44:47]
    ds_read_b64_tr_b16 v[138:139], v211 offset:38912
    v_mfma_f32_16x16x32_bf16 v[92:95], v[108:111], a[140:143], v[92:95]
    ds_read_b64_tr_b16 v[140:141], v211 offset:43008
    v_mfma_f32_16x16x32_bf16 v[92:95], v[104:107], a[136:139], v[92:95]
    ds_read_b64_tr_b16 v[142:143], v211 offset:47104
    s_waitcnt lgkmcnt(12)
    v_mfma_f32_16x16x32_bf16 v[32:35], v[112:115], a[144:147], v[32:35]
    s_waitcnt vmcnt(20)
    s_barrier
    ds_read_b64_tr_b16 v[96:97], v208 offset:49152
    v_mfma_f32_16x16x32_bf16 v[32:35], v[116:119], a[148:151], v[32:35]
    ds_read_b64_tr_b16 v[98:99], v208 offset:53248
    v_mfma_f32_16x16x32_bf16 v[80:83], v[116:119], a[156:159], v[80:83]
    ds_read_b64_tr_b16 v[100:101], v208 offset:57344
    v_mfma_f32_16x16x32_bf16 v[80:83], v[112:115], a[152:155], v[80:83]
    ds_read_b64_tr_b16 v[102:103], v208 offset:61440
    s_waitcnt lgkmcnt(12)
    v_mfma_f32_16x16x32_bf16 v[36:39], v[120:123], a[144:147], v[36:39]
    ds_read_b64_tr_b16 v[104:105], v209 offset:49152
    v_mfma_f32_16x16x32_bf16 v[36:39], v[124:127], a[148:151], v[36:39]
    ds_read_b64_tr_b16 v[106:107], v209 offset:53248
    v_mfma_f32_16x16x32_bf16 v[84:87], v[124:127], a[156:159], v[84:87]
    ds_read_b64_tr_b16 v[108:109], v209 offset:57344
    v_mfma_f32_16x16x32_bf16 v[84:87], v[120:123], a[152:155], v[84:87]
    ds_read_b64_tr_b16 v[110:111], v209 offset:61440
    s_waitcnt lgkmcnt(12)
    v_mfma_f32_16x16x32_bf16 v[40:43], v[128:131], a[144:147], v[40:43]
    ds_read_b64_tr_b16 v[112:113], v210 offset:49152
    v_mfma_f32_16x16x32_bf16 v[40:43], v[132:135], a[148:151], v[40:43]
    ds_read_b64_tr_b16 v[114:115], v210 offset:53248
    v_mfma_f32_16x16x32_bf16 v[88:91], v[132:135], a[156:159], v[88:91]
    ds_read_b64_tr_b16 v[116:117], v210 offset:57344
    v_mfma_f32_16x16x32_bf16 v[88:91], v[128:131], a[152:155], v[88:91]
    ds_read_b64_tr_b16 v[118:119], v210 offset:61440
    s_waitcnt lgkmcnt(12)
    v_mfma_f32_16x16x32_bf16 v[44:47], v[136:139], a[144:147], v[44:47]
    ds_read_b64_tr_b16 v[120:121], v211 offset:49152
    v_mfma_f32_16x16x32_bf16 v[44:47], v[140:143], a[148:151], v[44:47]
    ds_read_b64_tr_b16 v[122:123], v211 offset:53248
    v_mfma_f32_16x16x32_bf16 v[92:95], v[140:143], a[156:159], v[92:95]
    ds_read_b64_tr_b16 v[124:125], v211 offset:57344
    v_mfma_f32_16x16x32_bf16 v[92:95], v[136:139], a[152:155], v[92:95]
    ds_read_b64_tr_b16 v[126:127], v211 offset:61440
    s_waitcnt vmcnt(0)
    v_cmp_ne_u32 vcc, s33, v243
    s_cmp_eq_u64 vcc, 0
    s_cbranch_scc1 L_polldone1
    s_lshl_b32 s58, s40, 8
    s_add_u32 s58, s58, 33619968
    v_and_b32 v242, 15, v255
    v_lshlrev_b32 v242, 2, v242
    s_mov_b32 s59, 0x20000
L_poll1:
    buffer_load_dword v243, v242, s[16:19], s58 offen sc1
    s_sub_u32 s59, s59, 1
    s_cbranch_scc1 L_polldone1
    s_waitcnt vmcnt(0)
    v_cmp_ne_u32 vcc, s33, v243
    s_cmp_lg_u64 vcc, 0
    s_cbranch_scc1 L_poll1
L_polldone1:
    s_waitcnt lgkmcnt(12)
    v_mfma_f32_16x16x32_bf16 v[32:35], v[96:99], a[160:163], v[32:35]
    ds_read_b64_tr_b16 v[128:129], v208 offset:51200
    s_mul_i32 s50, s28, 81920
    v_mfma_f32_16x16x32_bf16 v[32:35], v[100:103], a[164:167], v[32:35]
    ds_read_b64_tr_b16 v[130:131], v208 offset:55296
    s_add_u32 s50, s50, 29360128
    v_mfma_f32_16x16x32_bf16 v[80:83], v[100:103], a[172:175], v[80:83]
    ds_read_b64_tr_b16 v[132:133], v208 offset:59392
    s_mov_b32 s51, s50
    v_mfma_f32_16x16x32_bf16 v[80:83], v[96:99], a[168:171], v[80:83]
    ds_read_b64_tr_b16 v[134:135], v208 offset:63488
    s_waitcnt lgkmcnt(12)
    v_mfma_f32_16x16x32_bf16 v[36:39], v[104:107], a[160:163], v[36:39]
    ds_read_b64_tr_b16 v[136:137], v209 offset:51200
    buffer_load_dwordx4 v[144:147], v250, s[16:19], s51 offen sc1
    v_mfma_f32_16x16x32_bf16 v[36:39], v[108:111], a[164:167], v[36:39]
    ds_read_b64_tr_b16 v[138:139], v209 offset:55296
    s_add_u32 s51, s51, 5120
    v_mfma_f32_16x16x32_bf16 v[84:87], v[108:111], a[172:175], v[84:87]
    ds_read_b64_tr_b16 v[140:141], v209 offset:59392
    buffer_load_dwordx4 v[148:151], v250, s[16:19], s51 offen sc1
    v_mfma_f32_16x16x32_bf16 v[84:87], v[104:107], a[168:171], v[84:87]
    ds_read_b64_tr_b16 v[142:143], v209 offset:63488
    s_waitcnt lgkmcnt(12)
    v_mfma_f32_16x16x32_bf16 v[40:43], v[112:115], a[160:163], v[40:43]
    ds_read_b64_tr_b16 v[96:97], v210 offset:51200
    s_add_u32 s51, s51, 5120
    v_mfma_f32_16x16x32_bf16 v[40:43], v[116:119], a[164:167], v[40:43]
    ds_read_b64_tr_b16 v[98:99], v210 offset:55296
    v_mfma_f32_16x16x32_bf16 v[88:91], v[116:119], a[172:175], v[88:91]
    ds_read_b64_tr_b16 v[100:101], v210 offset:59392
    buffer_load_dwordx4 v[152:155], v250, s[16:19], s51 offen sc1
    v_mfma_f32_16x16x32_bf16 v[88:91], v[112:115], a[168:171], v[88:91]
    ds_read_b64_tr_b16 v[102:103], v210 offset:63488
    s_waitcnt lgkmcnt(12)
    v_mfma_f32_16x16x32_bf16 v[44:47], v[120:123], a[160:163], v[44:47]
    ds_read_b64_tr_b16 v[104:105], v211 offset:51200
    s_add_u32 s51, s51, 5120
    v_mfma_f32_16x16x32_bf16 v[44:47], v[124:127], a[164:167], v[44:47]
    ds_read_b64_tr_b16 v[106:107], v211 offset:55296
    v_mfma_f32_16x16x32_bf16 v[92:95], v[124:127], a[172:175], v[92:95]
    ds_read_b64_tr_b16 v[108:109], v211 offset:59392
    buffer_load_dwordx4 v[156:159], v250, s[16:19], s51 offen sc1
    v_mfma_f32_16x16x32_bf16 v[92:95], v[120:123], a[168:171], v[92:95]
    ds_read_b64_tr_b16 v[110:111], v211 offset:63488
    s_waitcnt lgkmcnt(12)
    v_mfma_f32_16x16x32_bf16 v[32:35], v[128:131], a[176:179], v[32:35]
    s_waitcnt vmcnt(20)
    s_barrier
    ds_read_b64_tr_b16 v[112:113], v212 offset:0
    v_mfma_f32_16x16x32_bf16 v[32:35], v[132:135], a[180:183], v[32:35]
    ds_read_b64_tr_b16 v[114:115], v212 offset:4096
    s_add_u32 s51, s51, 5120
    v_mfma_f32_16x16x32_bf16 v[80:83], v[132:135], a[188:191], v[80:83]
    ds_read_b64_tr_b16 v[116:117], v212 offset:8192
    v_mfma_f32_16x16x32_bf16 v[80:83], v[128:131], a[184:187], v[80:83]
    ds_read_b64_tr_b16 v[118:119], v212 offset:12288
    s_waitcnt lgkmcnt(12)
    v_mfma_f32_16x16x32_bf16 v[36:39], v[136:139], a[176:179], v[36:39]
    ds_read_b64_tr_b16 v[120:121], v213 offset:0
    buffer_load_dwordx4 v[160:163], v250, s[16:19], s51 offen sc1
    v_mfma_f32_16x16x32_bf16 v[36:39], v[140:143], a[180:183], v[36:39]
    ds_read_b64_tr_b16 v[122:123], v213 offset:4096
    s_add_u32 s51, s51, 5120
    v_mfma_f32_16x16x32_bf16 v[84:87], v[140:143], a[188:191], v[84:87]
    ds_read_b64_tr_b16 v[124:125], v213 offset:8192
    v_mfma_f32_16x16x32_bf16 v[84:87], v[136:139], a[184:187], v[84:87]
    ds_read_b64_tr_b16 v[126:127], v213 offset:12288
    s_waitcnt lgkmcnt(12)
    v_mfma_f32_16x16x32_bf16 v[40:43], v[96:99], a[176:179], v[40:43]
    ds_read_b64_tr_b16 v[128:129], v214 offset:0
    buffer_load_dwordx4 v[164:167], v250, s[16:19], s51 offen sc1
    v_mfma_f32_16x16x32_bf16 v[40:43], v[100:103], a[180:183], v[40:43]
    ds_read_b64_tr_b16 v[130:131], v214 offset:4096
    s_add_u32 s51, s51, 5120
    v_mfma_f32_16x16x32_bf16 v[88:91], v[100:103], a[188:191], v[88:91]
    ds_read_b64_tr_b16 v[132:133], v214 offset:8192
    v_mfma_f32_16x16x32_bf16 v[88:91], v[96:99], a[184:187], v[88:91]
    ds_read_b64_tr_b16 v[134:135], v214 offset:12288
    s_waitcnt lgkmcnt(12)
    v_mfma_f32_16x16x32_bf16 v[44:47], v[104:107], a[176:179], v[44:47]
    ds_read_b64_tr_b16 v[136:137], v215 offset:0
    buffer_load_dwordx4 v[168:171], v250, s[16:19], s51 offen sc1
    v_mfma_f32_16x16x32_bf16 v[44:47], v[108:111], a[180:183], v[44:47]
    ds_read_b64_tr_b16 v[138:139], v215 offset:4096
    s_add_u32 s51, s51, 5120
    v_mfma_f32_16x16x32_bf16 v[92:95], v[108:111], a[188:191], v[92:95]
    ds_read_b64_tr_b16 v[140:141], v215 offset:8192
    v_mfma_f32_16x16x32_bf16 v[92:95], v[104:107], a[184:187], v[92:95]
    ds_read_b64_tr_b16 v[142:143], v215 offset:12288
    s_waitcnt lgkmcnt(12)
    v_mfma_f32_16x16x32_bf16 v[32:35], v[112:115], a[192:195], v[32:35]
    ds_read_b64_tr_b16 v[96:97], v212 offset:2048
    buffer_load_dwordx4 v[172:175], v250, s[16:19], s51 offen sc1
    v_mfma_f32_16x16x32_bf16 v[32:35], v[116:119], a[196:199], v[32:35]
    ds_read_b64_tr_b16 v[98:99], v212 offset:6144
    s_add_u32 s51, s51, 5120
    v_mfma_f32_16x16x32_bf16 v[80:83], v[116:119], a[204:207], v[80:83]
    ds_read_b64_tr_b16 v[100:101], v212 offset:10240
    v_mfma_f32_16x16x32_bf16 v[80:83], v[112:115], a[200:203], v[80:83]
    ds_read_b64_tr_b16 v[102:103], v212 offset:14336
    s_waitcnt lgkmcnt(12)
    v_mfma_f32_16x16x32_bf16 v[36:39], v[120:123], a[192:195], v[36:39]
    ds_read_b64_tr_b16 v[104:105], v213 offset:2048
    buffer_load_dwordx4 v[176:179], v250, s[16:19], s51 offen sc1
    v_mfma_f32_16x16x32_bf16 v[36:39], v[124:127], a[196:199], v[36:39]
    ds_read_b64_tr_b16 v[106:107], v213 offset:6144
    s_add_u32 s51, s51, 5120
    v_mfma_f32_16x16x32_bf16 v[84:87], v[124:127], a[204:207], v[84:87]
    ds_read_b64_tr_b16 v[108:109], v213 offset:10240
    v_mfma_f32_16x16x32_bf16 v[84:87], v[120:123], a[200:203], v[84:87]
    ds_read_b64_tr_b16 v[110:111], v213 offset:14336
    s_waitcnt lgkmcnt(12)
    v_mfma_f32_16x16x32_bf16 v[40:43], v[128:131], a[192:195], v[40:43]
    ds_read_b64_tr_b16 v[112:113], v214 offset:2048
    buffer_load_dwordx4 v[180:183], v250, s[16:19], s51 offen sc1
    v_mfma_f32_16x16x32_bf16 v[40:43], v[132:135], a[196:199], v[40:43]
    ds_read_b64_tr_b16 v[114:115], v214 offset:6144
    s_add_u32 s51, s51, 5120
    v_mfma_f32_16x16x32_bf16 v[88:91], v[132:135], a[204:207], v[88:91]
    ds_read_b64_tr_b16 v[116:117], v214 offset:10240
    v_mfma_f32_16x16x32_bf16 v[88:91], v[128:131], a[200:203], v[88:91]
    ds_read_b64_tr_b16 v[118:119], v214 offset:14336
    s_waitcnt lgkmcnt(12)
    v_mfma_f32_16x16x32_bf16 v[44:47], v[136:139], a[192:195], v[44:47]
    ds_read_b64_tr_b16 v[120:121], v215 offset:2048
    buffer_load_dwordx4 v[184:187], v250, s[16:19], s51 offen sc1
    v_mfma_f32_16x16x32_bf16 v[44:47], v[140:143], a[196:199], v[44:47]
    ds_read_b64_tr_b16 v[122:123], v215 offset:6144
    s_add_u32 s51, s51, 5120
    v_mfma_f32_16x16x32_bf16 v[92:95], v[140:143], a[204:207], v[92:95]
    ds_read_b64_tr_b16 v[124:125], v215 offset:10240
    v_mfma_f32_16x16x32_bf16 v[92:95], v[136:139], a[200:203], v[92:95]
    ds_read_b64_tr_b16 v[126:127], v215 offset:14336
    s_waitcnt lgkmcnt(12)
    v_mfma_f32_16x16x32_bf16 v[32:35], v[96:99], a[208:211], v[32:35]
    s_waitcnt vmcnt(23)
    s_barrier
    ds_read_b64_tr_b16 v[128:129], v212 offset:16384
    v_mfma_f32_16x16x32_bf16 v[32:35], v[100:103], a[212:215], v[32:35]
    ds_read_b64_tr_b16 v[130:131], v212 offset:20480
    buffer_load_dwordx4 v[188:191], v250, s[16:19], s51 offen sc1
    v_mfma_f32_16x16x32_bf16 v[80:83], v[100:103], a[220:223], v[80:83]
    ds_read_b64_tr_b16 v[132:133], v212 offset:24576
    s_add_u32 s51, s51, 5120
    v_mfma_f32_16x16x32_bf16 v[80:83], v[96:99], a[216:219], v[80:83]
    ds_read_b64_tr_b16 v[134:135], v212 offset:28672
    s_waitcnt lgkmcnt(12)
    v_mfma_f32_16x16x32_bf16 v[36:39], v[104:107], a[208:211], v[36:39]
    ds_read_b64_tr_b16 v[136:137], v213 offset:16384
    v_mfma_f32_16x16x32_bf16 v[36:39], v[108:111], a[212:215], v[36:39]
    ds_read_b64_tr_b16 v[138:139], v213 offset:20480
    buffer_load_dwordx4 v[192:195], v250, s[16:19], s51 offen sc1
    v_mfma_f32_16x16x32_bf16 v[84:87], v[108:111], a[220:223], v[84:87]
    ds_read_b64_tr_b16 v[140:141], v213 offset:24576
    s_add_u32 s51, s51, 5120
    v_mfma_f32_16x16x32_bf16 v[84:87], v[104:107], a[216:219], v[84:87]
    ds_read_b64_tr_b16 v[142:143], v213 offset:28672
    s_waitcnt lgkmcnt(12)
    v_mfma_f32_16x16x32_bf16 v[40:43], v[112:115], a[208:211], v[40:43]
    ds_read_b64_tr_b16 v[96:97], v214 offset:16384
    v_mfma_f32_16x16x32_bf16 v[40:43], v[116:119], a[212:215], v[40:43]
    ds_read_b64_tr_b16 v[98:99], v214 offset:20480
    buffer_load_dwordx4 v[196:199], v250, s[16:19], s51 offen sc1
    v_mfma_f32_16x16x32_bf16 v[88:91], v[116:119], a[220:223], v[88:91]
    ds_read_b64_tr_b16 v[100:101], v214 offset:24576
    s_add_u32 s51, s51, 5120
    v_mfma_f32_16x16x32_bf16 v[88:91], v[112:115], a[216:219], v[88:91]
    ds_read_b64_tr_b16 v[102:103], v214 offset:28672
    s_waitcnt lgkmcnt(12)
    v_mfma_f32_16x16x32_bf16 v[44:47], v[120:123], a[208:211], v[44:47]
    ds_read_b64_tr_b16 v[104:105], v215 offset:16384
    v_mfma_f32_16x16x32_bf16 v[44:47], v[124:127], a[212:215], v[44:47]
    ds_read_b64_tr_b16 v[106:107], v215 offset:20480
    buffer_load_dwordx4 v[200:203], v250, s[16:19], s51 offen sc1
    v_mfma_f32_16x16x32_bf16 v[92:95], v[124:127], a[220:223], v[92:95]
    ds_read_b64_tr_b16 v[108:109], v215 offset:24576
    s_add_u32 s51, s51, 5120
    v_mfma_f32_16x16x32_bf16 v[92:95], v[120:123], a[216:219], v[92:95]
    ds_read_b64_tr_b16 v[110:111], v215 offset:28672
    s_waitcnt lgkmcnt(12)
    v_mfma_f32_16x16x32_bf16 v[32:35], v[128:131], a[224:227], v[32:35]
    ds_read_b64_tr_b16 v[112:113], v212 offset:18432
    v_mfma_f32_16x16x32_bf16 v[32:35], v[132:135], a[228:231], v[32:35]
    ds_read_b64_tr_b16 v[114:115], v212 offset:22528
    buffer_load_dwordx4 v[204:207], v250, s[16:19], s51 offen sc1
    v_mfma_f32_16x16x32_bf16 v[80:83], v[132:135], a[236:239], v[80:83]
    ds_read_b64_tr_b16 v[116:117], v212 offset:26624
    s_add_u32 s51, s51, 5120
    v_mfma_f32_16x16x32_bf16 v[80:83], v[128:131], a[232:235], v[80:83]
    ds_read_b64_tr_b16 v[118:119], v212 offset:30720
    s_waitcnt lgkmcnt(12)
    v_mfma_f32_16x16x32_bf16 v[36:39], v[136:139], a[224:227], v[36:39]
    ds_read_b64_tr_b16 v[120:121], v213 offset:18432
    v_mfma_f32_16x16x32_bf16 v[36:39], v[140:143], a[228:231], v[36:39]
    ds_read_b64_tr_b16 v[122:123], v213 offset:22528
    buffer_load_dwordx4 v[0:3], v252, s[16:19], s50 offen sc1
    v_mfma_f32_16x16x32_bf16 v[84:87], v[140:143], a[236:239], v[84:87]
    ds_read_b64_tr_b16 v[124:125], v213 offset:26624
    v_mfma_f32_16x16x32_bf16 v[84:87], v[136:139], a[232:235], v[84:87]
    ds_read_b64_tr_b16 v[126:127], v213 offset:30720
    s_waitcnt lgkmcnt(12)
    v_mfma_f32_16x16x32_bf16 v[40:43], v[96:99], a[224:227], v[40:43]
    ds_read_b64_tr_b16 v[128:129], v214 offset:18432
    v_mfma_f32_16x16x32_bf16 v[40:43], v[100:103], a[228:231], v[40:43]
    ds_read_b64_tr_b16 v[130:131], v214 offset:22528
    buffer_load_dwordx4 v[4:7], v252, s[16:19], s50 offen offset:16 sc1
    v_mfma_f32_16x16x32_bf16 v[88:91], v[100:103], a[236:239], v[88:91]
    ds_read_b64_tr_b16 v[132:133], v214 offset:26624
    v_mfma_f32_16x16x32_bf16 v[88:91], v[96:99], a[232:235], v[88:91]
    ds_read_b64_tr_b16 v[134:135], v214 offset:30720
    s_waitcnt lgkmcnt(12)
    v_mfma_f32_16x16x32_bf16 v[44:47], v[104:107], a[224:227], v[44:47]
    ds_read_b64_tr_b16 v[136:137], v215 offset:18432
    v_mfma_f32_16x16x32_bf16 v[44:47], v[108:111], a[228:231], v[44:47]
    ds_read_b64_tr_b16 v[138:139], v215 offset:22528
    buffer_load_dwordx4 v[48:51], v253, s[16:19], s50 offen sc1
    v_mfma_f32_16x16x32_bf16 v[92:95], v[108:111], a[236:239], v[92:95]
    ds_read_b64_tr_b16 v[140:141], v215 offset:26624
    s_add_u32 s50, s50, 20480
    v_mfma_f32_16x16x32_bf16 v[92:95], v[104:107], a[232:235], v[92:95]
    ds_read_b64_tr_b16 v[142:143], v215 offset:30720
    s_waitcnt lgkmcnt(12)
    v_mfma_f32_16x16x32_bf16 v[32:35], v[112:115], a[240:243], v[32:35]
    v_mfma_f32_16x16x32_bf16 v[32:35], v[116:119], a[244:247], v[32:35]
    buffer_load_dwordx4 v[52:55], v253, s[16:19], s50 offen sc1
    v_mfma_f32_16x16x32_bf16 v[80:83], v[116:119], a[252:255], v[80:83]
    s_add_u32 s50, s50, 20480
    v_mfma_f32_16x16x32_bf16 v[80:83], v[112:115], a[248:251], v[80:83]
    s_waitcnt lgkmcnt(8)
    v_mfma_f32_16x16x32_bf16 v[36:39], v[120:123], a[240:243], v[36:39]
    buffer_load_dwordx4 v[56:59], v253, s[16:19], s50 offen sc1
    v_mfma_f32_16x16x32_bf16 v[36:39], v[124:127], a[244:247], v[36:39]
    s_add_u32 s50, s50, 20480
    v_mfma_f32_16x16x32_bf16 v[84:87], v[124:127], a[252:255], v[84:87]
    buffer_load_dwordx4 v[60:63], v253, s[16:19], s50 offen sc1
    v_mfma_f32_16x16x32_bf16 v[84:87], v[120:123], a[248:251], v[84:87]
    s_add_u32 s50, s50, 20480
    s_waitcnt lgkmcnt(4)
    v_mfma_f32_16x16x32_bf16 v[40:43], v[128:131], a[240:243], v[40:43]
    v_mfma_f32_16x16x32_bf16 v[40:43], v[132:135], a[244:247], v[40:43]
    v_mfma_f32_16x16x32_bf16 v[88:91], v[132:135], a[252:255], v[88:91]
    v_mfma_f32_16x16x32_bf16 v[88:91], v[128:131], a[248:251], v[88:91]
    s_waitcnt lgkmcnt(0)
    v_mfma_f32_16x16x32_bf16 v[44:47], v[136:139], a[240:243], v[44:47]
    v_mfma_f32_16x16x32_bf16 v[44:47], v[140:143], a[244:247], v[44:47]
    v_mfma_f32_16x16x32_bf16 v[92:95], v[140:143], a[252:255], v[92:95]
    v_mfma_f32_16x16x32_bf16 v[92:95], v[136:139], a[248:251], v[92:95]
    s_mov_b32 s52, 0x00003f80
    s_mov_b32 s53, 0x3f800000
    v_pk_mul_f32 v[8:9], v[32:33], s[34:35]
    v_pk_mul_f32 v[10:11], v[34:35], s[34:35]
    v_pk_mul_f32 v[12:13], v[36:37], s[34:35]
    v_pk_mul_f32 v[14:15], v[38:39], s[34:35]
    v_exp_f32_e64 v8, v8 clamp
    v_exp_f32_e64 v9, v9 clamp
    v_pk_add_f32 v[32:33], v[32:33], 1.0 op_sel_hi:[1,0]
    v_exp_f32_e64 v10, v10 clamp
    v_exp_f32_e64 v11, v11 clamp
    v_pk_add_f32 v[34:35], v[34:35], 1.0 op_sel_hi:[1,0]
    v_exp_f32_e64 v12, v12 clamp
    v_exp_f32_e64 v13, v13 clamp
    v_pk_add_f32 v[36:37], v[36:37], 1.0 op_sel_hi:[1,0]
    v_exp_f32_e64 v14, v14 clamp
    v_exp_f32_e64 v15, v15 clamp
    v_pk_add_f32 v[38:39], v[38:39], 1.0 op_sel_hi:[1,0]
    v_max_f32 v32, v32, v8
    s_add_u32 m0, s22, 114688
    s_add_u32 s84, s68, 262144
    s_addc_u32 s85, s69, 0
    buffer_load_dwordx4 v220, s[84:87], 0 offen offset:0 lds
    v_max_f32 v33, v33, v9
    v_max_f32 v34, v34, v10
    v_max_f32 v35, v35, v11
    v_max_f32 v36, v36, v12
    v_max_f32 v37, v37, v13
    v_max_f32 v38, v38, v14
    v_max_f32 v39, v39, v15
    v_pk_add_f32 v[32:33], v[32:33], s[36:37]
    v_pk_add_f32 v[34:35], v[34:35], s[36:37]
    v_pk_add_f32 v[36:37], v[36:37], s[36:37]
    v_pk_add_f32 v[38:39], v[38:39], s[36:37]
    v_cvt_pk_bf16_f32 v64, v32, v33
    v_cvt_pk_bf16_f32 v65, v34, v35
    v_cvt_pk_bf16_f32 v66, v36, v37
    v_cvt_pk_bf16_f32 v67, v38, v39
    v_pk_mul_f32 v[8:9], v[40:41], s[34:35]
    v_pk_mul_f32 v[10:11], v[42:43], s[34:35]
    buffer_load_dwordx4 v221, s[84:87], 0 offen offset:1024 lds
    v_pk_mul_f32 v[12:13], v[44:45], s[34:35]
    v_pk_mul_f32 v[14:15], v[46:47], s[34:35]
    v_exp_f32_e64 v8, v8 clamp
    v_exp_f32_e64 v9, v9 clamp
    v_pk_add_f32 v[40:41], v[40:41], 1.0 op_sel_hi:[1,0]
    v_exp_f32_e64 v10, v10 clamp
    v_exp_f32_e64 v11, v11 clamp
    v_pk_add_f32 v[42:43], v[42:43], 1.0 op_sel_hi:[1,0]
    v_exp_f32_e64 v12, v12 clamp
    v_exp_f32_e64 v13, v13 clamp
    v_pk_add_f32 v[44:45], v[44:45], 1.0 op_sel_hi:[1,0]
    v_exp_f32_e64 v14, v14 clamp
    v_exp_f32_e64 v15, v15 clamp
    v_pk_add_f32 v[46:47], v[46:47], 1.0 op_sel_hi:[1,0]
    v_max_f32 v40, v40, v8
    v_max_f32 v41, v41, v9
    v_max_f32 v42, v42, v10
    buffer_load_dwordx4 v230, s[84:87], 0 offen offset:2048 lds
    v_max_f32 v43, v43, v11
    v_max_f32 v44, v44, v12
    v_max_f32 v45, v45, v13
    v_max_f32 v46, v46, v14
    v_max_f32 v47, v47, v15
    v_pk_add_f32 v[40:41], v[40:41], s[36:37]
    v_pk_add_f32 v[42:43], v[42:43], s[36:37]
    v_pk_add_f32 v[44:45], v[44:45], s[36:37]
    v_pk_add_f32 v[46:47], v[46:47], s[36:37]
    v_cvt_pk_bf16_f32 v68, v40, v41
    v_cvt_pk_bf16_f32 v69, v42, v43
    v_cvt_pk_bf16_f32 v70, v44, v45
    v_cvt_pk_bf16_f32 v71, v46, v47
    v_pk_mul_f32 v[8:9], v[80:81], s[34:35]
    v_pk_mul_f32 v[10:11], v[82:83], s[34:35]
    v_pk_mul_f32 v[12:13], v[84:85], s[34:35]
    v_pk_mul_f32 v[14:15], v[86:87], s[34:35]
    buffer_load_dwordx4 v231, s[84:87], 0 offen offset:3072 lds
    v_exp_f32_e64 v8, v8 clamp
    v_exp_f32_e64 v9, v9 clamp
    v_pk_add_f32 v[80:81], v[80:81], 1.0 op_sel_hi:[1,0]
    v_exp_f32_e64 v10, v10 clamp
    v_exp_f32_e64 v11, v11 clamp
    v_pk_add_f32 v[82:83], v[82:83], 1.0 op_sel_hi:[1,0]
    v_exp_f32_e64 v12, v12 clamp
    v_exp_f32_e64 v13, v13 clamp
    v_pk_add_f32 v[84:85], v[84:85], 1.0 op_sel_hi:[1,0]
    v_exp_f32_e64 v14, v14 clamp
    v_exp_f32_e64 v15, v15 clamp
    v_pk_add_f32 v[86:87], v[86:87], 1.0 op_sel_hi:[1,0]
    v_max_f32 v80, v80, v8
    v_max_f32 v81, v81, v9
    v_max_f32 v82, v82, v10
    v_max_f32 v83, v83, v11
    v_max_f32 v84, v84, v12
    s_add_u32 m0, s22, 131072
    s_add_u32 s84, s68, 524288
    s_addc_u32 s85, s69, 0
    buffer_load_dwordx4 v220, s[84:87], 0 offen offset:0 lds
    v_max_f32 v85, v85, v13
    v_max_f32 v86, v86, v14
    v_max_f32 v87, v87, v15
    v_pk_add_f32 v[80:81], v[80:81], s[36:37]
    v_pk_add_f32 v[82:83], v[82:83], s[36:37]
    v_pk_add_f32 v[84:85], v[84:85], s[36:37]
    v_pk_add_f32 v[86:87], v[86:87], s[36:37]
    v_cvt_pk_bf16_f32 v72, v80, v81
    v_cvt_pk_bf16_f32 v73, v82, v83
    v_cvt_pk_bf16_f32 v74, v84, v85
    v_cvt_pk_bf16_f32 v75, v86, v87
    v_pk_mul_f32 v[8:9], v[88:89], s[34:35]
    v_pk_mul_f32 v[10:11], v[90:91], s[34:35]
    v_pk_mul_f32 v[12:13], v[92:93], s[34:35]
    v_pk_mul_f32 v[14:15], v[94:95], s[34:35]
    v_exp_f32_e64 v8, v8 clamp
    v_exp_f32_e64 v9, v9 clamp
    buffer_load_dwordx4 v221, s[84:87], 0 offen offset:1024 lds
    v_pk_add_f32 v[88:89], v[88:89], 1.0 op_sel_hi:[1,0]
    v_exp_f32_e64 v10, v10 clamp
    v_exp_f32_e64 v11, v11 clamp
    v_pk_add_f32 v[90:91], v[90:91], 1.0 op_sel_hi:[1,0]
    v_exp_f32_e64 v12, v12 clamp
    v_exp_f32_e64 v13, v13 clamp
    v_pk_add_f32 v[92:93], v[92:93], 1.0 op_sel_hi:[1,0]
    v_exp_f32_e64 v14, v14 clamp
    v_exp_f32_e64 v15, v15 clamp
    v_pk_add_f32 v[94:95], v[94:95], 1.0 op_sel_hi:[1,0]
    v_max_f32 v88, v88, v8
    v_max_f32 v89, v89, v9
    v_max_f32 v90, v90, v10
    v_max_f32 v91, v91, v11
    v_max_f32 v92, v92, v12
    v_max_f32 v93, v93, v13
    v_max_f32 v94, v94, v14
    buffer_load_dwordx4 v230, s[84:87], 0 offen offset:2048 lds
    v_max_f32 v95, v95, v15
    v_pk_add_f32 v[88:89], v[88:89], s[36:37]
    v_pk_add_f32 v[90:91], v[90:91], s[36:37]
    v_pk_add_f32 v[92:93], v[92:93], s[36:37]
    v_pk_add_f32 v[94:95], v[94:95], s[36:37]
    v_cvt_pk_bf16_f32 v76, v88, v89
    v_cvt_pk_bf16_f32 v77, v90, v91
    v_cvt_pk_bf16_f32 v78, v92, v93
    v_cvt_pk_bf16_f32 v79, v94, v95
    s_waitcnt vmcnt(28)
    v_lshlrev_b32 v16, 16, v144
    v_and_b32 v17, 0xffff0000, v144
    v_lshlrev_b32 v18, 16, v145
    v_and_b32 v19, 0xffff0000, v145
    v_lshlrev_b32 v20, 16, v146
    v_and_b32 v21, 0xffff0000, v146
    v_lshlrev_b32 v22, 16, v147
    buffer_load_dwordx4 v231, s[84:87], 0 offen offset:3072 lds
    v_and_b32 v23, 0xffff0000, v147
    s_waitcnt vmcnt(28)
    v_dot2c_f32_bf16 v16, s52, v148
    v_dot2c_f32_bf16 v17, s53, v148
    v_dot2c_f32_bf16 v18, s52, v149
    v_dot2c_f32_bf16 v19, s53, v149
    v_dot2c_f32_bf16 v20, s52, v150
    v_dot2c_f32_bf16 v21, s53, v150
    v_dot2c_f32_bf16 v22, s52, v151
    v_dot2c_f32_bf16 v23, s53, v151
    s_waitcnt vmcnt(27)
    v_dot2c_f32_bf16 v16, s52, v152
    v_dot2c_f32_bf16 v17, s53, v152
    v_dot2c_f32_bf16 v18, s52, v153
    v_dot2c_f32_bf16 v19, s53, v153
    v_dot2c_f32_bf16 v20, s52, v154
    v_dot2c_f32_bf16 v21, s53, v154
    s_add_u32 m0, s22, 0
    s_add_u32 s84, s68, 786432
    s_addc_u32 s85, s69, 0
    buffer_load_dwordx4 v220, s[84:87], 0 offen offset:0 lds
    v_dot2c_f32_bf16 v22, s52, v155
    v_dot2c_f32_bf16 v23, s53, v155
    s_waitcnt vmcnt(27)
    v_dot2c_f32_bf16 v16, s52, v156
    v_dot2c_f32_bf16 v17, s53, v156
    v_dot2c_f32_bf16 v18, s52, v157
    v_dot2c_f32_bf16 v19, s53, v157
    v_dot2c_f32_bf16 v20, s52, v158
    v_dot2c_f32_bf16 v21, s53, v158
    v_dot2c_f32_bf16 v22, s52, v159
    v_dot2c_f32_bf16 v23, s53, v159
    s_waitcnt vmcnt(26)
    v_dot2c_f32_bf16 v16, s52, v160
    v_dot2c_f32_bf16 v17, s53, v160
    v_dot2c_f32_bf16 v18, s52, v161
    v_dot2c_f32_bf16 v19, s53, v161
    v_dot2c_f32_bf16 v20, s52, v162
    buffer_load_dwordx4 v221, s[84:87], 0 offen offset:1024 lds
    v_dot2c_f32_bf16 v21, s53, v162
    v_dot2c_f32_bf16 v22, s52, v163
    v_dot2c_f32_bf16 v23, s53, v163
    s_waitcnt vmcnt(26)
    v_dot2c_f32_bf16 v16, s52, v164
    v_dot2c_f32_bf16 v17, s53, v164
    v_dot2c_f32_bf16 v18, s52, v165
    v_dot2c_f32_bf16 v19, s53, v165
    v_dot2c_f32_bf16 v20, s52, v166
    v_dot2c_f32_bf16 v21, s53, v166
    v_dot2c_f32_bf16 v22, s52, v167
    v_dot2c_f32_bf16 v23, s53, v167
    s_waitcnt vmcnt(25)
    v_dot2c_f32_bf16 v16, s52, v168
    v_dot2c_f32_bf16 v17, s53, v168
    v_dot2c_f32_bf16 v18, s52, v169
    v_dot2c_f32_bf16 v19, s53, v169
    buffer_load_dwordx4 v230, s[84:87], 0 offen offset:2048 lds
    v_dot2c_f32_bf16 v20, s52, v170
    v_dot2c_f32_bf16 v21, s53, v170
    v_dot2c_f32_bf16 v22, s52, v171
    v_dot2c_f32_bf16 v23, s53, v171
    s_waitcnt vmcnt(25)
    v_dot2c_f32_bf16 v16, s52, v172
    v_dot2c_f32_bf16 v17, s53, v172
    v_dot2c_f32_bf16 v18, s52, v173
    v_dot2c_f32_bf16 v19, s53, v173
    v_dot2c_f32_bf16 v20, s52, v174
    v_dot2c_f32_bf16 v21, s53, v174
    v_dot2c_f32_bf16 v22, s52, v175
    v_dot2c_f32_bf16 v23, s53, v175
    s_waitcnt vmcnt(24)
    v_dot2c_f32_bf16 v16, s52, v176
    v_dot2c_f32_bf16 v17, s53, v176
    v_dot2c_f32_bf16 v18, s52, v177
    buffer_load_dwordx4 v231, s[84:87], 0 offen offset:3072 lds
    v_dot2c_f32_bf16 v19, s53, v177
    v_dot2c_f32_bf16 v20, s52, v178
    v_dot2c_f32_bf16 v21, s53, v178
    v_dot2c_f32_bf16 v22, s52, v179
    v_dot2c_f32_bf16 v23, s53, v179
    s_waitcnt vmcnt(24)
    v_dot2c_f32_bf16 v16, s52, v180
    v_dot2c_f32_bf16 v17, s53, v180
    v_dot2c_f32_bf16 v18, s52, v181
    v_dot2c_f32_bf16 v19, s53, v181
    v_dot2c_f32_bf16 v20, s52, v182
    v_dot2c_f32_bf16 v21, s53, v182
    v_dot2c_f32_bf16 v22, s52, v183
    v_dot2c_f32_bf16 v23, s53, v183
    s_waitcnt vmcnt(23)
    v_dot2c_f32_bf16 v16, s52, v184
    v_dot2c_f32_bf16 v17, s53, v184
    s_add_u32 m0, s22, 16384
    s_add_u32 s84, s68, 1048576
    s_addc_u32 s85, s69, 0
    buffer_load_dwordx4 v220, s[84:87], 0 offen offset:0 lds
    v_dot2c_f32_bf16 v18, s52, v185
    v_dot2c_f32_bf16 v19, s53, v185
    v_dot2c_f32_bf16 v20, s52, v186
    v_dot2c_f32_bf16 v21, s53, v186
    v_dot2c_f32_bf16 v22, s52, v187
    v_dot2c_f32_bf16 v23, s53, v187
    s_waitcnt vmcnt(23)
    v_dot2c_f32_bf16 v16, s52, v188
    v_dot2c_f32_bf16 v17, s53, v188
    v_dot2c_f32_bf16 v18, s52, v189
    v_dot2c_f32_bf16 v19, s53, v189
    v_dot2c_f32_bf16 v20, s52, v190
    v_dot2c_f32_bf16 v21, s53, v190
    v_dot2c_f32_bf16 v22, s52, v191
    v_dot2c_f32_bf16 v23, s53, v191
    s_waitcnt vmcnt(22)
    v_dot2c_f32_bf16 v16, s52, v192
    buffer_load_dwordx4 v221, s[84:87], 0 offen offset:1024 lds
    v_dot2c_f32_bf16 v17, s53, v192
    v_dot2c_f32_bf16 v18, s52, v193
    v_dot2c_f32_bf16 v19, s53, v193
    v_dot2c_f32_bf16 v20, s52, v194
    v_dot2c_f32_bf16 v21, s53, v194
    v_dot2c_f32_bf16 v22, s52, v195
    v_dot2c_f32_bf16 v23, s53, v195
    s_waitcnt vmcnt(22)
    v_dot2c_f32_bf16 v16, s52, v196
    v_dot2c_f32_bf16 v17, s53, v196
    v_dot2c_f32_bf16 v18, s52, v197
    v_dot2c_f32_bf16 v19, s53, v197
    v_dot2c_f32_bf16 v20, s52, v198
    v_dot2c_f32_bf16 v21, s53, v198
    v_dot2c_f32_bf16 v22, s52, v199
    v_dot2c_f32_bf16 v23, s53, v199
    s_waitcnt vmcnt(21)
    buffer_load_dwordx4 v230, s[84:87], 0 offen offset:2048 lds
    v_dot2c_f32_bf16 v16, s52, v200
    v_dot2c_f32_bf16 v17, s53, v200
    v_dot2c_f32_bf16 v18, s52, v201
    v_dot2c_f32_bf16 v19, s53, v201
    v_dot2c_f32_bf16 v20, s52, v202
    v_dot2c_f32_bf16 v21, s53, v202
    v_dot2c_f32_bf16 v22, s52, v203
    v_dot2c_f32_bf16 v23, s53, v203
    s_waitcnt vmcnt(21)
    v_dot2c_f32_bf16 v16, s52, v204
    v_dot2c_f32_bf16 v17, s53, v204
    v_dot2c_f32_bf16 v18, s52, v205
    v_dot2c_f32_bf16 v19, s53, v205
    v_dot2c_f32_bf16 v20, s52, v206
    v_dot2c_f32_bf16 v21, s53, v206
    v_dot2c_f32_bf16 v22, s52, v207
    v_dot2c_f32_bf16 v23, s53, v207
    buffer_load_dwordx4 v231, s[84:87], 0 offen offset:3072 lds
    v_add_u32 v243, 98304, v254
    s_waitcnt vmcnt(20)
    v_add_f32_dpp v0, v0, v0 row_ror:8 row_mask:0xf bank_mask:0xf
    v_add_f32_dpp v1, v1, v1 row_ror:8 row_mask:0xf bank_mask:0xf
    v_add_f32_dpp v2, v2, v2 row_ror:8 row_mask:0xf bank_mask:0xf
    v_add_f32_dpp v3, v3, v3 row_ror:8 row_mask:0xf bank_mask:0xf
    v_add_f32_dpp v4, v4, v4 row_ror:8 row_mask:0xf bank_mask:0xf
    v_add_f32_dpp v5, v5, v5 row_ror:8 row_mask:0xf bank_mask:0xf
    v_add_f32_dpp v6, v6, v6 row_ror:8 row_mask:0xf bank_mask:0xf
    v_add_f32_dpp v7, v7, v7 row_ror:8 row_mask:0xf bank_mask:0xf
    v_cvt_pk_bf16_f32 v24, v16, v17
    v_cvt_pk_bf16_f32 v25, v18, v19
    v_cvt_pk_bf16_f32 v26, v20, v21
    v_cvt_pk_bf16_f32 v27, v22, v23
    ds_write_b128 v247, v[24:27]
    v_add_f32_dpp v0, v0, v0 row_ror:4 row_mask:0xf bank_mask:0xf
    v_add_f32_dpp v1, v1, v1 row_ror:4 row_mask:0xf bank_mask:0xf
    v_add_f32_dpp v2, v2, v2 row_ror:4 row_mask:0xf bank_mask:0xf
    v_add_f32_dpp v3, v3, v3 row_ror:4 row_mask:0xf bank_mask:0xf
    v_add_f32_dpp v4, v4, v4 row_ror:4 row_mask:0xf bank_mask:0xf
    v_add_f32_dpp v5, v5, v5 row_ror:4 row_mask:0xf bank_mask:0xf
    v_add_f32_dpp v6, v6, v6 row_ror:4 row_mask:0xf bank_mask:0xf
    v_add_f32_dpp v7, v7, v7 row_ror:4 row_mask:0xf bank_mask:0xf
    v_add_f32_dpp v0, v0, v0 row_ror:2 row_mask:0xf bank_mask:0xf
    v_add_f32_dpp v1, v1, v1 row_ror:2 row_mask:0xf bank_mask:0xf
    v_add_f32_dpp v2, v2, v2 row_ror:2 row_mask:0xf bank_mask:0xf
    v_add_f32_dpp v3, v3, v3 row_ror:2 row_mask:0xf bank_mask:0xf
    v_add_f32_dpp v4, v4, v4 row_ror:2 row_mask:0xf bank_mask:0xf
    v_add_f32_dpp v5, v5, v5 row_ror:2 row_mask:0xf bank_mask:0xf
    v_add_f32_dpp v6, v6, v6 row_ror:2 row_mask:0xf bank_mask:0xf
    v_add_f32_dpp v7, v7, v7 row_ror:2 row_mask:0xf bank_mask:0xf
    v_add_f32_dpp v0, v0, v0 row_ror:1 row_mask:0xf bank_mask:0xf
    v_add_f32_dpp v1, v1, v1 row_ror:1 row_mask:0xf bank_mask:0xf
    v_add_f32_dpp v2, v2, v2 row_ror:1 row_mask:0xf bank_mask:0xf
    v_add_f32_dpp v3, v3, v3 row_ror:1 row_mask:0xf bank_mask:0xf
    v_add_f32_dpp v4, v4, v4 row_ror:1 row_mask:0xf bank_mask:0xf
    v_add_f32_dpp v5, v5, v5 row_ror:1 row_mask:0xf bank_mask:0xf
    v_add_f32_dpp v6, v6, v6 row_ror:1 row_mask:0xf bank_mask:0xf
    v_add_f32_dpp v7, v7, v7 row_ror:1 row_mask:0xf bank_mask:0xf
    v_cvt_pk_bf16_f32 v8, v0, v1
    v_cvt_pk_bf16_f32 v9, v2, v3
    v_cvt_pk_bf16_f32 v10, v4, v5
    v_cvt_pk_bf16_f32 v11, v6, v7
    ds_write_b128 v247, v[8:11] offset:4096
    s_lshl_b32 s50, s27, 3
    s_lshl_b32 s51, s3, 1
    s_add_u32 s50, s50, s51
    s_lshl_b32 s52, s50, 6
    s_lshl_b32 s50, s50, 15
    s_lshl_b32 s51, s28, 11
    s_add_u32 s50, s50, s51
    s_add_u32 s50, s50, 4194304
    s_add_u32 s51, s50, 0x8000
    s_lshl_b32 s53, s28, 13
    s_add_u32 s52, s52, s53
    s_add_u32 s52, s52, 32505856
    s_waitcnt lgkmcnt(0)
    s_barrier
    ds_read_b128 v[16:19], v243 offset:4096
    ds_read_b128 v[0:3], v243 offset:0
    ds_read_b128 v[4:7], v243 offset:1024
    ds_read_b128 v[20:23], v243 offset:6144
    ds_read_b128 v[8:11], v243 offset:2048
    ds_read_b128 v[12:15], v243 offset:3072
    s_waitcnt lgkmcnt(3)
    v_mfma_f32_16x16x32_bf16 v[104:107], v[16:19], v[64:67], 0
    v_mfma_f32_16x16x32_bf16 v[96:99], v[0:3], v[64:67], 0
    v_mfma_f32_16x16x32_bf16 v[100:103], v[4:7], v[64:67], 0
    v_mfma_f32_16x16x32_bf16 v[128:131], v[16:19], v[72:75], 0
    v_mfma_f32_16x16x32_bf16 v[120:123], v[0:3], v[72:75], 0
    v_mfma_f32_16x16x32_bf16 v[124:127], v[4:7], v[72:75], 0
    s_waitcnt lgkmcnt(0)
    v_mfma_f32_16x16x32_bf16 v[116:119], v[20:23], v[68:71], 0
    v_mfma_f32_16x16x32_bf16 v[108:111], v[8:11], v[68:71], 0
    v_mfma_f32_16x16x32_bf16 v[112:115], v[12:15], v[68:71], 0
    v_mfma_f32_16x16x32_bf16 v[140:143], v[20:23], v[76:79], 0
    v_mfma_f32_16x16x32_bf16 v[132:135], v[8:11], v[76:79], 0
    v_mfma_f32_16x16x32_bf16 v[136:139], v[12:15], v[76:79], 0
    v_add_f32 v104, s36, v104
    v_rcp_f32 v104, v104
    s_nop 0
    v_pk_mul_f32 v[96:97], v[96:97], v[104:105] op_sel_hi:[1,0]
    v_pk_mul_f32 v[98:99], v[98:99], v[104:105] op_sel_hi:[1,0]
    v_pk_mul_f32 v[100:101], v[100:101], v[104:105] op_sel_hi:[1,0]
    v_pk_mul_f32 v[102:103], v[102:103], v[104:105] op_sel_hi:[1,0]
    v_cvt_pk_bf16_f32 v104, v96, v97
    v_cvt_pk_bf16_f32 v105, v98, v99
    v_cvt_pk_bf16_f32 v106, v100, v101
    v_cvt_pk_bf16_f32 v107, v102, v103
    buffer_store_dwordx4 v[104:107], v240, s[16:19], s50 offen offset:0 sc1
    v_add_f32 v128, s36, v128
    v_rcp_f32 v128, v128
    s_nop 0
    v_pk_mul_f32 v[120:121], v[120:121], v[128:129] op_sel_hi:[1,0]
    v_pk_mul_f32 v[122:123], v[122:123], v[128:129] op_sel_hi:[1,0]
    v_pk_mul_f32 v[124:125], v[124:125], v[128:129] op_sel_hi:[1,0]
    v_pk_mul_f32 v[126:127], v[126:127], v[128:129] op_sel_hi:[1,0]
    v_cvt_pk_bf16_f32 v128, v120, v121
    v_cvt_pk_bf16_f32 v129, v122, v123
    v_cvt_pk_bf16_f32 v130, v124, v125
    v_cvt_pk_bf16_f32 v131, v126, v127
    buffer_store_dwordx4 v[128:131], v240, s[16:19], s51 offen offset:0 sc1
    v_add_f32 v116, s36, v116
    v_rcp_f32 v116, v116
    s_nop 0
    v_pk_mul_f32 v[108:109], v[108:109], v[116:117] op_sel_hi:[1,0]
    v_pk_mul_f32 v[110:111], v[110:111], v[116:117] op_sel_hi:[1,0]
    v_pk_mul_f32 v[112:113], v[112:113], v[116:117] op_sel_hi:[1,0]
    v_pk_mul_f32 v[114:115], v[114:115], v[116:117] op_sel_hi:[1,0]
    v_cvt_pk_bf16_f32 v116, v108, v109
    v_cvt_pk_bf16_f32 v117, v110, v111
    v_cvt_pk_bf16_f32 v118, v112, v113
    v_cvt_pk_bf16_f32 v119, v114, v115
    buffer_store_dwordx4 v[116:119], v240, s[16:19], s50 offen offset:1024 sc1
    v_add_f32 v140, s36, v140
    v_rcp_f32 v140, v140
    s_nop 0
    v_pk_mul_f32 v[132:133], v[132:133], v[140:141] op_sel_hi:[1,0]
    v_pk_mul_f32 v[134:135], v[134:135], v[140:141] op_sel_hi:[1,0]
    v_pk_mul_f32 v[136:137], v[136:137], v[140:141] op_sel_hi:[1,0]
    v_pk_mul_f32 v[138:139], v[138:139], v[140:141] op_sel_hi:[1,0]
    v_cvt_pk_bf16_f32 v140, v132, v133
    v_cvt_pk_bf16_f32 v141, v134, v135
    v_cvt_pk_bf16_f32 v142, v136, v137
    v_cvt_pk_bf16_f32 v143, v138, v139
    buffer_store_dwordx4 v[140:143], v240, s[16:19], s51 offen offset:1024 sc1
    s_waitcnt vmcnt(20)
    v_pk_mul_f32 v[24:25], v[96:97], v[48:49]
    v_pk_fma_f32 v[24:25], v[98:99], v[50:51], v[24:25]
    v_pk_fma_f32 v[24:25], v[100:101], v[52:53], v[24:25]
    v_pk_fma_f32 v[24:25], v[102:103], v[54:55], v[24:25]
    v_pk_fma_f32 v[24:25], v[108:109], v[56:57], v[24:25]
    v_pk_fma_f32 v[24:25], v[110:111], v[58:59], v[24:25]
    v_pk_fma_f32 v[24:25], v[112:113], v[60:61], v[24:25]
    v_pk_fma_f32 v[24:25], v[114:115], v[62:63], v[24:25]
    v_pk_mul_f32 v[26:27], v[120:121], v[48:49]
    v_pk_fma_f32 v[26:27], v[122:123], v[50:51], v[26:27]
    v_pk_fma_f32 v[26:27], v[124:125], v[52:53], v[26:27]
    v_pk_fma_f32 v[26:27], v[126:127], v[54:55], v[26:27]
    v_pk_fma_f32 v[26:27], v[132:133], v[56:57], v[26:27]
    v_pk_fma_f32 v[26:27], v[134:135], v[58:59], v[26:27]
    v_pk_fma_f32 v[26:27], v[136:137], v[60:61], v[26:27]
    v_pk_fma_f32 v[26:27], v[138:139], v[62:63], v[26:27]
    v_add_f32 v24, v24, v25
    v_add_f32 v26, v26, v27
    v_lshlrev_b32 v242, 2, v255
    s_nop 0
    v_permlane16_swap_b32 v24, v26
    s_nop 0
    v_add_f32 v24, v24, v26
    v_mov_b32 v25, v24
    s_nop 1
    v_permlane32_swap_b32 v24, v25
    s_nop 0
    v_add_f32 v24, v24, v25
    s_mov_b32 exec_hi, 0
    buffer_store_dword v24, v242, s[16:19], s52 offen sc1
    s_mov_b64 exec, -1
    s_add_u32 m0, s22, 32768
    s_add_u32 s84, s68, 1310720
    s_addc_u32 s85, s69, 0
    buffer_load_dwordx4 v220, s[84:87], 0 offen offset:0 lds
    buffer_load_dwordx4 v221, s[84:87], 0 offen offset:1024 lds
    buffer_load_dwordx4 v230, s[84:87], 0 offen offset:2048 lds
    buffer_load_dwordx4 v231, s[84:87], 0 offen offset:3072 lds
    s_add_u32 m0, s22, 49152
    s_add_u32 s84, s68, 1572864
    s_addc_u32 s85, s69, 0
    buffer_load_dwordx4 v220, s[84:87], 0 offen offset:0 lds
    buffer_load_dwordx4 v221, s[84:87], 0 offen offset:1024 lds
    buffer_load_dwordx4 v230, s[84:87], 0 offen offset:2048 lds
    buffer_load_dwordx4 v231, s[84:87], 0 offen offset:3072 lds
    v_lshrrev_b32 v204, 3, v255
    v_lshrrev_b32 v205, 4, v255
    v_and_b32 v206, 7, v255
    v_xor_b32 v205, v205, v206
    v_xor_b32 v206, 4, v205
    v_lshlrev_b32 v204, 11, v204
    s_lshl_b32 s50, s43, 15
    s_lshl_b32 s51, s30, 7
    s_add_u32 s50, s50, s51
    v_add_u32 v204, s50, v204
    v_lshl_add_u32 v198, v205, 4, v204
    v_lshl_add_u32 v199, v206, 4, v204
    v_and_b32 v204, 15, v255
    v_lshrrev_b32 v205, 1, v204
    v_lshrrev_b32 v206, 5, v255
    v_xor_b32 v205, v205, v206
    v_lshlrev_b32 v204, 7, v204
    v_bfe_u32 v206, v255, 4, 1
    v_lshl_add_u32 v204, v206, 3, v204
    s_lshl_b32 s48, s3, 12
    s_add_u32 s48, s48, 147456
    v_add_u32 v204, s48, v204
    v_xor_b32 v206, 0, v205
    v_lshl_add_u32 v200, v206, 4, v204
    v_xor_b32 v206, 2, v205
    v_lshl_add_u32 v201, v206, 4, v204
    v_xor_b32 v206, 4, v205
    v_lshl_add_u32 v202, v206, 4, v204
    v_xor_b32 v206, 6, v205
    v_lshl_add_u32 v203, v206, 4, v204
    s_lshl_b32 s50, s27, 4
    s_lshl_b32 s58, s50, 8
    s_lshl_b32 s59, s28, 2
    s_add_u32 s59, s58, s59
    s_add_u32 s59, s59, 33685504
    v_lshlrev_b32 v242, 8, v255
    v_mov_b32 v243, s33
    s_waitcnt vmcnt(8)
    s_barrier
    s_cmp_lg_u32 s3, 0
    s_cbranch_scc1 L_nosend2
    s_mov_b64 exec, 0xffff
    buffer_store_dword v243, v242, s[16:19], s59 offen sc1
    s_mov_b64 exec, -1
L_nosend2:
    s_add_u32 m0, s22, 98304
    s_add_u32 s84, s68, 0
    s_addc_u32 s85, s69, 0
    buffer_load_dwordx4 v220, s[84:87], 0 offen offset:0 lds
    buffer_load_dwordx4 v221, s[84:87], 0 offen offset:1024 lds
    buffer_load_dwordx4 v230, s[84:87], 0 offen offset:2048 lds
    buffer_load_dwordx4 v231, s[84:87], 0 offen offset:3072 lds
    s_add_u32 m0, s22, 65536
    s_add_u32 s84, s68, 1835008
    s_addc_u32 s85, s69, 0
    buffer_load_dwordx4 v220, s[84:87], 0 offen offset:0 lds
    buffer_load_dwordx4 v221, s[84:87], 0 offen offset:1024 lds
    buffer_load_dwordx4 v230, s[84:87], 0 offen offset:2048 lds
    buffer_load_dwordx4 v231, s[84:87], 0 offen offset:3072 lds
    s_mov_b32 s42, s24
    s_lshl_b32 s50, s43, 15
    s_add_u32 s50, s50, 4194304
    v_add_u32 v196, s50, v240
    v_add_u32 v197, 0x8000, v196
    s_add_u32 s4, s82, 0
    s_addc_u32 s5, s83, 0
    s_mov_b32 s6, 134217728
    s_and_b32 s51, s3, 1
    s_mul_i32 s51, s51, 229376
    s_mul_i32 s52, s32, 224
    s_add_u32 s51, s51, s52
    s_and_b32 s52, s32, 1
    s_lshl_b32 s52, s52, 1
    v_add_u32 v237, 0, v255
    v_mul_u32_u24 v238, 4682, v237
    v_lshrrev_b32 v238, 16, v238
    v_mul_u32_u24 v239, 14, v238
    v_sub_u32 v239, v237, v239
    v_add_u32 v239, s52, v239
    v_subrev_u32 v237, 14, v239
    v_min_u32 v239, v239, v237
    v_mul_u32_u24 v238, 7168, v238
    v_lshl_add_u32 v238, v239, 4, v238
    s_sub_u32 s53, s51, 0
    v_add_u32 v228, s53, v238
    v_add_u32 v237, 64, v255
    v_mul_u32_u24 v238, 4682, v237
    v_lshrrev_b32 v238, 16, v238
    v_mul_u32_u24 v239, 14, v238
    v_sub_u32 v239, v237, v239
    v_add_u32 v239, s52, v239
    v_subrev_u32 v237, 14, v239
    v_min_u32 v239, v239, v237
    v_mul_u32_u24 v238, 7168, v238
    v_lshl_add_u32 v238, v239, 4, v238
    s_sub_u32 s53, s51, 1024
    v_add_u32 v229, s53, v238
    v_add_u32 v237, 128, v255
    v_mul_u32_u24 v238, 4682, v237
    v_lshrrev_b32 v238, 16, v238
    v_mul_u32_u24 v239, 14, v238
    v_sub_u32 v239, v237, v239
    v_add_u32 v239, s52, v239
    v_subrev_u32 v237, 14, v239
    v_min_u32 v239, v239, v237
    v_mul_u32_u24 v238, 7168, v238
    v_lshl_add_u32 v238, v239, 4, v238
    s_sub_u32 s53, s51, 2048
    v_add_u32 v230, s53, v238
    v_add_u32 v237, 192, v255
    v_mul_u32_u24 v238, 4682, v237
    v_lshrrev_b32 v238, 16, v238
    v_mul_u32_u24 v239, 14, v238
    v_sub_u32 v239, v237, v239
    v_add_u32 v239, s52, v239
    v_subrev_u32 v237, 14, v239
    v_min_u32 v239, v239, v237
    v_mul_u32_u24 v238, 7168, v238
    v_lshl_add_u32 v238, v239, 4, v238
    s_sub_u32 s53, s51, 3072
    v_add_u32 v231, s53, v238
    v_add_u32 v237, 256, v255
    v_mul_u32_u24 v238, 4682, v237
    v_lshrrev_b32 v238, 16, v238
    v_mul_u32_u24 v239, 14, v238
    v_sub_u32 v239, v237, v239
    v_add_u32 v239, s52, v239
    v_subrev_u32 v237, 14, v239
    v_min_u32 v239, v239, v237
    v_mul_u32_u24 v238, 7168, v238
    v_lshl_add_u32 v238, v239, 4, v238
    s_sub_u32 s53, s51, 0
    v_add_u32 v232, s53, v238
    v_add_u32 v237, 320, v255
    v_mul_u32_u24 v238, 4682, v237
    v_lshrrev_b32 v238, 16, v238
    v_mul_u32_u24 v239, 14, v238
    v_sub_u32 v239, v237, v239
    v_add_u32 v239, s52, v239
    v_subrev_u32 v237, 14, v239
    v_min_u32 v239, v239, v237
    v_mul_u32_u24 v238, 7168, v238
    v_lshl_add_u32 v238, v239, 4, v238
    s_sub_u32 s53, s51, 1024
    v_add_u32 v233, s53, v238
    v_add_u32 v237, 384, v255
    v_mul_u32_u24 v238, 4682, v237
    v_lshrrev_b32 v238, 16, v238
    v_mul_u32_u24 v239, 14, v238
    v_sub_u32 v239, v237, v239
    v_add_u32 v239, s52, v239
    v_subrev_u32 v237, 14, v239
    v_min_u32 v239, v239, v237
    v_mul_u32_u24 v238, 7168, v238
    v_lshl_add_u32 v238, v239, 4, v238
    s_sub_u32 s53, s51, 2048
    v_add_u32 v234, s53, v238
    s_mul_i32 s22, s3, 7168
    s_add_u32 s23, s22, 143360
    s_add_u32 s22, s22, 86016
    s_cmp_ge_u32 s3, 2
    s_cselect_b32 s8, s74, s72
    s_cselect_b32 s9, s75, s73
    s_mov_b32 s10, 7340032
    s_mov_b32 s11, 0x20000
    ds_read_b64 v[32:33], v200 offset:0
    ds_read_b64 v[34:35], v201 offset:0
    ds_read_b64 v[36:37], v202 offset:0
    ds_read_b64 v[38:39], v203 offset:0
    ds_read_b64 v[40:41], v200 offset:2048
    ds_read_b64 v[42:43], v201 offset:2048
    ds_read_b64 v[44:45], v202 offset:2048
    ds_read_b64 v[46:47], v203 offset:2048
    s_waitcnt lgkmcnt(0)
    v_lshlrev_b32 v0, 16, v32
    v_and_b32 v1, 0xffff0000, v32
    v_lshlrev_b32 v2, 16, v33
    v_and_b32 v3, 0xffff0000, v33
    v_lshlrev_b32 v4, 16, v34
    v_and_b32 v5, 0xffff0000, v34
    v_lshlrev_b32 v6, 16, v35
    v_and_b32 v7, 0xffff0000, v35
    v_lshlrev_b32 v8, 16, v36
    v_and_b32 v9, 0xffff0000, v36
    v_lshlrev_b32 v10, 16, v37
    v_and_b32 v11, 0xffff0000, v37
    v_lshlrev_b32 v12, 16, v38
    v_and_b32 v13, 0xffff0000, v38
    v_lshlrev_b32 v14, 16, v39
    v_and_b32 v15, 0xffff0000, v39
    v_lshlrev_b32 v16, 16, v40
    v_and_b32 v17, 0xffff0000, v40
    v_lshlrev_b32 v18, 16, v41
    v_and_b32 v19, 0xffff0000, v41
    v_lshlrev_b32 v20, 16, v42
    v_and_b32 v21, 0xffff0000, v42
    v_lshlrev_b32 v22, 16, v43
    v_and_b32 v23, 0xffff0000, v43
    v_lshlrev_b32 v24, 16, v44
    v_and_b32 v25, 0xffff0000, v44
    v_lshlrev_b32 v26, 16, v45
    v_and_b32 v27, 0xffff0000, v45
    v_lshlrev_b32 v28, 16, v46
    v_and_b32 v29, 0xffff0000, v46
    v_lshlrev_b32 v30, 16, v47
    v_and_b32 v31, 0xffff0000, v47
    s_lshl_b32 s58, s41, 8
    s_add_u32 s58, s58, 33685504
    v_and_b32 v204, 15, v255
    v_lshlrev_b32 v204, 2, v204
    s_mov_b32 s59, 0x20000
L_poll2:
    buffer_load_dword v205, v204, s[16:19], s58 offen sc1
    s_sub_u32 s59, s59, 1
    s_cbranch_scc1 L_polldone2
    s_waitcnt vmcnt(0)
    v_cmp_ne_u32 vcc, s33, v205
    s_cmp_lg_u64 vcc, 0
    s_cbranch_scc1 L_poll2
L_polldone2:
    buffer_load_dwordx4 a[0:3], v196, s[4:7], 0 offen offset:0 sc1
    buffer_load_dwordx4 a[4:7], v196, s[4:7], 0 offen offset:1024 sc1
    buffer_load_dwordx4 a[8:11], v197, s[4:7], 0 offen offset:0 sc1
    buffer_load_dwordx4 a[12:15], v197, s[4:7], 0 offen offset:1024 sc1
    buffer_load_dwordx4 a[16:19], v196, s[4:7], 0 offen offset:2048 sc1
    buffer_load_dwordx4 a[20:23], v196, s[4:7], 0 offen offset:3072 sc1
    buffer_load_dwordx4 a[24:27], v197, s[4:7], 0 offen offset:2048 sc1
    buffer_load_dwordx4 a[28:31], v197, s[4:7], 0 offen offset:3072 sc1
    s_add_u32 s4, s82, 4096
    s_addc_u32 s5, s83, 0
    buffer_load_dwordx4 a[32:35], v196, s[4:7], 0 offen offset:0 sc1
    buffer_load_dwordx4 a[36:39], v196, s[4:7], 0 offen offset:1024 sc1
    buffer_load_dwordx4 a[40:43], v197, s[4:7], 0 offen offset:0 sc1
    buffer_load_dwordx4 a[44:47], v197, s[4:7], 0 offen offset:1024 sc1
    s_barrier
    ds_read_b64_tr_b16 v[64:65], v212 offset:32768
    ds_read_b64_tr_b16 v[66:67], v212 offset:36864
    ds_read_b64_tr_b16 v[68:69], v212 offset:40960
    ds_read_b64_tr_b16 v[70:71], v212 offset:45056
    ds_read_b64_tr_b16 v[72:73], v213 offset:32768
    ds_read_b64_tr_b16 v[74:75], v213 offset:36864
    ds_read_b64_tr_b16 v[76:77], v213 offset:40960
    ds_read_b64_tr_b16 v[78:79], v213 offset:45056
    ds_read_b64_tr_b16 v[80:81], v214 offset:32768
    ds_read_b64_tr_b16 v[82:83], v214 offset:36864
    ds_read_b64_tr_b16 v[84:85], v214 offset:40960
    ds_read_b64_tr_b16 v[86:87], v214 offset:45056
    ds_read_b64_tr_b16 v[88:89], v215 offset:32768
    ds_read_b64_tr_b16 v[90:91], v215 offset:36864
    ds_read_b64_tr_b16 v[92:93], v215 offset:40960
    ds_read_b64_tr_b16 v[94:95], v215 offset:45056
    v_and_b32 v204, 31, v255
    v_lshlrev_b32 v204, 2, v204
    v_lshrrev_b32 v205, 5, v255
    v_lshl_add_u32 v205, v205, 16, v204
    s_lshl_b32 s50, s43, 6
    s_add_u32 s51, s50, 32505856
    s_add_u32 s52, s50, 32636928
    s_lshl_b32 s56, s43, 15
    s_lshl_b32 s57, s30, 11
    s_add_u32 s56, s56, s57
    s_add_u32 s56, s56, 8388608
    s_add_u32 s57, s56, 0x8000
    s_lshl_b32 s53, s30, 13
    s_add_u32 s50, s50, s53
    s_add_u32 s50, s50, 32768000
    s_or_b32 s53, s2, s3
    s_cbranch_scc1 L_noepoch
    v_mov_b32 v206, 34602752
    v_mov_b32 v207, s33
    s_mov_b64 exec, 1
    buffer_store_dword v207, v206, s[16:19], 0 offen sc1
    s_mov_b64 exec, -1
L_noepoch:
    buffer_load_dwordx4 a[48:51], v196, s[4:7], 0 offen offset:2048 sc1
    buffer_load_dwordx4 a[52:55], v196, s[4:7], 0 offen offset:3072 sc1
    buffer_load_dwordx4 a[56:59], v197, s[4:7], 0 offen offset:2048 sc1
    buffer_load_dwordx4 a[60:63], v197, s[4:7], 0 offen offset:3072 sc1
    s_waitcnt vmcnt(12) lgkmcnt(12)
    v_mfma_f32_16x16x32_bf16 v[0:3], v[64:67], a[0:3], v[0:3]
    ds_read_b64_tr_b16 v[96:97], v212 offset:34816
    s_add_u32 s4, s82, 8192
    v_mfma_f32_16x16x32_bf16 v[0:3], v[68:71], a[4:7], v[0:3]
    ds_read_b64_tr_b16 v[98:99], v212 offset:38912
    s_addc_u32 s5, s83, 0
    v_mfma_f32_16x16x32_bf16 v[16:19], v[68:71], a[12:15], v[16:19]
    ds_read_b64_tr_b16 v[100:101], v212 offset:43008
    buffer_load_dwordx4 a[64:67], v196, s[4:7], 0 offen offset:0 sc1
    v_mfma_f32_16x16x32_bf16 v[16:19], v[64:67], a[8:11], v[16:19]
    ds_read_b64_tr_b16 v[102:103], v212 offset:47104
    s_waitcnt lgkmcnt(12)
    v_mfma_f32_16x16x32_bf16 v[4:7], v[72:75], a[0:3], v[4:7]
    ds_read_b64_tr_b16 v[104:105], v213 offset:34816
    v_mfma_f32_16x16x32_bf16 v[4:7], v[76:79], a[4:7], v[4:7]
    ds_read_b64_tr_b16 v[106:107], v213 offset:38912
    v_mfma_f32_16x16x32_bf16 v[20:23], v[76:79], a[12:15], v[20:23]
    ds_read_b64_tr_b16 v[108:109], v213 offset:43008
    buffer_load_dwordx4 a[68:71], v196, s[4:7], 0 offen offset:1024 sc1
    v_mfma_f32_16x16x32_bf16 v[20:23], v[72:75], a[8:11], v[20:23]
    ds_read_b64_tr_b16 v[110:111], v213 offset:47104
    s_waitcnt lgkmcnt(12)
    v_mfma_f32_16x16x32_bf16 v[8:11], v[80:83], a[0:3], v[8:11]
    ds_read_b64_tr_b16 v[112:113], v214 offset:34816
    v_mfma_f32_16x16x32_bf16 v[8:11], v[84:87], a[4:7], v[8:11]
    ds_read_b64_tr_b16 v[114:115], v214 offset:38912
    v_mfma_f32_16x16x32_bf16 v[24:27], v[84:87], a[12:15], v[24:27]
    ds_read_b64_tr_b16 v[116:117], v214 offset:43008
    buffer_load_dwordx4 a[72:75], v197, s[4:7], 0 offen offset:0 sc1
    v_mfma_f32_16x16x32_bf16 v[24:27], v[80:83], a[8:11], v[24:27]
    ds_read_b64_tr_b16 v[118:119], v214 offset:47104
    s_waitcnt lgkmcnt(12)
    v_mfma_f32_16x16x32_bf16 v[12:15], v[88:91], a[0:3], v[12:15]
    ds_read_b64_tr_b16 v[120:121], v215 offset:34816
    v_mfma_f32_16x16x32_bf16 v[12:15], v[92:95], a[4:7], v[12:15]
    ds_read_b64_tr_b16 v[122:123], v215 offset:38912
    v_mfma_f32_16x16x32_bf16 v[28:31], v[92:95], a[12:15], v[28:31]
    ds_read_b64_tr_b16 v[124:125], v215 offset:43008
    buffer_load_dwordx4 a[76:79], v197, s[4:7], 0 offen offset:1024 sc1
    v_mfma_f32_16x16x32_bf16 v[28:31], v[88:91], a[8:11], v[28:31]
    ds_read_b64_tr_b16 v[126:127], v215 offset:47104
    s_waitcnt vmcnt(12) lgkmcnt(12)
    v_mfma_f32_16x16x32_bf16 v[0:3], v[96:99], a[16:19], v[0:3]
    ds_read_b64_tr_b16 v[64:65], v212 offset:49152
    buffer_load_dwordx4 a[80:83], v196, s[4:7], 0 offen offset:2048 sc1
    v_mfma_f32_16x16x32_bf16 v[0:3], v[100:103], a[20:23], v[0:3]
    ds_read_b64_tr_b16 v[66:67], v212 offset:53248
    v_mfma_f32_16x16x32_bf16 v[16:19], v[100:103], a[28:31], v[16:19]
    ds_read_b64_tr_b16 v[68:69], v212 offset:57344
    v_mfma_f32_16x16x32_bf16 v[16:19], v[96:99], a[24:27], v[16:19]
    ds_read_b64_tr_b16 v[70:71], v212 offset:61440
    s_waitcnt lgkmcnt(12)
    v_mfma_f32_16x16x32_bf16 v[4:7], v[104:107], a[16:19], v[4:7]
    ds_read_b64_tr_b16 v[72:73], v213 offset:49152
    buffer_load_dwordx4 a[84:87], v196, s[4:7], 0 offen offset:3072 sc1
    v_mfma_f32_16x16x32_bf16 v[4:7], v[108:111], a[20:23], v[4:7]
    ds_read_b64_tr_b16 v[74:75], v213 offset:53248
    v_mfma_f32_16x16x32_bf16 v[20:23], v[108:111], a[28:31], v[20:23]
    ds_read_b64_tr_b16 v[76:77], v213 offset:57344
    v_mfma_f32_16x16x32_bf16 v[20:23], v[104:107], a[24:27], v[20:23]
    ds_read_b64_tr_b16 v[78:79], v213 offset:61440
    s_waitcnt lgkmcnt(12)
    v_mfma_f32_16x16x32_bf16 v[8:11], v[112:115], a[16:19], v[8:11]
    ds_read_b64_tr_b16 v[80:81], v214 offset:49152
    buffer_load_dwordx4 a[88:91], v197, s[4:7], 0 offen offset:2048 sc1
    v_mfma_f32_16x16x32_bf16 v[8:11], v[116:119], a[20:23], v[8:11]
    ds_read_b64_tr_b16 v[82:83], v214 offset:53248
    v_mfma_f32_16x16x32_bf16 v[24:27], v[116:119], a[28:31], v[24:27]
    ds_read_b64_tr_b16 v[84:85], v214 offset:57344
    v_mfma_f32_16x16x32_bf16 v[24:27], v[112:115], a[24:27], v[24:27]
    ds_read_b64_tr_b16 v[86:87], v214 offset:61440
    s_waitcnt lgkmcnt(12)
    v_mfma_f32_16x16x32_bf16 v[12:15], v[120:123], a[16:19], v[12:15]
    ds_read_b64_tr_b16 v[88:89], v215 offset:49152
    buffer_load_dwordx4 a[92:95], v197, s[4:7], 0 offen offset:3072 sc1
    v_mfma_f32_16x16x32_bf16 v[12:15], v[124:127], a[20:23], v[12:15]
    ds_read_b64_tr_b16 v[90:91], v215 offset:53248
    v_mfma_f32_16x16x32_bf16 v[28:31], v[124:127], a[28:31], v[28:31]
    ds_read_b64_tr_b16 v[92:93], v215 offset:57344
    v_mfma_f32_16x16x32_bf16 v[28:31], v[120:123], a[24:27], v[28:31]
    ds_read_b64_tr_b16 v[94:95], v215 offset:61440
    s_waitcnt vmcnt(12) lgkmcnt(12)
    v_mfma_f32_16x16x32_bf16 v[0:3], v[64:67], a[32:35], v[0:3]
    ds_read_b64_tr_b16 v[96:97], v212 offset:51200
    s_add_u32 s4, s82, 12288
    v_mfma_f32_16x16x32_bf16 v[0:3], v[68:71], a[36:39], v[0:3]
    ds_read_b64_tr_b16 v[98:99], v212 offset:55296
    s_addc_u32 s5, s83, 0
    v_mfma_f32_16x16x32_bf16 v[16:19], v[68:71], a[44:47], v[16:19]
    ds_read_b64_tr_b16 v[100:101], v212 offset:59392
    buffer_load_dwordx4 a[96:99], v196, s[4:7], 0 offen offset:0 sc1
    v_mfma_f32_16x16x32_bf16 v[16:19], v[64:67], a[40:43], v[16:19]
    ds_read_b64_tr_b16 v[102:103], v212 offset:63488
    s_waitcnt lgkmcnt(12)
    v_mfma_f32_16x16x32_bf16 v[4:7], v[72:75], a[32:35], v[4:7]
    ds_read_b64_tr_b16 v[104:105], v213 offset:51200
    v_mfma_f32_16x16x32_bf16 v[4:7], v[76:79], a[36:39], v[4:7]
    ds_read_b64_tr_b16 v[106:107], v213 offset:55296
    v_mfma_f32_16x16x32_bf16 v[20:23], v[76:79], a[44:47], v[20:23]
    ds_read_b64_tr_b16 v[108:109], v213 offset:59392
    buffer_load_dwordx4 a[100:103], v196, s[4:7], 0 offen offset:1024 sc1
    v_mfma_f32_16x16x32_bf16 v[20:23], v[72:75], a[40:43], v[20:23]
    ds_read_b64_tr_b16 v[110:111], v213 offset:63488
    s_waitcnt lgkmcnt(12)
    v_mfma_f32_16x16x32_bf16 v[8:11], v[80:83], a[32:35], v[8:11]
    ds_read_b64_tr_b16 v[112:113], v214 offset:51200
    v_mfma_f32_16x16x32_bf16 v[8:11], v[84:87], a[36:39], v[8:11]
    ds_read_b64_tr_b16 v[114:115], v214 offset:55296
    v_mfma_f32_16x16x32_bf16 v[24:27], v[84:87], a[44:47], v[24:27]
    ds_read_b64_tr_b16 v[116:117], v214 offset:59392
    buffer_load_dwordx4 a[104:107], v197, s[4:7], 0 offen offset:0 sc1
    v_mfma_f32_16x16x32_bf16 v[24:27], v[80:83], a[40:43], v[24:27]
    ds_read_b64_tr_b16 v[118:119], v214 offset:63488
    s_waitcnt lgkmcnt(12)
    v_mfma_f32_16x16x32_bf16 v[12:15], v[88:91], a[32:35], v[12:15]
    ds_read_b64_tr_b16 v[120:121], v215 offset:51200
    v_mfma_f32_16x16x32_bf16 v[12:15], v[92:95], a[36:39], v[12:15]
    ds_read_b64_tr_b16 v[122:123], v215 offset:55296
    v_mfma_f32_16x16x32_bf16 v[28:31], v[92:95], a[44:47], v[28:31]
    ds_read_b64_tr_b16 v[124:125], v215 offset:59392
    buffer_load_dwordx4 a[108:111], v197, s[4:7], 0 offen offset:1024 sc1
    v_mfma_f32_16x16x32_bf16 v[28:31], v[88:91], a[40:43], v[28:31]
    ds_read_b64_tr_b16 v[126:127], v215 offset:63488
    s_waitcnt vmcnt(12) lgkmcnt(12)
    v_mfma_f32_16x16x32_bf16 v[0:3], v[96:99], a[48:51], v[0:3]
    ds_read_b64_tr_b16 v[64:65], v216 offset:0
    buffer_load_dwordx4 a[112:115], v196, s[4:7], 0 offen offset:2048 sc1
    v_mfma_f32_16x16x32_bf16 v[0:3], v[100:103], a[52:55], v[0:3]
    ds_read_b64_tr_b16 v[66:67], v216 offset:4096
    v_mfma_f32_16x16x32_bf16 v[16:19], v[100:103], a[60:63], v[16:19]
    ds_read_b64_tr_b16 v[68:69], v216 offset:8192
    v_mfma_f32_16x16x32_bf16 v[16:19], v[96:99], a[56:59], v[16:19]
    ds_read_b64_tr_b16 v[70:71], v216 offset:12288
    s_waitcnt lgkmcnt(12)
    v_mfma_f32_16x16x32_bf16 v[4:7], v[104:107], a[48:51], v[4:7]
    ds_read_b64_tr_b16 v[72:73], v217 offset:0
    buffer_load_dwordx4 a[116:119], v196, s[4:7], 0 offen offset:3072 sc1
    v_mfma_f32_16x16x32_bf16 v[4:7], v[108:111], a[52:55], v[4:7]
    ds_read_b64_tr_b16 v[74:75], v217 offset:4096
    v_mfma_f32_16x16x32_bf16 v[20:23], v[108:111], a[60:63], v[20:23]
    ds_read_b64_tr_b16 v[76:77], v217 offset:8192
    v_mfma_f32_16x16x32_bf16 v[20:23], v[104:107], a[56:59], v[20:23]
    ds_read_b64_tr_b16 v[78:79], v217 offset:12288
    s_waitcnt lgkmcnt(12)
    v_mfma_f32_16x16x32_bf16 v[8:11], v[112:115], a[48:51], v[8:11]
    ds_read_b64_tr_b16 v[80:81], v218 offset:0
    buffer_load_dwordx4 a[120:123], v197, s[4:7], 0 offen offset:2048 sc1
    v_mfma_f32_16x16x32_bf16 v[8:11], v[116:119], a[52:55], v[8:11]
    ds_read_b64_tr_b16 v[82:83], v218 offset:4096
    v_mfma_f32_16x16x32_bf16 v[24:27], v[116:119], a[60:63], v[24:27]
    ds_read_b64_tr_b16 v[84:85], v218 offset:8192
    v_mfma_f32_16x16x32_bf16 v[24:27], v[112:115], a[56:59], v[24:27]
    ds_read_b64_tr_b16 v[86:87], v218 offset:12288
    s_waitcnt lgkmcnt(12)
    v_mfma_f32_16x16x32_bf16 v[12:15], v[120:123], a[48:51], v[12:15]
    ds_read_b64_tr_b16 v[88:89], v219 offset:0
    buffer_load_dwordx4 a[124:127], v197, s[4:7], 0 offen offset:3072 sc1
    v_mfma_f32_16x16x32_bf16 v[12:15], v[124:127], a[52:55], v[12:15]
    ds_read_b64_tr_b16 v[90:91], v219 offset:4096
    v_mfma_f32_16x16x32_bf16 v[28:31], v[124:127], a[60:63], v[28:31]
    ds_read_b64_tr_b16 v[92:93], v219 offset:8192
    v_mfma_f32_16x16x32_bf16 v[28:31], v[120:123], a[56:59], v[28:31]
    ds_read_b64_tr_b16 v[94:95], v219 offset:12288
    s_waitcnt vmcnt(12) lgkmcnt(12)
    v_mfma_f32_16x16x32_bf16 v[0:3], v[64:67], a[64:67], v[0:3]
    ds_read_b64_tr_b16 v[96:97], v216 offset:2048
    s_add_u32 s4, s82, 16384
    v_mfma_f32_16x16x32_bf16 v[0:3], v[68:71], a[68:71], v[0:3]
    ds_read_b64_tr_b16 v[98:99], v216 offset:6144
    s_addc_u32 s5, s83, 0
    v_mfma_f32_16x16x32_bf16 v[16:19], v[68:71], a[76:79], v[16:19]
    ds_read_b64_tr_b16 v[100:101], v216 offset:10240
    buffer_load_dwordx4 a[128:131], v196, s[4:7], 0 offen offset:0 sc1
    v_mfma_f32_16x16x32_bf16 v[16:19], v[64:67], a[72:75], v[16:19]
    ds_read_b64_tr_b16 v[102:103], v216 offset:14336
    s_waitcnt lgkmcnt(12)
    v_mfma_f32_16x16x32_bf16 v[4:7], v[72:75], a[64:67], v[4:7]
    ds_read_b64_tr_b16 v[104:105], v217 offset:2048
    v_mfma_f32_16x16x32_bf16 v[4:7], v[76:79], a[68:71], v[4:7]
    ds_read_b64_tr_b16 v[106:107], v217 offset:6144
    v_mfma_f32_16x16x32_bf16 v[20:23], v[76:79], a[76:79], v[20:23]
    ds_read_b64_tr_b16 v[108:109], v217 offset:10240
    buffer_load_dwordx4 a[132:135], v196, s[4:7], 0 offen offset:1024 sc1
    v_mfma_f32_16x16x32_bf16 v[20:23], v[72:75], a[72:75], v[20:23]
    ds_read_b64_tr_b16 v[110:111], v217 offset:14336
    s_waitcnt lgkmcnt(12)
    v_mfma_f32_16x16x32_bf16 v[8:11], v[80:83], a[64:67], v[8:11]
    ds_read_b64_tr_b16 v[112:113], v218 offset:2048
    v_mfma_f32_16x16x32_bf16 v[8:11], v[84:87], a[68:71], v[8:11]
    ds_read_b64_tr_b16 v[114:115], v218 offset:6144
    v_mfma_f32_16x16x32_bf16 v[24:27], v[84:87], a[76:79], v[24:27]
    ds_read_b64_tr_b16 v[116:117], v218 offset:10240
    buffer_load_dwordx4 a[136:139], v197, s[4:7], 0 offen offset:0 sc1
    v_mfma_f32_16x16x32_bf16 v[24:27], v[80:83], a[72:75], v[24:27]
    ds_read_b64_tr_b16 v[118:119], v218 offset:14336
    s_waitcnt lgkmcnt(12)
    v_mfma_f32_16x16x32_bf16 v[12:15], v[88:91], a[64:67], v[12:15]
    ds_read_b64_tr_b16 v[120:121], v219 offset:2048
    v_mfma_f32_16x16x32_bf16 v[12:15], v[92:95], a[68:71], v[12:15]
    ds_read_b64_tr_b16 v[122:123], v219 offset:6144
    v_mfma_f32_16x16x32_bf16 v[28:31], v[92:95], a[76:79], v[28:31]
    ds_read_b64_tr_b16 v[124:125], v219 offset:10240
    buffer_load_dwordx4 a[140:143], v197, s[4:7], 0 offen offset:1024 sc1
    v_mfma_f32_16x16x32_bf16 v[28:31], v[88:91], a[72:75], v[28:31]
    ds_read_b64_tr_b16 v[126:127], v219 offset:14336
    s_waitcnt vmcnt(12) lgkmcnt(12)
    v_mfma_f32_16x16x32_bf16 v[0:3], v[96:99], a[80:83], v[0:3]
    ds_read_b64_tr_b16 v[64:65], v208 offset:0
    buffer_load_dwordx4 a[144:147], v196, s[4:7], 0 offen offset:2048 sc1
    v_mfma_f32_16x16x32_bf16 v[0:3], v[100:103], a[84:87], v[0:3]
    ds_read_b64_tr_b16 v[66:67], v208 offset:4096
    buffer_load_dwordx4 a[148:151], v196, s[4:7], 0 offen offset:3072 sc1
    v_mfma_f32_16x16x32_bf16 v[16:19], v[100:103], a[92:95], v[16:19]
    ds_read_b64_tr_b16 v[68:69], v208 offset:8192
    v_mfma_f32_16x16x32_bf16 v[16:19], v[96:99], a[88:91], v[16:19]
    ds_read_b64_tr_b16 v[70:71], v208 offset:12288
    s_waitcnt lgkmcnt(12)
    v_mfma_f32_16x16x32_bf16 v[4:7], v[104:107], a[80:83], v[4:7]
    ds_read_b64_tr_b16 v[72:73], v209 offset:0
    buffer_load_dwordx4 a[152:155], v197, s[4:7], 0 offen offset:2048 sc1
    v_mfma_f32_16x16x32_bf16 v[4:7], v[108:111], a[84:87], v[4:7]
    ds_read_b64_tr_b16 v[74:75], v209 offset:4096
    v_mfma_f32_16x16x32_bf16 v[20:23], v[108:111], a[92:95], v[20:23]
    ds_read_b64_tr_b16 v[76:77], v209 offset:8192
    buffer_load_dwordx4 a[156:159], v197, s[4:7], 0 offen offset:3072 sc1
    v_mfma_f32_16x16x32_bf16 v[20:23], v[104:107], a[88:91], v[20:23]
    ds_read_b64_tr_b16 v[78:79], v209 offset:12288
    s_waitcnt lgkmcnt(12)
    v_mfma_f32_16x16x32_bf16 v[8:11], v[112:115], a[80:83], v[8:11]
    ds_read_b64_tr_b16 v[80:81], v210 offset:0
    buffer_load_dword v128, v205, s[16:19], s51 offen sc1
    v_mfma_f32_16x16x32_bf16 v[8:11], v[116:119], a[84:87], v[8:11]
    ds_read_b64_tr_b16 v[82:83], v210 offset:4096
    s_add_u32 s51, s51, 8192
    v_mfma_f32_16x16x32_bf16 v[24:27], v[116:119], a[92:95], v[24:27]
    ds_read_b64_tr_b16 v[84:85], v210 offset:8192
    buffer_load_dword v129, v205, s[16:19], s51 offen sc1
    v_mfma_f32_16x16x32_bf16 v[24:27], v[112:115], a[88:91], v[24:27]
    ds_read_b64_tr_b16 v[86:87], v210 offset:12288
    s_waitcnt lgkmcnt(12)
    v_mfma_f32_16x16x32_bf16 v[12:15], v[120:123], a[80:83], v[12:15]
    ds_read_b64_tr_b16 v[88:89], v211 offset:0
    s_add_u32 s51, s51, 8192
    v_mfma_f32_16x16x32_bf16 v[12:15], v[124:127], a[84:87], v[12:15]
    ds_read_b64_tr_b16 v[90:91], v211 offset:4096
    buffer_load_dword v130, v205, s[16:19], s51 offen sc1
    v_mfma_f32_16x16x32_bf16 v[28:31], v[124:127], a[92:95], v[28:31]
    ds_read_b64_tr_b16 v[92:93], v211 offset:8192
    s_add_u32 s51, s51, 8192
    v_mfma_f32_16x16x32_bf16 v[28:31], v[120:123], a[88:91], v[28:31]
    ds_read_b64_tr_b16 v[94:95], v211 offset:12288
    s_waitcnt vmcnt(15) lgkmcnt(12)
    v_mfma_f32_16x16x32_bf16 v[0:3], v[64:67], a[96:99], v[0:3]
    ds_read_b64_tr_b16 v[96:97], v208 offset:2048
    s_add_u32 s4, s82, 20480
    v_mfma_f32_16x16x32_bf16 v[0:3], v[68:71], a[100:103], v[0:3]
    ds_read_b64_tr_b16 v[98:99], v208 offset:6144
    s_addc_u32 s5, s83, 0
    v_mfma_f32_16x16x32_bf16 v[16:19], v[68:71], a[108:111], v[16:19]
    ds_read_b64_tr_b16 v[100:101], v208 offset:10240
    buffer_load_dwordx4 a[160:163], v196, s[4:7], 0 offen offset:0 sc1
    v_mfma_f32_16x16x32_bf16 v[16:19], v[64:67], a[104:107], v[16:19]
    ds_read_b64_tr_b16 v[102:103], v208 offset:14336
    s_waitcnt lgkmcnt(12)
    v_mfma_f32_16x16x32_bf16 v[4:7], v[72:75], a[96:99], v[4:7]
    ds_read_b64_tr_b16 v[104:105], v209 offset:2048
    buffer_load_dwordx4 a[164:167], v196, s[4:7], 0 offen offset:1024 sc1
    v_mfma_f32_16x16x32_bf16 v[4:7], v[76:79], a[100:103], v[4:7]
    ds_read_b64_tr_b16 v[106:107], v209 offset:6144
    buffer_load_dwordx4 a[168:171], v197, s[4:7], 0 offen offset:0 sc1
    v_mfma_f32_16x16x32_bf16 v[20:23], v[76:79], a[108:111], v[20:23]
    ds_read_b64_tr_b16 v[108:109], v209 offset:10240
    buffer_load_dwordx4 a[172:175], v197, s[4:7], 0 offen offset:1024 sc1
    v_mfma_f32_16x16x32_bf16 v[20:23], v[72:75], a[104:107], v[20:23]
    ds_read_b64_tr_b16 v[110:111], v209 offset:14336
    s_waitcnt lgkmcnt(12)
    v_mfma_f32_16x16x32_bf16 v[8:11], v[80:83], a[96:99], v[8:11]
    ds_read_b64_tr_b16 v[112:113], v210 offset:2048
    buffer_load_dword v131, v205, s[16:19], s51 offen sc1
    v_mfma_f32_16x16x32_bf16 v[8:11], v[84:87], a[100:103], v[8:11]
    ds_read_b64_tr_b16 v[114:115], v210 offset:6144
    s_add_u32 s51, s51, 8192
    v_mfma_f32_16x16x32_bf16 v[24:27], v[84:87], a[108:111], v[24:27]
    ds_read_b64_tr_b16 v[116:117], v210 offset:10240
    buffer_load_dword v132, v205, s[16:19], s51 offen sc1
    v_mfma_f32_16x16x32_bf16 v[24:27], v[80:83], a[104:107], v[24:27]
    ds_read_b64_tr_b16 v[118:119], v210 offset:14336
    s_waitcnt lgkmcnt(12)
    v_mfma_f32_16x16x32_bf16 v[12:15], v[88:91], a[96:99], v[12:15]
    ds_read_b64_tr_b16 v[120:121], v211 offset:2048
    s_add_u32 s51, s51, 8192
    v_mfma_f32_16x16x32_bf16 v[12:15], v[92:95], a[100:103], v[12:15]
    ds_read_b64_tr_b16 v[122:123], v211 offset:6144
    buffer_load_dword v133, v205, s[16:19], s51 offen sc1
    v_mfma_f32_16x16x32_bf16 v[28:31], v[92:95], a[108:111], v[28:31]
    ds_read_b64_tr_b16 v[124:125], v211 offset:10240
    s_add_u32 s51, s51, 8192
    v_mfma_f32_16x16x32_bf16 v[28:31], v[88:91], a[104:107], v[28:31]
    ds_read_b64_tr_b16 v[126:127], v211 offset:14336
    s_waitcnt vmcnt(18) lgkmcnt(12)
    v_mfma_f32_16x16x32_bf16 v[0:3], v[96:99], a[112:115], v[0:3]
    ds_read_b64_tr_b16 v[64:65], v208 offset:16384
    buffer_load_dwordx4 a[176:179], v196, s[4:7], 0 offen offset:2048 sc1
    v_mfma_f32_16x16x32_bf16 v[0:3], v[100:103], a[116:119], v[0:3]
    ds_read_b64_tr_b16 v[66:67], v208 offset:20480
    buffer_load_dwordx4 a[180:183], v196, s[4:7], 0 offen offset:3072 sc1
    v_mfma_f32_16x16x32_bf16 v[16:19], v[100:103], a[124:127], v[16:19]
    ds_read_b64_tr_b16 v[68:69], v208 offset:24576
    v_mfma_f32_16x16x32_bf16 v[16:19], v[96:99], a[120:123], v[16:19]
    ds_read_b64_tr_b16 v[70:71], v208 offset:28672
    s_waitcnt lgkmcnt(12)
    v_mfma_f32_16x16x32_bf16 v[4:7], v[104:107], a[112:115], v[4:7]
    ds_read_b64_tr_b16 v[72:73], v209 offset:16384
    buffer_load_dwordx4 a[184:187], v197, s[4:7], 0 offen offset:2048 sc1
    v_mfma_f32_16x16x32_bf16 v[4:7], v[108:111], a[116:119], v[4:7]
    ds_read_b64_tr_b16 v[74:75], v209 offset:20480
    v_mfma_f32_16x16x32_bf16 v[20:23], v[108:111], a[124:127], v[20:23]
    ds_read_b64_tr_b16 v[76:77], v209 offset:24576
    buffer_load_dwordx4 a[188:191], v197, s[4:7], 0 offen offset:3072 sc1
    v_mfma_f32_16x16x32_bf16 v[20:23], v[104:107], a[120:123], v[20:23]
    ds_read_b64_tr_b16 v[78:79], v209 offset:28672
    s_waitcnt lgkmcnt(12)
    v_mfma_f32_16x16x32_bf16 v[8:11], v[112:115], a[112:115], v[8:11]
    ds_read_b64_tr_b16 v[80:81], v210 offset:16384
    buffer_load_dword v134, v205, s[16:19], s51 offen sc1
    v_mfma_f32_16x16x32_bf16 v[8:11], v[116:119], a[116:119], v[8:11]
    ds_read_b64_tr_b16 v[82:83], v210 offset:20480
    s_add_u32 s51, s51, 8192
    v_mfma_f32_16x16x32_bf16 v[24:27], v[116:119], a[124:127], v[24:27]
    ds_read_b64_tr_b16 v[84:85], v210 offset:24576
    buffer_load_dword v135, v205, s[16:19], s51 offen sc1
    v_mfma_f32_16x16x32_bf16 v[24:27], v[112:115], a[120:123], v[24:27]
    ds_read_b64_tr_b16 v[86:87], v210 offset:28672
    s_waitcnt lgkmcnt(12)
    v_mfma_f32_16x16x32_bf16 v[12:15], v[120:123], a[112:115], v[12:15]
    ds_read_b64_tr_b16 v[88:89], v211 offset:16384
    s_add_u32 s51, s51, 8192
    v_mfma_f32_16x16x32_bf16 v[12:15], v[124:127], a[116:119], v[12:15]
    ds_read_b64_tr_b16 v[90:91], v211 offset:20480
    buffer_load_dword v136, v204, s[16:19], s52 offen sc1
    v_mfma_f32_16x16x32_bf16 v[28:31], v[124:127], a[124:127], v[28:31]
    ds_read_b64_tr_b16 v[92:93], v211 offset:24576
    v_mfma_f32_16x16x32_bf16 v[28:31], v[120:123], a[120:123], v[28:31]
    ds_read_b64_tr_b16 v[94:95], v211 offset:28672
    s_waitcnt vmcnt(21) lgkmcnt(12)
    v_mfma_f32_16x16x32_bf16 v[0:3], v[64:67], a[128:131], v[0:3]
    ds_read_b64_tr_b16 v[96:97], v208 offset:18432
    s_add_u32 s4, s82, 24576
    v_mfma_f32_16x16x32_bf16 v[0:3], v[68:71], a[132:135], v[0:3]
    ds_read_b64_tr_b16 v[98:99], v208 offset:22528
    s_addc_u32 s5, s83, 0
    v_mfma_f32_16x16x32_bf16 v[16:19], v[68:71], a[140:143], v[16:19]
    ds_read_b64_tr_b16 v[100:101], v208 offset:26624
    buffer_load_dwordx4 a[192:195], v196, s[4:7], 0 offen offset:0 sc1
    v_mfma_f32_16x16x32_bf16 v[16:19], v[64:67], a[136:139], v[16:19]
    ds_read_b64_tr_b16 v[102:103], v208 offset:30720
    s_waitcnt lgkmcnt(12)
    v_mfma_f32_16x16x32_bf16 v[4:7], v[72:75], a[128:131], v[4:7]
    ds_read_b64_tr_b16 v[104:105], v209 offset:18432
    v_mfma_f32_16x16x32_bf16 v[4:7], v[76:79], a[132:135], v[4:7]
    ds_read_b64_tr_b16 v[106:107], v209 offset:22528
    v_mfma_f32_16x16x32_bf16 v[20:23], v[76:79], a[140:143], v[20:23]
    ds_read_b64_tr_b16 v[108:109], v209 offset:26624
    buffer_load_dwordx4 a[196:199], v196, s[4:7], 0 offen offset:1024 sc1
    v_mfma_f32_16x16x32_bf16 v[20:23], v[72:75], a[136:139], v[20:23]
    ds_read_b64_tr_b16 v[110:111], v209 offset:30720
    s_waitcnt lgkmcnt(12)
    v_mfma_f32_16x16x32_bf16 v[8:11], v[80:83], a[128:131], v[8:11]
    ds_read_b64_tr_b16 v[112:113], v210 offset:18432
    v_mfma_f32_16x16x32_bf16 v[8:11], v[84:87], a[132:135], v[8:11]
    ds_read_b64_tr_b16 v[114:115], v210 offset:22528
    v_mfma_f32_16x16x32_bf16 v[24:27], v[84:87], a[140:143], v[24:27]
    ds_read_b64_tr_b16 v[116:117], v210 offset:26624
    buffer_load_dwordx4 a[200:203], v197, s[4:7], 0 offen offset:0 sc1
    v_mfma_f32_16x16x32_bf16 v[24:27], v[80:83], a[136:139], v[24:27]
    ds_read_b64_tr_b16 v[118:119], v210 offset:30720
    s_waitcnt lgkmcnt(12)
    v_mfma_f32_16x16x32_bf16 v[12:15], v[88:91], a[128:131], v[12:15]
    ds_read_b64_tr_b16 v[120:121], v211 offset:18432
    v_mfma_f32_16x16x32_bf16 v[12:15], v[92:95], a[132:135], v[12:15]
    ds_read_b64_tr_b16 v[122:123], v211 offset:22528
    v_mfma_f32_16x16x32_bf16 v[28:31], v[92:95], a[140:143], v[28:31]
    ds_read_b64_tr_b16 v[124:125], v211 offset:26624
    buffer_load_dwordx4 a[204:207], v197, s[4:7], 0 offen offset:1024 sc1
    v_mfma_f32_16x16x32_bf16 v[28:31], v[88:91], a[136:139], v[28:31]
    ds_read_b64_tr_b16 v[126:127], v211 offset:30720
    s_waitcnt vmcnt(21) lgkmcnt(12)
    v_mfma_f32_16x16x32_bf16 v[0:3], v[96:99], a[144:147], v[0:3]
    ds_read_b64_tr_b16 v[64:65], v208 offset:32768
    buffer_load_dwordx4 a[208:211], v196, s[4:7], 0 offen offset:2048 sc1
    v_mfma_f32_16x16x32_bf16 v[0:3], v[100:103], a[148:151], v[0:3]
    ds_read_b64_tr_b16 v[66:67], v208 offset:36864
    v_mfma_f32_16x16x32_bf16 v[16:19], v[100:103], a[156:159], v[16:19]
    ds_read_b64_tr_b16 v[68:69], v208 offset:40960
    v_mfma_f32_16x16x32_bf16 v[16:19], v[96:99], a[152:155], v[16:19]
    ds_read_b64_tr_b16 v[70:71], v208 offset:45056
    s_waitcnt lgkmcnt(12)
    v_mfma_f32_16x16x32_bf16 v[4:7], v[104:107], a[144:147], v[4:7]
    ds_read_b64_tr_b16 v[72:73], v209 offset:32768
    buffer_load_dwordx4 a[212:215], v196, s[4:7], 0 offen offset:3072 sc1
    v_mfma_f32_16x16x32_bf16 v[4:7], v[108:111], a[148:151], v[4:7]
    ds_read_b64_tr_b16 v[74:75], v209 offset:36864
    v_mfma_f32_16x16x32_bf16 v[20:23], v[108:111], a[156:159], v[20:23]
    ds_read_b64_tr_b16 v[76:77], v209 offset:40960
    v_mfma_f32_16x16x32_bf16 v[20:23], v[104:107], a[152:155], v[20:23]
    ds_read_b64_tr_b16 v[78:79], v209 offset:45056
    s_waitcnt lgkmcnt(12)
    v_mfma_f32_16x16x32_bf16 v[8:11], v[112:115], a[144:147], v[8:11]
    ds_read_b64_tr_b16 v[80:81], v210 offset:32768
    buffer_load_dwordx4 a[216:219], v197, s[4:7], 0 offen offset:2048 sc1
    v_mfma_f32_16x16x32_bf16 v[8:11], v[116:119], a[148:151], v[8:11]
    ds_read_b64_tr_b16 v[82:83], v210 offset:36864
    v_mfma_f32_16x16x32_bf16 v[24:27], v[116:119], a[156:159], v[24:27]
    ds_read_b64_tr_b16 v[84:85], v210 offset:40960
    v_mfma_f32_16x16x32_bf16 v[24:27], v[112:115], a[152:155], v[24:27]
    ds_read_b64_tr_b16 v[86:87], v210 offset:45056
    s_waitcnt lgkmcnt(12)
    v_mfma_f32_16x16x32_bf16 v[12:15], v[120:123], a[144:147], v[12:15]
    ds_read_b64_tr_b16 v[88:89], v211 offset:32768
    buffer_load_dwordx4 a[220:223], v197, s[4:7], 0 offen offset:3072 sc1
    v_mfma_f32_16x16x32_bf16 v[12:15], v[124:127], a[148:151], v[12:15]
    ds_read_b64_tr_b16 v[90:91], v211 offset:36864
    v_mfma_f32_16x16x32_bf16 v[28:31], v[124:127], a[156:159], v[28:31]
    ds_read_b64_tr_b16 v[92:93], v211 offset:40960
    v_mfma_f32_16x16x32_bf16 v[28:31], v[120:123], a[152:155], v[28:31]
    ds_read_b64_tr_b16 v[94:95], v211 offset:45056
    s_waitcnt vmcnt(18) lgkmcnt(12)
    v_mfma_f32_16x16x32_bf16 v[0:3], v[64:67], a[160:163], v[0:3]
    ds_read_b64_tr_b16 v[96:97], v208 offset:34816
    s_add_u32 s4, s82, 28672
    v_mfma_f32_16x16x32_bf16 v[0:3], v[68:71], a[164:167], v[0:3]
    ds_read_b64_tr_b16 v[98:99], v208 offset:38912
    s_addc_u32 s5, s83, 0
    v_mfma_f32_16x16x32_bf16 v[16:19], v[68:71], a[172:175], v[16:19]
    ds_read_b64_tr_b16 v[100:101], v208 offset:43008
    buffer_load_dwordx4 a[224:227], v196, s[4:7], 0 offen offset:0 sc1
    v_mfma_f32_16x16x32_bf16 v[16:19], v[64:67], a[168:171], v[16:19]
    ds_read_b64_tr_b16 v[102:103], v208 offset:47104
    s_waitcnt lgkmcnt(12)
    v_mfma_f32_16x16x32_bf16 v[4:7], v[72:75], a[160:163], v[4:7]
    ds_read_b64_tr_b16 v[104:105], v209 offset:34816
    v_mfma_f32_16x16x32_bf16 v[4:7], v[76:79], a[164:167], v[4:7]
    ds_read_b64_tr_b16 v[106:107], v209 offset:38912
    v_mfma_f32_16x16x32_bf16 v[20:23], v[76:79], a[172:175], v[20:23]
    ds_read_b64_tr_b16 v[108:109], v209 offset:43008
    buffer_load_dwordx4 a[228:231], v196, s[4:7], 0 offen offset:1024 sc1
    v_mfma_f32_16x16x32_bf16 v[20:23], v[72:75], a[168:171], v[20:23]
    ds_read_b64_tr_b16 v[110:111], v209 offset:47104
    s_waitcnt lgkmcnt(12)
    v_mfma_f32_16x16x32_bf16 v[8:11], v[80:83], a[160:163], v[8:11]
    ds_read_b64_tr_b16 v[112:113], v210 offset:34816
    v_mfma_f32_16x16x32_bf16 v[8:11], v[84:87], a[164:167], v[8:11]
    ds_read_b64_tr_b16 v[114:115], v210 offset:38912
    v_mfma_f32_16x16x32_bf16 v[24:27], v[84:87], a[172:175], v[24:27]
    ds_read_b64_tr_b16 v[116:117], v210 offset:43008
    buffer_load_dwordx4 a[232:235], v197, s[4:7], 0 offen offset:0 sc1
    v_mfma_f32_16x16x32_bf16 v[24:27], v[80:83], a[168:171], v[24:27]
    ds_read_b64_tr_b16 v[118:119], v210 offset:47104
    s_waitcnt lgkmcnt(12)
    v_mfma_f32_16x16x32_bf16 v[12:15], v[88:91], a[160:163], v[12:15]
    ds_read_b64_tr_b16 v[120:121], v211 offset:34816
    v_mfma_f32_16x16x32_bf16 v[12:15], v[92:95], a[164:167], v[12:15]
    ds_read_b64_tr_b16 v[122:123], v211 offset:38912
    v_mfma_f32_16x16x32_bf16 v[28:31], v[92:95], a[172:175], v[28:31]
    ds_read_b64_tr_b16 v[124:125], v211 offset:43008
    buffer_load_dwordx4 a[236:239], v197, s[4:7], 0 offen offset:1024 sc1
    v_mfma_f32_16x16x32_bf16 v[28:31], v[88:91], a[168:171], v[28:31]
    ds_read_b64_tr_b16 v[126:127], v211 offset:47104
    s_waitcnt vmcnt(15) lgkmcnt(12)
    v_mfma_f32_16x16x32_bf16 v[0:3], v[96:99], a[176:179], v[0:3]
    ds_read_b64_tr_b16 v[64:65], v208 offset:49152
    buffer_load_dwordx4 a[240:243], v196, s[4:7], 0 offen offset:2048 sc1
    v_mfma_f32_16x16x32_bf16 v[0:3], v[100:103], a[180:183], v[0:3]
    ds_read_b64_tr_b16 v[66:67], v208 offset:53248
    v_mfma_f32_16x16x32_bf16 v[16:19], v[100:103], a[188:191], v[16:19]
    ds_read_b64_tr_b16 v[68:69], v208 offset:57344
    v_mfma_f32_16x16x32_bf16 v[16:19], v[96:99], a[184:187], v[16:19]
    ds_read_b64_tr_b16 v[70:71], v208 offset:61440
    s_waitcnt lgkmcnt(12)
    v_mfma_f32_16x16x32_bf16 v[4:7], v[104:107], a[176:179], v[4:7]
    ds_read_b64_tr_b16 v[72:73], v209 offset:49152
    buffer_load_dwordx4 a[244:247], v196, s[4:7], 0 offen offset:3072 sc1
    v_mfma_f32_16x16x32_bf16 v[4:7], v[108:111], a[180:183], v[4:7]
    ds_read_b64_tr_b16 v[74:75], v209 offset:53248
    v_mfma_f32_16x16x32_bf16 v[20:23], v[108:111], a[188:191], v[20:23]
    ds_read_b64_tr_b16 v[76:77], v209 offset:57344
    v_mfma_f32_16x16x32_bf16 v[20:23], v[104:107], a[184:187], v[20:23]
    ds_read_b64_tr_b16 v[78:79], v209 offset:61440
    s_waitcnt lgkmcnt(12)
    v_mfma_f32_16x16x32_bf16 v[8:11], v[112:115], a[176:179], v[8:11]
    ds_read_b64_tr_b16 v[80:81], v210 offset:49152
    buffer_load_dwordx4 a[248:251], v197, s[4:7], 0 offen offset:2048 sc1
    v_mfma_f32_16x16x32_bf16 v[8:11], v[116:119], a[180:183], v[8:11]
    ds_read_b64_tr_b16 v[82:83], v210 offset:53248
    v_mfma_f32_16x16x32_bf16 v[24:27], v[116:119], a[188:191], v[24:27]
    ds_read_b64_tr_b16 v[84:85], v210 offset:57344
    v_mfma_f32_16x16x32_bf16 v[24:27], v[112:115], a[184:187], v[24:27]
    ds_read_b64_tr_b16 v[86:87], v210 offset:61440
    s_waitcnt lgkmcnt(12)
    v_mfma_f32_16x16x32_bf16 v[12:15], v[120:123], a[176:179], v[12:15]
    ds_read_b64_tr_b16 v[88:89], v211 offset:49152
    buffer_load_dwordx4 a[252:255], v197, s[4:7], 0 offen offset:3072 sc1
    v_mfma_f32_16x16x32_bf16 v[12:15], v[124:127], a[180:183], v[12:15]
    ds_read_b64_tr_b16 v[90:91], v211 offset:53248
    v_mfma_f32_16x16x32_bf16 v[28:31], v[124:127], a[188:191], v[28:31]
    ds_read_b64_tr_b16 v[92:93], v211 offset:57344
    v_mfma_f32_16x16x32_bf16 v[28:31], v[120:123], a[184:187], v[28:31]
    ds_read_b64_tr_b16 v[94:95], v211 offset:61440
    s_waitcnt vmcnt(12) lgkmcnt(12)
    v_mfma_f32_16x16x32_bf16 v[0:3], v[64:67], a[192:195], v[0:3]
    ds_read_b64_tr_b16 v[96:97], v208 offset:51200
    s_barrier
    v_mfma_f32_16x16x32_bf16 v[0:3], v[68:71], a[196:199], v[0:3]
    ds_read_b64_tr_b16 v[98:99], v208 offset:55296
    s_add_u32 m0, s22, 0
    v_mfma_f32_16x16x32_bf16 v[16:19], v[68:71], a[204:207], v[16:19]
    ds_read_b64_tr_b16 v[100:101], v208 offset:59392
    buffer_load_dwordx4 v228, s[8:11], 0 offen offset:0 lds
    v_mfma_f32_16x16x32_bf16 v[16:19], v[64:67], a[200:203], v[16:19]
    ds_read_b64_tr_b16 v[102:103], v208 offset:63488
    s_waitcnt lgkmcnt(12)
    v_mfma_f32_16x16x32_bf16 v[4:7], v[72:75], a[192:195], v[4:7]
    ds_read_b64_tr_b16 v[104:105], v209 offset:51200
    v_mfma_f32_16x16x32_bf16 v[4:7], v[76:79], a[196:199], v[4:7]
    ds_read_b64_tr_b16 v[106:107], v209 offset:55296
    v_mfma_f32_16x16x32_bf16 v[20:23], v[76:79], a[204:207], v[20:23]
    ds_read_b64_tr_b16 v[108:109], v209 offset:59392
    v_mfma_f32_16x16x32_bf16 v[20:23], v[72:75], a[200:203], v[20:23]
    ds_read_b64_tr_b16 v[110:111], v209 offset:63488
    s_waitcnt lgkmcnt(12)
    v_mfma_f32_16x16x32_bf16 v[8:11], v[80:83], a[192:195], v[8:11]
    ds_read_b64_tr_b16 v[112:113], v210 offset:51200
    v_mfma_f32_16x16x32_bf16 v[8:11], v[84:87], a[196:199], v[8:11]
    ds_read_b64_tr_b16 v[114:115], v210 offset:55296
    v_mfma_f32_16x16x32_bf16 v[24:27], v[84:87], a[204:207], v[24:27]
    ds_read_b64_tr_b16 v[116:117], v210 offset:59392
    v_mfma_f32_16x16x32_bf16 v[24:27], v[80:83], a[200:203], v[24:27]
    ds_read_b64_tr_b16 v[118:119], v210 offset:63488
    s_waitcnt lgkmcnt(12)
    v_mfma_f32_16x16x32_bf16 v[12:15], v[88:91], a[192:195], v[12:15]
    ds_read_b64_tr_b16 v[120:121], v211 offset:51200
    buffer_load_dwordx4 v229, s[8:11], 0 offen offset:1024 lds
    v_mfma_f32_16x16x32_bf16 v[12:15], v[92:95], a[196:199], v[12:15]
    ds_read_b64_tr_b16 v[122:123], v211 offset:55296
    v_mfma_f32_16x16x32_bf16 v[28:31], v[92:95], a[204:207], v[28:31]
    ds_read_b64_tr_b16 v[124:125], v211 offset:59392
    v_mfma_f32_16x16x32_bf16 v[28:31], v[88:91], a[200:203], v[28:31]
    ds_read_b64_tr_b16 v[126:127], v211 offset:63488
    s_waitcnt vmcnt(10) lgkmcnt(12)
    v_mfma_f32_16x16x32_bf16 v[0:3], v[96:99], a[208:211], v[0:3]
    ds_read_b64_tr_b16 v[64:65], v212 offset:0
    s_waitcnt vmcnt(18)
    v_mfma_f32_16x16x32_bf16 v[0:3], v[100:103], a[212:215], v[0:3]
    ds_read_b64_tr_b16 v[66:67], v212 offset:4096
    v_mfma_f32_16x16x32_bf16 v[16:19], v[100:103], a[220:223], v[16:19]
    ds_read_b64_tr_b16 v[68:69], v212 offset:8192
    v_mfma_f32_16x16x32_bf16 v[16:19], v[96:99], a[216:219], v[16:19]
    ds_read_b64_tr_b16 v[70:71], v212 offset:12288
    v_add_f32 v128, v128, v129
    s_waitcnt lgkmcnt(12)
    v_mfma_f32_16x16x32_bf16 v[4:7], v[104:107], a[208:211], v[4:7]
    ds_read_b64_tr_b16 v[72:73], v213 offset:0
    v_mfma_f32_16x16x32_bf16 v[4:7], v[108:111], a[212:215], v[4:7]
    ds_read_b64_tr_b16 v[74:75], v213 offset:4096
    buffer_load_dwordx4 v230, s[8:11], 0 offen offset:2048 lds
    v_mfma_f32_16x16x32_bf16 v[20:23], v[108:111], a[220:223], v[20:23]
    ds_read_b64_tr_b16 v[76:77], v213 offset:8192
    v_add_f32 v128, v128, v130
    v_mfma_f32_16x16x32_bf16 v[20:23], v[104:107], a[216:219], v[20:23]
    ds_read_b64_tr_b16 v[78:79], v213 offset:12288
    s_waitcnt lgkmcnt(12)
    v_mfma_f32_16x16x32_bf16 v[8:11], v[112:115], a[208:211], v[8:11]
    ds_read_b64_tr_b16 v[80:81], v214 offset:0
    v_mfma_f32_16x16x32_bf16 v[8:11], v[116:119], a[212:215], v[8:11]
    ds_read_b64_tr_b16 v[82:83], v214 offset:4096
    v_add_f32 v128, v128, v131
    v_mfma_f32_16x16x32_bf16 v[24:27], v[116:119], a[220:223], v[24:27]
    ds_read_b64_tr_b16 v[84:85], v214 offset:8192
    v_mfma_f32_16x16x32_bf16 v[24:27], v[112:115], a[216:219], v[24:27]
    ds_read_b64_tr_b16 v[86:87], v214 offset:12288
    s_waitcnt lgkmcnt(12)
    v_mfma_f32_16x16x32_bf16 v[12:15], v[120:123], a[208:211], v[12:15]
    ds_read_b64_tr_b16 v[88:89], v215 offset:0
    v_add_f32 v128, v128, v132
    v_mfma_f32_16x16x32_bf16 v[12:15], v[124:127], a[212:215], v[12:15]
    ds_read_b64_tr_b16 v[90:91], v215 offset:4096
    v_mfma_f32_16x16x32_bf16 v[28:31], v[124:127], a[220:223], v[28:31]
    ds_read_b64_tr_b16 v[92:93], v215 offset:8192
    v_mfma_f32_16x16x32_bf16 v[28:31], v[120:123], a[216:219], v[28:31]
    ds_read_b64_tr_b16 v[94:95], v215 offset:12288
    v_add_f32 v128, v128, v133
    s_waitcnt vmcnt(7) lgkmcnt(12)
    v_mfma_f32_16x16x32_bf16 v[0:3], v[64:67], a[224:227], v[0:3]
    ds_read_b64_tr_b16 v[96:97], v212 offset:2048
    buffer_load_dwordx4 v231, s[8:11], 0 offen offset:3072 lds
    v_mfma_f32_16x16x32_bf16 v[0:3], v[68:71], a[228:231], v[0:3]
    ds_read_b64_tr_b16 v[98:99], v212 offset:6144
    s_add_u32 m0, s22, 4096
    v_mfma_f32_16x16x32_bf16 v[16:19], v[68:71], a[236:239], v[16:19]
    ds_read_b64_tr_b16 v[100:101], v212 offset:10240
    v_add_f32 v128, v128, v134
    v_mfma_f32_16x16x32_bf16 v[16:19], v[64:67], a[232:235], v[16:19]
    ds_read_b64_tr_b16 v[102:103], v212 offset:14336
    s_waitcnt lgkmcnt(12)
    v_mfma_f32_16x16x32_bf16 v[4:7], v[72:75], a[224:227], v[4:7]
    ds_read_b64_tr_b16 v[104:105], v213 offset:2048
    v_mfma_f32_16x16x32_bf16 v[4:7], v[76:79], a[228:231], v[4:7]
    ds_read_b64_tr_b16 v[106:107], v213 offset:6144
    v_add_f32 v128, v128, v135
    v_mfma_f32_16x16x32_bf16 v[20:23], v[76:79], a[236:239], v[20:23]
    ds_read_b64_tr_b16 v[108:109], v213 offset:10240
    v_mfma_f32_16x16x32_bf16 v[20:23], v[72:75], a[232:235], v[20:23]
    ds_read_b64_tr_b16 v[110:111], v213 offset:14336
    s_waitcnt lgkmcnt(12)
    v_mfma_f32_16x16x32_bf16 v[8:11], v[80:83], a[224:227], v[8:11]
    ds_read_b64_tr_b16 v[112:113], v214 offset:2048
    v_mov_b32 v129, v128
    v_mfma_f32_16x16x32_bf16 v[8:11], v[84:87], a[228:231], v[8:11]
    ds_read_b64_tr_b16 v[114:115], v214 offset:6144
    buffer_load_dwordx4 v232, s[8:11], 0 offen offset:0 lds
    v_mfma_f32_16x16x32_bf16 v[24:27], v[84:87], a[236:239], v[24:27]
    ds_read_b64_tr_b16 v[116:117], v214 offset:10240
    v_mfma_f32_16x16x32_bf16 v[24:27], v[80:83], a[232:235], v[24:27]
    ds_read_b64_tr_b16 v[118:119], v214 offset:14336
    s_nop 0
    s_waitcnt lgkmcnt(12)
    v_mfma_f32_16x16x32_bf16 v[12:15], v[88:91], a[224:227], v[12:15]
    ds_read_b64_tr_b16 v[120:121], v215 offset:2048
    v_mfma_f32_16x16x32_bf16 v[12:15], v[92:95], a[228:231], v[12:15]
    ds_read_b64_tr_b16 v[122:123], v215 offset:6144
    v_mfma_f32_16x16x32_bf16 v[28:31], v[92:95], a[236:239], v[28:31]
    ds_read_b64_tr_b16 v[124:125], v215 offset:10240
    v_permlane32_swap_b32 v128, v129
    v_mfma_f32_16x16x32_bf16 v[28:31], v[88:91], a[232:235], v[28:31]
    ds_read_b64_tr_b16 v[126:127], v215 offset:14336
    s_waitcnt vmcnt(5) lgkmcnt(12)
    v_mfma_f32_16x16x32_bf16 v[0:3], v[96:99], a[240:243], v[0:3]
    v_mfma_f32_16x16x32_bf16 v[0:3], v[100:103], a[244:247], v[0:3]
    v_add_f32 v128, v128, v129
    v_mfma_f32_16x16x32_bf16 v[16:19], v[100:103], a[252:255], v[16:19]
    v_mfma_f32_16x16x32_bf16 v[16:19], v[96:99], a[248:251], v[16:19]
    buffer_load_dwordx4 v233, s[8:11], 0 offen offset:1024 lds
    s_waitcnt lgkmcnt(8)
    v_mfma_f32_16x16x32_bf16 v[4:7], v[104:107], a[240:243], v[4:7]
    v_add_f32 v128, v128, v136
    v_mfma_f32_16x16x32_bf16 v[4:7], v[108:111], a[244:247], v[4:7]
    v_mfma_f32_16x16x32_bf16 v[20:23], v[108:111], a[252:255], v[20:23]
    v_mfma_f32_16x16x32_bf16 v[20:23], v[104:107], a[248:251], v[20:23]
    v_mov_b32 v130, v128
    s_waitcnt lgkmcnt(4)
    v_mfma_f32_16x16x32_bf16 v[8:11], v[112:115], a[240:243], v[8:11]
    v_mfma_f32_16x16x32_bf16 v[8:11], v[116:119], a[244:247], v[8:11]
    buffer_load_dwordx4 v234, s[8:11], 0 offen offset:2048 lds
    v_mfma_f32_16x16x32_bf16 v[24:27], v[116:119], a[252:255], v[24:27]
    s_add_u32 s8, s8, 458752
    s_nop 0
    v_mfma_f32_16x16x32_bf16 v[24:27], v[112:115], a[248:251], v[24:27]
    s_addc_u32 s9, s9, 0
    s_waitcnt lgkmcnt(0)
    v_mfma_f32_16x16x32_bf16 v[12:15], v[120:123], a[240:243], v[12:15]
    s_add_u32 s22, s22, 28672
    v_mfma_f32_16x16x32_bf16 v[12:15], v[124:127], a[244:247], v[12:15]
    s_cmp_ge_u32 s22, s23
    v_permlane16_swap_b32 v128, v130
    v_mfma_f32_16x16x32_bf16 v[28:31], v[124:127], a[252:255], v[28:31]
    s_cselect_b32 s26, 143360, 0
    v_mfma_f32_16x16x32_bf16 v[28:31], v[120:123], a[248:251], v[28:31]
    s_sub_u32 s22, s22, s26
    s_nop 1
    v_pk_add_f32 v[64:65], v[0:1], v[128:129] op_sel_hi:[1,0] neg_lo:[0,1] neg_hi:[0,1]
    v_cvt_pk_bf16_f32 v32, v64, v65
    v_pk_add_f32 v[66:67], v[2:3], v[128:129] op_sel_hi:[1,0] neg_lo:[0,1] neg_hi:[0,1]
    v_cvt_pk_bf16_f32 v33, v66, v67
    v_pk_add_f32 v[68:69], v[4:5], v[128:129] op_sel_hi:[1,0] neg_lo:[0,1] neg_hi:[0,1]
    v_cvt_pk_bf16_f32 v34, v68, v69
    v_pk_add_f32 v[70:71], v[6:7], v[128:129] op_sel_hi:[1,0] neg_lo:[0,1] neg_hi:[0,1]
    v_cvt_pk_bf16_f32 v35, v70, v71
    buffer_store_dwordx4 v[32:35], v240, s[16:19], s56 offen offset:0 sc1
    v_pk_add_f32 v[80:81], v[16:17], v[130:131] op_sel_hi:[1,0] neg_lo:[0,1] neg_hi:[0,1]
    v_cvt_pk_bf16_f32 v40, v80, v81
    v_pk_add_f32 v[82:83], v[18:19], v[130:131] op_sel_hi:[1,0] neg_lo:[0,1] neg_hi:[0,1]
    v_cvt_pk_bf16_f32 v41, v82, v83
    v_pk_add_f32 v[84:85], v[20:21], v[130:131] op_sel_hi:[1,0] neg_lo:[0,1] neg_hi:[0,1]
    v_cvt_pk_bf16_f32 v42, v84, v85
    v_pk_add_f32 v[86:87], v[22:23], v[130:131] op_sel_hi:[1,0] neg_lo:[0,1] neg_hi:[0,1]
    v_cvt_pk_bf16_f32 v43, v86, v87
    buffer_store_dwordx4 v[40:43], v240, s[16:19], s57 offen offset:0 sc1
    v_pk_add_f32 v[72:73], v[8:9], v[128:129] op_sel_hi:[1,0] neg_lo:[0,1] neg_hi:[0,1]
    v_cvt_pk_bf16_f32 v36, v72, v73
    v_pk_add_f32 v[74:75], v[10:11], v[128:129] op_sel_hi:[1,0] neg_lo:[0,1] neg_hi:[0,1]
    v_cvt_pk_bf16_f32 v37, v74, v75
    v_pk_add_f32 v[76:77], v[12:13], v[128:129] op_sel_hi:[1,0] neg_lo:[0,1] neg_hi:[0,1]
    v_cvt_pk_bf16_f32 v38, v76, v77
    v_pk_add_f32 v[78:79], v[14:15], v[128:129] op_sel_hi:[1,0] neg_lo:[0,1] neg_hi:[0,1]
    v_cvt_pk_bf16_f32 v39, v78, v79
    buffer_store_dwordx4 v[36:39], v240, s[16:19], s56 offen offset:1024 sc1
    v_pk_add_f32 v[88:89], v[24:25], v[130:131] op_sel_hi:[1,0] neg_lo:[0,1] neg_hi:[0,1]
    v_cvt_pk_bf16_f32 v44, v88, v89
    v_pk_add_f32 v[90:91], v[26:27], v[130:131] op_sel_hi:[1,0] neg_lo:[0,1] neg_hi:[0,1]
    v_cvt_pk_bf16_f32 v45, v90, v91
    v_pk_add_f32 v[92:93], v[28:29], v[130:131] op_sel_hi:[1,0] neg_lo:[0,1] neg_hi:[0,1]
    v_cvt_pk_bf16_f32 v46, v92, v93
    v_pk_add_f32 v[94:95], v[30:31], v[130:131] op_sel_hi:[1,0] neg_lo:[0,1] neg_hi:[0,1]
    v_cvt_pk_bf16_f32 v47, v94, v95
    buffer_store_dwordx4 v[44:47], v240, s[16:19], s57 offen offset:1024 sc1
    v_pk_mul_f32 v[52:53], v[64:65], v[64:65]
    v_pk_mul_f32 v[54:55], v[80:81], v[80:81]
    v_pk_fma_f32 v[52:53], v[66:67], v[66:67], v[52:53]
    v_pk_fma_f32 v[54:55], v[82:83], v[82:83], v[54:55]
    v_pk_fma_f32 v[52:53], v[68:69], v[68:69], v[52:53]
    v_pk_fma_f32 v[54:55], v[84:85], v[84:85], v[54:55]
    v_pk_fma_f32 v[52:53], v[70:71], v[70:71], v[52:53]
    v_pk_fma_f32 v[54:55], v[86:87], v[86:87], v[54:55]
    v_pk_fma_f32 v[52:53], v[72:73], v[72:73], v[52:53]
    v_pk_fma_f32 v[54:55], v[88:89], v[88:89], v[54:55]
    v_pk_fma_f32 v[52:53], v[74:75], v[74:75], v[52:53]
    v_pk_fma_f32 v[54:55], v[90:91], v[90:91], v[54:55]
    v_pk_fma_f32 v[52:53], v[76:77], v[76:77], v[52:53]
    v_pk_fma_f32 v[54:55], v[92:93], v[92:93], v[54:55]
    v_pk_fma_f32 v[52:53], v[78:79], v[78:79], v[52:53]
    v_pk_fma_f32 v[54:55], v[94:95], v[94:95], v[54:55]
    v_add_f32 v52, v52, v53
    v_add_f32 v54, v54, v55
    v_cvt_pk_bf16_f32 v48, v0, v1
    v_accvgpr_write_b32 a240, v48
    v_permlane16_swap_b32 v52, v54
    s_nop 0
    v_add_f32 v52, v52, v54
    v_mov_b32 v53, v52
    v_cvt_pk_bf16_f32 v49, v2, v3
    v_accvgpr_write_b32 a241, v49
    v_permlane32_swap_b32 v52, v53
    s_nop 0
    v_add_f32 v52, v52, v53
    s_mov_b32 exec_hi, 0
    buffer_store_dword v52, v204, s[16:19], s50 offen sc1
    s_mov_b64 exec, -1
    v_cvt_pk_bf16_f32 v48, v4, v5
    v_accvgpr_write_b32 a242, v48
    v_cvt_pk_bf16_f32 v49, v6, v7
    v_accvgpr_write_b32 a243, v49
    v_cvt_pk_bf16_f32 v48, v8, v9
    v_accvgpr_write_b32 a244, v48
    v_cvt_pk_bf16_f32 v49, v10, v11
    v_accvgpr_write_b32 a245, v49
    v_cvt_pk_bf16_f32 v48, v12, v13
    v_accvgpr_write_b32 a246, v48
    v_cvt_pk_bf16_f32 v49, v14, v15
    v_accvgpr_write_b32 a247, v49
    v_cvt_pk_bf16_f32 v48, v16, v17
    v_accvgpr_write_b32 a248, v48
    v_cvt_pk_bf16_f32 v49, v18, v19
    v_accvgpr_write_b32 a249, v49
    v_cvt_pk_bf16_f32 v48, v20, v21
    v_accvgpr_write_b32 a250, v48
    v_cvt_pk_bf16_f32 v49, v22, v23
    v_accvgpr_write_b32 a251, v49
    v_cvt_pk_bf16_f32 v48, v24, v25
    v_accvgpr_write_b32 a252, v48
    v_cvt_pk_bf16_f32 v49, v26, v27
    v_accvgpr_write_b32 a253, v49
    v_cvt_pk_bf16_f32 v48, v28, v29
    v_accvgpr_write_b32 a254, v48
    v_cvt_pk_bf16_f32 v49, v30, v31
    v_accvgpr_write_b32 a255, v49
    s_lshl_b32 s50, s30, 7
    v_subrev_u32 v242, s50, v220
    v_subrev_u32 v243, s50, v221
    v_accvgpr_write_b32 a236, v208
    v_accvgpr_write_b32 a237, v209
    v_accvgpr_write_b32 a238, v210
    v_accvgpr_write_b32 a239, v211
    v_accvgpr_write_b32 a230, v198
    v_accvgpr_write_b32 a231, v199
    v_accvgpr_write_b32 a232, v200
    v_accvgpr_write_b32 a233, v201
    v_accvgpr_write_b32 a234, v202
    v_accvgpr_write_b32 a235, v203
    v_pk_mov_b32 v[56:57], 0, 0
    v_pk_mov_b32 v[58:59], 0, 0
    v_pk_mov_b32 v[60:61], 0, 0
    v_pk_mov_b32 v[62:63], 0, 0
    v_pk_mov_b32 v[64:65], 0, 0
    v_pk_mov_b32 v[66:67], 0, 0
    v_pk_mov_b32 v[68:69], 0, 0
    v_pk_mov_b32 v[70:71], 0, 0
    v_pk_mov_b32 v[72:73], 0, 0
    v_pk_mov_b32 v[74:75], 0, 0
    v_pk_mov_b32 v[76:77], 0, 0
    v_pk_mov_b32 v[78:79], 0, 0
    v_pk_mov_b32 v[80:81], 0, 0
    v_pk_mov_b32 v[82:83], 0, 0
    v_pk_mov_b32 v[84:85], 0, 0
    v_pk_mov_b32 v[86:87], 0, 0
    v_pk_mov_b32 v[88:89], 0, 0
    v_pk_mov_b32 v[90:91], 0, 0
    v_pk_mov_b32 v[92:93], 0, 0
    v_pk_mov_b32 v[94:95], 0, 0
    v_pk_mov_b32 v[96:97], 0, 0
    v_pk_mov_b32 v[98:99], 0, 0
    v_pk_mov_b32 v[100:101], 0, 0
    v_pk_mov_b32 v[102:103], 0, 0
    v_pk_mov_b32 v[104:105], 0, 0
    v_pk_mov_b32 v[106:107], 0, 0
    v_pk_mov_b32 v[108:109], 0, 0
    v_pk_mov_b32 v[110:111], 0, 0
    v_pk_mov_b32 v[112:113], 0, 0
    v_pk_mov_b32 v[114:115], 0, 0
    v_pk_mov_b32 v[116:117], 0, 0
    v_pk_mov_b32 v[118:119], 0, 0
    v_pk_mov_b32 v[120:121], 0, 0
    v_pk_mov_b32 v[122:123], 0, 0
    v_pk_mov_b32 v[124:125], 0, 0
    v_pk_mov_b32 v[126:127], 0, 0
    v_pk_mov_b32 v[128:129], 0, 0
    v_pk_mov_b32 v[130:131], 0, 0
    v_pk_mov_b32 v[132:133], 0, 0
    v_pk_mov_b32 v[134:135], 0, 0
    v_pk_mov_b32 v[136:137], 0, 0
    v_pk_mov_b32 v[138:139], 0, 0
    v_pk_mov_b32 v[140:141], 0, 0
    v_pk_mov_b32 v[142:143], 0, 0
    v_pk_mov_b32 v[144:145], 0, 0
    v_pk_mov_b32 v[146:147], 0, 0
    v_pk_mov_b32 v[148:149], 0, 0
    v_pk_mov_b32 v[150:151], 0, 0
    v_pk_mov_b32 v[152:153], 0, 0
    v_pk_mov_b32 v[154:155], 0, 0
    v_pk_mov_b32 v[156:157], 0, 0
    v_pk_mov_b32 v[158:159], 0, 0
    v_pk_mov_b32 v[160:161], 0, 0
    v_pk_mov_b32 v[162:163], 0, 0
    v_pk_mov_b32 v[164:165], 0, 0
    v_pk_mov_b32 v[166:167], 0, 0
    v_pk_mov_b32 v[168:169], 0, 0
    v_pk_mov_b32 v[170:171], 0, 0
    v_pk_mov_b32 v[172:173], 0, 0
    v_pk_mov_b32 v[174:175], 0, 0
    v_pk_mov_b32 v[176:177], 0, 0
    v_pk_mov_b32 v[178:179], 0, 0
    v_pk_mov_b32 v[180:181], 0, 0
    v_pk_mov_b32 v[182:183], 0, 0
    v_pk_mov_b32 v[184:185], 0, 0
    v_pk_mov_b32 v[186:187], 0, 0
    v_pk_mov_b32 v[188:189], 0, 0
    v_pk_mov_b32 v[190:191], 0, 0
    v_pk_mov_b32 v[192:193], 0, 0
    v_pk_mov_b32 v[194:195], 0, 0
    v_pk_mov_b32 v[196:197], 0, 0
    v_pk_mov_b32 v[198:199], 0, 0
    v_pk_mov_b32 v[200:201], 0, 0
    v_pk_mov_b32 v[202:203], 0, 0
    v_pk_mov_b32 v[204:205], 0, 0
    v_pk_mov_b32 v[206:207], 0, 0
    v_pk_mov_b32 v[208:209], 0, 0
    v_pk_mov_b32 v[210:211], 0, 0
    v_pk_mov_b32 v[212:213], 0, 0
    v_pk_mov_b32 v[214:215], 0, 0
    v_pk_mov_b32 v[216:217], 0, 0
    v_pk_mov_b32 v[218:219], 0, 0
    v_pk_mov_b32 v[220:221], 0, 0
    v_pk_mov_b32 v[222:223], 0, 0
    s_lshr_b32 s50, s29, 1
    s_lshl_b32 s50, s50, 5
    s_and_b32 s51, s41, 31
    s_lshl_b32 s58, s50, 8
    s_lshl_b32 s59, s51, 2
    s_add_u32 s59, s58, s59
    s_add_u32 s59, s59, 33751040
    v_lshlrev_b32 v237, 8, v255
    v_mov_b32 v238, s33
    s_waitcnt vmcnt(0)
    s_barrier
    s_cmp_lg_u32 s3, 0
    s_cbranch_scc1 L_nosend3
    s_mov_b32 exec_hi, 0
    buffer_store_dword v238, v237, s[16:19], s59 offen sc1
    s_mov_b64 exec, -1
L_nosend3:
    s_add_u32 m0, s22, 0
    s_nop 0
    buffer_load_dwordx4 v228, s[8:11], 0 offen offset:0 lds
    buffer_load_dwordx4 v229, s[8:11], 0 offen offset:1024 lds
    buffer_load_dwordx4 v230, s[8:11], 0 offen offset:2048 lds
    buffer_load_dwordx4 v231, s[8:11], 0 offen offset:3072 lds
    s_add_u32 m0, s22, 4096
    s_nop 0
    buffer_load_dwordx4 v232, s[8:11], 0 offen offset:0 lds
    buffer_load_dwordx4 v233, s[8:11], 0 offen offset:1024 lds
    buffer_load_dwordx4 v234, s[8:11], 0 offen offset:2048 lds
    s_add_u32 s8, s8, 458752
    s_addc_u32 s9, s9, 0
    s_add_u32 s22, s22, 28672
    s_cmp_ge_u32 s22, s23
    s_cselect_b32 s26, 143360, 0
    s_sub_u32 s22, s22, s26
    s_add_u32 m0, s22, 0
    s_nop 0
    buffer_load_dwordx4 v228, s[8:11], 0 offen offset:0 lds
    buffer_load_dwordx4 v229, s[8:11], 0 offen offset:1024 lds
    buffer_load_dwordx4 v230, s[8:11], 0 offen offset:2048 lds
    buffer_load_dwordx4 v231, s[8:11], 0 offen offset:3072 lds
    s_add_u32 m0, s22, 4096
    s_nop 0
    buffer_load_dwordx4 v232, s[8:11], 0 offen offset:0 lds
    buffer_load_dwordx4 v233, s[8:11], 0 offen offset:1024 lds
    buffer_load_dwordx4 v234, s[8:11], 0 offen offset:2048 lds
    s_add_u32 s8, s8, 458752
    s_addc_u32 s9, s9, 0
    s_add_u32 s22, s22, 28672
    s_cmp_ge_u32 s22, s23
    s_cselect_b32 s26, 143360, 0
    s_sub_u32 s22, s22, s26
    v_pk_mov_b32 v[0:1], 0, 0
    v_pk_mov_b32 v[2:3], 0, 0
    v_pk_mov_b32 v[4:5], 0, 0
    v_pk_mov_b32 v[6:7], 0, 0
    v_pk_mov_b32 v[8:9], 0, 0
    v_pk_mov_b32 v[10:11], 0, 0
    v_pk_mov_b32 v[12:13], 0, 0
    v_pk_mov_b32 v[14:15], 0, 0
    v_pk_mov_b32 v[16:17], 0, 0
    v_pk_mov_b32 v[18:19], 0, 0
    v_pk_mov_b32 v[20:21], 0, 0
    v_pk_mov_b32 v[22:23], 0, 0
    v_pk_mov_b32 v[24:25], 0, 0
    v_pk_mov_b32 v[26:27], 0, 0
    v_pk_mov_b32 v[28:29], 0, 0
    v_pk_mov_b32 v[30:31], 0, 0
    v_pk_mov_b32 v[32:33], 0, 0
    v_pk_mov_b32 v[34:35], 0, 0
    v_pk_mov_b32 v[36:37], 0, 0
    v_pk_mov_b32 v[38:39], 0, 0
    v_pk_mov_b32 v[40:41], 0, 0
    v_pk_mov_b32 v[42:43], 0, 0
    v_pk_mov_b32 v[44:45], 0, 0
    v_pk_mov_b32 v[46:47], 0, 0
    v_pk_mov_b32 v[48:49], 0, 0
    v_pk_mov_b32 v[50:51], 0, 0
    v_pk_mov_b32 v[52:53], 0, 0
    v_pk_mov_b32 v[54:55], 0, 0
    s_lshl_b32 s50, s31, 4
    s_lshl_b32 s51, s3, 2
    s_add_u32 s50, s50, s51
    s_lshl_b32 s51, s50, 15
    s_add_u32 s51, s51, 8388608
    v_add_u32 v224, s51, v240
    v_add_u32 v225, 32768, v224
    v_add_u32 v226, 65536, v224
    v_add_u32 v227, 98304, v224
    v_lshrrev_b32 v237, 2, v255
    v_mul_u32_u24 v237, 224, v237
    v_and_b32 v238, 3, v255
    v_lshl_add_u32 v236, v238, 3, v237
    v_add_u32 v235, 86016, v236
    s_mov_b32 s24, 114688
    s_add_u32 s4, s82, 0
    s_addc_u32 s5, s83, 0
    s_mul_i32 s51, s32, 7
    s_add_u32 s51, s51, 1
    s_lshr_b32 s51, s51, 1
    s_mul_i32 s52, s50, 112
    s_add_u32 s51, s51, s52
    s_lshl_b32 s51, s51, 10
    s_add_u32 s51, s51, 12582912
    v_add_u32 v252, s51, v240
    s_and_b32 s52, s32, 1
    s_cselect_b32 s53, 0, 67108992
    s_mul_i32 s52, s52, -3584
    s_add_u32 s52, s52, 3072
    s_add_u32 s51, s51, s52
    v_cmp_le_u32 vcc, 48, v255
    v_lshl_add_u32 v253, v255, 3, s51
    v_add_u32 v237, s53, v253
    v_cndmask_b32 v253, v253, v237, vcc
    s_lshl_b32 s48, s50, 6
    s_add_u32 s48, s48, 32768000
    s_lshl_b32 s49, s3, 12
    s_and_b32 s57, s30, 1
    s_mul_i32 s57, s57, 3670016
    s_lshr_b32 s47, s3, 1
    s_mul_i32 s47, s47, 196608
    s_add_u32 s57, s57, s47
    s_add_u32 s20, s82, 41943168
    s_addc_u32 s21, s83, 0
    s_xor_b32 s56, s30, 1
    s_and_b32 s55, s56, 7
    s_cmp_eq_u32 s55, 3
    s_cselect_b32 s64, s20, s76
    s_cselect_b32 s65, s21, s77
    s_lshl_b32 s56, s56, 7
    s_add_u32 s56, s56, s57
    s_add_u32 s64, s64, s56
    s_addc_u32 s65, s65, 0
    s_xor_b32 s56, s30, 0
    s_and_b32 s55, s56, 7
    s_cmp_eq_u32 s55, 3
    s_cselect_b32 s66, s20, s76
    s_cselect_b32 s67, s21, s77
    s_lshl_b32 s56, s56, 7
    s_add_u32 s56, s56, s57
    s_add_u32 s66, s66, s56
    s_addc_u32 s67, s67, 0
    s_getpc_b64 s[52:53]
L_pc2:
    s_sub_u32 s52, s52, L_pc2-sequential_preLN__linear_attn_block__glu_gated_glu__prompt_kernel
    s_subb_u32 s53, s53, 0
    s_mov_b32 s54, L_end-sequential_preLN__linear_attn_block__glu_gated_glu__prompt_kernel
    s_mov_b32 s55, 0x20000
    s_lshr_b32 s56, s2, 3
    s_lshl_b32 s56, s56, 2
    s_add_u32 s56, s56, s3
    s_mul_i32 s56, s56, 640
    s_mov_b32 s12, s76
    s_mov_b32 s13, s77
    s_mov_b32 s14, 7340032
    s_mov_b32 s15, 0x20000
    s_cmp_ge_u32 s3, 2
    s_cselect_b32 s84, s74, s72
    s_cselect_b32 s85, s75, s73
    s_mov_b32 s86, 7340032
    s_mov_b32 s87, 0x20000
    v_lshlrev_b32 v244, 2, v255
    s_mov_b32 s35, 114688
    s_mov_b32 s36, 229376
    s_mov_b32 s37, 344064
    s_mul_i32 s46, s45, 3584
    s_add_u32 s46, s46, 2293760
    s_mul_i32 s50, s43, 114688
    s_and_b32 s51, s30, 1
    s_mul_i32 s51, s51, 57344
    s_add_u32 s50, s50, s51
    s_add_u32 s50, s50, 12582912
    s_add_u32 s68, s82, s50
    s_addc_u32 s69, s83, 0
    s_lshr_b32 s50, s44, 6
    s_mul_i32 s50, s50, 7
    s_bfe_u32 s51, s44, 0x10005
    s_lshl_b32 s51, s51, 2
    s_add_u32 s50, s50, s51
    s_lshl_b32 s50, s50, 16
    s_and_b32 s51, s44, 31
    s_lshl_b32 s51, s51, 11
    s_add_u32 s40, s50, s51
    s_lshl_b32 s28, s41, 8
    s_add_u32 s28, s28, 33816576
    s_lshl_b32 s50, s31, 5
    s_lshr_b32 s51, s32, 4
    s_add_u32 s27, s50, s51
    s_lshl_b32 s27, s27, 8
    s_and_b32 s51, s32, 15
    s_lshl_b32 s51, s51, 2
    s_add_u32 s27, s27, s51
    s_add_u32 s27, s27, 33816576
    s_add_u32 s50, s50, s32
    s_lshl_b32 s58, s50, 8
    s_add_u32 s58, s58, 33751040
    v_and_b32 v237, 31, v255
    v_lshlrev_b32 v237, 2, v237
    s_mov_b32 s59, 0x20000
L_poll3:
    buffer_load_dword v238, v237, s[16:19], s58 offen sc1
    s_sub_u32 s59, s59, 1
    s_cbranch_scc1 L_polldone3
    s_waitcnt vmcnt(0)
    v_cmp_ne_u32 vcc, s33, v238
    s_cmp_lg_u64 vcc, 0
    s_cbranch_scc1 L_poll3
L_polldone3:
    buffer_load_dwordx4 a[0:3], v224, s[4:7], 0 offen offset:0 sc1
    buffer_load_dwordx4 a[4:7], v224, s[4:7], 0 offen offset:1024 sc1
    buffer_load_dwordx4 a[8:11], v225, s[4:7], 0 offen offset:0 sc1
    buffer_load_dwordx4 a[12:15], v225, s[4:7], 0 offen offset:1024 sc1
    buffer_load_dwordx4 a[16:19], v226, s[4:7], 0 offen offset:0 sc1
    buffer_load_dwordx4 a[20:23], v226, s[4:7], 0 offen offset:1024 sc1
    buffer_load_dwordx4 a[24:27], v227, s[4:7], 0 offen offset:0 sc1
    buffer_load_dwordx4 a[28:31], v227, s[4:7], 0 offen offset:1024 sc1
    buffer_load_dwordx4 a[32:35], v224, s[4:7], 0 offen offset:2048 sc1
    buffer_load_dwordx4 a[36:39], v224, s[4:7], 0 offen offset:3072 sc1
    buffer_load_dwordx4 a[40:43], v225, s[4:7], 0 offen offset:2048 sc1
    buffer_load_dwordx4 a[44:47], v225, s[4:7], 0 offen offset:3072 sc1
    buffer_load_dwordx4 a[48:51], v226, s[4:7], 0 offen offset:2048 sc1
    buffer_load_dwordx4 a[52:55], v226, s[4:7], 0 offen offset:3072 sc1
    buffer_load_dwordx4 a[56:59], v227, s[4:7], 0 offen offset:2048 sc1
    buffer_load_dwordx4 a[60:63], v227, s[4:7], 0 offen offset:3072 sc1
    s_add_u32 s4, s4, 4096
    s_addc_u32 s5, s5, 0
    buffer_load_dwordx4 a[64:67], v224, s[4:7], 0 offen offset:0 sc1
    buffer_load_dwordx4 a[68:71], v224, s[4:7], 0 offen offset:1024 sc1
    buffer_load_dwordx4 a[72:75], v225, s[4:7], 0 offen offset:0 sc1
    buffer_load_dwordx4 a[76:79], v225, s[4:7], 0 offen offset:1024 sc1
    buffer_load_dwordx4 a[80:83], v226, s[4:7], 0 offen offset:0 sc1
    buffer_load_dwordx4 a[84:87], v226, s[4:7], 0 offen offset:1024 sc1
    buffer_load_dwordx4 a[88:91], v227, s[4:7], 0 offen offset:0 sc1
    buffer_load_dwordx4 a[92:95], v227, s[4:7], 0 offen offset:1024 sc1
    s_waitcnt vmcnt(43)
    s_barrier
    ds_read_b64_tr_b16 a[128:129], v235 offset:0
    ds_read_b64_tr_b16 a[130:131], v235 offset:3584
    ds_read_b64_tr_b16 a[132:133], v235 offset:7168
    ds_read_b64_tr_b16 a[134:135], v235 offset:10752
    ds_read_b64_tr_b16 a[136:137], v235 offset:14336
    ds_read_b64_tr_b16 a[138:139], v235 offset:17920
    ds_read_b64_tr_b16 a[140:141], v235 offset:21504
    ds_read_b64_tr_b16 a[142:143], v235 offset:25088
    ds_read_b64_tr_b16 a[144:145], v235 offset:32
    ds_read_b64_tr_b16 a[146:147], v235 offset:3616
    ds_read_b64_tr_b16 a[148:149], v235 offset:7200
    ds_read_b64_tr_b16 a[150:151], v235 offset:10784
    s_mov_b32 s25, 3
.p2align 3
L_p3:
    s_waitcnt vmcnt(16) lgkmcnt(8)
    v_mfma_f32_16x16x32_bf16 v[0:3], a[128:131], a[0:3], v[0:3]
    ds_read_b64_tr_b16 a[152:153], v235 offset:14368
    buffer_load_dwordx4 a[96:99], v224, s[4:7], 0 offen offset:2048 sc1
    v_mfma_f32_16x16x32_bf16 v[0:3], a[132:135], a[4:7], v[0:3]
    s_add_u32 m0, s22, 0
    v_mfma_f32_16x16x32_bf16 v[56:59], a[132:135], a[12:15], v[56:59]
    ds_read_b64_tr_b16 a[154:155], v235 offset:17952
    v_mfma_f32_16x16x32_bf16 v[56:59], a[128:131], a[8:11], v[56:59]
    v_mfma_f32_16x16x32_bf16 v[112:115], a[128:131], a[16:19], v[112:115]
    ds_read_b64_tr_b16 a[156:157], v235 offset:21536
    v_mfma_f32_16x16x32_bf16 v[112:115], a[132:135], a[20:23], v[112:115]
    v_mfma_f32_16x16x32_bf16 v[168:171], a[132:135], a[28:31], v[168:171]
    ds_read_b64_tr_b16 a[158:159], v235 offset:25120
    v_mfma_f32_16x16x32_bf16 v[168:171], a[128:131], a[24:27], v[168:171]
    buffer_load_dwordx4 v228, s[8:11], 0 offen offset:0 lds
    s_waitcnt lgkmcnt(8)
    v_mfma_f32_16x16x32_bf16 v[4:7], a[136:139], a[0:3], v[4:7]
    ds_read_b64_tr_b16 a[128:129], v235 offset:64
    v_mfma_f32_16x16x32_bf16 v[4:7], a[140:143], a[4:7], v[4:7]
    v_mfma_f32_16x16x32_bf16 v[60:63], a[140:143], a[12:15], v[60:63]
    ds_read_b64_tr_b16 a[130:131], v235 offset:3648
    v_mfma_f32_16x16x32_bf16 v[60:63], a[136:139], a[8:11], v[60:63]
    v_mfma_f32_16x16x32_bf16 v[116:119], a[136:139], a[16:19], v[116:119]
    ds_read_b64_tr_b16 a[132:133], v235 offset:7232
    v_mfma_f32_16x16x32_bf16 v[116:119], a[140:143], a[20:23], v[116:119]
    v_mfma_f32_16x16x32_bf16 v[172:175], a[140:143], a[28:31], v[172:175]
    ds_read_b64_tr_b16 a[134:135], v235 offset:10816
    buffer_load_dwordx4 a[100:103], v224, s[4:7], 0 offen offset:3072 sc1
    v_mfma_f32_16x16x32_bf16 v[172:175], a[136:139], a[24:27], v[172:175]
    v_add_u32 v237, s24, v236
    s_waitcnt lgkmcnt(8)
    v_mfma_f32_16x16x32_bf16 v[8:11], a[144:147], a[0:3], v[8:11]
    ds_read_b64_tr_b16 a[136:137], v235 offset:14400
    s_add_u32 s24, s24, 28672
    v_mfma_f32_16x16x32_bf16 v[8:11], a[148:151], a[4:7], v[8:11]
    s_cmp_ge_u32 s24, 143360
    v_mfma_f32_16x16x32_bf16 v[64:67], a[148:151], a[12:15], v[64:67]
    ds_read_b64_tr_b16 a[138:139], v235 offset:17984
    s_cselect_b32 s24, 0, s24
    v_mfma_f32_16x16x32_bf16 v[64:67], a[144:147], a[8:11], v[64:67]
    v_mfma_f32_16x16x32_bf16 v[120:123], a[144:147], a[16:19], v[120:123]
    ds_read_b64_tr_b16 a[140:141], v235 offset:21568
    v_mfma_f32_16x16x32_bf16 v[120:123], a[148:151], a[20:23], v[120:123]
    buffer_load_dwordx4 v229, s[8:11], 0 offen offset:1024 lds
    v_mfma_f32_16x16x32_bf16 v[176:179], a[148:151], a[28:31], v[176:179]
    ds_read_b64_tr_b16 a[142:143], v235 offset:25152
    v_mfma_f32_16x16x32_bf16 v[176:179], a[144:147], a[24:27], v[176:179]
    s_waitcnt lgkmcnt(8)
    v_mfma_f32_16x16x32_bf16 v[12:15], a[152:155], a[0:3], v[12:15]
    ds_read_b64_tr_b16 a[144:145], v235 offset:96
    v_mfma_f32_16x16x32_bf16 v[12:15], a[156:159], a[4:7], v[12:15]
    v_mfma_f32_16x16x32_bf16 v[68:71], a[156:159], a[12:15], v[68:71]
    ds_read_b64_tr_b16 a[146:147], v235 offset:3680
    v_mfma_f32_16x16x32_bf16 v[68:71], a[152:155], a[8:11], v[68:71]
    v_mfma_f32_16x16x32_bf16 v[124:127], a[152:155], a[16:19], v[124:127]
    ds_read_b64_tr_b16 a[148:149], v235 offset:7264
    buffer_load_dwordx4 a[104:107], v225, s[4:7], 0 offen offset:2048 sc1
    v_mfma_f32_16x16x32_bf16 v[124:127], a[156:159], a[20:23], v[124:127]
    v_mfma_f32_16x16x32_bf16 v[180:183], a[156:159], a[28:31], v[180:183]
    ds_read_b64_tr_b16 a[150:151], v235 offset:10848
    v_mfma_f32_16x16x32_bf16 v[180:183], a[152:155], a[24:27], v[180:183]
    s_waitcnt lgkmcnt(8)
    v_mfma_f32_16x16x32_bf16 v[16:19], a[128:131], a[0:3], v[16:19]
    ds_read_b64_tr_b16 a[152:153], v235 offset:14432
    v_mfma_f32_16x16x32_bf16 v[16:19], a[132:135], a[4:7], v[16:19]
    v_mfma_f32_16x16x32_bf16 v[72:75], a[132:135], a[12:15], v[72:75]
    ds_read_b64_tr_b16 a[154:155], v235 offset:18016
    v_mfma_f32_16x16x32_bf16 v[72:75], a[128:131], a[8:11], v[72:75]
    buffer_load_dwordx4 v230, s[8:11], 0 offen offset:2048 lds
    v_mfma_f32_16x16x32_bf16 v[128:131], a[128:131], a[16:19], v[128:131]
    ds_read_b64_tr_b16 a[156:157], v235 offset:21600
    v_mfma_f32_16x16x32_bf16 v[128:131], a[132:135], a[20:23], v[128:131]
    v_mfma_f32_16x16x32_bf16 v[184:187], a[132:135], a[28:31], v[184:187]
    ds_read_b64_tr_b16 a[158:159], v235 offset:25184
    v_mfma_f32_16x16x32_bf16 v[184:187], a[128:131], a[24:27], v[184:187]
    s_waitcnt lgkmcnt(8)
    v_mfma_f32_16x16x32_bf16 v[20:23], a[136:139], a[0:3], v[20:23]
    ds_read_b64_tr_b16 a[128:129], v235 offset:128
    v_mfma_f32_16x16x32_bf16 v[20:23], a[140:143], a[4:7], v[20:23]
    v_mfma_f32_16x16x32_bf16 v[76:79], a[140:143], a[12:15], v[76:79]
    ds_read_b64_tr_b16 a[130:131], v235 offset:3712
    buffer_load_dwordx4 a[108:111], v225, s[4:7], 0 offen offset:3072 sc1
    v_mfma_f32_16x16x32_bf16 v[76:79], a[136:139], a[8:11], v[76:79]
    v_mfma_f32_16x16x32_bf16 v[132:135], a[136:139], a[16:19], v[132:135]
    ds_read_b64_tr_b16 a[132:133], v235 offset:7296
    v_mfma_f32_16x16x32_bf16 v[132:135], a[140:143], a[20:23], v[132:135]
    v_mfma_f32_16x16x32_bf16 v[188:191], a[140:143], a[28:31], v[188:191]
    ds_read_b64_tr_b16 a[134:135], v235 offset:10880
    v_mfma_f32_16x16x32_bf16 v[188:191], a[136:139], a[24:27], v[188:191]
    s_waitcnt lgkmcnt(8)
    v_mfma_f32_16x16x32_bf16 v[24:27], a[144:147], a[0:3], v[24:27]
    ds_read_b64_tr_b16 a[136:137], v235 offset:14464
    v_mfma_f32_16x16x32_bf16 v[24:27], a[148:151], a[4:7], v[24:27]
    buffer_load_dwordx4 v231, s[8:11], 0 offen offset:3072 lds
    v_mfma_f32_16x16x32_bf16 v[80:83], a[148:151], a[12:15], v[80:83]
    ds_read_b64_tr_b16 a[138:139], v235 offset:18048
    v_mfma_f32_16x16x32_bf16 v[80:83], a[144:147], a[8:11], v[80:83]
    v_mfma_f32_16x16x32_bf16 v[136:139], a[144:147], a[16:19], v[136:139]
    ds_read_b64_tr_b16 a[140:141], v235 offset:21632
    v_mfma_f32_16x16x32_bf16 v[136:139], a[148:151], a[20:23], v[136:139]
    v_mfma_f32_16x16x32_bf16 v[192:195], a[148:151], a[28:31], v[192:195]
    ds_read_b64_tr_b16 a[142:143], v235 offset:25216
    v_mfma_f32_16x16x32_bf16 v[192:195], a[144:147], a[24:27], v[192:195]
    s_waitcnt lgkmcnt(8)
    v_mfma_f32_16x16x32_bf16 v[28:31], a[152:155], a[0:3], v[28:31]
    ds_read_b64_tr_b16 a[144:145], v235 offset:160
    buffer_load_dwordx4 a[112:115], v226, s[4:7], 0 offen offset:2048 sc1
    v_mfma_f32_16x16x32_bf16 v[28:31], a[156:159], a[4:7], v[28:31]
    s_add_u32 m0, s22, 4096
    v_mfma_f32_16x16x32_bf16 v[84:87], a[156:159], a[12:15], v[84:87]
    ds_read_b64_tr_b16 a[146:147], v235 offset:3744
    v_mfma_f32_16x16x32_bf16 v[84:87], a[152:155], a[8:11], v[84:87]
    v_mfma_f32_16x16x32_bf16 v[140:143], a[152:155], a[16:19], v[140:143]
    ds_read_b64_tr_b16 a[148:149], v235 offset:7328
    v_mfma_f32_16x16x32_bf16 v[140:143], a[156:159], a[20:23], v[140:143]
    v_mfma_f32_16x16x32_bf16 v[196:199], a[156:159], a[28:31], v[196:199]
    ds_read_b64_tr_b16 a[150:151], v235 offset:10912
    v_mfma_f32_16x16x32_bf16 v[196:199], a[152:155], a[24:27], v[196:199]
    buffer_load_dwordx4 v232, s[8:11], 0 offen offset:0 lds
    s_waitcnt lgkmcnt(8)
    v_mfma_f32_16x16x32_bf16 v[32:35], a[128:131], a[0:3], v[32:35]
    ds_read_b64_tr_b16 a[152:153], v235 offset:14496
    v_mfma_f32_16x16x32_bf16 v[32:35], a[132:135], a[4:7], v[32:35]
    v_mfma_f32_16x16x32_bf16 v[88:91], a[132:135], a[12:15], v[88:91]
    ds_read_b64_tr_b16 a[154:155], v235 offset:18080
    v_mfma_f32_16x16x32_bf16 v[88:91], a[128:131], a[8:11], v[88:91]
    v_mfma_f32_16x16x32_bf16 v[144:147], a[128:131], a[16:19], v[144:147]
    ds_read_b64_tr_b16 a[156:157], v235 offset:21664
    v_mfma_f32_16x16x32_bf16 v[144:147], a[132:135], a[20:23], v[144:147]
    v_mfma_f32_16x16x32_bf16 v[200:203], a[132:135], a[28:31], v[200:203]
    ds_read_b64_tr_b16 a[158:159], v235 offset:25248
    buffer_load_dwordx4 a[116:119], v226, s[4:7], 0 offen offset:3072 sc1
    v_mfma_f32_16x16x32_bf16 v[200:203], a[128:131], a[24:27], v[200:203]
    s_waitcnt lgkmcnt(8)
    v_mfma_f32_16x16x32_bf16 v[36:39], a[136:139], a[0:3], v[36:39]
    ds_read_b64_tr_b16 a[128:129], v235 offset:192
    v_mfma_f32_16x16x32_bf16 v[36:39], a[140:143], a[4:7], v[36:39]
    v_mfma_f32_16x16x32_bf16 v[92:95], a[140:143], a[12:15], v[92:95]
    ds_read_b64_tr_b16 a[130:131], v235 offset:3776
    v_mfma_f32_16x16x32_bf16 v[92:95], a[136:139], a[8:11], v[92:95]
    v_mfma_f32_16x16x32_bf16 v[148:151], a[136:139], a[16:19], v[148:151]
    ds_read_b64_tr_b16 a[132:133], v235 offset:7360
    v_mfma_f32_16x16x32_bf16 v[148:151], a[140:143], a[20:23], v[148:151]
    buffer_load_dwordx4 v233, s[8:11], 0 offen offset:1024 lds
    v_mfma_f32_16x16x32_bf16 v[204:207], a[140:143], a[28:31], v[204:207]
    ds_read_b64_tr_b16 a[134:135], v235 offset:10944
    v_mfma_f32_16x16x32_bf16 v[204:207], a[136:139], a[24:27], v[204:207]
    s_waitcnt lgkmcnt(8)
    v_mfma_f32_16x16x32_bf16 v[40:43], a[144:147], a[0:3], v[40:43]
    ds_read_b64_tr_b16 a[136:137], v235 offset:14528
    v_mfma_f32_16x16x32_bf16 v[40:43], a[148:151], a[4:7], v[40:43]
    v_mfma_f32_16x16x32_bf16 v[96:99], a[148:151], a[12:15], v[96:99]
    ds_read_b64_tr_b16 a[138:139], v235 offset:18112
    v_mfma_f32_16x16x32_bf16 v[96:99], a[144:147], a[8:11], v[96:99]
    v_mfma_f32_16x16x32_bf16 v[152:155], a[144:147], a[16:19], v[152:155]
    ds_read_b64_tr_b16 a[140:141], v235 offset:21696
    buffer_load_dwordx4 a[120:123], v227, s[4:7], 0 offen offset:2048 sc1
    v_mfma_f32_16x16x32_bf16 v[152:155], a[148:151], a[20:23], v[152:155]
    v_mfma_f32_16x16x32_bf16 v[208:211], a[148:151], a[28:31], v[208:211]
    ds_read_b64_tr_b16 a[142:143], v235 offset:25280
    v_mfma_f32_16x16x32_bf16 v[208:211], a[144:147], a[24:27], v[208:211]
    s_waitcnt lgkmcnt(8)
    v_mfma_f32_16x16x32_bf16 v[44:47], a[152:155], a[0:3], v[44:47]
    s_waitcnt vmcnt(29)
    s_barrier
    ds_read_b64_tr_b16 a[144:145], v237 offset:0
    v_mfma_f32_16x16x32_bf16 v[44:47], a[156:159], a[4:7], v[44:47]
    v_mfma_f32_16x16x32_bf16 v[100:103], a[156:159], a[12:15], v[100:103]
    ds_read_b64_tr_b16 a[146:147], v237 offset:3584
    v_mfma_f32_16x16x32_bf16 v[100:103], a[152:155], a[8:11], v[100:103]
    v_mfma_f32_16x16x32_bf16 v[156:159], a[152:155], a[16:19], v[156:159]
    ds_read_b64_tr_b16 a[148:149], v237 offset:7168
    buffer_load_dwordx4 v234, s[8:11], 0 offen offset:2048 lds
    v_mfma_f32_16x16x32_bf16 v[156:159], a[156:159], a[20:23], v[156:159]
    s_add_u32 s8, s8, 458752
    v_mfma_f32_16x16x32_bf16 v[212:215], a[156:159], a[28:31], v[212:215]
    ds_read_b64_tr_b16 a[150:151], v237 offset:10752
    s_addc_u32 s9, s9, 0
    v_mfma_f32_16x16x32_bf16 v[212:215], a[152:155], a[24:27], v[212:215]
    s_add_u32 s22, s22, 28672
    s_waitcnt lgkmcnt(8)
    v_mfma_f32_16x16x32_bf16 v[48:51], a[128:131], a[0:3], v[48:51]
    ds_read_b64_tr_b16 a[152:153], v237 offset:14336
    s_cmp_ge_u32 s22, s23
    v_mfma_f32_16x16x32_bf16 v[48:51], a[132:135], a[4:7], v[48:51]
    s_cselect_b32 s26, 143360, 0
    v_mfma_f32_16x16x32_bf16 v[104:107], a[132:135], a[12:15], v[104:107]
    ds_read_b64_tr_b16 a[154:155], v237 offset:17920
    s_sub_u32 s22, s22, s26
    v_mfma_f32_16x16x32_bf16 v[104:107], a[128:131], a[8:11], v[104:107]
    buffer_load_dwordx4 a[124:127], v227, s[4:7], 0 offen offset:3072 sc1
    v_mfma_f32_16x16x32_bf16 v[160:163], a[128:131], a[16:19], v[160:163]
    ds_read_b64_tr_b16 a[156:157], v237 offset:21504
    s_add_u32 s4, s4, 4096
    v_mfma_f32_16x16x32_bf16 v[160:163], a[132:135], a[20:23], v[160:163]
    s_addc_u32 s5, s5, 0
    v_mfma_f32_16x16x32_bf16 v[216:219], a[132:135], a[28:31], v[216:219]
    ds_read_b64_tr_b16 a[158:159], v237 offset:25088
    v_mfma_f32_16x16x32_bf16 v[216:219], a[128:131], a[24:27], v[216:219]
    s_waitcnt lgkmcnt(8)
    v_mfma_f32_16x16x32_bf16 v[52:55], a[136:139], a[0:3], v[52:55]
    ds_read_b64_tr_b16 a[128:129], v237 offset:32
    v_mfma_f32_16x16x32_bf16 v[52:55], a[140:143], a[4:7], v[52:55]
    v_mfma_f32_16x16x32_bf16 v[108:111], a[140:143], a[12:15], v[108:111]
    ds_read_b64_tr_b16 a[130:131], v237 offset:3616
    v_mfma_f32_16x16x32_bf16 v[108:111], a[136:139], a[8:11], v[108:111]
    s_mov_b64 exec, 0xfffffff
    buffer_load_dword a208, v241, s[84:87], s46 offen
    s_mov_b64 exec, -1
    v_mfma_f32_16x16x32_bf16 v[164:167], a[136:139], a[16:19], v[164:167]
    ds_read_b64_tr_b16 a[132:133], v237 offset:7200
    s_add_u32 s46, s46, 1835008
    v_mfma_f32_16x16x32_bf16 v[164:167], a[140:143], a[20:23], v[164:167]
    v_mfma_f32_16x16x32_bf16 v[220:223], a[140:143], a[28:31], v[220:223]
    ds_read_b64_tr_b16 a[134:135], v237 offset:10784
    v_mfma_f32_16x16x32_bf16 v[220:223], a[136:139], a[24:27], v[220:223]
    s_waitcnt vmcnt(24) lgkmcnt(8)
    v_mfma_f32_16x16x32_bf16 v[0:3], a[144:147], a[32:35], v[0:3]
    ds_read_b64_tr_b16 a[136:137], v237 offset:14368
    buffer_load_dwordx4 a[0:3], v224, s[4:7], 0 offen offset:0 sc1
    v_mfma_f32_16x16x32_bf16 v[0:3], a[148:151], a[36:39], v[0:3]
    s_add_u32 m0, s22, 0
    v_mfma_f32_16x16x32_bf16 v[56:59], a[148:151], a[44:47], v[56:59]
    ds_read_b64_tr_b16 a[138:139], v237 offset:17952
    v_mfma_f32_16x16x32_bf16 v[56:59], a[144:147], a[40:43], v[56:59]
    v_mfma_f32_16x16x32_bf16 v[112:115], a[144:147], a[48:51], v[112:115]
    ds_read_b64_tr_b16 a[140:141], v237 offset:21536
    v_mfma_f32_16x16x32_bf16 v[112:115], a[148:151], a[52:55], v[112:115]
    v_mfma_f32_16x16x32_bf16 v[168:171], a[148:151], a[60:63], v[168:171]
    ds_read_b64_tr_b16 a[142:143], v237 offset:25120
    v_mfma_f32_16x16x32_bf16 v[168:171], a[144:147], a[56:59], v[168:171]
    buffer_load_dwordx4 v228, s[8:11], 0 offen offset:0 lds
    s_waitcnt lgkmcnt(8)
    v_mfma_f32_16x16x32_bf16 v[4:7], a[152:155], a[32:35], v[4:7]
    ds_read_b64_tr_b16 a[144:145], v237 offset:64
    v_mfma_f32_16x16x32_bf16 v[4:7], a[156:159], a[36:39], v[4:7]
    v_mfma_f32_16x16x32_bf16 v[60:63], a[156:159], a[44:47], v[60:63]
    ds_read_b64_tr_b16 a[146:147], v237 offset:3648
    v_mfma_f32_16x16x32_bf16 v[60:63], a[152:155], a[40:43], v[60:63]
    v_mfma_f32_16x16x32_bf16 v[116:119], a[152:155], a[48:51], v[116:119]
    ds_read_b64_tr_b16 a[148:149], v237 offset:7232
    v_mfma_f32_16x16x32_bf16 v[116:119], a[156:159], a[52:55], v[116:119]
    v_mfma_f32_16x16x32_bf16 v[172:175], a[156:159], a[60:63], v[172:175]
    ds_read_b64_tr_b16 a[150:151], v237 offset:10816
    buffer_load_dwordx4 a[4:7], v224, s[4:7], 0 offen offset:1024 sc1
    v_mfma_f32_16x16x32_bf16 v[172:175], a[152:155], a[56:59], v[172:175]
    v_add_u32 v235, s24, v236
    s_waitcnt lgkmcnt(8)
    v_mfma_f32_16x16x32_bf16 v[8:11], a[128:131], a[32:35], v[8:11]
    ds_read_b64_tr_b16 a[152:153], v237 offset:14400
    s_add_u32 s24, s24, 28672
    v_mfma_f32_16x16x32_bf16 v[8:11], a[132:135], a[36:39], v[8:11]
    s_cmp_ge_u32 s24, 143360
    v_mfma_f32_16x16x32_bf16 v[64:67], a[132:135], a[44:47], v[64:67]
    ds_read_b64_tr_b16 a[154:155], v237 offset:17984
    s_cselect_b32 s24, 0, s24
    v_mfma_f32_16x16x32_bf16 v[64:67], a[128:131], a[40:43], v[64:67]
    v_mfma_f32_16x16x32_bf16 v[120:123], a[128:131], a[48:51], v[120:123]
    ds_read_b64_tr_b16 a[156:157], v237 offset:21568
    v_mfma_f32_16x16x32_bf16 v[120:123], a[132:135], a[52:55], v[120:123]
    v_mfma_f32_16x16x32_bf16 v[176:179], a[132:135], a[60:63], v[176:179]
    ds_read_b64_tr_b16 a[158:159], v237 offset:25152
    buffer_load_dwordx4 v229, s[8:11], 0 offen offset:1024 lds
    v_mfma_f32_16x16x32_bf16 v[176:179], a[128:131], a[56:59], v[176:179]
    s_waitcnt lgkmcnt(8)
    v_mfma_f32_16x16x32_bf16 v[12:15], a[136:139], a[32:35], v[12:15]
    ds_read_b64_tr_b16 a[128:129], v237 offset:96
    v_mfma_f32_16x16x32_bf16 v[12:15], a[140:143], a[36:39], v[12:15]
    v_mfma_f32_16x16x32_bf16 v[68:71], a[140:143], a[44:47], v[68:71]
    ds_read_b64_tr_b16 a[130:131], v237 offset:3680
    v_mfma_f32_16x16x32_bf16 v[68:71], a[136:139], a[40:43], v[68:71]
    v_mfma_f32_16x16x32_bf16 v[124:127], a[136:139], a[48:51], v[124:127]
    ds_read_b64_tr_b16 a[132:133], v237 offset:7264
    v_mfma_f32_16x16x32_bf16 v[124:127], a[140:143], a[52:55], v[124:127]
    buffer_load_dwordx4 a[8:11], v225, s[4:7], 0 offen offset:0 sc1
    v_mfma_f32_16x16x32_bf16 v[180:183], a[140:143], a[60:63], v[180:183]
    ds_read_b64_tr_b16 a[134:135], v237 offset:10848
    v_mfma_f32_16x16x32_bf16 v[180:183], a[136:139], a[56:59], v[180:183]
    s_waitcnt lgkmcnt(8)
    v_mfma_f32_16x16x32_bf16 v[16:19], a[144:147], a[32:35], v[16:19]
    ds_read_b64_tr_b16 a[136:137], v237 offset:14432
    v_mfma_f32_16x16x32_bf16 v[16:19], a[148:151], a[36:39], v[16:19]
    v_mfma_f32_16x16x32_bf16 v[72:75], a[148:151], a[44:47], v[72:75]
    ds_read_b64_tr_b16 a[138:139], v237 offset:18016
    v_mfma_f32_16x16x32_bf16 v[72:75], a[144:147], a[40:43], v[72:75]
    v_mfma_f32_16x16x32_bf16 v[128:131], a[144:147], a[48:51], v[128:131]
    ds_read_b64_tr_b16 a[140:141], v237 offset:21600
    v_mfma_f32_16x16x32_bf16 v[128:131], a[148:151], a[52:55], v[128:131]
    buffer_load_dwordx4 v230, s[8:11], 0 offen offset:2048 lds
    v_mfma_f32_16x16x32_bf16 v[184:187], a[148:151], a[60:63], v[184:187]
    ds_read_b64_tr_b16 a[142:143], v237 offset:25184
    v_mfma_f32_16x16x32_bf16 v[184:187], a[144:147], a[56:59], v[184:187]
    s_waitcnt lgkmcnt(8)
    v_mfma_f32_16x16x32_bf16 v[20:23], a[152:155], a[32:35], v[20:23]
    ds_read_b64_tr_b16 a[144:145], v237 offset:128
    v_mfma_f32_16x16x32_bf16 v[20:23], a[156:159], a[36:39], v[20:23]
    v_mfma_f32_16x16x32_bf16 v[76:79], a[156:159], a[44:47], v[76:79]
    ds_read_b64_tr_b16 a[146:147], v237 offset:3712
    v_mfma_f32_16x16x32_bf16 v[76:79], a[152:155], a[40:43], v[76:79]
    v_mfma_f32_16x16x32_bf16 v[132:135], a[152:155], a[48:51], v[132:135]
    ds_read_b64_tr_b16 a[148:149], v237 offset:7296
    buffer_load_dwordx4 a[12:15], v225, s[4:7], 0 offen offset:1024 sc1
    v_mfma_f32_16x16x32_bf16 v[132:135], a[156:159], a[52:55], v[132:135]
    v_mfma_f32_16x16x32_bf16 v[188:191], a[156:159], a[60:63], v[188:191]
    ds_read_b64_tr_b16 a[150:151], v237 offset:10880
    v_mfma_f32_16x16x32_bf16 v[188:191], a[152:155], a[56:59], v[188:191]
    s_waitcnt lgkmcnt(8)
    v_mfma_f32_16x16x32_bf16 v[24:27], a[128:131], a[32:35], v[24:27]
    ds_read_b64_tr_b16 a[152:153], v237 offset:14464
    v_mfma_f32_16x16x32_bf16 v[24:27], a[132:135], a[36:39], v[24:27]
    v_mfma_f32_16x16x32_bf16 v[80:83], a[132:135], a[44:47], v[80:83]
    ds_read_b64_tr_b16 a[154:155], v237 offset:18048
    v_mfma_f32_16x16x32_bf16 v[80:83], a[128:131], a[40:43], v[80:83]
    buffer_load_dwordx4 v231, s[8:11], 0 offen offset:3072 lds
    v_mfma_f32_16x16x32_bf16 v[136:139], a[128:131], a[48:51], v[136:139]
    ds_read_b64_tr_b16 a[156:157], v237 offset:21632
    v_mfma_f32_16x16x32_bf16 v[136:139], a[132:135], a[52:55], v[136:139]
    v_mfma_f32_16x16x32_bf16 v[192:195], a[132:135], a[60:63], v[192:195]
    ds_read_b64_tr_b16 a[158:159], v237 offset:25216
    v_mfma_f32_16x16x32_bf16 v[192:195], a[128:131], a[56:59], v[192:195]
    s_waitcnt lgkmcnt(8)
    v_mfma_f32_16x16x32_bf16 v[28:31], a[136:139], a[32:35], v[28:31]
    ds_read_b64_tr_b16 a[128:129], v237 offset:160
    v_mfma_f32_16x16x32_bf16 v[28:31], a[140:143], a[36:39], v[28:31]
    v_mfma_f32_16x16x32_bf16 v[84:87], a[140:143], a[44:47], v[84:87]
    ds_read_b64_tr_b16 a[130:131], v237 offset:3744
    v_mfma_f32_16x16x32_bf16 v[84:87], a[136:139], a[40:43], v[84:87]
    buffer_load_dwordx4 a[16:19], v226, s[4:7], 0 offen offset:0 sc1
    v_mfma_f32_16x16x32_bf16 v[140:143], a[136:139], a[48:51], v[140:143]
    ds_read_b64_tr_b16 a[132:133], v237 offset:7328
    s_add_u32 m0, s22, 4096
    v_mfma_f32_16x16x32_bf16 v[140:143], a[140:143], a[52:55], v[140:143]
    v_mfma_f32_16x16x32_bf16 v[196:199], a[140:143], a[60:63], v[196:199]
    ds_read_b64_tr_b16 a[134:135], v237 offset:10912
    v_mfma_f32_16x16x32_bf16 v[196:199], a[136:139], a[56:59], v[196:199]
    s_waitcnt lgkmcnt(8)
    v_mfma_f32_16x16x32_bf16 v[32:35], a[144:147], a[32:35], v[32:35]
    ds_read_b64_tr_b16 a[136:137], v237 offset:14496
    v_mfma_f32_16x16x32_bf16 v[32:35], a[148:151], a[36:39], v[32:35]
    v_mfma_f32_16x16x32_bf16 v[88:91], a[148:151], a[44:47], v[88:91]
    ds_read_b64_tr_b16 a[138:139], v237 offset:18080
    buffer_load_dwordx4 v232, s[8:11], 0 offen offset:0 lds
    v_mfma_f32_16x16x32_bf16 v[88:91], a[144:147], a[40:43], v[88:91]
    v_mfma_f32_16x16x32_bf16 v[144:147], a[144:147], a[48:51], v[144:147]
    ds_read_b64_tr_b16 a[140:141], v237 offset:21664
    v_mfma_f32_16x16x32_bf16 v[144:147], a[148:151], a[52:55], v[144:147]
    v_mfma_f32_16x16x32_bf16 v[200:203], a[148:151], a[60:63], v[200:203]
    ds_read_b64_tr_b16 a[142:143], v237 offset:25248
    v_mfma_f32_16x16x32_bf16 v[200:203], a[144:147], a[56:59], v[200:203]
    s_waitcnt lgkmcnt(8)
    v_mfma_f32_16x16x32_bf16 v[36:39], a[152:155], a[32:35], v[36:39]
    ds_read_b64_tr_b16 a[144:145], v237 offset:192
    v_mfma_f32_16x16x32_bf16 v[36:39], a[156:159], a[36:39], v[36:39]
    v_mfma_f32_16x16x32_bf16 v[92:95], a[156:159], a[44:47], v[92:95]
    ds_read_b64_tr_b16 a[146:147], v237 offset:3776
    buffer_load_dwordx4 a[20:23], v226, s[4:7], 0 offen offset:1024 sc1
    v_mfma_f32_16x16x32_bf16 v[92:95], a[152:155], a[40:43], v[92:95]
    v_mfma_f32_16x16x32_bf16 v[148:151], a[152:155], a[48:51], v[148:151]
    ds_read_b64_tr_b16 a[148:149], v237 offset:7360
    v_mfma_f32_16x16x32_bf16 v[148:151], a[156:159], a[52:55], v[148:151]
    v_mfma_f32_16x16x32_bf16 v[204:207], a[156:159], a[60:63], v[204:207]
    ds_read_b64_tr_b16 a[150:151], v237 offset:10944
    v_mfma_f32_16x16x32_bf16 v[204:207], a[152:155], a[56:59], v[204:207]
    s_waitcnt lgkmcnt(8)
    v_mfma_f32_16x16x32_bf16 v[40:43], a[128:131], a[32:35], v[40:43]
    ds_read_b64_tr_b16 a[152:153], v237 offset:14528
    v_mfma_f32_16x16x32_bf16 v[40:43], a[132:135], a[36:39], v[40:43]
    buffer_load_dwordx4 v233, s[8:11], 0 offen offset:1024 lds
    v_mfma_f32_16x16x32_bf16 v[96:99], a[132:135], a[44:47], v[96:99]
    ds_read_b64_tr_b16 a[154:155], v237 offset:18112
    v_mfma_f32_16x16x32_bf16 v[96:99], a[128:131], a[40:43], v[96:99]
    v_mfma_f32_16x16x32_bf16 v[152:155], a[128:131], a[48:51], v[152:155]
    ds_read_b64_tr_b16 a[156:157], v237 offset:21696
    v_mfma_f32_16x16x32_bf16 v[152:155], a[132:135], a[52:55], v[152:155]
    v_mfma_f32_16x16x32_bf16 v[208:211], a[132:135], a[60:63], v[208:211]
    ds_read_b64_tr_b16 a[158:159], v237 offset:25280
    v_mfma_f32_16x16x32_bf16 v[208:211], a[128:131], a[56:59], v[208:211]
    s_waitcnt lgkmcnt(8)
    v_mfma_f32_16x16x32_bf16 v[44:47], a[136:139], a[32:35], v[44:47]
    s_waitcnt vmcnt(29)
    s_barrier
    ds_read_b64_tr_b16 a[128:129], v235 offset:0
    v_mfma_f32_16x16x32_bf16 v[44:47], a[140:143], a[36:39], v[44:47]
    buffer_load_dwordx4 a[24:27], v227, s[4:7], 0 offen offset:0 sc1
    v_mfma_f32_16x16x32_bf16 v[100:103], a[140:143], a[44:47], v[100:103]
    ds_read_b64_tr_b16 a[130:131], v235 offset:3584
    v_mfma_f32_16x16x32_bf16 v[100:103], a[136:139], a[40:43], v[100:103]
    v_mfma_f32_16x16x32_bf16 v[156:159], a[136:139], a[48:51], v[156:159]
    ds_read_b64_tr_b16 a[132:133], v235 offset:7168
    v_mfma_f32_16x16x32_bf16 v[156:159], a[140:143], a[52:55], v[156:159]
    v_mfma_f32_16x16x32_bf16 v[212:215], a[140:143], a[60:63], v[212:215]
    ds_read_b64_tr_b16 a[134:135], v235 offset:10752
    v_mfma_f32_16x16x32_bf16 v[212:215], a[136:139], a[56:59], v[212:215]
    s_waitcnt lgkmcnt(8)
    v_mfma_f32_16x16x32_bf16 v[48:51], a[144:147], a[32:35], v[48:51]
    ds_read_b64_tr_b16 a[136:137], v235 offset:14336
    v_mfma_f32_16x16x32_bf16 v[48:51], a[148:151], a[36:39], v[48:51]
    buffer_load_dwordx4 v234, s[8:11], 0 offen offset:2048 lds
    v_mfma_f32_16x16x32_bf16 v[104:107], a[148:151], a[44:47], v[104:107]
    ds_read_b64_tr_b16 a[138:139], v235 offset:17920
    s_add_u32 s8, s8, 458752
    v_mfma_f32_16x16x32_bf16 v[104:107], a[144:147], a[40:43], v[104:107]
    s_addc_u32 s9, s9, 0
    v_mfma_f32_16x16x32_bf16 v[160:163], a[144:147], a[48:51], v[160:163]
    ds_read_b64_tr_b16 a[140:141], v235 offset:21504
    s_add_u32 s22, s22, 28672
    v_mfma_f32_16x16x32_bf16 v[160:163], a[148:151], a[52:55], v[160:163]
    s_cmp_ge_u32 s22, s23
    v_mfma_f32_16x16x32_bf16 v[216:219], a[148:151], a[60:63], v[216:219]
    ds_read_b64_tr_b16 a[142:143], v235 offset:25088
    s_cselect_b32 s26, 143360, 0
    v_mfma_f32_16x16x32_bf16 v[216:219], a[144:147], a[56:59], v[216:219]
    s_sub_u32 s22, s22, s26
    s_waitcnt lgkmcnt(8)
    v_mfma_f32_16x16x32_bf16 v[52:55], a[152:155], a[32:35], v[52:55]
    ds_read_b64_tr_b16 a[144:145], v235 offset:32
    buffer_load_dwordx4 a[28:31], v227, s[4:7], 0 offen offset:1024 sc1
    v_mfma_f32_16x16x32_bf16 v[52:55], a[156:159], a[36:39], v[52:55]
    v_mfma_f32_16x16x32_bf16 v[108:111], a[156:159], a[44:47], v[108:111]
    ds_read_b64_tr_b16 a[146:147], v235 offset:3616
    v_mfma_f32_16x16x32_bf16 v[108:111], a[152:155], a[40:43], v[108:111]
    v_mfma_f32_16x16x32_bf16 v[164:167], a[152:155], a[48:51], v[164:167]
    ds_read_b64_tr_b16 a[148:149], v235 offset:7200
    v_mfma_f32_16x16x32_bf16 v[164:167], a[156:159], a[52:55], v[164:167]
    v_mfma_f32_16x16x32_bf16 v[220:223], a[156:159], a[60:63], v[220:223]
    ds_read_b64_tr_b16 a[150:151], v235 offset:10784
    v_mfma_f32_16x16x32_bf16 v[220:223], a[152:155], a[56:59], v[220:223]
    s_waitcnt vmcnt(31) lgkmcnt(8)
    v_mfma_f32_16x16x32_bf16 v[0:3], a[128:131], a[64:67], v[0:3]
    ds_read_b64_tr_b16 a[152:153], v235 offset:14368
    buffer_load_dwordx4 a[32:35], v224, s[4:7], 0 offen offset:2048 sc1
    v_mfma_f32_16x16x32_bf16 v[0:3], a[132:135], a[68:71], v[0:3]
    s_add_u32 m0, s22, 0
    v_mfma_f32_16x16x32_bf16 v[56:59], a[132:135], a[76:79], v[56:59]
    ds_read_b64_tr_b16 a[154:155], v235 offset:17952
    v_mfma_f32_16x16x32_bf16 v[56:59], a[128:131], a[72:75], v[56:59]
    v_mfma_f32_16x16x32_bf16 v[112:115], a[128:131], a[80:83], v[112:115]
    ds_read_b64_tr_b16 a[156:157], v235 offset:21536
    v_mfma_f32_16x16x32_bf16 v[112:115], a[132:135], a[84:87], v[112:115]
    v_mfma_f32_16x16x32_bf16 v[168:171], a[132:135], a[92:95], v[168:171]
    ds_read_b64_tr_b16 a[158:159], v235 offset:25120
    v_mfma_f32_16x16x32_bf16 v[168:171], a[128:131], a[88:91], v[168:171]
    buffer_load_dwordx4 v228, s[8:11], 0 offen offset:0 lds
    s_waitcnt lgkmcnt(8)
    v_mfma_f32_16x16x32_bf16 v[4:7], a[136:139], a[64:67], v[4:7]
    ds_read_b64_tr_b16 a[128:129], v235 offset:64
    v_mfma_f32_16x16x32_bf16 v[4:7], a[140:143], a[68:71], v[4:7]
    v_mfma_f32_16x16x32_bf16 v[60:63], a[140:143], a[76:79], v[60:63]
    ds_read_b64_tr_b16 a[130:131], v235 offset:3648
    v_mfma_f32_16x16x32_bf16 v[60:63], a[136:139], a[72:75], v[60:63]
    v_mfma_f32_16x16x32_bf16 v[116:119], a[136:139], a[80:83], v[116:119]
    ds_read_b64_tr_b16 a[132:133], v235 offset:7232
    v_mfma_f32_16x16x32_bf16 v[116:119], a[140:143], a[84:87], v[116:119]
    v_mfma_f32_16x16x32_bf16 v[172:175], a[140:143], a[92:95], v[172:175]
    ds_read_b64_tr_b16 a[134:135], v235 offset:10816
    buffer_load_dwordx4 a[36:39], v224, s[4:7], 0 offen offset:3072 sc1
    v_mfma_f32_16x16x32_bf16 v[172:175], a[136:139], a[88:91], v[172:175]
    v_add_u32 v237, s24, v236
    s_waitcnt lgkmcnt(8)
    v_mfma_f32_16x16x32_bf16 v[8:11], a[144:147], a[64:67], v[8:11]
    ds_read_b64_tr_b16 a[136:137], v235 offset:14400
    s_add_u32 s24, s24, 28672
    v_mfma_f32_16x16x32_bf16 v[8:11], a[148:151], a[68:71], v[8:11]
    s_cmp_ge_u32 s24, 143360
    v_mfma_f32_16x16x32_bf16 v[64:67], a[148:151], a[76:79], v[64:67]
    ds_read_b64_tr_b16 a[138:139], v235 offset:17984
    s_cselect_b32 s24, 0, s24
    v_mfma_f32_16x16x32_bf16 v[64:67], a[144:147], a[72:75], v[64:67]
    v_mfma_f32_16x16x32_bf16 v[120:123], a[144:147], a[80:83], v[120:123]
    ds_read_b64_tr_b16 a[140:141], v235 offset:21568
    v_mfma_f32_16x16x32_bf16 v[120:123], a[148:151], a[84:87], v[120:123]
    v_mfma_f32_16x16x32_bf16 v[176:179], a[148:151], a[92:95], v[176:179]
    ds_read_b64_tr_b16 a[142:143], v235 offset:25152
    buffer_load_dwordx4 v229, s[8:11], 0 offen offset:1024 lds
    v_mfma_f32_16x16x32_bf16 v[176:179], a[144:147], a[88:91], v[176:179]
    s_waitcnt lgkmcnt(8)
    v_mfma_f32_16x16x32_bf16 v[12:15], a[152:155], a[64:67], v[12:15]
    ds_read_b64_tr_b16 a[144:145], v235 offset:96
    v_mfma_f32_16x16x32_bf16 v[12:15], a[156:159], a[68:71], v[12:15]
    v_mfma_f32_16x16x32_bf16 v[68:71], a[156:159], a[76:79], v[68:71]
    ds_read_b64_tr_b16 a[146:147], v235 offset:3680
    v_mfma_f32_16x16x32_bf16 v[68:71], a[152:155], a[72:75], v[68:71]
    v_mfma_f32_16x16x32_bf16 v[124:127], a[152:155], a[80:83], v[124:127]
    ds_read_b64_tr_b16 a[148:149], v235 offset:7264
    v_mfma_f32_16x16x32_bf16 v[124:127], a[156:159], a[84:87], v[124:127]
    buffer_load_dwordx4 a[40:43], v225, s[4:7], 0 offen offset:2048 sc1
    v_mfma_f32_16x16x32_bf16 v[180:183], a[156:159], a[92:95], v[180:183]
    ds_read_b64_tr_b16 a[150:151], v235 offset:10848
    v_mfma_f32_16x16x32_bf16 v[180:183], a[152:155], a[88:91], v[180:183]
    s_waitcnt lgkmcnt(8)
    v_mfma_f32_16x16x32_bf16 v[16:19], a[128:131], a[64:67], v[16:19]
    ds_read_b64_tr_b16 a[152:153], v235 offset:14432
    v_mfma_f32_16x16x32_bf16 v[16:19], a[132:135], a[68:71], v[16:19]
    v_mfma_f32_16x16x32_bf16 v[72:75], a[132:135], a[76:79], v[72:75]
    ds_read_b64_tr_b16 a[154:155], v235 offset:18016
    v_mfma_f32_16x16x32_bf16 v[72:75], a[128:131], a[72:75], v[72:75]
    v_mfma_f32_16x16x32_bf16 v[128:131], a[128:131], a[80:83], v[128:131]
    ds_read_b64_tr_b16 a[156:157], v235 offset:21600
    v_mfma_f32_16x16x32_bf16 v[128:131], a[132:135], a[84:87], v[128:131]
    buffer_load_dwordx4 v230, s[8:11], 0 offen offset:2048 lds
    v_mfma_f32_16x16x32_bf16 v[184:187], a[132:135], a[92:95], v[184:187]
    ds_read_b64_tr_b16 a[158:159], v235 offset:25184
    s_cmp_lg_u32 s25, 1
    s_cbranch_scc1 L_nosq0
    buffer_load_dword a192, v244, s[16:19], s48 offen sc1
    s_add_u32 s48, s48, 8192
    buffer_load_dword a193, v244, s[16:19], s48 offen sc1
    s_add_u32 s48, s48, 8192
    buffer_load_dword a194, v244, s[16:19], s48 offen sc1
    s_add_u32 s48, s48, 8192
    buffer_load_dword a195, v244, s[16:19], s48 offen sc1
    s_add_u32 s48, s48, 8192
L_nosq0:
    v_mfma_f32_16x16x32_bf16 v[184:187], a[128:131], a[88:91], v[184:187]
    s_waitcnt lgkmcnt(8)
    v_mfma_f32_16x16x32_bf16 v[20:23], a[136:139], a[64:67], v[20:23]
    ds_read_b64_tr_b16 a[128:129], v235 offset:128
    v_mfma_f32_16x16x32_bf16 v[20:23], a[140:143], a[68:71], v[20:23]
    v_mfma_f32_16x16x32_bf16 v[76:79], a[140:143], a[76:79], v[76:79]
    ds_read_b64_tr_b16 a[130:131], v235 offset:3712
    v_mfma_f32_16x16x32_bf16 v[76:79], a[136:139], a[72:75], v[76:79]
    v_mfma_f32_16x16x32_bf16 v[132:135], a[136:139], a[80:83], v[132:135]
    ds_read_b64_tr_b16 a[132:133], v235 offset:7296
    buffer_load_dwordx4 a[44:47], v225, s[4:7], 0 offen offset:3072 sc1
    v_mfma_f32_16x16x32_bf16 v[132:135], a[140:143], a[84:87], v[132:135]
    v_mfma_f32_16x16x32_bf16 v[188:191], a[140:143], a[92:95], v[188:191]
    ds_read_b64_tr_b16 a[134:135], v235 offset:10880
    v_mfma_f32_16x16x32_bf16 v[188:191], a[136:139], a[88:91], v[188:191]
    s_waitcnt lgkmcnt(8)
    v_mfma_f32_16x16x32_bf16 v[24:27], a[144:147], a[64:67], v[24:27]
    ds_read_b64_tr_b16 a[136:137], v235 offset:14464
    v_mfma_f32_16x16x32_bf16 v[24:27], a[148:151], a[68:71], v[24:27]
    v_mfma_f32_16x16x32_bf16 v[80:83], a[148:151], a[76:79], v[80:83]
    ds_read_b64_tr_b16 a[138:139], v235 offset:18048
    v_mfma_f32_16x16x32_bf16 v[80:83], a[144:147], a[72:75], v[80:83]
    buffer_load_dwordx4 v231, s[8:11], 0 offen offset:3072 lds
    v_mfma_f32_16x16x32_bf16 v[136:139], a[144:147], a[80:83], v[136:139]
    ds_read_b64_tr_b16 a[140:141], v235 offset:21632
    v_mfma_f32_16x16x32_bf16 v[136:139], a[148:151], a[84:87], v[136:139]
    v_mfma_f32_16x16x32_bf16 v[192:195], a[148:151], a[92:95], v[192:195]
    ds_read_b64_tr_b16 a[142:143], v235 offset:25216
    v_mfma_f32_16x16x32_bf16 v[192:195], a[144:147], a[88:91], v[192:195]
    s_waitcnt lgkmcnt(8)
    v_mfma_f32_16x16x32_bf16 v[28:31], a[152:155], a[64:67], v[28:31]
    ds_read_b64_tr_b16 a[144:145], v235 offset:160
    v_mfma_f32_16x16x32_bf16 v[28:31], a[156:159], a[68:71], v[28:31]
    v_mfma_f32_16x16x32_bf16 v[84:87], a[156:159], a[76:79], v[84:87]
    ds_read_b64_tr_b16 a[146:147], v235 offset:3744
    v_mfma_f32_16x16x32_bf16 v[84:87], a[152:155], a[72:75], v[84:87]
    buffer_load_dwordx4 a[48:51], v226, s[4:7], 0 offen offset:2048 sc1
    v_mfma_f32_16x16x32_bf16 v[140:143], a[152:155], a[80:83], v[140:143]
    ds_read_b64_tr_b16 a[148:149], v235 offset:7328
    s_add_u32 m0, s22, 4096
    v_mfma_f32_16x16x32_bf16 v[140:143], a[156:159], a[84:87], v[140:143]
    v_mfma_f32_16x16x32_bf16 v[196:199], a[156:159], a[92:95], v[196:199]
    ds_read_b64_tr_b16 a[150:151], v235 offset:10912
    v_mfma_f32_16x16x32_bf16 v[196:199], a[152:155], a[88:91], v[196:199]
    s_waitcnt lgkmcnt(8)
    v_mfma_f32_16x16x32_bf16 v[32:35], a[128:131], a[64:67], v[32:35]
    ds_read_b64_tr_b16 a[152:153], v235 offset:14496
    v_mfma_f32_16x16x32_bf16 v[32:35], a[132:135], a[68:71], v[32:35]
    v_mfma_f32_16x16x32_bf16 v[88:91], a[132:135], a[76:79], v[88:91]
    ds_read_b64_tr_b16 a[154:155], v235 offset:18080
    buffer_load_dwordx4 v232, s[8:11], 0 offen offset:0 lds
    v_mfma_f32_16x16x32_bf16 v[88:91], a[128:131], a[72:75], v[88:91]
    v_mfma_f32_16x16x32_bf16 v[144:147], a[128:131], a[80:83], v[144:147]
    ds_read_b64_tr_b16 a[156:157], v235 offset:21664
    v_mfma_f32_16x16x32_bf16 v[144:147], a[132:135], a[84:87], v[144:147]
    v_mfma_f32_16x16x32_bf16 v[200:203], a[132:135], a[92:95], v[200:203]
    ds_read_b64_tr_b16 a[158:159], v235 offset:25248
    v_mfma_f32_16x16x32_bf16 v[200:203], a[128:131], a[88:91], v[200:203]
    s_waitcnt lgkmcnt(8)
    v_mfma_f32_16x16x32_bf16 v[36:39], a[136:139], a[64:67], v[36:39]
    ds_read_b64_tr_b16 a[128:129], v235 offset:192
    v_mfma_f32_16x16x32_bf16 v[36:39], a[140:143], a[68:71], v[36:39]
    v_mfma_f32_16x16x32_bf16 v[92:95], a[140:143], a[76:79], v[92:95]
    ds_read_b64_tr_b16 a[130:131], v235 offset:3776
    buffer_load_dwordx4 a[52:55], v226, s[4:7], 0 offen offset:3072 sc1
    v_mfma_f32_16x16x32_bf16 v[92:95], a[136:139], a[72:75], v[92:95]
    v_mfma_f32_16x16x32_bf16 v[148:151], a[136:139], a[80:83], v[148:151]
    ds_read_b64_tr_b16 a[132:133], v235 offset:7360
    v_mfma_f32_16x16x32_bf16 v[148:151], a[140:143], a[84:87], v[148:151]
    v_mfma_f32_16x16x32_bf16 v[204:207], a[140:143], a[92:95], v[204:207]
    ds_read_b64_tr_b16 a[134:135], v235 offset:10944
    v_mfma_f32_16x16x32_bf16 v[204:207], a[136:139], a[88:91], v[204:207]
    s_waitcnt lgkmcnt(8)
    v_mfma_f32_16x16x32_bf16 v[40:43], a[144:147], a[64:67], v[40:43]
    ds_read_b64_tr_b16 a[136:137], v235 offset:14528
    v_mfma_f32_16x16x32_bf16 v[40:43], a[148:151], a[68:71], v[40:43]
    buffer_load_dwordx4 v233, s[8:11], 0 offen offset:1024 lds
    v_mfma_f32_16x16x32_bf16 v[96:99], a[148:151], a[76:79], v[96:99]
    ds_read_b64_tr_b16 a[138:139], v235 offset:18112
    s_cmp_lg_u32 s25, 1
    s_cbranch_scc1 L_nosq1
    buffer_load_dword a196, v244, s[16:19], s48 offen sc1
    s_add_u32 s48, s48, 8192
    buffer_load_dword a197, v244, s[16:19], s48 offen sc1
    s_add_u32 s48, s48, 8192
    buffer_load_dword a198, v244, s[16:19], s48 offen sc1
    s_add_u32 s48, s48, 8192
    buffer_load_dword a199, v244, s[16:19], s48 offen sc1
    s_add_u32 s48, s48, 8192
L_nosq1:
    v_mfma_f32_16x16x32_bf16 v[96:99], a[144:147], a[72:75], v[96:99]
    v_mfma_f32_16x16x32_bf16 v[152:155], a[144:147], a[80:83], v[152:155]
    ds_read_b64_tr_b16 a[140:141], v235 offset:21696
    v_mfma_f32_16x16x32_bf16 v[152:155], a[148:151], a[84:87], v[152:155]
    v_mfma_f32_16x16x32_bf16 v[208:211], a[148:151], a[92:95], v[208:211]
    ds_read_b64_tr_b16 a[142:143], v235 offset:25280
    v_mfma_f32_16x16x32_bf16 v[208:211], a[144:147], a[88:91], v[208:211]
    s_waitcnt lgkmcnt(8)
    v_mfma_f32_16x16x32_bf16 v[44:47], a[152:155], a[64:67], v[44:47]
    s_waitcnt vmcnt(29)
    s_barrier
    ds_read_b64_tr_b16 a[144:145], v237 offset:0
    v_mfma_f32_16x16x32_bf16 v[44:47], a[156:159], a[68:71], v[44:47]
    buffer_load_dwordx4 a[56:59], v227, s[4:7], 0 offen offset:2048 sc1
    v_mfma_f32_16x16x32_bf16 v[100:103], a[156:159], a[76:79], v[100:103]
    ds_read_b64_tr_b16 a[146:147], v237 offset:3584
    v_mfma_f32_16x16x32_bf16 v[100:103], a[152:155], a[72:75], v[100:103]
    v_mfma_f32_16x16x32_bf16 v[156:159], a[152:155], a[80:83], v[156:159]
    ds_read_b64_tr_b16 a[148:149], v237 offset:7168
    v_mfma_f32_16x16x32_bf16 v[156:159], a[156:159], a[84:87], v[156:159]
    v_mfma_f32_16x16x32_bf16 v[212:215], a[156:159], a[92:95], v[212:215]
    ds_read_b64_tr_b16 a[150:151], v237 offset:10752
    v_mfma_f32_16x16x32_bf16 v[212:215], a[152:155], a[88:91], v[212:215]
    s_waitcnt lgkmcnt(8)
    v_mfma_f32_16x16x32_bf16 v[48:51], a[128:131], a[64:67], v[48:51]
    ds_read_b64_tr_b16 a[152:153], v237 offset:14336
    v_mfma_f32_16x16x32_bf16 v[48:51], a[132:135], a[68:71], v[48:51]
    buffer_load_dwordx4 v234, s[8:11], 0 offen offset:2048 lds
    v_mfma_f32_16x16x32_bf16 v[104:107], a[132:135], a[76:79], v[104:107]
    ds_read_b64_tr_b16 a[154:155], v237 offset:17920
    s_add_u32 s8, s8, 458752
    v_mfma_f32_16x16x32_bf16 v[104:107], a[128:131], a[72:75], v[104:107]
    s_addc_u32 s9, s9, 0
    v_mfma_f32_16x16x32_bf16 v[160:163], a[128:131], a[80:83], v[160:163]
    ds_read_b64_tr_b16 a[156:157], v237 offset:21504
    s_add_u32 s22, s22, 28672
    v_mfma_f32_16x16x32_bf16 v[160:163], a[132:135], a[84:87], v[160:163]
    s_cmp_ge_u32 s22, s23
    v_mfma_f32_16x16x32_bf16 v[216:219], a[132:135], a[92:95], v[216:219]
    ds_read_b64_tr_b16 a[158:159], v237 offset:25088
    s_cselect_b32 s26, 143360, 0
    v_mfma_f32_16x16x32_bf16 v[216:219], a[128:131], a[88:91], v[216:219]
    s_sub_u32 s22, s22, s26
    s_waitcnt lgkmcnt(8)
    v_mfma_f32_16x16x32_bf16 v[52:55], a[136:139], a[64:67], v[52:55]
    ds_read_b64_tr_b16 a[128:129], v237 offset:32
    buffer_load_dwordx4 a[60:63], v227, s[4:7], 0 offen offset:3072 sc1
    v_mfma_f32_16x16x32_bf16 v[52:55], a[140:143], a[68:71], v[52:55]
    s_add_u32 s4, s4, 4096
    v_mfma_f32_16x16x32_bf16 v[108:111], a[140:143], a[76:79], v[108:111]
    ds_read_b64_tr_b16 a[130:131], v237 offset:3616
    s_addc_u32 s5, s5, 0
    v_mfma_f32_16x16x32_bf16 v[108:111], a[136:139], a[72:75], v[108:111]
    v_mfma_f32_16x16x32_bf16 v[164:167], a[136:139], a[80:83], v[164:167]
    ds_read_b64_tr_b16 a[132:133], v237 offset:7200
    v_mfma_f32_16x16x32_bf16 v[164:167], a[140:143], a[84:87], v[164:167]
    v_mfma_f32_16x16x32_bf16 v[220:223], a[140:143], a[92:95], v[220:223]
    ds_read_b64_tr_b16 a[134:135], v237 offset:10784
    v_mfma_f32_16x16x32_bf16 v[220:223], a[136:139], a[88:91], v[220:223]
    s_waitcnt vmcnt(31) lgkmcnt(8)
    v_mfma_f32_16x16x32_bf16 v[0:3], a[144:147], a[96:99], v[0:3]
    ds_read_b64_tr_b16 a[136:137], v237 offset:14368
    buffer_load_dwordx4 a[64:67], v224, s[4:7], 0 offen offset:0 sc1
    v_mfma_f32_16x16x32_bf16 v[0:3], a[148:151], a[100:103], v[0:3]
    s_add_u32 m0, s22, 0
    v_mfma_f32_16x16x32_bf16 v[56:59], a[148:151], a[108:111], v[56:59]
    ds_read_b64_tr_b16 a[138:139], v237 offset:17952
    v_mfma_f32_16x16x32_bf16 v[56:59], a[144:147], a[104:107], v[56:59]
    v_mfma_f32_16x16x32_bf16 v[112:115], a[144:147], a[112:115], v[112:115]
    ds_read_b64_tr_b16 a[140:141], v237 offset:21536
    v_mfma_f32_16x16x32_bf16 v[112:115], a[148:151], a[116:119], v[112:115]
    v_mfma_f32_16x16x32_bf16 v[168:171], a[148:151], a[124:127], v[168:171]
    ds_read_b64_tr_b16 a[142:143], v237 offset:25120
    v_mfma_f32_16x16x32_bf16 v[168:171], a[144:147], a[120:123], v[168:171]
    buffer_load_dwordx4 v228, s[8:11], 0 offen offset:0 lds
    s_waitcnt lgkmcnt(8)
    v_mfma_f32_16x16x32_bf16 v[4:7], a[152:155], a[96:99], v[4:7]
    ds_read_b64_tr_b16 a[144:145], v237 offset:64
    v_mfma_f32_16x16x32_bf16 v[4:7], a[156:159], a[100:103], v[4:7]
    v_mfma_f32_16x16x32_bf16 v[60:63], a[156:159], a[108:111], v[60:63]
    ds_read_b64_tr_b16 a[146:147], v237 offset:3648
    v_mfma_f32_16x16x32_bf16 v[60:63], a[152:155], a[104:107], v[60:63]
    v_mfma_f32_16x16x32_bf16 v[116:119], a[152:155], a[112:115], v[116:119]
    ds_read_b64_tr_b16 a[148:149], v237 offset:7232
    v_mfma_f32_16x16x32_bf16 v[116:119], a[156:159], a[116:119], v[116:119]
    v_mfma_f32_16x16x32_bf16 v[172:175], a[156:159], a[124:127], v[172:175]
    ds_read_b64_tr_b16 a[150:151], v237 offset:10816
    buffer_load_dwordx4 a[68:71], v224, s[4:7], 0 offen offset:1024 sc1
    v_mfma_f32_16x16x32_bf16 v[172:175], a[152:155], a[120:123], v[172:175]
    v_add_u32 v235, s24, v236
    s_waitcnt lgkmcnt(8)
    v_mfma_f32_16x16x32_bf16 v[8:11], a[128:131], a[96:99], v[8:11]
    ds_read_b64_tr_b16 a[152:153], v237 offset:14400
    s_add_u32 s24, s24, 28672
    v_mfma_f32_16x16x32_bf16 v[8:11], a[132:135], a[100:103], v[8:11]
    s_cmp_ge_u32 s24, 143360
    v_mfma_f32_16x16x32_bf16 v[64:67], a[132:135], a[108:111], v[64:67]
    ds_read_b64_tr_b16 a[154:155], v237 offset:17984
    s_cselect_b32 s24, 0, s24
    v_mfma_f32_16x16x32_bf16 v[64:67], a[128:131], a[104:107], v[64:67]
    v_mfma_f32_16x16x32_bf16 v[120:123], a[128:131], a[112:115], v[120:123]
    ds_read_b64_tr_b16 a[156:157], v237 offset:21568
    v_mfma_f32_16x16x32_bf16 v[120:123], a[132:135], a[116:119], v[120:123]
    v_mfma_f32_16x16x32_bf16 v[176:179], a[132:135], a[124:127], v[176:179]
    ds_read_b64_tr_b16 a[158:159], v237 offset:25152
    buffer_load_dwordx4 v229, s[8:11], 0 offen offset:1024 lds
    v_mfma_f32_16x16x32_bf16 v[176:179], a[128:131], a[120:123], v[176:179]
    s_waitcnt lgkmcnt(8)
    v_mfma_f32_16x16x32_bf16 v[12:15], a[136:139], a[96:99], v[12:15]
    ds_read_b64_tr_b16 a[128:129], v237 offset:96
    v_mfma_f32_16x16x32_bf16 v[12:15], a[140:143], a[100:103], v[12:15]
    v_mfma_f32_16x16x32_bf16 v[68:71], a[140:143], a[108:111], v[68:71]
    ds_read_b64_tr_b16 a[130:131], v237 offset:3680
    v_mfma_f32_16x16x32_bf16 v[68:71], a[136:139], a[104:107], v[68:71]
    v_mfma_f32_16x16x32_bf16 v[124:127], a[136:139], a[112:115], v[124:127]
    ds_read_b64_tr_b16 a[132:133], v237 offset:7264
    v_mfma_f32_16x16x32_bf16 v[124:127], a[140:143], a[116:119], v[124:127]
    buffer_load_dwordx4 a[72:75], v225, s[4:7], 0 offen offset:0 sc1
    v_mfma_f32_16x16x32_bf16 v[180:183], a[140:143], a[124:127], v[180:183]
    ds_read_b64_tr_b16 a[134:135], v237 offset:10848
    v_mfma_f32_16x16x32_bf16 v[180:183], a[136:139], a[120:123], v[180:183]
    s_waitcnt lgkmcnt(8)
    v_mfma_f32_16x16x32_bf16 v[16:19], a[144:147], a[96:99], v[16:19]
    ds_read_b64_tr_b16 a[136:137], v237 offset:14432
    v_mfma_f32_16x16x32_bf16 v[16:19], a[148:151], a[100:103], v[16:19]
    v_mfma_f32_16x16x32_bf16 v[72:75], a[148:151], a[108:111], v[72:75]
    ds_read_b64_tr_b16 a[138:139], v237 offset:18016
    v_mfma_f32_16x16x32_bf16 v[72:75], a[144:147], a[104:107], v[72:75]
    v_mfma_f32_16x16x32_bf16 v[128:131], a[144:147], a[112:115], v[128:131]
    ds_read_b64_tr_b16 a[140:141], v237 offset:21600
    v_mfma_f32_16x16x32_bf16 v[128:131], a[148:151], a[116:119], v[128:131]
    buffer_load_dwordx4 v230, s[8:11], 0 offen offset:2048 lds
    v_mfma_f32_16x16x32_bf16 v[184:187], a[148:151], a[124:127], v[184:187]
    ds_read_b64_tr_b16 a[142:143], v237 offset:25184
    s_cmp_lg_u32 s25, 1
    s_cbranch_scc1 L_nosq2
    buffer_load_dword a200, v244, s[16:19], s48 offen sc1
    s_add_u32 s48, s48, 8192
    buffer_load_dword a201, v244, s[16:19], s48 offen sc1
    s_add_u32 s48, s48, 8192
    buffer_load_dword a202, v244, s[16:19], s48 offen sc1
    s_add_u32 s48, s48, 8192
    buffer_load_dword a203, v244, s[16:19], s48 offen sc1
    s_add_u32 s48, s48, 8192
L_nosq2:
    v_mfma_f32_16x16x32_bf16 v[184:187], a[144:147], a[120:123], v[184:187]
    s_waitcnt lgkmcnt(8)
    v_mfma_f32_16x16x32_bf16 v[20:23], a[152:155], a[96:99], v[20:23]
    ds_read_b64_tr_b16 a[144:145], v237 offset:128
    v_mfma_f32_16x16x32_bf16 v[20:23], a[156:159], a[100:103], v[20:23]
    v_mfma_f32_16x16x32_bf16 v[76:79], a[156:159], a[108:111], v[76:79]
    ds_read_b64_tr_b16 a[146:147], v237 offset:3712
    v_mfma_f32_16x16x32_bf16 v[76:79], a[152:155], a[104:107], v[76:79]
    v_mfma_f32_16x16x32_bf16 v[132:135], a[152:155], a[112:115], v[132:135]
    ds_read_b64_tr_b16 a[148:149], v237 offset:7296
    buffer_load_dwordx4 a[76:79], v225, s[4:7], 0 offen offset:1024 sc1
    v_mfma_f32_16x16x32_bf16 v[132:135], a[156:159], a[116:119], v[132:135]
    v_mfma_f32_16x16x32_bf16 v[188:191], a[156:159], a[124:127], v[188:191]
    ds_read_b64_tr_b16 a[150:151], v237 offset:10880
    v_mfma_f32_16x16x32_bf16 v[188:191], a[152:155], a[120:123], v[188:191]
    s_waitcnt lgkmcnt(8)
    v_mfma_f32_16x16x32_bf16 v[24:27], a[128:131], a[96:99], v[24:27]
    ds_read_b64_tr_b16 a[152:153], v237 offset:14464
    v_mfma_f32_16x16x32_bf16 v[24:27], a[132:135], a[100:103], v[24:27]
    v_mfma_f32_16x16x32_bf16 v[80:83], a[132:135], a[108:111], v[80:83]
    ds_read_b64_tr_b16 a[154:155], v237 offset:18048
    v_mfma_f32_16x16x32_bf16 v[80:83], a[128:131], a[104:107], v[80:83]
    buffer_load_dwordx4 v231, s[8:11], 0 offen offset:3072 lds
    v_mfma_f32_16x16x32_bf16 v[136:139], a[128:131], a[112:115], v[136:139]
    ds_read_b64_tr_b16 a[156:157], v237 offset:21632
    v_mfma_f32_16x16x32_bf16 v[136:139], a[132:135], a[116:119], v[136:139]
    v_mfma_f32_16x16x32_bf16 v[192:195], a[132:135], a[124:127], v[192:195]
    ds_read_b64_tr_b16 a[158:159], v237 offset:25216
    v_mfma_f32_16x16x32_bf16 v[192:195], a[128:131], a[120:123], v[192:195]
    s_waitcnt lgkmcnt(8)
    v_mfma_f32_16x16x32_bf16 v[28:31], a[136:139], a[96:99], v[28:31]
    ds_read_b64_tr_b16 a[128:129], v237 offset:160
    v_mfma_f32_16x16x32_bf16 v[28:31], a[140:143], a[100:103], v[28:31]
    v_mfma_f32_16x16x32_bf16 v[84:87], a[140:143], a[108:111], v[84:87]
    ds_read_b64_tr_b16 a[130:131], v237 offset:3744
    v_mfma_f32_16x16x32_bf16 v[84:87], a[136:139], a[104:107], v[84:87]
    buffer_load_dwordx4 a[80:83], v226, s[4:7], 0 offen offset:0 sc1
    v_mfma_f32_16x16x32_bf16 v[140:143], a[136:139], a[112:115], v[140:143]
    ds_read_b64_tr_b16 a[132:133], v237 offset:7328
    s_add_u32 m0, s22, 4096
    v_mfma_f32_16x16x32_bf16 v[140:143], a[140:143], a[116:119], v[140:143]
    v_mfma_f32_16x16x32_bf16 v[196:199], a[140:143], a[124:127], v[196:199]
    ds_read_b64_tr_b16 a[134:135], v237 offset:10912
    v_mfma_f32_16x16x32_bf16 v[196:199], a[136:139], a[120:123], v[196:199]
    s_waitcnt lgkmcnt(8)
    v_mfma_f32_16x16x32_bf16 v[32:35], a[144:147], a[96:99], v[32:35]
    ds_read_b64_tr_b16 a[136:137], v237 offset:14496
    v_mfma_f32_16x16x32_bf16 v[32:35], a[148:151], a[100:103], v[32:35]
    v_mfma_f32_16x16x32_bf16 v[88:91], a[148:151], a[108:111], v[88:91]
    ds_read_b64_tr_b16 a[138:139], v237 offset:18080
    buffer_load_dwordx4 v232, s[8:11], 0 offen offset:0 lds
    v_mfma_f32_16x16x32_bf16 v[88:91], a[144:147], a[104:107], v[88:91]
    v_mfma_f32_16x16x32_bf16 v[144:147], a[144:147], a[112:115], v[144:147]
    ds_read_b64_tr_b16 a[140:141], v237 offset:21664
    v_mfma_f32_16x16x32_bf16 v[144:147], a[148:151], a[116:119], v[144:147]
    v_mfma_f32_16x16x32_bf16 v[200:203], a[148:151], a[124:127], v[200:203]
    ds_read_b64_tr_b16 a[142:143], v237 offset:25248
    v_mfma_f32_16x16x32_bf16 v[200:203], a[144:147], a[120:123], v[200:203]
    s_waitcnt lgkmcnt(8)
    v_mfma_f32_16x16x32_bf16 v[36:39], a[152:155], a[96:99], v[36:39]
    ds_read_b64_tr_b16 a[144:145], v237 offset:192
    v_mfma_f32_16x16x32_bf16 v[36:39], a[156:159], a[100:103], v[36:39]
    v_mfma_f32_16x16x32_bf16 v[92:95], a[156:159], a[108:111], v[92:95]
    ds_read_b64_tr_b16 a[146:147], v237 offset:3776
    buffer_load_dwordx4 a[84:87], v226, s[4:7], 0 offen offset:1024 sc1
    v_mfma_f32_16x16x32_bf16 v[92:95], a[152:155], a[104:107], v[92:95]
    v_mfma_f32_16x16x32_bf16 v[148:151], a[152:155], a[112:115], v[148:151]
    ds_read_b64_tr_b16 a[148:149], v237 offset:7360
    v_mfma_f32_16x16x32_bf16 v[148:151], a[156:159], a[116:119], v[148:151]
    v_mfma_f32_16x16x32_bf16 v[204:207], a[156:159], a[124:127], v[204:207]
    ds_read_b64_tr_b16 a[150:151], v237 offset:10944
    v_mfma_f32_16x16x32_bf16 v[204:207], a[152:155], a[120:123], v[204:207]
    s_waitcnt lgkmcnt(8)
    v_mfma_f32_16x16x32_bf16 v[40:43], a[128:131], a[96:99], v[40:43]
    ds_read_b64_tr_b16 a[152:153], v237 offset:14528
    v_mfma_f32_16x16x32_bf16 v[40:43], a[132:135], a[100:103], v[40:43]
    buffer_load_dwordx4 v233, s[8:11], 0 offen offset:1024 lds
    v_mfma_f32_16x16x32_bf16 v[96:99], a[132:135], a[108:111], v[96:99]
    ds_read_b64_tr_b16 a[154:155], v237 offset:18112
    s_cmp_lg_u32 s25, 1
    s_cbranch_scc1 L_nosq3
    buffer_load_dword a204, v244, s[16:19], s48 offen sc1
    s_add_u32 s48, s48, 8192
    buffer_load_dword a205, v244, s[16:19], s48 offen sc1
    s_add_u32 s48, s48, 8192
    buffer_load_dword a206, v244, s[16:19], s48 offen sc1
    s_add_u32 s48, s48, 8192
    buffer_load_dword a207, v244, s[16:19], s48 offen sc1
    s_add_u32 s48, s48, 8192
L_nosq3:
    v_mfma_f32_16x16x32_bf16 v[96:99], a[128:131], a[104:107], v[96:99]
    v_mfma_f32_16x16x32_bf16 v[152:155], a[128:131], a[112:115], v[152:155]
    ds_read_b64_tr_b16 a[156:157], v237 offset:21696
    v_mfma_f32_16x16x32_bf16 v[152:155], a[132:135], a[116:119], v[152:155]
    v_mfma_f32_16x16x32_bf16 v[208:211], a[132:135], a[124:127], v[208:211]
    ds_read_b64_tr_b16 a[158:159], v237 offset:25280
    v_mfma_f32_16x16x32_bf16 v[208:211], a[128:131], a[120:123], v[208:211]
    s_waitcnt lgkmcnt(8)
    v_mfma_f32_16x16x32_bf16 v[44:47], a[136:139], a[96:99], v[44:47]
    s_waitcnt vmcnt(28)
    s_barrier
    ds_read_b64_tr_b16 a[128:129], v235 offset:0
    v_mfma_f32_16x16x32_bf16 v[44:47], a[140:143], a[100:103], v[44:47]
    buffer_load_dwordx4 a[88:91], v227, s[4:7], 0 offen offset:0 sc1
    v_mfma_f32_16x16x32_bf16 v[100:103], a[140:143], a[108:111], v[100:103]
    ds_read_b64_tr_b16 a[130:131], v235 offset:3584
    v_mfma_f32_16x16x32_bf16 v[100:103], a[136:139], a[104:107], v[100:103]
    v_mfma_f32_16x16x32_bf16 v[156:159], a[136:139], a[112:115], v[156:159]
    ds_read_b64_tr_b16 a[132:133], v235 offset:7168
    v_mfma_f32_16x16x32_bf16 v[156:159], a[140:143], a[116:119], v[156:159]
    v_mfma_f32_16x16x32_bf16 v[212:215], a[140:143], a[124:127], v[212:215]
    ds_read_b64_tr_b16 a[134:135], v235 offset:10752
    v_mfma_f32_16x16x32_bf16 v[212:215], a[136:139], a[120:123], v[212:215]
    s_waitcnt lgkmcnt(8)
    v_mfma_f32_16x16x32_bf16 v[48:51], a[144:147], a[96:99], v[48:51]
    ds_read_b64_tr_b16 a[136:137], v235 offset:14336
    v_mfma_f32_16x16x32_bf16 v[48:51], a[148:151], a[100:103], v[48:51]
    buffer_load_dwordx4 v234, s[8:11], 0 offen offset:2048 lds
    v_mfma_f32_16x16x32_bf16 v[104:107], a[148:151], a[108:111], v[104:107]
    ds_read_b64_tr_b16 a[138:139], v235 offset:17920
    s_add_u32 s8, s8, 458752
    v_mfma_f32_16x16x32_bf16 v[104:107], a[144:147], a[104:107], v[104:107]
    s_addc_u32 s9, s9, 0
    v_mfma_f32_16x16x32_bf16 v[160:163], a[144:147], a[112:115], v[160:163]
    ds_read_b64_tr_b16 a[140:141], v235 offset:21504
    s_add_u32 s22, s22, 28672
    v_mfma_f32_16x16x32_bf16 v[160:163], a[148:151], a[116:119], v[160:163]
    s_cmp_ge_u32 s22, s23
    v_mfma_f32_16x16x32_bf16 v[216:219], a[148:151], a[124:127], v[216:219]
    ds_read_b64_tr_b16 a[142:143], v235 offset:25088
    s_cselect_b32 s26, 143360, 0
    v_mfma_f32_16x16x32_bf16 v[216:219], a[144:147], a[120:123], v[216:219]
    s_sub_u32 s22, s22, s26
    s_waitcnt lgkmcnt(8)
    v_mfma_f32_16x16x32_bf16 v[52:55], a[152:155], a[96:99], v[52:55]
    ds_read_b64_tr_b16 a[144:145], v235 offset:32
    buffer_load_dwordx4 a[92:95], v227, s[4:7], 0 offen offset:1024 sc1
    v_mfma_f32_16x16x32_bf16 v[52:55], a[156:159], a[100:103], v[52:55]
    v_mfma_f32_16x16x32_bf16 v[108:111], a[156:159], a[108:111], v[108:111]
    ds_read_b64_tr_b16 a[146:147], v235 offset:3616
    v_mfma_f32_16x16x32_bf16 v[108:111], a[152:155], a[104:107], v[108:111]
    v_mfma_f32_16x16x32_bf16 v[164:167], a[152:155], a[112:115], v[164:167]
    ds_read_b64_tr_b16 a[148:149], v235 offset:7200
    v_mfma_f32_16x16x32_bf16 v[164:167], a[156:159], a[116:119], v[164:167]
    v_mfma_f32_16x16x32_bf16 v[220:223], a[156:159], a[124:127], v[220:223]
    ds_read_b64_tr_b16 a[150:151], v235 offset:10784
    v_mfma_f32_16x16x32_bf16 v[220:223], a[152:155], a[120:123], v[220:223]
    s_sub_u32 s25, s25, 1
    s_cmp_lg_u32 s25, 0
    s_cbranch_scc1 L_p3
    s_waitcnt vmcnt(30) lgkmcnt(8)
    v_mfma_f32_16x16x32_bf16 v[0:3], a[128:131], a[0:3], v[0:3]
    ds_read_b64_tr_b16 a[152:153], v235 offset:14368
    v_add_u32 v237, 28672, v236
    v_mfma_f32_16x16x32_bf16 v[0:3], a[132:135], a[4:7], v[0:3]
    s_add_u32 m0, s22, 0
    v_mfma_f32_16x16x32_bf16 v[56:59], a[132:135], a[12:15], v[56:59]
    ds_read_b64_tr_b16 a[154:155], v235 offset:17952
    v_add_u32 v238, 57344, v236
    v_mfma_f32_16x16x32_bf16 v[56:59], a[128:131], a[8:11], v[56:59]
    buffer_load_dwordx4 v228, s[8:11], 0 offen offset:0 lds
    v_mfma_f32_16x16x32_bf16 v[112:115], a[128:131], a[16:19], v[112:115]
    ds_read_b64_tr_b16 a[156:157], v235 offset:21536
    v_add_u32 v239, 86016, v236
    v_mfma_f32_16x16x32_bf16 v[112:115], a[132:135], a[20:23], v[112:115]
    buffer_load_dwordx4 v229, s[8:11], 0 offen offset:1024 lds
    v_mfma_f32_16x16x32_bf16 v[168:171], a[132:135], a[28:31], v[168:171]
    ds_read_b64_tr_b16 a[158:159], v235 offset:25120
    v_mfma_f32_16x16x32_bf16 v[168:171], a[128:131], a[24:27], v[168:171]
    s_waitcnt lgkmcnt(8)
    v_mfma_f32_16x16x32_bf16 v[4:7], a[136:139], a[0:3], v[4:7]
    s_waitcnt vmcnt(18)
    s_barrier
    ds_read_b64_tr_b16 a[128:129], v237 offset:0
    v_mfma_f32_16x16x32_bf16 v[4:7], a[140:143], a[4:7], v[4:7]
    buffer_load_dwordx4 v230, s[8:11], 0 offen offset:2048 lds
    v_mfma_f32_16x16x32_bf16 v[60:63], a[140:143], a[12:15], v[60:63]
    ds_read_b64_tr_b16 a[130:131], v237 offset:3584
    v_mfma_f32_16x16x32_bf16 v[60:63], a[136:139], a[8:11], v[60:63]
    v_mfma_f32_16x16x32_bf16 v[116:119], a[136:139], a[16:19], v[116:119]
    ds_read_b64_tr_b16 a[132:133], v237 offset:7168
    v_mfma_f32_16x16x32_bf16 v[116:119], a[140:143], a[20:23], v[116:119]
    buffer_load_dwordx4 v231, s[8:11], 0 offen offset:3072 lds
    v_mfma_f32_16x16x32_bf16 v[172:175], a[140:143], a[28:31], v[172:175]
    ds_read_b64_tr_b16 a[134:135], v237 offset:10752
    v_mfma_f32_16x16x32_bf16 v[172:175], a[136:139], a[24:27], v[172:175]
    s_waitcnt lgkmcnt(8)
    v_mfma_f32_16x16x32_bf16 v[8:11], a[144:147], a[0:3], v[8:11]
    ds_read_b64_tr_b16 a[136:137], v237 offset:14336
    v_mfma_f32_16x16x32_bf16 v[8:11], a[148:151], a[4:7], v[8:11]
    s_add_u32 m0, s22, 4096
    v_mfma_f32_16x16x32_bf16 v[64:67], a[148:151], a[12:15], v[64:67]
    ds_read_b64_tr_b16 a[138:139], v237 offset:17920
    v_mfma_f32_16x16x32_bf16 v[64:67], a[144:147], a[8:11], v[64:67]
    buffer_load_dwordx4 v232, s[8:11], 0 offen offset:0 lds
    v_mfma_f32_16x16x32_bf16 v[120:123], a[144:147], a[16:19], v[120:123]
    ds_read_b64_tr_b16 a[140:141], v237 offset:21504
    v_mfma_f32_16x16x32_bf16 v[120:123], a[148:151], a[20:23], v[120:123]
    buffer_load_dwordx4 v233, s[8:11], 0 offen offset:1024 lds
    v_mfma_f32_16x16x32_bf16 v[176:179], a[148:151], a[28:31], v[176:179]
    ds_read_b64_tr_b16 a[142:143], v237 offset:25088
    v_mfma_f32_16x16x32_bf16 v[176:179], a[144:147], a[24:27], v[176:179]
    s_waitcnt lgkmcnt(8)
    v_mfma_f32_16x16x32_bf16 v[12:15], a[152:155], a[0:3], v[12:15]
    ds_read_b64_tr_b16 a[144:145], v237 offset:32
    v_mfma_f32_16x16x32_bf16 v[12:15], a[156:159], a[4:7], v[12:15]
    v_mfma_f32_16x16x32_bf16 v[68:71], a[156:159], a[12:15], v[68:71]
    ds_read_b64_tr_b16 a[146:147], v237 offset:3616
    v_mfma_f32_16x16x32_bf16 v[68:71], a[152:155], a[8:11], v[68:71]
    buffer_load_dwordx4 v234, s[8:11], 0 offen offset:2048 lds
    v_mfma_f32_16x16x32_bf16 v[124:127], a[152:155], a[16:19], v[124:127]
    ds_read_b64_tr_b16 a[148:149], v237 offset:7200
    v_mfma_f32_16x16x32_bf16 v[124:127], a[156:159], a[20:23], v[124:127]
    v_mfma_f32_16x16x32_bf16 v[180:183], a[156:159], a[28:31], v[180:183]
    ds_read_b64_tr_b16 a[150:151], v237 offset:10784
    v_mfma_f32_16x16x32_bf16 v[180:183], a[152:155], a[24:27], v[180:183]
    s_waitcnt vmcnt(22) lgkmcnt(8)
    v_mfma_f32_16x16x32_bf16 v[0:3], a[128:131], a[32:35], v[0:3]
    ds_read_b64_tr_b16 a[152:153], v237 offset:14368
    v_mfma_f32_16x16x32_bf16 v[0:3], a[132:135], a[36:39], v[0:3]
    buffer_load_dwordx4 a[96:99], v224, s[4:7], 0 offen offset:2048 sc1
    v_mfma_f32_16x16x32_bf16 v[56:59], a[132:135], a[44:47], v[56:59]
    ds_read_b64_tr_b16 a[154:155], v237 offset:17952
    v_mfma_f32_16x16x32_bf16 v[56:59], a[128:131], a[40:43], v[56:59]
    buffer_load_dwordx4 a[100:103], v224, s[4:7], 0 offen offset:3072 sc1
    v_mfma_f32_16x16x32_bf16 v[112:115], a[128:131], a[48:51], v[112:115]
    ds_read_b64_tr_b16 a[156:157], v237 offset:21536
    v_mfma_f32_16x16x32_bf16 v[112:115], a[132:135], a[52:55], v[112:115]
    v_mfma_f32_16x16x32_bf16 v[168:171], a[132:135], a[60:63], v[168:171]
    ds_read_b64_tr_b16 a[158:159], v237 offset:25120
    v_mfma_f32_16x16x32_bf16 v[168:171], a[128:131], a[56:59], v[168:171]
    s_waitcnt lgkmcnt(8)
    v_mfma_f32_16x16x32_bf16 v[4:7], a[136:139], a[32:35], v[4:7]
    s_waitcnt vmcnt(10)
    s_barrier
    ds_read_b64_tr_b16 a[128:129], v238 offset:0
    v_mfma_f32_16x16x32_bf16 v[4:7], a[140:143], a[36:39], v[4:7]
    buffer_load_dwordx4 a[104:107], v225, s[4:7], 0 offen offset:2048 sc1
    v_accvgpr_read_b32 v228, a192
    v_mfma_f32_16x16x32_bf16 v[60:63], a[140:143], a[44:47], v[60:63]
    ds_read_b64_tr_b16 a[130:131], v238 offset:3584
    v_accvgpr_read_b32 v229, a193
    v_mfma_f32_16x16x32_bf16 v[60:63], a[136:139], a[40:43], v[60:63]
    v_add_f32 v228, v228, v229
    v_accvgpr_read_b32 v229, a194
    v_mfma_f32_16x16x32_bf16 v[116:119], a[136:139], a[48:51], v[116:119]
    ds_read_b64_tr_b16 a[132:133], v238 offset:7168
    v_add_f32 v228, v228, v229
    v_mfma_f32_16x16x32_bf16 v[116:119], a[140:143], a[52:55], v[116:119]
    buffer_load_dwordx4 a[108:111], v225, s[4:7], 0 offen offset:3072 sc1
    v_accvgpr_read_b32 v229, a195
    v_mfma_f32_16x16x32_bf16 v[172:175], a[140:143], a[60:63], v[172:175]
    ds_read_b64_tr_b16 a[134:135], v238 offset:10752
    v_add_f32 v228, v228, v229
    v_mfma_f32_16x16x32_bf16 v[172:175], a[136:139], a[56:59], v[172:175]
    v_accvgpr_read_b32 v229, a196
    s_waitcnt lgkmcnt(8)
    v_mfma_f32_16x16x32_bf16 v[8:11], a[144:147], a[32:35], v[8:11]
    ds_read_b64_tr_b16 a[136:137], v238 offset:14336
    v_add_f32 v228, v228, v229
    v_mfma_f32_16x16x32_bf16 v[8:11], a[148:151], a[36:39], v[8:11]
    v_accvgpr_read_b32 v229, a197
    v_add_f32 v228, v228, v229
    v_mfma_f32_16x16x32_bf16 v[64:67], a[148:151], a[44:47], v[64:67]
    ds_read_b64_tr_b16 a[138:139], v238 offset:17920
    v_accvgpr_read_b32 v229, a198
    v_mfma_f32_16x16x32_bf16 v[64:67], a[144:147], a[40:43], v[64:67]
    buffer_load_dwordx4 a[112:115], v226, s[4:7], 0 offen offset:2048 sc1
    v_add_f32 v228, v228, v229
    v_mfma_f32_16x16x32_bf16 v[120:123], a[144:147], a[48:51], v[120:123]
    ds_read_b64_tr_b16 a[140:141], v238 offset:21504
    v_accvgpr_read_b32 v229, a199
    v_mfma_f32_16x16x32_bf16 v[120:123], a[148:151], a[52:55], v[120:123]
    buffer_load_dwordx4 a[116:119], v226, s[4:7], 0 offen offset:3072 sc1
    v_add_f32 v228, v228, v229
    v_mfma_f32_16x16x32_bf16 v[176:179], a[148:151], a[60:63], v[176:179]
    ds_read_b64_tr_b16 a[142:143], v238 offset:25088
    v_accvgpr_read_b32 v229, a200
    v_mfma_f32_16x16x32_bf16 v[176:179], a[144:147], a[56:59], v[176:179]
    v_add_f32 v228, v228, v229
    s_waitcnt lgkmcnt(8)
    v_mfma_f32_16x16x32_bf16 v[12:15], a[152:155], a[32:35], v[12:15]
    ds_read_b64_tr_b16 a[144:145], v238 offset:32
    v_accvgpr_read_b32 v229, a201
    v_mfma_f32_16x16x32_bf16 v[12:15], a[156:159], a[36:39], v[12:15]
    v_add_f32 v228, v228, v229
    v_accvgpr_read_b32 v229, a202
    v_mfma_f32_16x16x32_bf16 v[68:71], a[156:159], a[44:47], v[68:71]
    ds_read_b64_tr_b16 a[146:147], v238 offset:3616
    v_add_f32 v228, v228, v229
    v_mfma_f32_16x16x32_bf16 v[68:71], a[152:155], a[40:43], v[68:71]
    buffer_load_dwordx4 a[120:123], v227, s[4:7], 0 offen offset:2048 sc1
    v_accvgpr_read_b32 v229, a203
    v_mfma_f32_16x16x32_bf16 v[124:127], a[152:155], a[48:51], v[124:127]
    ds_read_b64_tr_b16 a[148:149], v238 offset:7200
    v_add_f32 v228, v228, v229
    v_mfma_f32_16x16x32_bf16 v[124:127], a[156:159], a[52:55], v[124:127]
    v_accvgpr_read_b32 v229, a204
    v_add_f32 v228, v228, v229
    v_mfma_f32_16x16x32_bf16 v[180:183], a[156:159], a[60:63], v[180:183]
    ds_read_b64_tr_b16 a[150:151], v238 offset:10784
    v_accvgpr_read_b32 v229, a205
    v_mfma_f32_16x16x32_bf16 v[180:183], a[152:155], a[56:59], v[180:183]
    v_add_f32 v228, v228, v229
    s_waitcnt vmcnt(14) lgkmcnt(8)
    v_mfma_f32_16x16x32_bf16 v[0:3], a[128:131], a[64:67], v[0:3]
    ds_read_b64_tr_b16 a[152:153], v238 offset:14368
    v_accvgpr_read_b32 v229, a206
    v_mfma_f32_16x16x32_bf16 v[0:3], a[132:135], a[68:71], v[0:3]
    buffer_load_dwordx4 a[124:127], v227, s[4:7], 0 offen offset:3072 sc1
    v_add_f32 v228, v228, v229
    v_mfma_f32_16x16x32_bf16 v[56:59], a[132:135], a[76:79], v[56:59]
    ds_read_b64_tr_b16 a[154:155], v238 offset:17952
    v_accvgpr_read_b32 v229, a207
    v_mfma_f32_16x16x32_bf16 v[56:59], a[128:131], a[72:75], v[56:59]
    s_mov_b32 s8, s76
    s_mov_b32 s9, s77
    s_mov_b32 s10, 7340032
    v_mfma_f32_16x16x32_bf16 v[112:115], a[128:131], a[80:83], v[112:115]
    ds_read_b64_tr_b16 a[156:157], v238 offset:21536
    v_add_f32 v228, v228, v229
    v_mfma_f32_16x16x32_bf16 v[112:115], a[132:135], a[84:87], v[112:115]
    s_mov_b64 exec, 0xffff
    buffer_load_dword a208, v241, s[8:11], s40 offen
    s_mov_b64 exec, -1
    v_mfma_f32_16x16x32_bf16 v[168:171], a[132:135], a[92:95], v[168:171]
    ds_read_b64_tr_b16 a[158:159], v238 offset:25120
    v_mov_b32 v229, 0x3727c5ac
    v_mfma_f32_16x16x32_bf16 v[168:171], a[128:131], a[88:91], v[168:171]
    v_fmac_f32 v229, 0x3a800000, v228
    s_waitcnt lgkmcnt(8)
    v_mfma_f32_16x16x32_bf16 v[4:7], a[136:139], a[64:67], v[4:7]
    s_waitcnt vmcnt(9)
    s_barrier
    ds_read_b64_tr_b16 a[128:129], v239 offset:0
    v_mfma_f32_16x16x32_bf16 v[4:7], a[140:143], a[68:71], v[4:7]
    s_add_u32 s40, s40, 0x10000
    v_mfma_f32_16x16x32_bf16 v[60:63], a[140:143], a[76:79], v[60:63]
    ds_read_b64_tr_b16 a[130:131], v239 offset:3584
    v_mfma_f32_16x16x32_bf16 v[60:63], a[136:139], a[72:75], v[60:63]
    s_mov_b64 exec, 0xffff
    buffer_load_dword a208, v241, s[8:11], s40 offen
    s_mov_b64 exec, -1
    v_mfma_f32_16x16x32_bf16 v[116:119], a[136:139], a[80:83], v[116:119]
    ds_read_b64_tr_b16 a[132:133], v239 offset:7168
    v_mfma_f32_16x16x32_bf16 v[116:119], a[140:143], a[84:87], v[116:119]
    s_add_u32 s40, s40, 0x10000
    v_mfma_f32_16x16x32_bf16 v[172:175], a[140:143], a[92:95], v[172:175]
    ds_read_b64_tr_b16 a[134:135], v239 offset:10752
    v_mfma_f32_16x16x32_bf16 v[172:175], a[136:139], a[88:91], v[172:175]
    s_waitcnt lgkmcnt(8)
    v_mfma_f32_16x16x32_bf16 v[8:11], a[144:147], a[64:67], v[8:11]
    ds_read_b64_tr_b16 a[136:137], v239 offset:14336
    v_mfma_f32_16x16x32_bf16 v[8:11], a[148:151], a[68:71], v[8:11]
    s_mov_b64 exec, 0x1f
    buffer_load_dword a208, v241, s[52:55], s56 offen
    s_mov_b64 exec, -1
    v_mfma_f32_16x16x32_bf16 v[64:67], a[148:151], a[76:79], v[64:67]
    ds_read_b64_tr_b16 a[138:139], v239 offset:17920
    v_mfma_f32_16x16x32_bf16 v[64:67], a[144:147], a[72:75], v[64:67]
    s_mov_b32 s14, 131072
    s_mov_b32 s86, 131072
    v_mfma_f32_16x16x32_bf16 v[120:123], a[144:147], a[80:83], v[120:123]
    ds_read_b64_tr_b16 a[140:141], v239 offset:21504
    v_rsq_f32 v228, v229
    v_and_b32 v230, 15, v255
    v_mul_f32 v229, v229, v228
    v_mul_f32 v228, 0xbfb8aa3b, v228
    v_lshlrev_b32 v230, 2, v230
    v_lshlrev_b32 v231, 9, v255
    v_mov_b32 v232, s33
    v_mov_b32 v233, v230
    v_mfma_f32_16x16x32_bf16 v[120:123], a[148:151], a[84:87], v[120:123]
    ds_bpermute_b32 v244, v230, v228 offset:0
    v_mfma_f32_16x16x32_bf16 v[176:179], a[148:151], a[92:95], v[176:179]
    ds_read_b64_tr_b16 a[142:143], v239 offset:25088
    v_mov_b32 v224, v240
    v_mfma_f32_16x16x32_bf16 v[176:179], a[144:147], a[88:91], v[176:179]
    s_waitcnt lgkmcnt(9)
    v_mfma_f32_16x16x32_bf16 v[12:15], a[152:155], a[64:67], v[12:15]
    ds_read_b64_tr_b16 a[144:145], v239 offset:32
    v_add_u32 v225, 114688, v240
    v_mfma_f32_16x16x32_bf16 v[12:15], a[156:159], a[68:71], v[12:15]
    ds_bpermute_b32 v245, v230, v229 offset:0
    v_mfma_f32_16x16x32_bf16 v[68:71], a[156:159], a[76:79], v[68:71]
    ds_read_b64_tr_b16 a[146:147], v239 offset:3616
    v_mfma_f32_16x16x32_bf16 v[68:71], a[152:155], a[72:75], v[68:71]
    ds_bpermute_b32 v246, v230, v228 offset:64
    v_mfma_f32_16x16x32_bf16 v[124:127], a[152:155], a[80:83], v[124:127]
    ds_read_b64_tr_b16 a[148:149], v239 offset:7200
    v_mfma_f32_16x16x32_bf16 v[124:127], a[156:159], a[84:87], v[124:127]
    ds_bpermute_b32 v247, v230, v229 offset:64
    v_mfma_f32_16x16x32_bf16 v[180:183], a[156:159], a[92:95], v[180:183]
    ds_read_b64_tr_b16 a[150:151], v239 offset:10784
    v_add_u32 v226, 4096, v240
    v_mfma_f32_16x16x32_bf16 v[180:183], a[152:155], a[88:91], v[180:183]
    s_waitcnt vmcnt(3) lgkmcnt(12)
    v_mfma_f32_16x16x32_bf16 v[0:3], a[128:131], a[96:99], v[0:3]
    ds_read_b64_tr_b16 a[152:153], v239 offset:14368
    v_add_u32 v227, 118784, v240
    v_mfma_f32_16x16x32_bf16 v[0:3], a[132:135], a[100:103], v[0:3]
    ds_bpermute_b32 v248, v230, v228 offset:128
    v_mfma_f32_16x16x32_bf16 v[56:59], a[132:135], a[108:111], v[56:59]
    ds_read_b64_tr_b16 a[154:155], v239 offset:17952
    v_mfma_f32_16x16x32_bf16 v[56:59], a[128:131], a[104:107], v[56:59]
    ds_bpermute_b32 v249, v230, v229 offset:128
    v_mfma_f32_16x16x32_bf16 v[112:115], a[128:131], a[112:115], v[112:115]
    ds_read_b64_tr_b16 a[156:157], v239 offset:21536
    v_mfma_f32_16x16x32_bf16 v[112:115], a[132:135], a[116:119], v[112:115]
    ds_bpermute_b32 v250, v230, v228 offset:192
    v_mfma_f32_16x16x32_bf16 v[168:171], a[132:135], a[124:127], v[168:171]
    ds_read_b64_tr_b16 a[158:159], v239 offset:25120
    v_mfma_f32_16x16x32_bf16 v[168:171], a[128:131], a[120:123], v[168:171]
    s_waitcnt lgkmcnt(14)
    v_mfma_f32_16x16x32_bf16 v[4:7], a[136:139], a[96:99], v[4:7]
    ds_read_b64_tr_b16 a[128:129], v235 offset:64
    v_mfma_f32_16x16x32_bf16 v[4:7], a[140:143], a[100:103], v[4:7]
    ds_bpermute_b32 v251, v230, v229 offset:192
    v_mfma_f32_16x16x32_bf16 v[60:63], a[140:143], a[108:111], v[60:63]
    ds_read_b64_tr_b16 a[130:131], v235 offset:3648
    v_mfma_f32_16x16x32_bf16 v[60:63], a[136:139], a[104:107], v[60:63]
    v_mfma_f32_16x16x32_bf16 v[116:119], a[136:139], a[112:115], v[116:119]
    ds_read_b64_tr_b16 a[132:133], v235 offset:7232
    v_mfma_f32_16x16x32_bf16 v[116:119], a[140:143], a[116:119], v[116:119]
    v_mfma_f32_16x16x32_bf16 v[172:175], a[140:143], a[124:127], v[172:175]
    ds_read_b64_tr_b16 a[134:135], v235 offset:10816
    v_mfma_f32_16x16x32_bf16 v[172:175], a[136:139], a[120:123], v[172:175]
    s_waitcnt lgkmcnt(3)
    v_mfma_f32_16x16x32_bf16 v[8:11], a[144:147], a[96:99], v[8:11]
    ds_read_b64_tr_b16 a[136:137], v235 offset:14400
    v_mfma_f32_16x16x32_bf16 v[8:11], a[148:151], a[100:103], v[8:11]
    v_mfma_f32_16x16x32_bf16 v[64:67], a[148:151], a[108:111], v[64:67]
    ds_read_b64_tr_b16 a[138:139], v235 offset:17984
    v_mfma_f32_16x16x32_bf16 v[64:67], a[144:147], a[104:107], v[64:67]
    v_mfma_f32_16x16x32_bf16 v[120:123], a[144:147], a[112:115], v[120:123]
    ds_read_b64_tr_b16 a[140:141], v235 offset:21568
    v_mul_f32 v0, v0, v244
    v_mul_f32 v1, v1, v244
    v_mfma_f32_16x16x32_bf16 v[120:123], a[148:151], a[116:119], v[120:123]
    v_exp_f32 v0, v0
    v_mul_f32 v2, v2, v244
    v_mul_f32 v3, v3, v244
    v_mfma_f32_16x16x32_bf16 v[176:179], a[148:151], a[124:127], v[176:179]
    ds_read_b64_tr_b16 a[142:143], v235 offset:25152
    v_fma_f32 v0, v0, v245, v245
    v_mul_f32 v56, v56, v246
    v_mfma_f32_16x16x32_bf16 v[176:179], a[144:147], a[120:123], v[176:179]
    v_mul_f32 v57, v57, v246
    v_mul_f32 v58, v58, v246
    v_mul_f32 v59, v59, v246
    s_waitcnt lgkmcnt(9)
    v_mfma_f32_16x16x32_bf16 v[12:15], a[152:155], a[96:99], v[12:15]
    ds_read_b64_tr_b16 a[144:145], v237 offset:64
    v_mul_f32 v112, v112, v248
    v_mul_f32 v113, v113, v248
    v_mfma_f32_16x16x32_bf16 v[12:15], a[156:159], a[100:103], v[12:15]
    v_exp_f32 v1, v1
    v_mul_f32 v114, v114, v248
    v_mul_f32 v115, v115, v248
    v_mfma_f32_16x16x32_bf16 v[68:71], a[156:159], a[108:111], v[68:71]
    ds_read_b64_tr_b16 a[146:147], v237 offset:3648
    v_fma_f32 v1, v1, v245, v245
    v_mfma_f32_16x16x32_bf16 v[68:71], a[152:155], a[104:107], v[68:71]
    v_exp_f32 v2, v2
    v_exp_f32 v3, v3
    v_mfma_f32_16x16x32_bf16 v[124:127], a[152:155], a[112:115], v[124:127]
    ds_read_b64_tr_b16 a[148:149], v237 offset:7232
    v_fma_f32 v2, v2, v245, v245
    v_fma_f32 v3, v3, v245, v245
    v_mfma_f32_16x16x32_bf16 v[124:127], a[156:159], a[116:119], v[124:127]
    v_rcp_f32 v0, v0
    v_rcp_f32 v1, v1
    v_mfma_f32_16x16x32_bf16 v[180:183], a[156:159], a[124:127], v[180:183]
    ds_read_b64_tr_b16 a[150:151], v237 offset:10816
    v_mul_f32 v4, v4, v0
    v_mul_f32 v5, v5, v1
    v_mfma_f32_16x16x32_bf16 v[180:183], a[152:155], a[120:123], v[180:183]
    v_cvt_pk_bf16_f32 v0, v4, v5
    v_rcp_f32 v2, v2
    s_waitcnt lgkmcnt(8)
    v_mfma_f32_16x16x32_bf16 v[16:19], a[128:131], a[0:3], v[16:19]
    ds_read_b64_tr_b16 a[152:153], v237 offset:14400
    v_mul_f32 v6, v6, v2
    v_rcp_f32 v3, v3
    v_mfma_f32_16x16x32_bf16 v[16:19], a[132:135], a[4:7], v[16:19]
    v_exp_f32 v56, v56
    v_mul_f32 v7, v7, v3
    v_mul_f32 v168, v168, v250
    v_mfma_f32_16x16x32_bf16 v[72:75], a[132:135], a[12:15], v[72:75]
    ds_read_b64_tr_b16 a[154:155], v237 offset:17984
    v_cvt_pk_bf16_f32 v1, v6, v7
    v_fma_f32 v56, v56, v247, v247
    v_mfma_f32_16x16x32_bf16 v[72:75], a[128:131], a[8:11], v[72:75]
    v_exp_f32 v57, v57
    v_mul_f32 v169, v169, v250
    v_mul_f32 v170, v170, v250
    v_mfma_f32_16x16x32_bf16 v[128:131], a[128:131], a[16:19], v[128:131]
    ds_read_b64_tr_b16 a[156:157], v237 offset:21568
    v_fma_f32 v57, v57, v247, v247
    v_mul_f32 v171, v171, v250
    v_mfma_f32_16x16x32_bf16 v[128:131], a[132:135], a[20:23], v[128:131]
    v_exp_f32 v58, v58
    v_exp_f32 v59, v59
    v_mfma_f32_16x16x32_bf16 v[184:187], a[132:135], a[28:31], v[184:187]
    ds_read_b64_tr_b16 a[158:159], v237 offset:25152
    v_fma_f32 v58, v58, v247, v247
    v_fma_f32 v59, v59, v247, v247
    v_mfma_f32_16x16x32_bf16 v[184:187], a[128:131], a[24:27], v[184:187]
    v_rcp_f32 v56, v56
    s_waitcnt lgkmcnt(8)
    v_mfma_f32_16x16x32_bf16 v[20:23], a[136:139], a[0:3], v[20:23]
    ds_read_b64_tr_b16 a[128:129], v238 offset:64
    v_mul_f32 v60, v60, v56
    v_rcp_f32 v57, v57
    v_mfma_f32_16x16x32_bf16 v[20:23], a[140:143], a[4:7], v[20:23]
    v_rcp_f32 v58, v58
    v_mul_f32 v61, v61, v57
    v_mfma_f32_16x16x32_bf16 v[76:79], a[140:143], a[12:15], v[76:79]
    ds_read_b64_tr_b16 a[130:131], v238 offset:3648
    v_mul_f32 v62, v62, v58
    v_cvt_pk_bf16_f32 v56, v60, v61
    v_mfma_f32_16x16x32_bf16 v[76:79], a[136:139], a[8:11], v[76:79]
    v_rcp_f32 v59, v59
    v_mul_f32 v8, v8, v244
    v_exp_f32 v112, v112
    v_mfma_f32_16x16x32_bf16 v[132:135], a[136:139], a[16:19], v[132:135]
    ds_read_b64_tr_b16 a[132:133], v238 offset:7232
    v_mul_f32 v63, v63, v59
    v_fma_f32 v112, v112, v249, v249
    v_mfma_f32_16x16x32_bf16 v[132:135], a[140:143], a[20:23], v[132:135]
    v_exp_f32 v113, v113
    v_cvt_pk_bf16_f32 v57, v62, v63
    v_mul_f32 v9, v9, v244
    v_mfma_f32_16x16x32_bf16 v[188:191], a[140:143], a[28:31], v[188:191]
    ds_read_b64_tr_b16 a[134:135], v238 offset:10816
    v_fma_f32 v113, v113, v249, v249
    v_mul_f32 v10, v10, v244
    v_mfma_f32_16x16x32_bf16 v[188:191], a[136:139], a[24:27], v[188:191]
    v_mul_f32 v11, v11, v244
    v_exp_f32 v114, v114
    s_waitcnt lgkmcnt(8)
    v_mfma_f32_16x16x32_bf16 v[16:19], a[144:147], a[32:35], v[16:19]
    ds_read_b64_tr_b16 a[136:137], v238 offset:14400
    v_fma_f32 v114, v114, v249, v249
    v_mfma_f32_16x16x32_bf16 v[16:19], a[148:151], a[36:39], v[16:19]
    v_exp_f32 v115, v115
    v_rcp_f32 v112, v112
    v_mfma_f32_16x16x32_bf16 v[72:75], a[148:151], a[44:47], v[72:75]
    ds_read_b64_tr_b16 a[138:139], v238 offset:17984
    v_fma_f32 v115, v115, v249, v249
    v_mul_f32 v116, v116, v112
    v_mfma_f32_16x16x32_bf16 v[72:75], a[144:147], a[40:43], v[72:75]
    v_rcp_f32 v113, v113
    v_rcp_f32 v114, v114
    v_mfma_f32_16x16x32_bf16 v[128:131], a[144:147], a[48:51], v[128:131]
    ds_read_b64_tr_b16 a[140:141], v238 offset:21568
    v_mul_f32 v117, v117, v113
    v_mul_f32 v118, v118, v114
    v_mfma_f32_16x16x32_bf16 v[128:131], a[148:151], a[52:55], v[128:131]
    v_rcp_f32 v115, v115
    v_cvt_pk_bf16_f32 v112, v116, v117
    v_exp_f32 v168, v168
    v_mfma_f32_16x16x32_bf16 v[184:187], a[148:151], a[60:63], v[184:187]
    ds_read_b64_tr_b16 a[142:143], v238 offset:25152
    v_mul_f32 v119, v119, v115
    v_fma_f32 v168, v168, v251, v251
    v_mfma_f32_16x16x32_bf16 v[184:187], a[144:147], a[56:59], v[184:187]
    v_cvt_pk_bf16_f32 v113, v118, v119
    v_mul_f32 v64, v64, v246
    v_mul_f32 v65, v65, v246
    s_waitcnt lgkmcnt(8)
    v_mfma_f32_16x16x32_bf16 v[20:23], a[152:155], a[32:35], v[20:23]
    ds_read_b64_tr_b16 a[144:145], v239 offset:64
    v_mul_f32 v66, v66, v246
    v_mul_f32 v67, v67, v246
    v_mfma_f32_16x16x32_bf16 v[20:23], a[156:159], a[36:39], v[20:23]
    v_exp_f32 v169, v169
    v_exp_f32 v170, v170
    v_mfma_f32_16x16x32_bf16 v[76:79], a[156:159], a[44:47], v[76:79]
    ds_read_b64_tr_b16 a[146:147], v239 offset:3648
    v_fma_f32 v169, v169, v251, v251
    v_fma_f32 v170, v170, v251, v251
    v_mfma_f32_16x16x32_bf16 v[76:79], a[152:155], a[40:43], v[76:79]
    v_exp_f32 v171, v171
    v_rcp_f32 v168, v168
    v_mfma_f32_16x16x32_bf16 v[132:135], a[152:155], a[48:51], v[132:135]
    ds_read_b64_tr_b16 a[148:149], v239 offset:7232
    v_fma_f32 v171, v171, v251, v251
    v_mul_f32 v172, v172, v168
    v_mfma_f32_16x16x32_bf16 v[132:135], a[156:159], a[52:55], v[132:135]
    v_rcp_f32 v169, v169
    v_rcp_f32 v170, v170
    v_mfma_f32_16x16x32_bf16 v[188:191], a[156:159], a[60:63], v[188:191]
    ds_read_b64_tr_b16 a[150:151], v239 offset:10816
    v_mul_f32 v173, v173, v169
    v_mul_f32 v174, v174, v170
    v_mfma_f32_16x16x32_bf16 v[188:191], a[152:155], a[56:59], v[188:191]
    v_cvt_pk_bf16_f32 v168, v172, v173
    v_rcp_f32 v171, v171
    s_waitcnt lgkmcnt(8)
    v_mfma_f32_16x16x32_bf16 v[16:19], a[128:131], a[64:67], v[16:19]
    ds_read_b64_tr_b16 a[152:153], v239 offset:14400
    v_mul_f32 v175, v175, v171
    v_mul_f32 v120, v120, v248
    v_mfma_f32_16x16x32_bf16 v[16:19], a[132:135], a[68:71], v[16:19]
    v_exp_f32 v8, v8
    v_cvt_pk_bf16_f32 v169, v174, v175
    v_mul_f32 v121, v121, v248
    v_mfma_f32_16x16x32_bf16 v[72:75], a[132:135], a[76:79], v[72:75]
    ds_read_b64_tr_b16 a[154:155], v239 offset:17984
    v_fma_f32 v8, v8, v245, v245
    v_mul_f32 v122, v122, v248
    v_mfma_f32_16x16x32_bf16 v[72:75], a[128:131], a[72:75], v[72:75]
    v_exp_f32 v9, v9
    v_mul_f32 v123, v123, v248
    v_mfma_f32_16x16x32_bf16 v[128:131], a[128:131], a[80:83], v[128:131]
    ds_read_b64_tr_b16 a[156:157], v239 offset:21568
    v_fma_f32 v9, v9, v245, v245
    v_exp_f32 v10, v10
    v_mfma_f32_16x16x32_bf16 v[128:131], a[132:135], a[84:87], v[128:131]
    v_exp_f32 v11, v11
    v_fma_f32 v10, v10, v245, v245
    v_mfma_f32_16x16x32_bf16 v[184:187], a[132:135], a[92:95], v[184:187]
    ds_read_b64_tr_b16 a[158:159], v239 offset:25152
    v_fma_f32 v11, v11, v245, v245
    v_rcp_f32 v8, v8
    v_mfma_f32_16x16x32_bf16 v[184:187], a[128:131], a[88:91], v[184:187]
    v_mul_f32 v12, v12, v8
    v_rcp_f32 v9, v9
    s_waitcnt lgkmcnt(8)
    v_mfma_f32_16x16x32_bf16 v[20:23], a[136:139], a[64:67], v[20:23]
    ds_read_b64_tr_b16 a[128:129], v235 offset:96
    v_mul_f32 v13, v13, v9
    v_mfma_f32_16x16x32_bf16 v[20:23], a[140:143], a[68:71], v[20:23]
    v_rcp_f32 v10, v10
    v_cvt_pk_bf16_f32 v2, v12, v13
    v_rcp_f32 v11, v11
    v_mfma_f32_16x16x32_bf16 v[76:79], a[140:143], a[76:79], v[76:79]
    ds_read_b64_tr_b16 a[130:131], v235 offset:3680
    v_mul_f32 v14, v14, v10
    v_mul_f32 v15, v15, v11
    v_mfma_f32_16x16x32_bf16 v[76:79], a[136:139], a[72:75], v[76:79]
    v_exp_f32 v64, v64
    v_cvt_pk_bf16_f32 v3, v14, v15
    v_mul_f32 v176, v176, v250
    v_mfma_f32_16x16x32_bf16 v[132:135], a[136:139], a[80:83], v[132:135]
    ds_read_b64_tr_b16 a[132:133], v235 offset:7264
    buffer_store_dwordx4 v[0:3], v252, s[16:19], 0 offen offset:0 sc1
    v_fma_f32 v64, v64, v247, v247
    v_mfma_f32_16x16x32_bf16 v[132:135], a[140:143], a[84:87], v[132:135]
    v_exp_f32 v65, v65
    v_mul_f32 v177, v177, v250
    v_mul_f32 v178, v178, v250
    v_mfma_f32_16x16x32_bf16 v[188:191], a[140:143], a[92:95], v[188:191]
    ds_read_b64_tr_b16 a[134:135], v235 offset:10848
    v_fma_f32 v65, v65, v247, v247
    v_mul_f32 v179, v179, v250
    v_mfma_f32_16x16x32_bf16 v[188:191], a[136:139], a[88:91], v[188:191]
    v_exp_f32 v66, v66
    s_waitcnt lgkmcnt(8)
    v_mfma_f32_16x16x32_bf16 v[16:19], a[144:147], a[96:99], v[16:19]
    ds_read_b64_tr_b16 a[136:137], v235 offset:14432
    v_fma_f32 v66, v66, v247, v247
    v_exp_f32 v67, v67
    v_mfma_f32_16x16x32_bf16 v[16:19], a[148:151], a[100:103], v[16:19]
    v_rcp_f32 v64, v64
    v_fma_f32 v67, v67, v247, v247
    v_mfma_f32_16x16x32_bf16 v[72:75], a[148:151], a[108:111], v[72:75]
    ds_read_b64_tr_b16 a[138:139], v235 offset:18016
    v_mul_f32 v68, v68, v64
    v_rcp_f32 v65, v65
    v_mfma_f32_16x16x32_bf16 v[72:75], a[144:147], a[104:107], v[72:75]
    v_rcp_f32 v66, v66
    v_mul_f32 v69, v69, v65
    v_mfma_f32_16x16x32_bf16 v[128:131], a[144:147], a[112:115], v[128:131]
    ds_read_b64_tr_b16 a[140:141], v235 offset:21600
    v_mul_f32 v70, v70, v66
    v_cvt_pk_bf16_f32 v58, v68, v69
    v_mfma_f32_16x16x32_bf16 v[128:131], a[148:151], a[116:119], v[128:131]
    v_rcp_f32 v67, v67
    v_exp_f32 v120, v120
    v_mfma_f32_16x16x32_bf16 v[184:187], a[148:151], a[124:127], v[184:187]
    ds_read_b64_tr_b16 a[142:143], v235 offset:25184
    v_mul_f32 v71, v71, v67
    v_fma_f32 v120, v120, v249, v249
    v_mfma_f32_16x16x32_bf16 v[184:187], a[144:147], a[120:123], v[184:187]
    v_cvt_pk_bf16_f32 v59, v70, v71
    v_exp_f32 v121, v121
    s_waitcnt lgkmcnt(8)
    v_mfma_f32_16x16x32_bf16 v[20:23], a[152:155], a[96:99], v[20:23]
    ds_read_b64_tr_b16 a[144:145], v237 offset:96
    buffer_store_dwordx4 v[56:59], v252, s[16:19], s35 offen offset:0 sc1
    v_fma_f32 v121, v121, v249, v249
    v_mfma_f32_16x16x32_bf16 v[20:23], a[156:159], a[100:103], v[20:23]
    v_exp_f32 v122, v122
    v_exp_f32 v123, v123
    v_mfma_f32_16x16x32_bf16 v[76:79], a[156:159], a[108:111], v[76:79]
    ds_read_b64_tr_b16 a[146:147], v237 offset:3680
    v_fma_f32 v122, v122, v249, v249
    v_fma_f32 v123, v123, v249, v249
    v_mfma_f32_16x16x32_bf16 v[76:79], a[152:155], a[104:107], v[76:79]
    v_rcp_f32 v120, v120
    v_rcp_f32 v121, v121
    v_mfma_f32_16x16x32_bf16 v[132:135], a[152:155], a[112:115], v[132:135]
    ds_read_b64_tr_b16 a[148:149], v237 offset:7264
    v_mul_f32 v124, v124, v120
    v_mul_f32 v125, v125, v121
    v_mfma_f32_16x16x32_bf16 v[132:135], a[156:159], a[116:119], v[132:135]
    v_rcp_f32 v122, v122
    v_cvt_pk_bf16_f32 v114, v124, v125
    v_rcp_f32 v123, v123
    v_mfma_f32_16x16x32_bf16 v[188:191], a[156:159], a[124:127], v[188:191]
    ds_read_b64_tr_b16 a[150:151], v237 offset:10848
    v_mul_f32 v126, v126, v122
    v_mul_f32 v127, v127, v123
    v_mfma_f32_16x16x32_bf16 v[188:191], a[152:155], a[120:123], v[188:191]
    v_cvt_pk_bf16_f32 v115, v126, v127
    v_exp_f32 v176, v176
    s_waitcnt lgkmcnt(8)
    v_mfma_f32_16x16x32_bf16 v[24:27], a[128:131], a[0:3], v[24:27]
    ds_read_b64_tr_b16 a[152:153], v237 offset:14432
    buffer_store_dwordx4 v[112:115], v252, s[16:19], s36 offen offset:0 sc1
    v_fma_f32 v176, v176, v251, v251
    v_mfma_f32_16x16x32_bf16 v[24:27], a[132:135], a[4:7], v[24:27]
    v_exp_f32 v177, v177
    v_exp_f32 v178, v178
    v_mfma_f32_16x16x32_bf16 v[80:83], a[132:135], a[12:15], v[80:83]
    ds_read_b64_tr_b16 a[154:155], v237 offset:18016
    v_fma_f32 v177, v177, v251, v251
    v_fma_f32 v178, v178, v251, v251
    v_mfma_f32_16x16x32_bf16 v[80:83], a[128:131], a[8:11], v[80:83]
    v_exp_f32 v179, v179
    v_rcp_f32 v176, v176
    v_mfma_f32_16x16x32_bf16 v[136:139], a[128:131], a[16:19], v[136:139]
    ds_read_b64_tr_b16 a[156:157], v237 offset:21600
    v_fma_f32 v179, v179, v251, v251
    v_mul_f32 v180, v180, v176
    v_mfma_f32_16x16x32_bf16 v[136:139], a[132:135], a[20:23], v[136:139]
    v_rcp_f32 v177, v177
    v_rcp_f32 v178, v178
    v_mfma_f32_16x16x32_bf16 v[192:195], a[132:135], a[28:31], v[192:195]
    ds_read_b64_tr_b16 a[158:159], v237 offset:25184
    v_mul_f32 v181, v181, v177
    v_mul_f32 v182, v182, v178
    v_mfma_f32_16x16x32_bf16 v[192:195], a[128:131], a[24:27], v[192:195]
    v_cvt_pk_bf16_f32 v170, v180, v181
    v_rcp_f32 v179, v179
    s_waitcnt lgkmcnt(8)
    v_mfma_f32_16x16x32_bf16 v[28:31], a[136:139], a[0:3], v[28:31]
    ds_read_b64_tr_b16 a[128:129], v238 offset:96
    v_mul_f32 v183, v183, v179
    v_mfma_f32_16x16x32_bf16 v[28:31], a[140:143], a[4:7], v[28:31]
    v_cvt_pk_bf16_f32 v171, v182, v183
    v_mfma_f32_16x16x32_bf16 v[84:87], a[140:143], a[12:15], v[84:87]
    ds_read_b64_tr_b16 a[130:131], v238 offset:3680
    buffer_store_dwordx4 v[168:171], v252, s[16:19], s37 offen offset:0 sc1
    v_mfma_f32_16x16x32_bf16 v[84:87], a[136:139], a[8:11], v[84:87]
    v_mul_f32 v16, v16, v244
    v_mul_f32 v17, v17, v244
    v_mfma_f32_16x16x32_bf16 v[140:143], a[136:139], a[16:19], v[140:143]
    ds_read_b64_tr_b16 a[132:133], v238 offset:7264
    s_add_u32 m0, s49, 114688
    v_mfma_f32_16x16x32_bf16 v[140:143], a[140:143], a[20:23], v[140:143]
    v_exp_f32 v16, v16
    v_mfma_f32_16x16x32_bf16 v[196:199], a[140:143], a[28:31], v[196:199]
    ds_read_b64_tr_b16 a[134:135], v238 offset:10848
    s_add_u32 s12, s64, 0
    v_mfma_f32_16x16x32_bf16 v[196:199], a[136:139], a[24:27], v[196:199]
    s_addc_u32 s13, s65, 0
    s_waitcnt lgkmcnt(8)
    v_mfma_f32_16x16x32_bf16 v[24:27], a[144:147], a[32:35], v[24:27]
    ds_read_b64_tr_b16 a[136:137], v238 offset:14432
    buffer_load_dwordx4 v242, s[12:15], 0 offen offset:0 sc1 lds
    v_mfma_f32_16x16x32_bf16 v[24:27], a[148:151], a[36:39], v[24:27]
    v_exp_f32 v17, v17
    v_mfma_f32_16x16x32_bf16 v[80:83], a[148:151], a[44:47], v[80:83]
    ds_read_b64_tr_b16 a[138:139], v238 offset:18016
    buffer_load_dwordx4 v243, s[12:15], 0 offen offset:1024 sc1 lds
    v_mfma_f32_16x16x32_bf16 v[80:83], a[144:147], a[40:43], v[80:83]
    v_mul_f32 v18, v18, v244
    v_mul_f32 v19, v19, v244
    v_mfma_f32_16x16x32_bf16 v[136:139], a[144:147], a[48:51], v[136:139]
    ds_read_b64_tr_b16 a[140:141], v238 offset:21600
    s_add_u32 m0, s49, 116736
    v_mfma_f32_16x16x32_bf16 v[136:139], a[148:151], a[52:55], v[136:139]
    v_exp_f32 v18, v18
    v_mfma_f32_16x16x32_bf16 v[192:195], a[148:151], a[60:63], v[192:195]
    ds_read_b64_tr_b16 a[142:143], v238 offset:25184
    s_add_u32 s84, s66, 0
    v_mfma_f32_16x16x32_bf16 v[192:195], a[144:147], a[56:59], v[192:195]
    s_addc_u32 s85, s67, 0
    s_waitcnt lgkmcnt(8)
    v_mfma_f32_16x16x32_bf16 v[28:31], a[152:155], a[32:35], v[28:31]
    ds_read_b64_tr_b16 a[144:145], v239 offset:96
    buffer_load_dwordx4 v242, s[84:87], 0 offen offset:0 sc1 lds
    v_mfma_f32_16x16x32_bf16 v[28:31], a[156:159], a[36:39], v[28:31]
    v_exp_f32 v19, v19
    v_mfma_f32_16x16x32_bf16 v[84:87], a[156:159], a[44:47], v[84:87]
    ds_read_b64_tr_b16 a[146:147], v239 offset:3680
    buffer_load_dwordx4 v243, s[84:87], 0 offen offset:1024 sc1 lds
    v_mfma_f32_16x16x32_bf16 v[84:87], a[152:155], a[40:43], v[84:87]
    v_fma_f32 v16, v16, v245, v245
    v_fma_f32 v17, v17, v245, v245
    v_mfma_f32_16x16x32_bf16 v[140:143], a[152:155], a[48:51], v[140:143]
    ds_read_b64_tr_b16 a[148:149], v239 offset:7264
    s_add_u32 m0, s49, 131072
    v_mfma_f32_16x16x32_bf16 v[140:143], a[156:159], a[52:55], v[140:143]
    v_rcp_f32 v16, v16
    v_mfma_f32_16x16x32_bf16 v[196:199], a[156:159], a[60:63], v[196:199]
    ds_read_b64_tr_b16 a[150:151], v239 offset:10848
    s_add_u32 s12, s64, 458752
    v_mfma_f32_16x16x32_bf16 v[196:199], a[152:155], a[56:59], v[196:199]
    s_addc_u32 s13, s65, 0
    s_waitcnt lgkmcnt(8)
    v_mfma_f32_16x16x32_bf16 v[24:27], a[128:131], a[64:67], v[24:27]
    ds_read_b64_tr_b16 a[152:153], v239 offset:14432
    buffer_load_dwordx4 v242, s[12:15], 0 offen offset:0 sc1 lds
    v_mfma_f32_16x16x32_bf16 v[24:27], a[132:135], a[68:71], v[24:27]
    v_rcp_f32 v17, v17
    v_mfma_f32_16x16x32_bf16 v[80:83], a[132:135], a[76:79], v[80:83]
    ds_read_b64_tr_b16 a[154:155], v239 offset:18016
    buffer_load_dwordx4 v243, s[12:15], 0 offen offset:1024 sc1 lds
    v_mfma_f32_16x16x32_bf16 v[80:83], a[128:131], a[72:75], v[80:83]
    v_fma_f32 v18, v18, v245, v245
    v_fma_f32 v19, v19, v245, v245
    v_mfma_f32_16x16x32_bf16 v[136:139], a[128:131], a[80:83], v[136:139]
    ds_read_b64_tr_b16 a[156:157], v239 offset:21600
    s_add_u32 m0, s49, 133120
    v_mfma_f32_16x16x32_bf16 v[136:139], a[132:135], a[84:87], v[136:139]
    v_rcp_f32 v18, v18
    v_mfma_f32_16x16x32_bf16 v[192:195], a[132:135], a[92:95], v[192:195]
    ds_read_b64_tr_b16 a[158:159], v239 offset:25184
    s_add_u32 s84, s66, 458752
    v_mfma_f32_16x16x32_bf16 v[192:195], a[128:131], a[88:91], v[192:195]
    s_addc_u32 s85, s67, 0
    s_waitcnt lgkmcnt(8)
    v_mfma_f32_16x16x32_bf16 v[28:31], a[136:139], a[64:67], v[28:31]
    ds_read_b64_tr_b16 a[128:129], v235 offset:128
    buffer_load_dwordx4 v242, s[84:87], 0 offen offset:0 sc1 lds
    v_mfma_f32_16x16x32_bf16 v[28:31], a[140:143], a[68:71], v[28:31]
    v_rcp_f32 v19, v19
    v_mfma_f32_16x16x32_bf16 v[84:87], a[140:143], a[76:79], v[84:87]
    ds_read_b64_tr_b16 a[130:131], v235 offset:3712
    buffer_load_dwordx4 v243, s[84:87], 0 offen offset:1024 sc1 lds
    v_mfma_f32_16x16x32_bf16 v[84:87], a[136:139], a[72:75], v[84:87]
    v_mul_f32 v20, v20, v16
    v_mul_f32 v21, v21, v17
    v_mfma_f32_16x16x32_bf16 v[140:143], a[136:139], a[80:83], v[140:143]
    ds_read_b64_tr_b16 a[132:133], v235 offset:7296
    s_add_u32 m0, s49, 147456
    v_mfma_f32_16x16x32_bf16 v[140:143], a[140:143], a[84:87], v[140:143]
    v_mul_f32 v22, v22, v18
    v_mul_f32 v23, v23, v19
    v_mfma_f32_16x16x32_bf16 v[196:199], a[140:143], a[92:95], v[196:199]
    ds_read_b64_tr_b16 a[134:135], v235 offset:10880
    s_add_u32 s12, s64, 917504
    v_mfma_f32_16x16x32_bf16 v[196:199], a[136:139], a[88:91], v[196:199]
    s_addc_u32 s13, s65, 0
    s_waitcnt lgkmcnt(8)
    v_mfma_f32_16x16x32_bf16 v[24:27], a[144:147], a[96:99], v[24:27]
    ds_read_b64_tr_b16 a[136:137], v235 offset:14464
    buffer_load_dwordx4 v242, s[12:15], 0 offen offset:0 sc1 lds
    v_mfma_f32_16x16x32_bf16 v[24:27], a[148:151], a[100:103], v[24:27]
    v_cvt_pk_bf16_f32 v16, v20, v21
    v_cvt_pk_bf16_f32 v17, v22, v23
    v_mfma_f32_16x16x32_bf16 v[80:83], a[148:151], a[108:111], v[80:83]
    ds_read_b64_tr_b16 a[138:139], v235 offset:18048
    buffer_load_dwordx4 v243, s[12:15], 0 offen offset:1024 sc1 lds
    v_mfma_f32_16x16x32_bf16 v[80:83], a[144:147], a[104:107], v[80:83]
    v_mul_f32 v72, v72, v246
    v_mul_f32 v73, v73, v246
    v_mfma_f32_16x16x32_bf16 v[136:139], a[144:147], a[112:115], v[136:139]
    ds_read_b64_tr_b16 a[140:141], v235 offset:21632
    s_add_u32 m0, s49, 149504
    v_mfma_f32_16x16x32_bf16 v[136:139], a[148:151], a[116:119], v[136:139]
    v_exp_f32 v72, v72
    v_mfma_f32_16x16x32_bf16 v[192:195], a[148:151], a[124:127], v[192:195]
    ds_read_b64_tr_b16 a[142:143], v235 offset:25216
    s_add_u32 s84, s66, 917504
    v_mfma_f32_16x16x32_bf16 v[192:195], a[144:147], a[120:123], v[192:195]
    s_addc_u32 s85, s67, 0
    s_waitcnt lgkmcnt(8)
    v_mfma_f32_16x16x32_bf16 v[28:31], a[152:155], a[96:99], v[28:31]
    ds_read_b64_tr_b16 a[144:145], v237 offset:128
    buffer_load_dwordx4 v242, s[84:87], 0 offen offset:0 sc1 lds
    v_mfma_f32_16x16x32_bf16 v[28:31], a[156:159], a[100:103], v[28:31]
    v_exp_f32 v73, v73
    v_mfma_f32_16x16x32_bf16 v[84:87], a[156:159], a[108:111], v[84:87]
    ds_read_b64_tr_b16 a[146:147], v237 offset:3712
    buffer_load_dwordx4 v243, s[84:87], 0 offen offset:1024 sc1 lds
    v_mfma_f32_16x16x32_bf16 v[84:87], a[152:155], a[104:107], v[84:87]
    s_waitcnt vmcnt(12)
    s_barrier
    s_cmp_lg_u32 s3, 0
    s_cbranch_scc1 L_nosend40
    s_mov_b64 exec, 0xffff
    buffer_store_dword v232, v231, s[16:19], s27 offen offset:0 sc1
    s_mov_b64 exec, -1
L_nosend40:
    v_mfma_f32_16x16x32_bf16 v[140:143], a[152:155], a[112:115], v[140:143]
    ds_read_b64_tr_b16 a[148:149], v237 offset:7296
    v_mul_f32 v74, v74, v246
    v_mfma_f32_16x16x32_bf16 v[140:143], a[156:159], a[116:119], v[140:143]
    s_mov_b64 exec, 0xffff
    buffer_load_dword a208, v241, s[8:11], s40 offen
    s_mov_b64 exec, -1
    v_mfma_f32_16x16x32_bf16 v[196:199], a[156:159], a[124:127], v[196:199]
    ds_read_b64_tr_b16 a[150:151], v237 offset:10880
    s_add_u32 s40, s40, 0x10000
    v_mfma_f32_16x16x32_bf16 v[196:199], a[152:155], a[120:123], v[196:199]
    v_mul_f32 v75, v75, v246
    s_waitcnt lgkmcnt(8)
    v_mfma_f32_16x16x32_bf16 v[32:35], a[128:131], a[0:3], v[32:35]
    ds_read_b64_tr_b16 a[152:153], v237 offset:14464
    v_fma_f32 v72, v72, v247, v247
    v_mfma_f32_16x16x32_bf16 v[32:35], a[132:135], a[4:7], v[32:35]
    s_mov_b64 exec, 0xffff
    buffer_load_dword a208, v241, s[8:11], s40 offen
    s_mov_b64 exec, -1
    v_mfma_f32_16x16x32_bf16 v[88:91], a[132:135], a[12:15], v[88:91]
    ds_read_b64_tr_b16 a[154:155], v237 offset:18048
    s_add_u32 s40, s40, 0x10000
    v_mfma_f32_16x16x32_bf16 v[88:91], a[128:131], a[8:11], v[88:91]
    v_exp_f32 v74, v74
    v_mfma_f32_16x16x32_bf16 v[144:147], a[128:131], a[16:19], v[144:147]
    ds_read_b64_tr_b16 a[156:157], v237 offset:21632
    v_fma_f32 v73, v73, v247, v247
    v_mfma_f32_16x16x32_bf16 v[144:147], a[132:135], a[20:23], v[144:147]
    v_exp_f32 v75, v75
    v_mfma_f32_16x16x32_bf16 v[200:203], a[132:135], a[28:31], v[200:203]
    ds_read_b64_tr_b16 a[158:159], v237 offset:25216
    v_fma_f32 v74, v74, v247, v247
    v_mfma_f32_16x16x32_bf16 v[200:203], a[128:131], a[24:27], v[200:203]
    v_fma_f32 v75, v75, v247, v247
    s_waitcnt lgkmcnt(8)
    v_mfma_f32_16x16x32_bf16 v[36:39], a[136:139], a[0:3], v[36:39]
    ds_read_b64_tr_b16 a[128:129], v238 offset:128
    v_mul_f32 v128, v128, v248
    v_mfma_f32_16x16x32_bf16 v[36:39], a[140:143], a[4:7], v[36:39]
    v_rcp_f32 v72, v72
    v_mfma_f32_16x16x32_bf16 v[92:95], a[140:143], a[12:15], v[92:95]
    ds_read_b64_tr_b16 a[130:131], v238 offset:3712
    v_mul_f32 v76, v76, v72
    v_mfma_f32_16x16x32_bf16 v[92:95], a[136:139], a[8:11], v[92:95]
    v_rcp_f32 v73, v73
    v_mfma_f32_16x16x32_bf16 v[148:151], a[136:139], a[16:19], v[148:151]
    ds_read_b64_tr_b16 a[132:133], v238 offset:7296
    v_mul_f32 v77, v77, v73
    v_mfma_f32_16x16x32_bf16 v[148:151], a[140:143], a[20:23], v[148:151]
    v_rcp_f32 v74, v74
    v_mfma_f32_16x16x32_bf16 v[204:207], a[140:143], a[28:31], v[204:207]
    ds_read_b64_tr_b16 a[134:135], v238 offset:10880
    v_mul_f32 v78, v78, v74
    v_mfma_f32_16x16x32_bf16 v[204:207], a[136:139], a[24:27], v[204:207]
    v_cvt_pk_bf16_f32 v72, v76, v77
    s_waitcnt lgkmcnt(8)
    v_mfma_f32_16x16x32_bf16 v[32:35], a[144:147], a[32:35], v[32:35]
    ds_read_b64_tr_b16 a[136:137], v238 offset:14464
    v_mul_f32 v129, v129, v248
    v_mfma_f32_16x16x32_bf16 v[32:35], a[148:151], a[36:39], v[32:35]
    v_rcp_f32 v75, v75
    v_mfma_f32_16x16x32_bf16 v[88:91], a[148:151], a[44:47], v[88:91]
    ds_read_b64_tr_b16 a[138:139], v238 offset:18048
    v_mul_f32 v79, v79, v75
    v_mfma_f32_16x16x32_bf16 v[88:91], a[144:147], a[40:43], v[88:91]
    v_exp_f32 v128, v128
    v_mfma_f32_16x16x32_bf16 v[144:147], a[144:147], a[48:51], v[144:147]
    ds_read_b64_tr_b16 a[140:141], v238 offset:21632
    v_cvt_pk_bf16_f32 v73, v78, v79
    v_mfma_f32_16x16x32_bf16 v[144:147], a[148:151], a[52:55], v[144:147]
    v_exp_f32 v129, v129
    v_mfma_f32_16x16x32_bf16 v[200:203], a[148:151], a[60:63], v[200:203]
    ds_read_b64_tr_b16 a[142:143], v238 offset:25216
    v_mul_f32 v130, v130, v248
    v_mfma_f32_16x16x32_bf16 v[200:203], a[144:147], a[56:59], v[200:203]
    v_mul_f32 v131, v131, v248
    s_waitcnt lgkmcnt(8)
    v_mfma_f32_16x16x32_bf16 v[36:39], a[152:155], a[32:35], v[36:39]
    ds_read_b64_tr_b16 a[144:145], v239 offset:128
    v_fma_f32 v128, v128, v249, v249
    v_mfma_f32_16x16x32_bf16 v[36:39], a[156:159], a[36:39], v[36:39]
    v_exp_f32 v130, v130
    v_mfma_f32_16x16x32_bf16 v[92:95], a[156:159], a[44:47], v[92:95]
    ds_read_b64_tr_b16 a[146:147], v239 offset:3712
    v_fma_f32 v129, v129, v249, v249
    v_mfma_f32_16x16x32_bf16 v[92:95], a[152:155], a[40:43], v[92:95]
    v_exp_f32 v131, v131
    v_mfma_f32_16x16x32_bf16 v[148:151], a[152:155], a[48:51], v[148:151]
    ds_read_b64_tr_b16 a[148:149], v239 offset:7296
    v_fma_f32 v130, v130, v249, v249
    v_mfma_f32_16x16x32_bf16 v[148:151], a[156:159], a[52:55], v[148:151]
    v_rcp_f32 v128, v128
    v_mfma_f32_16x16x32_bf16 v[204:207], a[156:159], a[60:63], v[204:207]
    ds_read_b64_tr_b16 a[150:151], v239 offset:10880
    v_fma_f32 v131, v131, v249, v249
    v_mfma_f32_16x16x32_bf16 v[204:207], a[152:155], a[56:59], v[204:207]
    v_mul_f32 v132, v132, v128
    s_waitcnt lgkmcnt(8)
    v_mfma_f32_16x16x32_bf16 v[32:35], a[128:131], a[64:67], v[32:35]
    ds_read_b64_tr_b16 a[152:153], v239 offset:14464
    v_mul_f32 v184, v184, v250
    v_mfma_f32_16x16x32_bf16 v[32:35], a[132:135], a[68:71], v[32:35]
    v_rcp_f32 v129, v129
    v_mfma_f32_16x16x32_bf16 v[88:91], a[132:135], a[76:79], v[88:91]
    ds_read_b64_tr_b16 a[154:155], v239 offset:18048
    v_mul_f32 v133, v133, v129
    v_mfma_f32_16x16x32_bf16 v[88:91], a[128:131], a[72:75], v[88:91]
    v_rcp_f32 v130, v130
    v_mfma_f32_16x16x32_bf16 v[144:147], a[128:131], a[80:83], v[144:147]
    ds_read_b64_tr_b16 a[156:157], v239 offset:21632
    v_mul_f32 v134, v134, v130
    v_mfma_f32_16x16x32_bf16 v[144:147], a[132:135], a[84:87], v[144:147]
    v_rcp_f32 v131, v131
    v_mfma_f32_16x16x32_bf16 v[200:203], a[132:135], a[92:95], v[200:203]
    ds_read_b64_tr_b16 a[158:159], v239 offset:25216
    v_mul_f32 v135, v135, v131
    v_mfma_f32_16x16x32_bf16 v[200:203], a[128:131], a[88:91], v[200:203]
    v_cvt_pk_bf16_f32 v128, v132, v133
    s_waitcnt lgkmcnt(8)
    v_mfma_f32_16x16x32_bf16 v[36:39], a[136:139], a[64:67], v[36:39]
    ds_read_b64_tr_b16 a[128:129], v235 offset:160
    v_cvt_pk_bf16_f32 v129, v134, v135
    v_mfma_f32_16x16x32_bf16 v[36:39], a[140:143], a[68:71], v[36:39]
    v_exp_f32 v184, v184
    v_mfma_f32_16x16x32_bf16 v[92:95], a[140:143], a[76:79], v[92:95]
    ds_read_b64_tr_b16 a[130:131], v235 offset:3744
    v_mul_f32 v185, v185, v250
    v_mfma_f32_16x16x32_bf16 v[92:95], a[136:139], a[72:75], v[92:95]
    v_exp_f32 v185, v185
    v_mfma_f32_16x16x32_bf16 v[148:151], a[136:139], a[80:83], v[148:151]
    ds_read_b64_tr_b16 a[132:133], v235 offset:7328
    v_mul_f32 v186, v186, v250
    v_mfma_f32_16x16x32_bf16 v[148:151], a[140:143], a[84:87], v[148:151]
    v_exp_f32 v186, v186
    v_mfma_f32_16x16x32_bf16 v[204:207], a[140:143], a[92:95], v[204:207]
    ds_read_b64_tr_b16 a[134:135], v235 offset:10912
    v_mul_f32 v187, v187, v250
    v_mfma_f32_16x16x32_bf16 v[204:207], a[136:139], a[88:91], v[204:207]
    v_fma_f32 v184, v184, v251, v251
    s_waitcnt lgkmcnt(8)
    v_mfma_f32_16x16x32_bf16 v[32:35], a[144:147], a[96:99], v[32:35]
    ds_read_b64_tr_b16 a[136:137], v235 offset:14496
    v_fma_f32 v185, v185, v251, v251
    v_mfma_f32_16x16x32_bf16 v[32:35], a[148:151], a[100:103], v[32:35]
    v_exp_f32 v187, v187
    v_mfma_f32_16x16x32_bf16 v[88:91], a[148:151], a[108:111], v[88:91]
    ds_read_b64_tr_b16 a[138:139], v235 offset:18080
    v_fma_f32 v186, v186, v251, v251
    v_mfma_f32_16x16x32_bf16 v[88:91], a[144:147], a[104:107], v[88:91]
    v_rcp_f32 v184, v184
    v_mfma_f32_16x16x32_bf16 v[144:147], a[144:147], a[112:115], v[144:147]
    ds_read_b64_tr_b16 a[140:141], v235 offset:21664
    v_fma_f32 v187, v187, v251, v251
    v_mfma_f32_16x16x32_bf16 v[144:147], a[148:151], a[116:119], v[144:147]
    v_rcp_f32 v185, v185
    v_mfma_f32_16x16x32_bf16 v[200:203], a[148:151], a[124:127], v[200:203]
    ds_read_b64_tr_b16 a[142:143], v235 offset:25248
    v_mul_f32 v188, v188, v184
    v_mfma_f32_16x16x32_bf16 v[200:203], a[144:147], a[120:123], v[200:203]
    v_mul_f32 v189, v189, v185
    s_waitcnt lgkmcnt(8)
    v_mfma_f32_16x16x32_bf16 v[36:39], a[152:155], a[96:99], v[36:39]
    ds_read_b64_tr_b16 a[144:145], v237 offset:160
    v_cvt_pk_bf16_f32 v184, v188, v189
    v_mfma_f32_16x16x32_bf16 v[36:39], a[156:159], a[100:103], v[36:39]
    v_rcp_f32 v186, v186
    v_mfma_f32_16x16x32_bf16 v[92:95], a[156:159], a[108:111], v[92:95]
    ds_read_b64_tr_b16 a[146:147], v237 offset:3744
    v_mul_f32 v190, v190, v186
    v_mfma_f32_16x16x32_bf16 v[92:95], a[152:155], a[104:107], v[92:95]
    v_rcp_f32 v187, v187
    v_mfma_f32_16x16x32_bf16 v[148:151], a[152:155], a[112:115], v[148:151]
    ds_read_b64_tr_b16 a[148:149], v237 offset:7328
    v_mul_f32 v191, v191, v187
    v_mfma_f32_16x16x32_bf16 v[148:151], a[156:159], a[116:119], v[148:151]
    v_cvt_pk_bf16_f32 v185, v190, v191
    v_mul_f32 v24, v24, v244
    v_mfma_f32_16x16x32_bf16 v[204:207], a[156:159], a[124:127], v[204:207]
    ds_read_b64_tr_b16 a[150:151], v237 offset:10912
    v_mul_f32 v25, v25, v244
    v_mfma_f32_16x16x32_bf16 v[204:207], a[152:155], a[120:123], v[204:207]
    v_mul_f32 v26, v26, v244
    s_waitcnt lgkmcnt(8)
    v_mfma_f32_16x16x32_bf16 v[40:43], a[128:131], a[0:3], v[40:43]
    ds_read_b64_tr_b16 a[152:153], v237 offset:14496
    v_mul_f32 v27, v27, v244
    v_mfma_f32_16x16x32_bf16 v[40:43], a[132:135], a[4:7], v[40:43]
    v_exp_f32 v24, v24
    v_mfma_f32_16x16x32_bf16 v[96:99], a[132:135], a[12:15], v[96:99]
    ds_read_b64_tr_b16 a[154:155], v237 offset:18080
    v_fma_f32 v24, v24, v245, v245
    v_mfma_f32_16x16x32_bf16 v[96:99], a[128:131], a[8:11], v[96:99]
    v_exp_f32 v25, v25
    v_mfma_f32_16x16x32_bf16 v[152:155], a[128:131], a[16:19], v[152:155]
    ds_read_b64_tr_b16 a[156:157], v237 offset:21664
    v_fma_f32 v25, v25, v245, v245
    v_mfma_f32_16x16x32_bf16 v[152:155], a[132:135], a[20:23], v[152:155]
    v_exp_f32 v26, v26
    v_mfma_f32_16x16x32_bf16 v[208:211], a[132:135], a[28:31], v[208:211]
    ds_read_b64_tr_b16 a[158:159], v237 offset:25248
    v_fma_f32 v26, v26, v245, v245
    v_mfma_f32_16x16x32_bf16 v[208:211], a[128:131], a[24:27], v[208:211]
    v_mul_f32 v80, v80, v246
    s_waitcnt lgkmcnt(8)
    v_mfma_f32_16x16x32_bf16 v[44:47], a[136:139], a[0:3], v[44:47]
    ds_read_b64_tr_b16 a[128:129], v238 offset:160
    v_mul_f32 v81, v81, v246
    v_mfma_f32_16x16x32_bf16 v[44:47], a[140:143], a[4:7], v[44:47]
    v_exp_f32 v27, v27
    v_mfma_f32_16x16x32_bf16 v[100:103], a[140:143], a[12:15], v[100:103]
    ds_read_b64_tr_b16 a[130:131], v238 offset:3744
    v_fma_f32 v27, v27, v245, v245
    v_mfma_f32_16x16x32_bf16 v[100:103], a[136:139], a[8:11], v[100:103]
    v_rcp_f32 v24, v24
    v_mfma_f32_16x16x32_bf16 v[156:159], a[136:139], a[16:19], v[156:159]
    ds_read_b64_tr_b16 a[132:133], v238 offset:7328
    v_mul_f32 v28, v28, v24
    v_mfma_f32_16x16x32_bf16 v[156:159], a[140:143], a[20:23], v[156:159]
    v_rcp_f32 v25, v25
    v_mfma_f32_16x16x32_bf16 v[212:215], a[140:143], a[28:31], v[212:215]
    ds_read_b64_tr_b16 a[134:135], v238 offset:10912
    v_mul_f32 v29, v29, v25
    v_mfma_f32_16x16x32_bf16 v[212:215], a[136:139], a[24:27], v[212:215]
    v_cvt_pk_bf16_f32 v18, v28, v29
    s_waitcnt lgkmcnt(8)
    v_mfma_f32_16x16x32_bf16 v[40:43], a[144:147], a[32:35], v[40:43]
    ds_read_b64_tr_b16 a[136:137], v238 offset:14496
    v_mul_f32 v82, v82, v246
    v_mfma_f32_16x16x32_bf16 v[40:43], a[148:151], a[36:39], v[40:43]
    v_rcp_f32 v26, v26
    v_mfma_f32_16x16x32_bf16 v[96:99], a[148:151], a[44:47], v[96:99]
    ds_read_b64_tr_b16 a[138:139], v238 offset:18080
    v_mul_f32 v30, v30, v26
    v_mfma_f32_16x16x32_bf16 v[96:99], a[144:147], a[40:43], v[96:99]
    v_rcp_f32 v27, v27
    v_mfma_f32_16x16x32_bf16 v[152:155], a[144:147], a[48:51], v[152:155]
    ds_read_b64_tr_b16 a[140:141], v238 offset:21664
    v_mul_f32 v31, v31, v27
    v_mfma_f32_16x16x32_bf16 v[152:155], a[148:151], a[52:55], v[152:155]
    v_exp_f32 v80, v80
    v_mfma_f32_16x16x32_bf16 v[208:211], a[148:151], a[60:63], v[208:211]
    ds_read_b64_tr_b16 a[142:143], v238 offset:25248
    v_cvt_pk_bf16_f32 v19, v30, v31
    v_mfma_f32_16x16x32_bf16 v[208:211], a[144:147], a[56:59], v[208:211]
    buffer_store_dwordx4 v[16:19], v252, s[16:19], 0 offen offset:1024 sc1
    s_waitcnt lgkmcnt(8)
    v_mfma_f32_16x16x32_bf16 v[44:47], a[152:155], a[32:35], v[44:47]
    ds_read_b64_tr_b16 a[144:145], v239 offset:160
    v_mul_f32 v83, v83, v246
    v_mfma_f32_16x16x32_bf16 v[44:47], a[156:159], a[36:39], v[44:47]
    v_exp_f32 v81, v81
    v_mfma_f32_16x16x32_bf16 v[100:103], a[156:159], a[44:47], v[100:103]
    ds_read_b64_tr_b16 a[146:147], v239 offset:3744
    v_fma_f32 v80, v80, v247, v247
    v_mfma_f32_16x16x32_bf16 v[100:103], a[152:155], a[40:43], v[100:103]
    v_exp_f32 v82, v82
    v_mfma_f32_16x16x32_bf16 v[156:159], a[152:155], a[48:51], v[156:159]
    ds_read_b64_tr_b16 a[148:149], v239 offset:7328
    v_fma_f32 v81, v81, v247, v247
    v_mfma_f32_16x16x32_bf16 v[156:159], a[156:159], a[52:55], v[156:159]
    v_exp_f32 v83, v83
    v_mfma_f32_16x16x32_bf16 v[212:215], a[156:159], a[60:63], v[212:215]
    ds_read_b64_tr_b16 a[150:151], v239 offset:10912
    v_fma_f32 v82, v82, v247, v247
    v_mfma_f32_16x16x32_bf16 v[212:215], a[152:155], a[56:59], v[212:215]
    v_fma_f32 v83, v83, v247, v247
    s_waitcnt lgkmcnt(8)
    v_mfma_f32_16x16x32_bf16 v[40:43], a[128:131], a[64:67], v[40:43]
    ds_read_b64_tr_b16 a[152:153], v239 offset:14496
    v_mul_f32 v136, v136, v248
    v_mfma_f32_16x16x32_bf16 v[40:43], a[132:135], a[68:71], v[40:43]
    v_rcp_f32 v80, v80
    v_mfma_f32_16x16x32_bf16 v[96:99], a[132:135], a[76:79], v[96:99]
    ds_read_b64_tr_b16 a[154:155], v239 offset:18080
    v_mul_f32 v84, v84, v80
    v_mfma_f32_16x16x32_bf16 v[96:99], a[128:131], a[72:75], v[96:99]
    v_rcp_f32 v81, v81
    v_mfma_f32_16x16x32_bf16 v[152:155], a[128:131], a[80:83], v[152:155]
    ds_read_b64_tr_b16 a[156:157], v239 offset:21664
    v_mul_f32 v85, v85, v81
    v_mfma_f32_16x16x32_bf16 v[152:155], a[132:135], a[84:87], v[152:155]
    v_rcp_f32 v82, v82
    v_mfma_f32_16x16x32_bf16 v[208:211], a[132:135], a[92:95], v[208:211]
    ds_read_b64_tr_b16 a[158:159], v239 offset:25248
    v_mul_f32 v86, v86, v82
    v_mfma_f32_16x16x32_bf16 v[208:211], a[128:131], a[88:91], v[208:211]
    v_cvt_pk_bf16_f32 v74, v84, v85
    s_waitcnt lgkmcnt(8)
    v_mfma_f32_16x16x32_bf16 v[44:47], a[136:139], a[64:67], v[44:47]
    ds_read_b64_tr_b16 a[128:129], v235 offset:192
    v_mul_f32 v137, v137, v248
    v_mfma_f32_16x16x32_bf16 v[44:47], a[140:143], a[68:71], v[44:47]
    v_rcp_f32 v83, v83
    v_mfma_f32_16x16x32_bf16 v[100:103], a[140:143], a[76:79], v[100:103]
    ds_read_b64_tr_b16 a[130:131], v235 offset:3776
    v_mul_f32 v87, v87, v83
    v_mfma_f32_16x16x32_bf16 v[100:103], a[136:139], a[72:75], v[100:103]
    v_exp_f32 v136, v136
    v_mfma_f32_16x16x32_bf16 v[156:159], a[136:139], a[80:83], v[156:159]
    ds_read_b64_tr_b16 a[132:133], v235 offset:7360
    v_cvt_pk_bf16_f32 v75, v86, v87
    v_mfma_f32_16x16x32_bf16 v[156:159], a[140:143], a[84:87], v[156:159]
    v_exp_f32 v137, v137
    v_mfma_f32_16x16x32_bf16 v[212:215], a[140:143], a[92:95], v[212:215]
    ds_read_b64_tr_b16 a[134:135], v235 offset:10944
    buffer_store_dwordx4 v[72:75], v252, s[16:19], s35 offen offset:1024 sc1
    v_mfma_f32_16x16x32_bf16 v[212:215], a[136:139], a[88:91], v[212:215]
    v_mul_f32 v138, v138, v248
    s_waitcnt lgkmcnt(8)
    v_mfma_f32_16x16x32_bf16 v[40:43], a[144:147], a[96:99], v[40:43]
    ds_read_b64_tr_b16 a[136:137], v235 offset:14528
    v_mul_f32 v139, v139, v248
    v_mfma_f32_16x16x32_bf16 v[40:43], a[148:151], a[100:103], v[40:43]
    v_exp_f32 v138, v138
    v_mfma_f32_16x16x32_bf16 v[96:99], a[148:151], a[108:111], v[96:99]
    ds_read_b64_tr_b16 a[138:139], v235 offset:18112
    v_fma_f32 v136, v136, v249, v249
    v_mfma_f32_16x16x32_bf16 v[96:99], a[144:147], a[104:107], v[96:99]
    v_exp_f32 v139, v139
    v_mfma_f32_16x16x32_bf16 v[152:155], a[144:147], a[112:115], v[152:155]
    ds_read_b64_tr_b16 a[140:141], v235 offset:21696
    v_fma_f32 v137, v137, v249, v249
    v_mfma_f32_16x16x32_bf16 v[152:155], a[148:151], a[116:119], v[152:155]
    v_rcp_f32 v136, v136
    v_mfma_f32_16x16x32_bf16 v[208:211], a[148:151], a[124:127], v[208:211]
    ds_read_b64_tr_b16 a[142:143], v235 offset:25280
    v_fma_f32 v138, v138, v249, v249
    v_mfma_f32_16x16x32_bf16 v[208:211], a[144:147], a[120:123], v[208:211]
    v_fma_f32 v139, v139, v249, v249
    s_waitcnt lgkmcnt(8)
    v_mfma_f32_16x16x32_bf16 v[44:47], a[152:155], a[96:99], v[44:47]
    ds_read_b64_tr_b16 a[144:145], v237 offset:192
    v_mul_f32 v140, v140, v136
    v_mfma_f32_16x16x32_bf16 v[44:47], a[156:159], a[100:103], v[44:47]
    v_rcp_f32 v137, v137
    v_mfma_f32_16x16x32_bf16 v[100:103], a[156:159], a[108:111], v[100:103]
    ds_read_b64_tr_b16 a[146:147], v237 offset:3776
    v_mul_f32 v141, v141, v137
    v_mfma_f32_16x16x32_bf16 v[100:103], a[152:155], a[104:107], v[100:103]
    v_rcp_f32 v138, v138
    v_mfma_f32_16x16x32_bf16 v[156:159], a[152:155], a[112:115], v[156:159]
    ds_read_b64_tr_b16 a[148:149], v237 offset:7360
    v_mul_f32 v142, v142, v138
    v_mfma_f32_16x16x32_bf16 v[156:159], a[156:159], a[116:119], v[156:159]
    v_rcp_f32 v139, v139
    v_mfma_f32_16x16x32_bf16 v[212:215], a[156:159], a[124:127], v[212:215]
    ds_read_b64_tr_b16 a[150:151], v237 offset:10944
    v_mul_f32 v143, v143, v139
    v_mfma_f32_16x16x32_bf16 v[212:215], a[152:155], a[120:123], v[212:215]
    v_cvt_pk_bf16_f32 v130, v140, v141
    s_waitcnt lgkmcnt(8)
    v_mfma_f32_16x16x32_bf16 v[48:51], a[128:131], a[0:3], v[48:51]
    ds_read_b64_tr_b16 a[152:153], v237 offset:14528
    v_cvt_pk_bf16_f32 v131, v142, v143
    v_mfma_f32_16x16x32_bf16 v[48:51], a[132:135], a[4:7], v[48:51]
    buffer_store_dwordx4 v[128:131], v252, s[16:19], s36 offen offset:1024 sc1
    v_mul_f32 v192, v192, v250
    v_mfma_f32_16x16x32_bf16 v[104:107], a[132:135], a[12:15], v[104:107]
    ds_read_b64_tr_b16 a[154:155], v237 offset:18112
    v_mul_f32 v193, v193, v250
    v_mfma_f32_16x16x32_bf16 v[104:107], a[128:131], a[8:11], v[104:107]
    v_exp_f32 v192, v192
    v_mfma_f32_16x16x32_bf16 v[160:163], a[128:131], a[16:19], v[160:163]
    ds_read_b64_tr_b16 a[156:157], v237 offset:21696
    v_mul_f32 v194, v194, v250
    v_mfma_f32_16x16x32_bf16 v[160:163], a[132:135], a[20:23], v[160:163]
    v_exp_f32 v193, v193
    v_mfma_f32_16x16x32_bf16 v[216:219], a[132:135], a[28:31], v[216:219]
    ds_read_b64_tr_b16 a[158:159], v237 offset:25280
    v_mul_f32 v195, v195, v250
    v_mfma_f32_16x16x32_bf16 v[216:219], a[128:131], a[24:27], v[216:219]
    v_fma_f32 v192, v192, v251, v251
    s_waitcnt lgkmcnt(8)
    v_mfma_f32_16x16x32_bf16 v[52:55], a[136:139], a[0:3], v[52:55]
    ds_read_b64_tr_b16 a[128:129], v238 offset:192
    v_fma_f32 v193, v193, v251, v251
    v_mfma_f32_16x16x32_bf16 v[52:55], a[140:143], a[4:7], v[52:55]
    v_exp_f32 v194, v194
    v_mfma_f32_16x16x32_bf16 v[108:111], a[140:143], a[12:15], v[108:111]
    ds_read_b64_tr_b16 a[130:131], v238 offset:3776
    v_fma_f32 v194, v194, v251, v251
    v_mfma_f32_16x16x32_bf16 v[108:111], a[136:139], a[8:11], v[108:111]
    v_exp_f32 v195, v195
    v_mfma_f32_16x16x32_bf16 v[164:167], a[136:139], a[16:19], v[164:167]
    ds_read_b64_tr_b16 a[132:133], v238 offset:7360
    v_fma_f32 v195, v195, v251, v251
    v_mfma_f32_16x16x32_bf16 v[164:167], a[140:143], a[20:23], v[164:167]
    v_rcp_f32 v192, v192
    v_mfma_f32_16x16x32_bf16 v[220:223], a[140:143], a[28:31], v[220:223]
    ds_read_b64_tr_b16 a[134:135], v238 offset:10944
    v_mul_f32 v196, v196, v192
    v_mfma_f32_16x16x32_bf16 v[220:223], a[136:139], a[24:27], v[220:223]
    v_mul_f32 v32, v32, v244
    s_waitcnt lgkmcnt(8)
    v_mfma_f32_16x16x32_bf16 v[48:51], a[144:147], a[32:35], v[48:51]
    ds_read_b64_tr_b16 a[136:137], v238 offset:14528
    v_mul_f32 v33, v33, v244
    v_mfma_f32_16x16x32_bf16 v[48:51], a[148:151], a[36:39], v[48:51]
    v_rcp_f32 v193, v193
    v_mfma_f32_16x16x32_bf16 v[104:107], a[148:151], a[44:47], v[104:107]
    ds_read_b64_tr_b16 a[138:139], v238 offset:18112
    v_mul_f32 v197, v197, v193
    v_mfma_f32_16x16x32_bf16 v[104:107], a[144:147], a[40:43], v[104:107]
    v_rcp_f32 v194, v194
    v_mfma_f32_16x16x32_bf16 v[160:163], a[144:147], a[48:51], v[160:163]
    ds_read_b64_tr_b16 a[140:141], v238 offset:21696
    v_mul_f32 v198, v198, v194
    v_mfma_f32_16x16x32_bf16 v[160:163], a[148:151], a[52:55], v[160:163]
    v_rcp_f32 v195, v195
    v_mfma_f32_16x16x32_bf16 v[216:219], a[148:151], a[60:63], v[216:219]
    ds_read_b64_tr_b16 a[142:143], v238 offset:25280
    v_mul_f32 v199, v199, v195
    v_mfma_f32_16x16x32_bf16 v[216:219], a[144:147], a[56:59], v[216:219]
    v_cvt_pk_bf16_f32 v186, v196, v197
    s_waitcnt lgkmcnt(8)
    v_mfma_f32_16x16x32_bf16 v[52:55], a[152:155], a[32:35], v[52:55]
    ds_read_b64_tr_b16 a[144:145], v239 offset:192
    v_cvt_pk_bf16_f32 v187, v198, v199
    v_mfma_f32_16x16x32_bf16 v[52:55], a[156:159], a[36:39], v[52:55]
    v_exp_f32 v32, v32
    v_mfma_f32_16x16x32_bf16 v[108:111], a[156:159], a[44:47], v[108:111]
    ds_read_b64_tr_b16 a[146:147], v239 offset:3776
    buffer_store_dwordx4 v[184:187], v252, s[16:19], s37 offen offset:1024 sc1
    v_mfma_f32_16x16x32_bf16 v[108:111], a[152:155], a[40:43], v[108:111]
    v_exp_f32 v33, v33
    v_mfma_f32_16x16x32_bf16 v[164:167], a[152:155], a[48:51], v[164:167]
    ds_read_b64_tr_b16 a[148:149], v239 offset:7360
    v_mul_f32 v34, v34, v244
    v_mfma_f32_16x16x32_bf16 v[164:167], a[156:159], a[52:55], v[164:167]
    v_exp_f32 v34, v34
    v_mfma_f32_16x16x32_bf16 v[220:223], a[156:159], a[60:63], v[220:223]
    ds_read_b64_tr_b16 a[150:151], v239 offset:10944
    v_mul_f32 v35, v35, v244
    v_mfma_f32_16x16x32_bf16 v[220:223], a[152:155], a[56:59], v[220:223]
    v_fma_f32 v32, v32, v245, v245
    s_waitcnt lgkmcnt(8)
    v_mfma_f32_16x16x32_bf16 v[48:51], a[128:131], a[64:67], v[48:51]
    ds_read_b64_tr_b16 a[152:153], v239 offset:14528
    v_fma_f32 v33, v33, v245, v245
    v_mfma_f32_16x16x32_bf16 v[48:51], a[132:135], a[68:71], v[48:51]
    v_exp_f32 v35, v35
    v_mfma_f32_16x16x32_bf16 v[104:107], a[132:135], a[76:79], v[104:107]
    ds_read_b64_tr_b16 a[154:155], v239 offset:18112
    v_fma_f32 v34, v34, v245, v245
    v_mfma_f32_16x16x32_bf16 v[104:107], a[128:131], a[72:75], v[104:107]
    v_rcp_f32 v32, v32
    v_mfma_f32_16x16x32_bf16 v[160:163], a[128:131], a[80:83], v[160:163]
    ds_read_b64_tr_b16 a[156:157], v239 offset:21696
    v_fma_f32 v35, v35, v245, v245
    v_mfma_f32_16x16x32_bf16 v[160:163], a[132:135], a[84:87], v[160:163]
    v_rcp_f32 v33, v33
    v_mfma_f32_16x16x32_bf16 v[216:219], a[132:135], a[92:95], v[216:219]
    ds_read_b64_tr_b16 a[158:159], v239 offset:25280
    v_mul_f32 v36, v36, v32
    v_mfma_f32_16x16x32_bf16 v[216:219], a[128:131], a[88:91], v[216:219]
    v_mul_f32 v37, v37, v33
    s_waitcnt lgkmcnt(8)
    v_mfma_f32_16x16x32_bf16 v[52:55], a[136:139], a[64:67], v[52:55]
    v_rcp_f32 v34, v34
    v_mfma_f32_16x16x32_bf16 v[52:55], a[140:143], a[68:71], v[52:55]
    v_rcp_f32 v35, v35
    v_mfma_f32_16x16x32_bf16 v[108:111], a[140:143], a[76:79], v[108:111]
    v_mul_f32 v38, v38, v34
    v_mul_f32 v39, v39, v35
    v_mfma_f32_16x16x32_bf16 v[108:111], a[136:139], a[72:75], v[108:111]
    v_cvt_pk_bf16_f32 v32, v36, v37
    v_cvt_pk_bf16_f32 v33, v38, v39
    v_mfma_f32_16x16x32_bf16 v[164:167], a[136:139], a[80:83], v[164:167]
    v_mul_f32 v88, v88, v246
    v_mul_f32 v89, v89, v246
    v_mfma_f32_16x16x32_bf16 v[164:167], a[140:143], a[84:87], v[164:167]
    v_exp_f32 v88, v88
    v_mfma_f32_16x16x32_bf16 v[220:223], a[140:143], a[92:95], v[220:223]
    v_exp_f32 v89, v89
    v_mfma_f32_16x16x32_bf16 v[220:223], a[136:139], a[88:91], v[220:223]
    v_mul_f32 v90, v90, v246
    s_waitcnt lgkmcnt(4)
    v_mfma_f32_16x16x32_bf16 v[48:51], a[144:147], a[96:99], v[48:51]
    v_exp_f32 v90, v90
    v_mfma_f32_16x16x32_bf16 v[48:51], a[148:151], a[100:103], v[48:51]
    v_mul_f32 v91, v91, v246
    v_fma_f32 v88, v88, v247, v247
    v_mfma_f32_16x16x32_bf16 v[104:107], a[148:151], a[108:111], v[104:107]
    v_exp_f32 v91, v91
    v_mfma_f32_16x16x32_bf16 v[104:107], a[144:147], a[104:107], v[104:107]
    v_rcp_f32 v88, v88
    v_mfma_f32_16x16x32_bf16 v[160:163], a[144:147], a[112:115], v[160:163]
    v_fma_f32 v89, v89, v247, v247
    v_fma_f32 v90, v90, v247, v247
    v_mfma_f32_16x16x32_bf16 v[160:163], a[148:151], a[116:119], v[160:163]
    v_rcp_f32 v89, v89
    v_mfma_f32_16x16x32_bf16 v[216:219], a[148:151], a[124:127], v[216:219]
    v_rcp_f32 v90, v90
    v_mfma_f32_16x16x32_bf16 v[216:219], a[144:147], a[120:123], v[216:219]
    v_fma_f32 v91, v91, v247, v247
    s_waitcnt lgkmcnt(0)
    v_mfma_f32_16x16x32_bf16 v[52:55], a[152:155], a[96:99], v[52:55]
    v_rcp_f32 v91, v91
    v_mfma_f32_16x16x32_bf16 v[52:55], a[156:159], a[100:103], v[52:55]
    v_mul_f32 v92, v92, v88
    v_mul_f32 v93, v93, v89
    v_mfma_f32_16x16x32_bf16 v[108:111], a[156:159], a[108:111], v[108:111]
    v_mul_f32 v94, v94, v90
    v_mul_f32 v95, v95, v91
    v_mfma_f32_16x16x32_bf16 v[108:111], a[152:155], a[104:107], v[108:111]
    v_cvt_pk_bf16_f32 v88, v92, v93
    v_cvt_pk_bf16_f32 v89, v94, v95
    v_mfma_f32_16x16x32_bf16 v[164:167], a[152:155], a[112:115], v[164:167]
    v_mfma_f32_16x16x32_bf16 v[164:167], a[156:159], a[116:119], v[164:167]
    v_mfma_f32_16x16x32_bf16 v[220:223], a[156:159], a[124:127], v[220:223]
    v_mfma_f32_16x16x32_bf16 v[220:223], a[152:155], a[120:123], v[220:223]
    buffer_load_dword v234, v233, s[16:19], s28 offen offset:0 sc1
    s_barrier
    s_nop 1
    v_pk_mul_f32 v[40:41], v[40:41], v[244:245] op_sel_hi:[1,0]
    v_pk_mul_f32 v[42:43], v[42:43], v[244:245] op_sel_hi:[1,0]
    v_exp_f32 v40, v40
    v_exp_f32 v41, v41
    v_exp_f32 v42, v42
    v_exp_f32 v43, v43
    v_pk_fma_f32 v[40:41], v[40:41], v[244:245], v[244:245] op_sel:[0,1,1] op_sel_hi:[1,1,1]
    v_pk_fma_f32 v[42:43], v[42:43], v[244:245], v[244:245] op_sel:[0,1,1] op_sel_hi:[1,1,1]
    v_rcp_f32 v40, v40
    v_rcp_f32 v41, v41
    v_rcp_f32 v42, v42
    v_rcp_f32 v43, v43
    v_pk_mul_f32 v[44:45], v[44:45], v[40:41]
    v_pk_mul_f32 v[46:47], v[46:47], v[42:43]
    v_cvt_pk_bf16_f32 v34, v44, v45
    v_cvt_pk_bf16_f32 v35, v46, v47
    buffer_store_dwordx4 v[32:35], v252, s[16:19], 0 offen offset:2048 sc1
    s_add_u32 m0, s49, 16384
    s_add_u32 s12, s64, 1376256
    s_addc_u32 s13, s65, 0
    buffer_load_dwordx4 v242, s[12:15], 0 offen offset:0 sc1 lds
    v_pk_mul_f32 v[48:49], v[48:49], v[244:245] op_sel_hi:[1,0]
    v_pk_mul_f32 v[50:51], v[50:51], v[244:245] op_sel_hi:[1,0]
    v_exp_f32 v48, v48
    v_exp_f32 v49, v49
    v_exp_f32 v50, v50
    v_exp_f32 v51, v51
    v_pk_fma_f32 v[48:49], v[48:49], v[244:245], v[244:245] op_sel:[0,1,1] op_sel_hi:[1,1,1]
    v_pk_fma_f32 v[50:51], v[50:51], v[244:245], v[244:245] op_sel:[0,1,1] op_sel_hi:[1,1,1]
    v_rcp_f32 v48, v48
    v_rcp_f32 v49, v49
    v_rcp_f32 v50, v50
    v_rcp_f32 v51, v51
    v_pk_mul_f32 v[52:53], v[52:53], v[48:49]
    v_pk_mul_f32 v[54:55], v[54:55], v[50:51]
    v_cvt_pk_bf16_f32 v48, v52, v53
    v_cvt_pk_bf16_f32 v49, v54, v55
    buffer_store_dwordx2 v[48:49], v253, s[16:19], 0 offen sc1
    buffer_load_dwordx4 v243, s[12:15], 0 offen offset:1024 sc1 lds
    v_pk_mul_f32 v[96:97], v[96:97], v[246:247] op_sel_hi:[1,0]
    v_pk_mul_f32 v[98:99], v[98:99], v[246:247] op_sel_hi:[1,0]
    v_exp_f32 v96, v96
    v_exp_f32 v97, v97
    v_exp_f32 v98, v98
    v_exp_f32 v99, v99
    v_pk_fma_f32 v[96:97], v[96:97], v[246:247], v[246:247] op_sel:[0,1,1] op_sel_hi:[1,1,1]
    v_pk_fma_f32 v[98:99], v[98:99], v[246:247], v[246:247] op_sel:[0,1,1] op_sel_hi:[1,1,1]
    v_rcp_f32 v96, v96
    v_rcp_f32 v97, v97
    v_rcp_f32 v98, v98
    v_rcp_f32 v99, v99
    v_pk_mul_f32 v[100:101], v[100:101], v[96:97]
    v_pk_mul_f32 v[102:103], v[102:103], v[98:99]
    v_cvt_pk_bf16_f32 v90, v100, v101
    v_cvt_pk_bf16_f32 v91, v102, v103
    buffer_store_dwordx4 v[88:91], v252, s[16:19], s35 offen offset:2048 sc1
    s_add_u32 m0, s49, 18432
    s_add_u32 s84, s66, 1376256
    s_addc_u32 s85, s67, 0
    buffer_load_dwordx4 v242, s[84:87], 0 offen offset:0 sc1 lds
    v_pk_mul_f32 v[104:105], v[104:105], v[246:247] op_sel_hi:[1,0]
    v_pk_mul_f32 v[106:107], v[106:107], v[246:247] op_sel_hi:[1,0]
    v_exp_f32 v104, v104
    v_exp_f32 v105, v105
    v_exp_f32 v106, v106
    v_exp_f32 v107, v107
    v_pk_fma_f32 v[104:105], v[104:105], v[246:247], v[246:247] op_sel:[0,1,1] op_sel_hi:[1,1,1]
    v_pk_fma_f32 v[106:107], v[106:107], v[246:247], v[246:247] op_sel:[0,1,1] op_sel_hi:[1,1,1]
    v_rcp_f32 v104, v104
    v_rcp_f32 v105, v105
    v_rcp_f32 v106, v106
    v_rcp_f32 v107, v107
    v_pk_mul_f32 v[108:109], v[108:109], v[104:105]
    v_pk_mul_f32 v[110:111], v[110:111], v[106:107]
    v_cvt_pk_bf16_f32 v104, v108, v109
    v_cvt_pk_bf16_f32 v105, v110, v111
    buffer_store_dwordx2 v[104:105], v253, s[16:19], s35 offen sc1
    buffer_load_dwordx4 v243, s[84:87], 0 offen offset:1024 sc1 lds
    s_waitcnt vmcnt(8)
    s_mov_b32 s59, 0x20000
L_poll40:
    v_cmp_ne_u32 vcc, s33, v234
    s_cmp_eq_u64 vcc, 0
    s_cbranch_scc1 L_polldone40
    s_sub_u32 s59, s59, 1
    s_cbranch_scc1 L_polldone40
    buffer_load_dword v234, v233, s[16:19], s28 offen offset:0 sc1
    s_waitcnt vmcnt(0)
    s_branch L_poll40
L_polldone40:
    v_pk_mul_f32 v[144:145], v[144:145], v[248:249] op_sel_hi:[1,0]
    v_pk_mul_f32 v[146:147], v[146:147], v[248:249] op_sel_hi:[1,0]
    v_exp_f32 v144, v144
    v_exp_f32 v145, v145
    v_exp_f32 v146, v146
    v_exp_f32 v147, v147
    v_pk_fma_f32 v[144:145], v[144:145], v[248:249], v[248:249] op_sel:[0,1,1] op_sel_hi:[1,1,1]
    v_pk_fma_f32 v[146:147], v[146:147], v[248:249], v[248:249] op_sel:[0,1,1] op_sel_hi:[1,1,1]
    s_add_u32 s4, s68, 0
    s_addc_u32 s5, s69, 0
    buffer_load_dwordx4 a[0:3], v224, s[4:7], 0 offen sc1
    v_rcp_f32 v144, v144
    v_rcp_f32 v145, v145
    v_rcp_f32 v146, v146
    v_rcp_f32 v147, v147
    v_pk_mul_f32 v[148:149], v[148:149], v[144:145]
    v_pk_mul_f32 v[150:151], v[150:151], v[146:147]
    v_cvt_pk_bf16_f32 v144, v148, v149
    v_cvt_pk_bf16_f32 v145, v150, v151
    buffer_load_dwordx4 a[8:11], v225, s[4:7], 0 offen sc1
    v_pk_mul_f32 v[152:153], v[152:153], v[248:249] op_sel_hi:[1,0]
    v_pk_mul_f32 v[154:155], v[154:155], v[248:249] op_sel_hi:[1,0]
    v_exp_f32 v152, v152
    v_exp_f32 v153, v153
    v_exp_f32 v154, v154
    v_exp_f32 v155, v155
    v_pk_fma_f32 v[152:153], v[152:153], v[248:249], v[248:249] op_sel:[0,1,1] op_sel_hi:[1,1,1]
    v_pk_fma_f32 v[154:155], v[154:155], v[248:249], v[248:249] op_sel:[0,1,1] op_sel_hi:[1,1,1]
    buffer_load_dwordx4 a[4:7], v226, s[4:7], 0 offen sc1
    v_rcp_f32 v152, v152
    v_rcp_f32 v153, v153
    v_rcp_f32 v154, v154
    v_rcp_f32 v155, v155
    v_pk_mul_f32 v[156:157], v[156:157], v[152:153]
    v_pk_mul_f32 v[158:159], v[158:159], v[154:155]
    v_cvt_pk_bf16_f32 v146, v156, v157
    v_cvt_pk_bf16_f32 v147, v158, v159
    buffer_load_dwordx4 a[12:15], v227, s[4:7], 0 offen sc1
    buffer_store_dwordx4 v[144:147], v252, s[16:19], s36 offen offset:2048 sc1
    v_pk_mul_f32 v[160:161], v[160:161], v[248:249] op_sel_hi:[1,0]
    v_pk_mul_f32 v[162:163], v[162:163], v[248:249] op_sel_hi:[1,0]
    v_exp_f32 v160, v160
    v_exp_f32 v161, v161
    v_exp_f32 v162, v162
    v_exp_f32 v163, v163
    v_pk_fma_f32 v[160:161], v[160:161], v[248:249], v[248:249] op_sel:[0,1,1] op_sel_hi:[1,1,1]
    s_add_u32 s4, s68, 7168
    s_addc_u32 s5, s69, 0
    buffer_load_dwordx4 a[16:19], v224, s[4:7], 0 offen sc1
    v_pk_fma_f32 v[162:163], v[162:163], v[248:249], v[248:249] op_sel:[0,1,1] op_sel_hi:[1,1,1]
    v_rcp_f32 v160, v160
    v_rcp_f32 v161, v161
    v_rcp_f32 v162, v162
    v_rcp_f32 v163, v163
    v_pk_mul_f32 v[164:165], v[164:165], v[160:161]
    v_pk_mul_f32 v[166:167], v[166:167], v[162:163]
    v_cvt_pk_bf16_f32 v160, v164, v165
    buffer_load_dwordx4 a[24:27], v225, s[4:7], 0 offen sc1
    v_cvt_pk_bf16_f32 v161, v166, v167
    buffer_store_dwordx2 v[160:161], v253, s[16:19], s36 offen sc1
    v_pk_mul_f32 v[200:201], v[200:201], v[250:251] op_sel_hi:[1,0]
    v_pk_mul_f32 v[202:203], v[202:203], v[250:251] op_sel_hi:[1,0]
    v_exp_f32 v200, v200
    v_exp_f32 v201, v201
    v_exp_f32 v202, v202
    v_exp_f32 v203, v203
    buffer_load_dwordx4 a[20:23], v226, s[4:7], 0 offen sc1
    v_pk_fma_f32 v[200:201], v[200:201], v[250:251], v[250:251] op_sel:[0,1,1] op_sel_hi:[1,1,1]
    v_pk_fma_f32 v[202:203], v[202:203], v[250:251], v[250:251] op_sel:[0,1,1] op_sel_hi:[1,1,1]
    v_rcp_f32 v200, v200
    v_rcp_f32 v201, v201
    v_rcp_f32 v202, v202
    v_rcp_f32 v203, v203
    v_pk_mul_f32 v[204:205], v[204:205], v[200:201]
    v_pk_mul_f32 v[206:207], v[206:207], v[202:203]
    buffer_load_dwordx4 a[28:31], v227, s[4:7], 0 offen sc1
    v_cvt_pk_bf16_f32 v200, v204, v205
    v_cvt_pk_bf16_f32 v201, v206, v207
    v_pk_mul_f32 v[208:209], v[208:209], v[250:251] op_sel_hi:[1,0]
    v_pk_mul_f32 v[210:211], v[210:211], v[250:251] op_sel_hi:[1,0]
    v_exp_f32 v208, v208
    v_exp_f32 v209, v209
    v_exp_f32 v210, v210
    v_exp_f32 v211, v211
    s_add_u32 s4, s68, 14336
    s_addc_u32 s5, s69, 0
    buffer_load_dwordx4 a[32:35], v224, s[4:7], 0 offen sc1
    v_pk_fma_f32 v[208:209], v[208:209], v[250:251], v[250:251] op_sel:[0,1,1] op_sel_hi:[1,1,1]
    v_pk_fma_f32 v[210:211], v[210:211], v[250:251], v[250:251] op_sel:[0,1,1] op_sel_hi:[1,1,1]
    v_rcp_f32 v208, v208
    v_rcp_f32 v209, v209
    v_rcp_f32 v210, v210
    v_rcp_f32 v211, v211
    v_pk_mul_f32 v[212:213], v[212:213], v[208:209]
    v_pk_mul_f32 v[214:215], v[214:215], v[210:211]
    buffer_load_dwordx4 a[40:43], v225, s[4:7], 0 offen sc1
    v_cvt_pk_bf16_f32 v202, v212, v213
    v_cvt_pk_bf16_f32 v203, v214, v215
    buffer_store_dwordx4 v[200:203], v252, s[16:19], s37 offen offset:2048 sc1
    v_pk_mul_f32 v[216:217], v[216:217], v[250:251] op_sel_hi:[1,0]
    v_pk_mul_f32 v[218:219], v[218:219], v[250:251] op_sel_hi:[1,0]
    v_exp_f32 v216, v216
    v_exp_f32 v217, v217
    v_exp_f32 v218, v218
    buffer_load_dwordx4 a[36:39], v226, s[4:7], 0 offen sc1
    v_exp_f32 v219, v219
    v_pk_fma_f32 v[216:217], v[216:217], v[250:251], v[250:251] op_sel:[0,1,1] op_sel_hi:[1,1,1]
    v_pk_fma_f32 v[218:219], v[218:219], v[250:251], v[250:251] op_sel:[0,1,1] op_sel_hi:[1,1,1]
    v_rcp_f32 v216, v216
    v_rcp_f32 v217, v217
    v_rcp_f32 v218, v218
    v_rcp_f32 v219, v219
    v_pk_mul_f32 v[220:221], v[220:221], v[216:217]
    buffer_load_dwordx4 a[44:47], v227, s[4:7], 0 offen sc1
    v_pk_mul_f32 v[222:223], v[222:223], v[218:219]
    v_cvt_pk_bf16_f32 v216, v220, v221
    v_cvt_pk_bf16_f32 v217, v222, v223
    buffer_store_dwordx2 v[216:217], v253, s[16:19], s37 offen sc1
    v_accvgpr_read_b32 v64, a236
    v_accvgpr_read_b32 v65, a237
    v_accvgpr_read_b32 v66, a238
    v_accvgpr_read_b32 v67, a239
    v_add_u32 v72, 147456, v64
    v_add_u32 v73, 147456, v65
    v_add_u32 v74, 147456, v66
    v_add_u32 v75, 147456, v67
    v_add_u32 v68, 81920, v64
    v_add_u32 v69, 81920, v65
    v_add_u32 v70, 81920, v66
    v_add_u32 v71, 81920, v67
    v_add_u32 v64, 16384, v64
    v_add_u32 v65, 16384, v65
    v_add_u32 v66, 16384, v66
    v_add_u32 v67, 16384, v67
    s_waitcnt vmcnt(39)
    s_barrier
    ds_read_b64_tr_b16 a[128:129], v68 offset:32768
    ds_read_b64_tr_b16 a[130:131], v68 offset:36864
    ds_read_b64_tr_b16 a[132:133], v68 offset:40960
    ds_read_b64_tr_b16 a[134:135], v68 offset:45056
    ds_read_b64_tr_b16 a[136:137], v69 offset:32768
    ds_read_b64_tr_b16 a[138:139], v69 offset:36864
    ds_read_b64_tr_b16 a[140:141], v69 offset:40960
    ds_read_b64_tr_b16 a[142:143], v69 offset:45056
    ds_read_b64_tr_b16 a[144:145], v70 offset:32768
    ds_read_b64_tr_b16 a[146:147], v70 offset:36864
    ds_read_b64_tr_b16 a[148:149], v70 offset:40960
    ds_read_b64_tr_b16 a[150:151], v70 offset:45056
    ds_read_b64_tr_b16 a[152:153], v71 offset:32768
    ds_read_b64_tr_b16 a[154:155], v71 offset:36864
    ds_read_b64_tr_b16 a[156:157], v71 offset:40960
    ds_read_b64_tr_b16 a[158:159], v71 offset:45056
    s_waitcnt vmcnt(12) lgkmcnt(12)
    v_mfma_f32_16x16x32_bf16 v[0:3], a[128:131], a[0:3], 0
    ds_read_b64_tr_b16 a[160:161], v68 offset:34816
    s_add_u32 s4, s68, 21504
    v_mfma_f32_16x16x32_bf16 v[0:3], a[132:135], a[4:7], v[0:3]
    ds_read_b64_tr_b16 a[162:163], v68 offset:38912
    s_addc_u32 s5, s69, 0
    v_mfma_f32_16x16x32_bf16 v[32:35], a[132:135], a[12:15], 0
    ds_read_b64_tr_b16 a[164:165], v68 offset:43008
    buffer_load_dwordx4 a[48:51], v224, s[4:7], 0 offen sc1
    v_mfma_f32_16x16x32_bf16 v[32:35], a[128:131], a[8:11], v[32:35]
    ds_read_b64_tr_b16 a[166:167], v68 offset:47104
    s_waitcnt lgkmcnt(12)
    v_mfma_f32_16x16x32_bf16 v[4:7], a[136:139], a[0:3], 0
    ds_read_b64_tr_b16 a[168:169], v69 offset:34816
    buffer_load_dwordx4 a[56:59], v225, s[4:7], 0 offen sc1
    v_mfma_f32_16x16x32_bf16 v[4:7], a[140:143], a[4:7], v[4:7]
    ds_read_b64_tr_b16 a[170:171], v69 offset:38912
    v_mfma_f32_16x16x32_bf16 v[36:39], a[140:143], a[12:15], 0
    ds_read_b64_tr_b16 a[172:173], v69 offset:43008
    v_mfma_f32_16x16x32_bf16 v[36:39], a[136:139], a[8:11], v[36:39]
    ds_read_b64_tr_b16 a[174:175], v69 offset:47104
    s_waitcnt lgkmcnt(12)
    v_mfma_f32_16x16x32_bf16 v[8:11], a[144:147], a[0:3], 0
    ds_read_b64_tr_b16 a[176:177], v70 offset:34816
    buffer_load_dwordx4 a[52:55], v226, s[4:7], 0 offen sc1
    v_mfma_f32_16x16x32_bf16 v[8:11], a[148:151], a[4:7], v[8:11]
    ds_read_b64_tr_b16 a[178:179], v70 offset:38912
    v_mfma_f32_16x16x32_bf16 v[40:43], a[148:151], a[12:15], 0
    ds_read_b64_tr_b16 a[180:181], v70 offset:43008
    v_mfma_f32_16x16x32_bf16 v[40:43], a[144:147], a[8:11], v[40:43]
    ds_read_b64_tr_b16 a[182:183], v70 offset:47104
    s_waitcnt lgkmcnt(12)
    v_mfma_f32_16x16x32_bf16 v[12:15], a[152:155], a[0:3], 0
    ds_read_b64_tr_b16 a[128:129], v71 offset:34816
    buffer_load_dwordx4 a[60:63], v227, s[4:7], 0 offen sc1
    v_mfma_f32_16x16x32_bf16 v[12:15], a[156:159], a[4:7], v[12:15]
    ds_read_b64_tr_b16 a[130:131], v71 offset:38912
    s_add_u32 m0, s49, 32768
    v_mfma_f32_16x16x32_bf16 v[44:47], a[156:159], a[12:15], 0
    ds_read_b64_tr_b16 a[132:133], v71 offset:43008
    s_add_u32 s12, s64, 1835008
    v_mfma_f32_16x16x32_bf16 v[44:47], a[152:155], a[8:11], v[44:47]
    ds_read_b64_tr_b16 a[134:135], v71 offset:47104
    s_waitcnt lgkmcnt(12)
    v_mfma_f32_16x16x32_bf16 v[16:19], a[160:163], a[0:3], 0
    s_waitcnt vmcnt(39)
    s_barrier
    ds_read_b64_tr_b16 a[136:137], v68 offset:49152
    v_mfma_f32_16x16x32_bf16 v[16:19], a[164:167], a[4:7], v[16:19]
    ds_read_b64_tr_b16 a[138:139], v68 offset:53248
    s_addc_u32 s13, s65, 0
    v_mfma_f32_16x16x32_bf16 v[48:51], a[164:167], a[12:15], 0
    ds_read_b64_tr_b16 a[140:141], v68 offset:57344
    buffer_load_dwordx4 v242, s[12:15], 0 offen offset:0 sc1 lds
    v_mfma_f32_16x16x32_bf16 v[48:51], a[160:163], a[8:11], v[48:51]
    ds_read_b64_tr_b16 a[142:143], v68 offset:61440
    s_waitcnt lgkmcnt(12)
    v_mfma_f32_16x16x32_bf16 v[20:23], a[168:171], a[0:3], 0
    ds_read_b64_tr_b16 a[144:145], v69 offset:49152
    buffer_load_dwordx4 v243, s[12:15], 0 offen offset:1024 sc1 lds
    v_mfma_f32_16x16x32_bf16 v[20:23], a[172:175], a[4:7], v[20:23]
    ds_read_b64_tr_b16 a[146:147], v69 offset:53248
    s_add_u32 m0, s49, 34816
    v_mfma_f32_16x16x32_bf16 v[52:55], a[172:175], a[12:15], 0
    ds_read_b64_tr_b16 a[148:149], v69 offset:57344
    s_add_u32 s84, s66, 1835008
    v_mfma_f32_16x16x32_bf16 v[52:55], a[168:171], a[8:11], v[52:55]
    ds_read_b64_tr_b16 a[150:151], v69 offset:61440
    s_waitcnt lgkmcnt(12)
    v_mfma_f32_16x16x32_bf16 v[24:27], a[176:179], a[0:3], 0
    ds_read_b64_tr_b16 a[152:153], v70 offset:49152
    s_addc_u32 s85, s67, 0
    v_mfma_f32_16x16x32_bf16 v[24:27], a[180:183], a[4:7], v[24:27]
    ds_read_b64_tr_b16 a[154:155], v70 offset:53248
    buffer_load_dwordx4 v242, s[84:87], 0 offen offset:0 sc1 lds
    v_mfma_f32_16x16x32_bf16 v[56:59], a[180:183], a[12:15], 0
    ds_read_b64_tr_b16 a[156:157], v70 offset:57344
    v_mfma_f32_16x16x32_bf16 v[56:59], a[176:179], a[8:11], v[56:59]
    ds_read_b64_tr_b16 a[158:159], v70 offset:61440
    s_waitcnt lgkmcnt(12)
    v_mfma_f32_16x16x32_bf16 v[28:31], a[128:131], a[0:3], 0
    ds_read_b64_tr_b16 a[160:161], v71 offset:49152
    buffer_load_dwordx4 v243, s[84:87], 0 offen offset:1024 sc1 lds
    v_mfma_f32_16x16x32_bf16 v[28:31], a[132:135], a[4:7], v[28:31]
    ds_read_b64_tr_b16 a[162:163], v71 offset:53248
    s_add_u32 s4, s68, 28672
    v_mfma_f32_16x16x32_bf16 v[60:63], a[132:135], a[12:15], 0
    ds_read_b64_tr_b16 a[164:165], v71 offset:57344
    s_addc_u32 s5, s69, 0
    v_mfma_f32_16x16x32_bf16 v[60:63], a[128:131], a[8:11], v[60:63]
    ds_read_b64_tr_b16 a[166:167], v71 offset:61440
    s_waitcnt vmcnt(14) lgkmcnt(12)
    v_mfma_f32_16x16x32_bf16 v[0:3], a[136:139], a[16:19], v[0:3]
    ds_read_b64_tr_b16 a[168:169], v68 offset:51200
    buffer_load_dwordx4 a[64:67], v224, s[4:7], 0 offen sc1
    v_mfma_f32_16x16x32_bf16 v[0:3], a[140:143], a[20:23], v[0:3]
    ds_read_b64_tr_b16 a[170:171], v68 offset:55296
    v_mfma_f32_16x16x32_bf16 v[32:35], a[140:143], a[28:31], v[32:35]
    ds_read_b64_tr_b16 a[172:173], v68 offset:59392
    v_mfma_f32_16x16x32_bf16 v[32:35], a[136:139], a[24:27], v[32:35]
    ds_read_b64_tr_b16 a[174:175], v68 offset:63488
    s_waitcnt lgkmcnt(12)
    v_mfma_f32_16x16x32_bf16 v[4:7], a[144:147], a[16:19], v[4:7]
    ds_read_b64_tr_b16 a[176:177], v69 offset:51200
    buffer_load_dwordx4 a[72:75], v225, s[4:7], 0 offen sc1
    v_mfma_f32_16x16x32_bf16 v[4:7], a[148:151], a[20:23], v[4:7]
    ds_read_b64_tr_b16 a[178:179], v69 offset:55296
    v_mfma_f32_16x16x32_bf16 v[36:39], a[148:151], a[28:31], v[36:39]
    ds_read_b64_tr_b16 a[180:181], v69 offset:59392
    v_mfma_f32_16x16x32_bf16 v[36:39], a[144:147], a[24:27], v[36:39]
    ds_read_b64_tr_b16 a[182:183], v69 offset:63488
    s_waitcnt lgkmcnt(12)
    v_mfma_f32_16x16x32_bf16 v[8:11], a[152:155], a[16:19], v[8:11]
    ds_read_b64_tr_b16 a[128:129], v70 offset:51200
    buffer_load_dwordx4 a[68:71], v226, s[4:7], 0 offen sc1
    v_mfma_f32_16x16x32_bf16 v[8:11], a[156:159], a[20:23], v[8:11]
    ds_read_b64_tr_b16 a[130:131], v70 offset:55296
    v_mfma_f32_16x16x32_bf16 v[40:43], a[156:159], a[28:31], v[40:43]
    ds_read_b64_tr_b16 a[132:133], v70 offset:59392
    v_mfma_f32_16x16x32_bf16 v[40:43], a[152:155], a[24:27], v[40:43]
    ds_read_b64_tr_b16 a[134:135], v70 offset:63488
    s_waitcnt lgkmcnt(12)
    v_mfma_f32_16x16x32_bf16 v[12:15], a[160:163], a[16:19], v[12:15]
    ds_read_b64_tr_b16 a[136:137], v71 offset:51200
    buffer_load_dwordx4 a[76:79], v227, s[4:7], 0 offen sc1
    v_mfma_f32_16x16x32_bf16 v[12:15], a[164:167], a[20:23], v[12:15]
    ds_read_b64_tr_b16 a[138:139], v71 offset:55296
    s_add_u32 m0, s49, 49152
    v_mfma_f32_16x16x32_bf16 v[44:47], a[164:167], a[28:31], v[44:47]
    ds_read_b64_tr_b16 a[140:141], v71 offset:59392
    s_add_u32 s12, s64, 2293760
    s_addc_u32 s13, s65, 0
    v_mfma_f32_16x16x32_bf16 v[44:47], a[160:163], a[24:27], v[44:47]
    ds_read_b64_tr_b16 a[142:143], v71 offset:63488
    s_waitcnt lgkmcnt(12)
    v_mfma_f32_16x16x32_bf16 v[16:19], a[168:171], a[16:19], v[16:19]
    s_waitcnt vmcnt(12)
    s_barrier
    ds_read_b64_tr_b16 a[144:145], v72 offset:0
    s_cmp_lg_u32 s3, 0
    s_cbranch_scc1 L_nosend41
    s_mov_b64 exec, 0xffff
    buffer_store_dword v232, v231, s[16:19], s27 offen offset:64 sc1
    s_mov_b64 exec, -1
L_nosend41:
    v_mfma_f32_16x16x32_bf16 v[16:19], a[172:175], a[20:23], v[16:19]
    ds_read_b64_tr_b16 a[146:147], v72 offset:4096
    buffer_load_dwordx4 v242, s[12:15], 0 offen offset:0 sc1 lds
    v_mfma_f32_16x16x32_bf16 v[48:51], a[172:175], a[28:31], v[48:51]
    ds_read_b64_tr_b16 a[148:149], v72 offset:8192
    v_mfma_f32_16x16x32_bf16 v[48:51], a[168:171], a[24:27], v[48:51]
    ds_read_b64_tr_b16 a[150:151], v72 offset:12288
    s_waitcnt lgkmcnt(12)
    v_mfma_f32_16x16x32_bf16 v[20:23], a[176:179], a[16:19], v[20:23]
    ds_read_b64_tr_b16 a[152:153], v73 offset:0
    buffer_load_dwordx4 v243, s[12:15], 0 offen offset:1024 sc1 lds
    v_mfma_f32_16x16x32_bf16 v[20:23], a[180:183], a[20:23], v[20:23]
    ds_read_b64_tr_b16 a[154:155], v73 offset:4096
    s_add_u32 m0, s49, 51200
    v_mfma_f32_16x16x32_bf16 v[52:55], a[180:183], a[28:31], v[52:55]
    ds_read_b64_tr_b16 a[156:157], v73 offset:8192
    s_add_u32 s84, s66, 2293760
    v_mfma_f32_16x16x32_bf16 v[52:55], a[176:179], a[24:27], v[52:55]
    ds_read_b64_tr_b16 a[158:159], v73 offset:12288
    s_waitcnt lgkmcnt(12)
    v_mfma_f32_16x16x32_bf16 v[24:27], a[128:131], a[16:19], v[24:27]
    ds_read_b64_tr_b16 a[160:161], v74 offset:0
    s_addc_u32 s85, s67, 0
    v_mfma_f32_16x16x32_bf16 v[24:27], a[132:135], a[20:23], v[24:27]
    ds_read_b64_tr_b16 a[162:163], v74 offset:4096
    buffer_load_dwordx4 v242, s[84:87], 0 offen offset:0 sc1 lds
    v_mfma_f32_16x16x32_bf16 v[56:59], a[132:135], a[28:31], v[56:59]
    ds_read_b64_tr_b16 a[164:165], v74 offset:8192
    v_mfma_f32_16x16x32_bf16 v[56:59], a[128:131], a[24:27], v[56:59]
    ds_read_b64_tr_b16 a[166:167], v74 offset:12288
    s_waitcnt lgkmcnt(12)
    v_mfma_f32_16x16x32_bf16 v[28:31], a[136:139], a[16:19], v[28:31]
    ds_read_b64_tr_b16 a[168:169], v75 offset:0
    buffer_load_dwordx4 v243, s[84:87], 0 offen offset:1024 sc1 lds
    v_mfma_f32_16x16x32_bf16 v[28:31], a[140:143], a[20:23], v[28:31]
    ds_read_b64_tr_b16 a[170:171], v75 offset:4096
    s_add_u32 s4, s68, 35840
    v_mfma_f32_16x16x32_bf16 v[60:63], a[140:143], a[28:31], v[60:63]
    ds_read_b64_tr_b16 a[172:173], v75 offset:8192
    s_addc_u32 s5, s69, 0
    v_mfma_f32_16x16x32_bf16 v[60:63], a[136:139], a[24:27], v[60:63]
    ds_read_b64_tr_b16 a[174:175], v75 offset:12288
    s_waitcnt vmcnt(17) lgkmcnt(12)
    v_mfma_f32_16x16x32_bf16 v[0:3], a[144:147], a[32:35], v[0:3]
    ds_read_b64_tr_b16 a[176:177], v72 offset:2048
    buffer_load_dwordx4 a[80:83], v224, s[4:7], 0 offen sc1
    v_mfma_f32_16x16x32_bf16 v[0:3], a[148:151], a[36:39], v[0:3]
    ds_read_b64_tr_b16 a[178:179], v72 offset:6144
    v_mfma_f32_16x16x32_bf16 v[32:35], a[148:151], a[44:47], v[32:35]
    ds_read_b64_tr_b16 a[180:181], v72 offset:10240
    v_mfma_f32_16x16x32_bf16 v[32:35], a[144:147], a[40:43], v[32:35]
    ds_read_b64_tr_b16 a[182:183], v72 offset:14336
    s_waitcnt lgkmcnt(12)
    v_mfma_f32_16x16x32_bf16 v[4:7], a[152:155], a[32:35], v[4:7]
    ds_read_b64_tr_b16 a[128:129], v73 offset:2048
    buffer_load_dwordx4 a[88:91], v225, s[4:7], 0 offen sc1
    v_mfma_f32_16x16x32_bf16 v[4:7], a[156:159], a[36:39], v[4:7]
    ds_read_b64_tr_b16 a[130:131], v73 offset:6144
    v_mfma_f32_16x16x32_bf16 v[36:39], a[156:159], a[44:47], v[36:39]
    ds_read_b64_tr_b16 a[132:133], v73 offset:10240
    v_mfma_f32_16x16x32_bf16 v[36:39], a[152:155], a[40:43], v[36:39]
    ds_read_b64_tr_b16 a[134:135], v73 offset:14336
    s_waitcnt lgkmcnt(12)
    v_mfma_f32_16x16x32_bf16 v[8:11], a[160:163], a[32:35], v[8:11]
    ds_read_b64_tr_b16 a[136:137], v74 offset:2048
    buffer_load_dwordx4 a[84:87], v226, s[4:7], 0 offen sc1
    v_mfma_f32_16x16x32_bf16 v[8:11], a[164:167], a[36:39], v[8:11]
    ds_read_b64_tr_b16 a[138:139], v74 offset:6144
    v_mfma_f32_16x16x32_bf16 v[40:43], a[164:167], a[44:47], v[40:43]
    ds_read_b64_tr_b16 a[140:141], v74 offset:10240
    v_mfma_f32_16x16x32_bf16 v[40:43], a[160:163], a[40:43], v[40:43]
    ds_read_b64_tr_b16 a[142:143], v74 offset:14336
    s_waitcnt lgkmcnt(12)
    v_mfma_f32_16x16x32_bf16 v[12:15], a[168:171], a[32:35], v[12:15]
    ds_read_b64_tr_b16 a[144:145], v75 offset:2048
    buffer_load_dwordx4 a[92:95], v227, s[4:7], 0 offen sc1
    v_mfma_f32_16x16x32_bf16 v[12:15], a[172:175], a[36:39], v[12:15]
    ds_read_b64_tr_b16 a[146:147], v75 offset:6144
    s_add_u32 m0, s49, 65536
    v_mfma_f32_16x16x32_bf16 v[44:47], a[172:175], a[44:47], v[44:47]
    ds_read_b64_tr_b16 a[148:149], v75 offset:10240
    s_add_u32 s12, s64, 2752512
    v_mfma_f32_16x16x32_bf16 v[44:47], a[168:171], a[40:43], v[44:47]
    ds_read_b64_tr_b16 a[150:151], v75 offset:14336
    s_waitcnt lgkmcnt(12)
    v_mfma_f32_16x16x32_bf16 v[16:19], a[176:179], a[32:35], v[16:19]
    s_waitcnt vmcnt(36)
    s_barrier
    ds_read_b64_tr_b16 a[152:153], v64 offset:0
    v_mfma_f32_16x16x32_bf16 v[16:19], a[180:183], a[36:39], v[16:19]
    ds_read_b64_tr_b16 a[154:155], v64 offset:4096
    s_addc_u32 s13, s65, 0
    v_mfma_f32_16x16x32_bf16 v[48:51], a[180:183], a[44:47], v[48:51]
    ds_read_b64_tr_b16 a[156:157], v64 offset:8192
    buffer_load_dwordx4 v242, s[12:15], 0 offen offset:0 sc1 lds
    v_mfma_f32_16x16x32_bf16 v[48:51], a[176:179], a[40:43], v[48:51]
    ds_read_b64_tr_b16 a[158:159], v64 offset:12288
    s_waitcnt lgkmcnt(12)
    v_mfma_f32_16x16x32_bf16 v[20:23], a[128:131], a[32:35], v[20:23]
    ds_read_b64_tr_b16 a[160:161], v65 offset:0
    buffer_load_dwordx4 v243, s[12:15], 0 offen offset:1024 sc1 lds
    v_mfma_f32_16x16x32_bf16 v[20:23], a[132:135], a[36:39], v[20:23]
    ds_read_b64_tr_b16 a[162:163], v65 offset:4096
    s_add_u32 m0, s49, 67584
    v_mfma_f32_16x16x32_bf16 v[52:55], a[132:135], a[44:47], v[52:55]
    ds_read_b64_tr_b16 a[164:165], v65 offset:8192
    s_add_u32 s84, s66, 2752512
    v_mfma_f32_16x16x32_bf16 v[52:55], a[128:131], a[40:43], v[52:55]
    ds_read_b64_tr_b16 a[166:167], v65 offset:12288
    s_waitcnt lgkmcnt(12)
    v_mfma_f32_16x16x32_bf16 v[24:27], a[136:139], a[32:35], v[24:27]
    ds_read_b64_tr_b16 a[168:169], v66 offset:0
    s_addc_u32 s85, s67, 0
    v_mfma_f32_16x16x32_bf16 v[24:27], a[140:143], a[36:39], v[24:27]
    ds_read_b64_tr_b16 a[170:171], v66 offset:4096
    buffer_load_dwordx4 v242, s[84:87], 0 offen offset:0 sc1 lds
    v_mfma_f32_16x16x32_bf16 v[56:59], a[140:143], a[44:47], v[56:59]
    ds_read_b64_tr_b16 a[172:173], v66 offset:8192
    v_mfma_f32_16x16x32_bf16 v[56:59], a[136:139], a[40:43], v[56:59]
    ds_read_b64_tr_b16 a[174:175], v66 offset:12288
    s_waitcnt lgkmcnt(12)
    v_mfma_f32_16x16x32_bf16 v[28:31], a[144:147], a[32:35], v[28:31]
    ds_read_b64_tr_b16 a[176:177], v67 offset:0
    buffer_load_dwordx4 v243, s[84:87], 0 offen offset:1024 sc1 lds
    v_mfma_f32_16x16x32_bf16 v[28:31], a[148:151], a[36:39], v[28:31]
    ds_read_b64_tr_b16 a[178:179], v67 offset:4096
    s_add_u32 s4, s68, 43008
    v_mfma_f32_16x16x32_bf16 v[60:63], a[148:151], a[44:47], v[60:63]
    ds_read_b64_tr_b16 a[180:181], v67 offset:8192
    s_addc_u32 s5, s69, 0
    v_mfma_f32_16x16x32_bf16 v[60:63], a[144:147], a[40:43], v[60:63]
    ds_read_b64_tr_b16 a[182:183], v67 offset:12288
    s_waitcnt vmcnt(20) lgkmcnt(12)
    v_mfma_f32_16x16x32_bf16 v[0:3], a[152:155], a[48:51], v[0:3]
    ds_read_b64_tr_b16 a[128:129], v64 offset:2048
    buffer_load_dwordx4 a[96:99], v224, s[4:7], 0 offen sc1
    v_mfma_f32_16x16x32_bf16 v[0:3], a[156:159], a[52:55], v[0:3]
    ds_read_b64_tr_b16 a[130:131], v64 offset:6144
    v_mfma_f32_16x16x32_bf16 v[32:35], a[156:159], a[60:63], v[32:35]
    ds_read_b64_tr_b16 a[132:133], v64 offset:10240
    v_mfma_f32_16x16x32_bf16 v[32:35], a[152:155], a[56:59], v[32:35]
    ds_read_b64_tr_b16 a[134:135], v64 offset:14336
    s_waitcnt lgkmcnt(12)
    v_mfma_f32_16x16x32_bf16 v[4:7], a[160:163], a[48:51], v[4:7]
    ds_read_b64_tr_b16 a[136:137], v65 offset:2048
    buffer_load_dwordx4 a[104:107], v225, s[4:7], 0 offen sc1
    v_mfma_f32_16x16x32_bf16 v[4:7], a[164:167], a[52:55], v[4:7]
    ds_read_b64_tr_b16 a[138:139], v65 offset:6144
    v_mfma_f32_16x16x32_bf16 v[36:39], a[164:167], a[60:63], v[36:39]
    ds_read_b64_tr_b16 a[140:141], v65 offset:10240
    v_mfma_f32_16x16x32_bf16 v[36:39], a[160:163], a[56:59], v[36:39]
    ds_read_b64_tr_b16 a[142:143], v65 offset:14336
    s_waitcnt lgkmcnt(12)
    v_mfma_f32_16x16x32_bf16 v[8:11], a[168:171], a[48:51], v[8:11]
    ds_read_b64_tr_b16 a[144:145], v66 offset:2048
    buffer_load_dwordx4 a[100:103], v226, s[4:7], 0 offen sc1
    v_mfma_f32_16x16x32_bf16 v[8:11], a[172:175], a[52:55], v[8:11]
    ds_read_b64_tr_b16 a[146:147], v66 offset:6144
    v_mfma_f32_16x16x32_bf16 v[40:43], a[172:175], a[60:63], v[40:43]
    ds_read_b64_tr_b16 a[148:149], v66 offset:10240
    v_mfma_f32_16x16x32_bf16 v[40:43], a[168:171], a[56:59], v[40:43]
    ds_read_b64_tr_b16 a[150:151], v66 offset:14336
    s_waitcnt lgkmcnt(12)
    v_mfma_f32_16x16x32_bf16 v[12:15], a[176:179], a[48:51], v[12:15]
    ds_read_b64_tr_b16 a[152:153], v67 offset:2048
    buffer_load_dwordx4 a[108:111], v227, s[4:7], 0 offen sc1
    v_mfma_f32_16x16x32_bf16 v[12:15], a[180:183], a[52:55], v[12:15]
    ds_read_b64_tr_b16 a[154:155], v67 offset:6144
    s_add_u32 m0, s49, 81920
    v_mfma_f32_16x16x32_bf16 v[44:47], a[180:183], a[60:63], v[44:47]
    ds_read_b64_tr_b16 a[156:157], v67 offset:10240
    s_add_u32 s12, s64, 3211264
    v_mfma_f32_16x16x32_bf16 v[44:47], a[176:179], a[56:59], v[44:47]
    ds_read_b64_tr_b16 a[158:159], v67 offset:14336
    s_waitcnt lgkmcnt(12)
    v_mfma_f32_16x16x32_bf16 v[16:19], a[128:131], a[48:51], v[16:19]
    s_waitcnt vmcnt(20)
    s_barrier
    ds_read_b64_tr_b16 a[160:161], v64 offset:16384
    v_mfma_f32_16x16x32_bf16 v[16:19], a[132:135], a[52:55], v[16:19]
    ds_read_b64_tr_b16 a[162:163], v64 offset:20480
    s_addc_u32 s13, s65, 0
    v_mfma_f32_16x16x32_bf16 v[48:51], a[132:135], a[60:63], v[48:51]
    ds_read_b64_tr_b16 a[164:165], v64 offset:24576
    buffer_load_dwordx4 v242, s[12:15], 0 offen offset:0 sc1 lds
    v_mfma_f32_16x16x32_bf16 v[48:51], a[128:131], a[56:59], v[48:51]
    ds_read_b64_tr_b16 a[166:167], v64 offset:28672
    s_waitcnt lgkmcnt(12)
    v_mfma_f32_16x16x32_bf16 v[20:23], a[136:139], a[48:51], v[20:23]
    ds_read_b64_tr_b16 a[168:169], v65 offset:16384
    buffer_load_dwordx4 v243, s[12:15], 0 offen offset:1024 sc1 lds
    v_mfma_f32_16x16x32_bf16 v[20:23], a[140:143], a[52:55], v[20:23]
    ds_read_b64_tr_b16 a[170:171], v65 offset:20480
    s_add_u32 m0, s49, 83968
    v_mfma_f32_16x16x32_bf16 v[52:55], a[140:143], a[60:63], v[52:55]
    ds_read_b64_tr_b16 a[172:173], v65 offset:24576
    s_add_u32 s84, s66, 3211264
    v_mfma_f32_16x16x32_bf16 v[52:55], a[136:139], a[56:59], v[52:55]
    ds_read_b64_tr_b16 a[174:175], v65 offset:28672
    s_waitcnt lgkmcnt(12)
    v_mfma_f32_16x16x32_bf16 v[24:27], a[144:147], a[48:51], v[24:27]
    ds_read_b64_tr_b16 a[176:177], v66 offset:16384
    s_addc_u32 s85, s67, 0
    v_mfma_f32_16x16x32_bf16 v[24:27], a[148:151], a[52:55], v[24:27]
    ds_read_b64_tr_b16 a[178:179], v66 offset:20480
    buffer_load_dwordx4 v242, s[84:87], 0 offen offset:0 sc1 lds
    v_mfma_f32_16x16x32_bf16 v[56:59], a[148:151], a[60:63], v[56:59]
    ds_read_b64_tr_b16 a[180:181], v66 offset:24576
    v_mfma_f32_16x16x32_bf16 v[56:59], a[144:147], a[56:59], v[56:59]
    ds_read_b64_tr_b16 a[182:183], v66 offset:28672
    s_waitcnt lgkmcnt(12)
    v_mfma_f32_16x16x32_bf16 v[28:31], a[152:155], a[48:51], v[28:31]
    ds_read_b64_tr_b16 a[128:129], v67 offset:16384
    buffer_load_dwordx4 v243, s[84:87], 0 offen offset:1024 sc1 lds
    v_mfma_f32_16x16x32_bf16 v[28:31], a[156:159], a[52:55], v[28:31]
    ds_read_b64_tr_b16 a[130:131], v67 offset:20480
    s_add_u32 s4, s68, 50176
    v_mfma_f32_16x16x32_bf16 v[60:63], a[156:159], a[60:63], v[60:63]
    ds_read_b64_tr_b16 a[132:133], v67 offset:24576
    s_addc_u32 s5, s69, 0
    v_mfma_f32_16x16x32_bf16 v[60:63], a[152:155], a[56:59], v[60:63]
    ds_read_b64_tr_b16 a[134:135], v67 offset:28672
    s_waitcnt vmcnt(20) lgkmcnt(12)
    v_mfma_f32_16x16x32_bf16 v[0:3], a[160:163], a[64:67], v[0:3]
    ds_read_b64_tr_b16 a[136:137], v64 offset:18432
    buffer_load_dwordx4 a[112:115], v224, s[4:7], 0 offen sc1
    v_mfma_f32_16x16x32_bf16 v[0:3], a[164:167], a[68:71], v[0:3]
    ds_read_b64_tr_b16 a[138:139], v64 offset:22528
    v_mfma_f32_16x16x32_bf16 v[32:35], a[164:167], a[76:79], v[32:35]
    ds_read_b64_tr_b16 a[140:141], v64 offset:26624
    v_mfma_f32_16x16x32_bf16 v[32:35], a[160:163], a[72:75], v[32:35]
    ds_read_b64_tr_b16 a[142:143], v64 offset:30720
    s_waitcnt lgkmcnt(12)
    v_mfma_f32_16x16x32_bf16 v[4:7], a[168:171], a[64:67], v[4:7]
    ds_read_b64_tr_b16 a[144:145], v65 offset:18432
    buffer_load_dwordx4 a[120:123], v225, s[4:7], 0 offen sc1
    v_mfma_f32_16x16x32_bf16 v[4:7], a[172:175], a[68:71], v[4:7]
    ds_read_b64_tr_b16 a[146:147], v65 offset:22528
    v_mfma_f32_16x16x32_bf16 v[36:39], a[172:175], a[76:79], v[36:39]
    ds_read_b64_tr_b16 a[148:149], v65 offset:26624
    v_mfma_f32_16x16x32_bf16 v[36:39], a[168:171], a[72:75], v[36:39]
    ds_read_b64_tr_b16 a[150:151], v65 offset:30720
    s_waitcnt lgkmcnt(12)
    v_mfma_f32_16x16x32_bf16 v[8:11], a[176:179], a[64:67], v[8:11]
    ds_read_b64_tr_b16 a[152:153], v66 offset:18432
    buffer_load_dwordx4 a[116:119], v226, s[4:7], 0 offen sc1
    v_mfma_f32_16x16x32_bf16 v[8:11], a[180:183], a[68:71], v[8:11]
    ds_read_b64_tr_b16 a[154:155], v66 offset:22528
    v_mfma_f32_16x16x32_bf16 v[40:43], a[180:183], a[76:79], v[40:43]
    ds_read_b64_tr_b16 a[156:157], v66 offset:26624
    v_mfma_f32_16x16x32_bf16 v[40:43], a[176:179], a[72:75], v[40:43]
    ds_read_b64_tr_b16 a[158:159], v66 offset:30720
    s_waitcnt lgkmcnt(12)
    v_mfma_f32_16x16x32_bf16 v[12:15], a[128:131], a[64:67], v[12:15]
    ds_read_b64_tr_b16 a[160:161], v67 offset:18432
    buffer_load_dwordx4 a[124:127], v227, s[4:7], 0 offen sc1
    v_mfma_f32_16x16x32_bf16 v[12:15], a[132:135], a[68:71], v[12:15]
    ds_read_b64_tr_b16 a[162:163], v67 offset:22528
    s_add_u32 m0, s49, 98304
    v_mfma_f32_16x16x32_bf16 v[44:47], a[132:135], a[76:79], v[44:47]
    ds_read_b64_tr_b16 a[164:165], v67 offset:26624
    s_add_u32 s12, s64, 65536
    v_mfma_f32_16x16x32_bf16 v[44:47], a[128:131], a[72:75], v[44:47]
    ds_read_b64_tr_b16 a[166:167], v67 offset:30720
    s_waitcnt lgkmcnt(12)
    v_mfma_f32_16x16x32_bf16 v[16:19], a[136:139], a[64:67], v[16:19]
    s_waitcnt vmcnt(20)
    s_barrier
    ds_read_b64_tr_b16 a[168:169], v64 offset:32768
    v_mfma_f32_16x16x32_bf16 v[16:19], a[140:143], a[68:71], v[16:19]
    ds_read_b64_tr_b16 a[170:171], v64 offset:36864
    s_addc_u32 s13, s65, 0
    v_mfma_f32_16x16x32_bf16 v[48:51], a[140:143], a[76:79], v[48:51]
    ds_read_b64_tr_b16 a[172:173], v64 offset:40960
    buffer_load_dwordx4 v242, s[12:15], 0 offen offset:0 sc1 lds
    v_mfma_f32_16x16x32_bf16 v[48:51], a[136:139], a[72:75], v[48:51]
    ds_read_b64_tr_b16 a[174:175], v64 offset:45056
    s_waitcnt lgkmcnt(12)
    v_mfma_f32_16x16x32_bf16 v[20:23], a[144:147], a[64:67], v[20:23]
    ds_read_b64_tr_b16 a[176:177], v65 offset:32768
    buffer_load_dwordx4 v243, s[12:15], 0 offen offset:1024 sc1 lds
    v_mfma_f32_16x16x32_bf16 v[20:23], a[148:151], a[68:71], v[20:23]
    ds_read_b64_tr_b16 a[178:179], v65 offset:36864
    s_add_u32 m0, s49, 100352
    v_mfma_f32_16x16x32_bf16 v[52:55], a[148:151], a[76:79], v[52:55]
    ds_read_b64_tr_b16 a[180:181], v65 offset:40960
    s_add_u32 s84, s66, 65536
    v_mfma_f32_16x16x32_bf16 v[52:55], a[144:147], a[72:75], v[52:55]
    ds_read_b64_tr_b16 a[182:183], v65 offset:45056
    s_waitcnt lgkmcnt(12)
    v_mfma_f32_16x16x32_bf16 v[24:27], a[152:155], a[64:67], v[24:27]
    ds_read_b64_tr_b16 a[128:129], v66 offset:32768
    s_addc_u32 s85, s67, 0
    v_mfma_f32_16x16x32_bf16 v[24:27], a[156:159], a[68:71], v[24:27]
    ds_read_b64_tr_b16 a[130:131], v66 offset:36864
    buffer_load_dwordx4 v242, s[84:87], 0 offen offset:0 sc1 lds
    v_mfma_f32_16x16x32_bf16 v[56:59], a[156:159], a[76:79], v[56:59]
    ds_read_b64_tr_b16 a[132:133], v66 offset:40960
    v_mfma_f32_16x16x32_bf16 v[56:59], a[152:155], a[72:75], v[56:59]
    ds_read_b64_tr_b16 a[134:135], v66 offset:45056
    s_waitcnt lgkmcnt(12)
    v_mfma_f32_16x16x32_bf16 v[28:31], a[160:163], a[64:67], v[28:31]
    ds_read_b64_tr_b16 a[136:137], v67 offset:32768
    buffer_load_dwordx4 v243, s[84:87], 0 offen offset:1024 sc1 lds
    v_mfma_f32_16x16x32_bf16 v[28:31], a[164:167], a[68:71], v[28:31]
    ds_read_b64_tr_b16 a[138:139], v67 offset:36864
    s_add_u32 m0, s49, 114688
    v_mfma_f32_16x16x32_bf16 v[60:63], a[164:167], a[76:79], v[60:63]
    ds_read_b64_tr_b16 a[140:141], v67 offset:40960
    s_add_u32 s12, s64, 524288
    v_mfma_f32_16x16x32_bf16 v[60:63], a[160:163], a[72:75], v[60:63]
    ds_read_b64_tr_b16 a[142:143], v67 offset:45056
    s_waitcnt vmcnt(20) lgkmcnt(12)
    v_mfma_f32_16x16x32_bf16 v[0:3], a[168:171], a[80:83], v[0:3]
    ds_read_b64_tr_b16 a[144:145], v64 offset:34816
    s_addc_u32 s13, s65, 0
    v_mfma_f32_16x16x32_bf16 v[0:3], a[172:175], a[84:87], v[0:3]
    ds_read_b64_tr_b16 a[146:147], v64 offset:38912
    buffer_load_dword v234, v233, s[16:19], s28 offen offset:64 sc1
    v_mfma_f32_16x16x32_bf16 v[32:35], a[172:175], a[92:95], v[32:35]
    ds_read_b64_tr_b16 a[148:149], v64 offset:43008
    buffer_load_dwordx4 v242, s[12:15], 0 offen offset:0 sc1 lds
    v_mfma_f32_16x16x32_bf16 v[32:35], a[168:171], a[88:91], v[32:35]
    ds_read_b64_tr_b16 a[150:151], v64 offset:47104
    s_waitcnt lgkmcnt(12)
    v_mfma_f32_16x16x32_bf16 v[4:7], a[176:179], a[80:83], v[4:7]
    ds_read_b64_tr_b16 a[152:153], v65 offset:34816
    buffer_load_dwordx4 v243, s[12:15], 0 offen offset:1024 sc1 lds
    v_mfma_f32_16x16x32_bf16 v[4:7], a[180:183], a[84:87], v[4:7]
    ds_read_b64_tr_b16 a[154:155], v65 offset:38912
    s_add_u32 m0, s49, 116736
    v_mfma_f32_16x16x32_bf16 v[36:39], a[180:183], a[92:95], v[36:39]
    ds_read_b64_tr_b16 a[156:157], v65 offset:43008
    s_add_u32 s84, s66, 524288
    v_mfma_f32_16x16x32_bf16 v[36:39], a[176:179], a[88:91], v[36:39]
    ds_read_b64_tr_b16 a[158:159], v65 offset:47104
    s_waitcnt lgkmcnt(12)
    v_mfma_f32_16x16x32_bf16 v[8:11], a[128:131], a[80:83], v[8:11]
    ds_read_b64_tr_b16 a[160:161], v66 offset:34816
    s_addc_u32 s85, s67, 0
    v_mfma_f32_16x16x32_bf16 v[8:11], a[132:135], a[84:87], v[8:11]
    ds_read_b64_tr_b16 a[162:163], v66 offset:38912
    buffer_load_dwordx4 v242, s[84:87], 0 offen offset:0 sc1 lds
    v_mfma_f32_16x16x32_bf16 v[40:43], a[132:135], a[92:95], v[40:43]
    ds_read_b64_tr_b16 a[164:165], v66 offset:43008
    v_mfma_f32_16x16x32_bf16 v[40:43], a[128:131], a[88:91], v[40:43]
    ds_read_b64_tr_b16 a[166:167], v66 offset:47104
    s_waitcnt lgkmcnt(12)
    v_mfma_f32_16x16x32_bf16 v[12:15], a[136:139], a[80:83], v[12:15]
    ds_read_b64_tr_b16 a[168:169], v67 offset:34816
    buffer_load_dwordx4 v243, s[84:87], 0 offen offset:1024 sc1 lds
    v_mfma_f32_16x16x32_bf16 v[12:15], a[140:143], a[84:87], v[12:15]
    ds_read_b64_tr_b16 a[170:171], v67 offset:38912
    s_add_u32 m0, s49, 131072
    v_mfma_f32_16x16x32_bf16 v[44:47], a[140:143], a[92:95], v[44:47]
    ds_read_b64_tr_b16 a[172:173], v67 offset:43008
    s_add_u32 s12, s64, 983040
    v_mfma_f32_16x16x32_bf16 v[44:47], a[136:139], a[88:91], v[44:47]
    ds_read_b64_tr_b16 a[174:175], v67 offset:47104
    s_waitcnt lgkmcnt(12)
    v_mfma_f32_16x16x32_bf16 v[16:19], a[144:147], a[80:83], v[16:19]
    s_waitcnt vmcnt(21)
    s_barrier
    ds_read_b64_tr_b16 a[176:177], v64 offset:49152
    v_mfma_f32_16x16x32_bf16 v[16:19], a[148:151], a[84:87], v[16:19]
    ds_read_b64_tr_b16 a[178:179], v64 offset:53248
    s_addc_u32 s13, s65, 0
    v_mfma_f32_16x16x32_bf16 v[48:51], a[148:151], a[92:95], v[48:51]
    ds_read_b64_tr_b16 a[180:181], v64 offset:57344
    buffer_load_dwordx4 v242, s[12:15], 0 offen offset:0 sc1 lds
    v_mfma_f32_16x16x32_bf16 v[48:51], a[144:147], a[88:91], v[48:51]
    ds_read_b64_tr_b16 a[182:183], v64 offset:61440
    s_waitcnt lgkmcnt(12)
    v_mfma_f32_16x16x32_bf16 v[20:23], a[152:155], a[80:83], v[20:23]
    ds_read_b64_tr_b16 a[128:129], v65 offset:49152
    buffer_load_dwordx4 v243, s[12:15], 0 offen offset:1024 sc1 lds
    v_mfma_f32_16x16x32_bf16 v[20:23], a[156:159], a[84:87], v[20:23]
    ds_read_b64_tr_b16 a[130:131], v65 offset:53248
    s_add_u32 m0, s49, 133120
    v_mfma_f32_16x16x32_bf16 v[52:55], a[156:159], a[92:95], v[52:55]
    ds_read_b64_tr_b16 a[132:133], v65 offset:57344
    s_add_u32 s84, s66, 983040
    v_mfma_f32_16x16x32_bf16 v[52:55], a[152:155], a[88:91], v[52:55]
    ds_read_b64_tr_b16 a[134:135], v65 offset:61440
    s_waitcnt lgkmcnt(12)
    v_mfma_f32_16x16x32_bf16 v[24:27], a[160:163], a[80:83], v[24:27]
    ds_read_b64_tr_b16 a[136:137], v66 offset:49152
    s_addc_u32 s85, s67, 0
    v_mfma_f32_16x16x32_bf16 v[24:27], a[164:167], a[84:87], v[24:27]
    ds_read_b64_tr_b16 a[138:139], v66 offset:53248
    buffer_load_dwordx4 v242, s[84:87], 0 offen offset:0 sc1 lds
    v_mfma_f32_16x16x32_bf16 v[56:59], a[164:167], a[92:95], v[56:59]
    ds_read_b64_tr_b16 a[140:141], v66 offset:57344
    v_mfma_f32_16x16x32_bf16 v[56:59], a[160:163], a[88:91], v[56:59]
    ds_read_b64_tr_b16 a[142:143], v66 offset:61440
    s_waitcnt lgkmcnt(12)
    v_mfma_f32_16x16x32_bf16 v[28:31], a[168:171], a[80:83], v[28:31]
    ds_read_b64_tr_b16 a[144:145], v67 offset:49152
    buffer_load_dwordx4 v243, s[84:87], 0 offen offset:1024 sc1 lds
    v_mfma_f32_16x16x32_bf16 v[28:31], a[172:175], a[84:87], v[28:31]
    ds_read_b64_tr_b16 a[146:147], v67 offset:53248
    s_add_u32 m0, s49, 147456
    v_mfma_f32_16x16x32_bf16 v[60:63], a[172:175], a[92:95], v[60:63]
    ds_read_b64_tr_b16 a[148:149], v67 offset:57344
    s_add_u32 s12, s64, 1441792
    v_mfma_f32_16x16x32_bf16 v[60:63], a[168:171], a[88:91], v[60:63]
    ds_read_b64_tr_b16 a[150:151], v67 offset:61440
    s_waitcnt vmcnt(21) lgkmcnt(12)
    v_mfma_f32_16x16x32_bf16 v[0:3], a[176:179], a[96:99], v[0:3]
    ds_read_b64_tr_b16 a[152:153], v64 offset:51200
    s_addc_u32 s13, s65, 0
    v_mfma_f32_16x16x32_bf16 v[0:3], a[180:183], a[100:103], v[0:3]
    ds_read_b64_tr_b16 a[154:155], v64 offset:55296
    s_waitcnt vmcnt(8)
    s_mov_b32 s59, 0x20000
L_poll41:
    v_cmp_ne_u32 vcc, s33, v234
    s_cmp_eq_u64 vcc, 0
    s_cbranch_scc1 L_polldone41
    s_sub_u32 s59, s59, 1
    s_cbranch_scc1 L_polldone41
    buffer_load_dword v234, v233, s[16:19], s28 offen offset:64 sc1
    s_waitcnt vmcnt(0)
    s_branch L_poll41
L_polldone41:
    v_mfma_f32_16x16x32_bf16 v[32:35], a[180:183], a[108:111], v[32:35]
    ds_read_b64_tr_b16 a[156:157], v64 offset:59392
    buffer_load_dwordx4 v242, s[12:15], 0 offen offset:0 sc1 lds
    v_mfma_f32_16x16x32_bf16 v[32:35], a[176:179], a[104:107], v[32:35]
    ds_read_b64_tr_b16 a[158:159], v64 offset:63488
    s_waitcnt lgkmcnt(12)
    v_mfma_f32_16x16x32_bf16 v[4:7], a[128:131], a[96:99], v[4:7]
    ds_read_b64_tr_b16 a[160:161], v65 offset:51200
    buffer_load_dwordx4 v243, s[12:15], 0 offen offset:1024 sc1 lds
    v_mfma_f32_16x16x32_bf16 v[4:7], a[132:135], a[100:103], v[4:7]
    ds_read_b64_tr_b16 a[162:163], v65 offset:55296
    s_add_u32 s4, s68, 1024
    v_mfma_f32_16x16x32_bf16 v[36:39], a[132:135], a[108:111], v[36:39]
    ds_read_b64_tr_b16 a[164:165], v65 offset:59392
    s_addc_u32 s5, s69, 0
    v_mfma_f32_16x16x32_bf16 v[36:39], a[128:131], a[104:107], v[36:39]
    ds_read_b64_tr_b16 a[166:167], v65 offset:63488
    s_waitcnt lgkmcnt(12)
    v_mfma_f32_16x16x32_bf16 v[8:11], a[136:139], a[96:99], v[8:11]
    ds_read_b64_tr_b16 a[168:169], v66 offset:51200
    buffer_load_dwordx4 a[0:3], v224, s[4:7], 0 offen sc1
    v_mfma_f32_16x16x32_bf16 v[8:11], a[140:143], a[100:103], v[8:11]
    ds_read_b64_tr_b16 a[170:171], v66 offset:55296
    v_cmp_le_u32 s[56:57], 48, v255
    v_mfma_f32_16x16x32_bf16 v[40:43], a[140:143], a[108:111], v[40:43]
    ds_read_b64_tr_b16 a[172:173], v66 offset:59392
    v_lshlrev_b32 v78, 3, v255
    v_mfma_f32_16x16x32_bf16 v[40:43], a[136:139], a[104:107], v[40:43]
    ds_read_b64_tr_b16 a[174:175], v66 offset:63488
    s_waitcnt lgkmcnt(12)
    v_mfma_f32_16x16x32_bf16 v[12:15], a[144:147], a[96:99], v[12:15]
    ds_read_b64_tr_b16 a[176:177], v67 offset:51200
    buffer_load_dwordx4 a[8:11], v225, s[4:7], 0 offen sc1
    v_mfma_f32_16x16x32_bf16 v[12:15], a[148:151], a[100:103], v[12:15]
    ds_read_b64_tr_b16 a[178:179], v67 offset:55296
    v_add_u32 v76, 67108992, v78
    v_mfma_f32_16x16x32_bf16 v[44:47], a[148:151], a[108:111], v[44:47]
    ds_read_b64_tr_b16 a[180:181], v67 offset:59392
    v_cndmask_b32 v76, v78, v76, s[56:57]
    v_mfma_f32_16x16x32_bf16 v[44:47], a[144:147], a[104:107], v[44:47]
    ds_read_b64_tr_b16 a[182:183], v67 offset:63488
    s_waitcnt lgkmcnt(12)
    v_mfma_f32_16x16x32_bf16 v[16:19], a[152:155], a[96:99], v[16:19]
    s_waitcnt vmcnt(21)
    s_barrier
    ds_read_b64_tr_b16 a[128:129], v68 offset:0
    v_mfma_f32_16x16x32_bf16 v[16:19], a[156:159], a[100:103], v[16:19]
    ds_read_b64_tr_b16 a[130:131], v68 offset:4096
    buffer_load_dwordx4 a[4:7], v226, s[4:7], 0 offen sc1
    v_mfma_f32_16x16x32_bf16 v[48:51], a[156:159], a[108:111], v[48:51]
    ds_read_b64_tr_b16 a[132:133], v68 offset:8192
    v_add_u32 v79, 114688, v78
    v_mfma_f32_16x16x32_bf16 v[48:51], a[152:155], a[104:107], v[48:51]
    ds_read_b64_tr_b16 a[134:135], v68 offset:12288
    s_waitcnt lgkmcnt(12)
    v_mfma_f32_16x16x32_bf16 v[20:23], a[160:163], a[96:99], v[20:23]
    ds_read_b64_tr_b16 a[136:137], v69 offset:0
    buffer_load_dwordx4 a[12:15], v227, s[4:7], 0 offen sc1
    v_mfma_f32_16x16x32_bf16 v[20:23], a[164:167], a[100:103], v[20:23]
    ds_read_b64_tr_b16 a[138:139], v69 offset:4096
    s_add_u32 s4, s68, 8192
    v_mfma_f32_16x16x32_bf16 v[52:55], a[164:167], a[108:111], v[52:55]
    ds_read_b64_tr_b16 a[140:141], v69 offset:8192
    s_addc_u32 s5, s69, 0
    v_mfma_f32_16x16x32_bf16 v[52:55], a[160:163], a[104:107], v[52:55]
    ds_read_b64_tr_b16 a[142:143], v69 offset:12288
    s_waitcnt lgkmcnt(12)
    v_mfma_f32_16x16x32_bf16 v[24:27], a[168:171], a[96:99], v[24:27]
    ds_read_b64_tr_b16 a[144:145], v70 offset:0
    buffer_load_dwordx4 a[16:19], v224, s[4:7], 0 offen sc1
    v_mfma_f32_16x16x32_bf16 v[24:27], a[172:175], a[100:103], v[24:27]
    ds_read_b64_tr_b16 a[146:147], v70 offset:4096
    v_add_u32 v77, 114688, v76
    v_mfma_f32_16x16x32_bf16 v[56:59], a[172:175], a[108:111], v[56:59]
    ds_read_b64_tr_b16 a[148:149], v70 offset:8192
    v_accvgpr_read_b32 v244, a230
    v_mfma_f32_16x16x32_bf16 v[56:59], a[168:171], a[104:107], v[56:59]
    ds_read_b64_tr_b16 a[150:151], v70 offset:12288
    s_waitcnt lgkmcnt(12)
    v_mfma_f32_16x16x32_bf16 v[28:31], a[176:179], a[96:99], v[28:31]
    ds_read_b64_tr_b16 a[152:153], v71 offset:0
    buffer_load_dwordx4 a[24:27], v225, s[4:7], 0 offen sc1
    v_mfma_f32_16x16x32_bf16 v[28:31], a[180:183], a[100:103], v[28:31]
    ds_read_b64_tr_b16 a[154:155], v71 offset:4096
    v_accvgpr_read_b32 v245, a231
    v_mfma_f32_16x16x32_bf16 v[60:63], a[180:183], a[108:111], v[60:63]
    ds_read_b64_tr_b16 a[156:157], v71 offset:8192
    v_accvgpr_read_b32 v246, a232
    v_mfma_f32_16x16x32_bf16 v[60:63], a[176:179], a[104:107], v[60:63]
    ds_read_b64_tr_b16 a[158:159], v71 offset:12288
    s_waitcnt vmcnt(21) lgkmcnt(12)
    v_mfma_f32_16x16x32_bf16 v[0:3], a[128:131], a[112:115], v[0:3]
    ds_read_b64_tr_b16 a[160:161], v68 offset:2048
    buffer_load_dwordx4 a[20:23], v226, s[4:7], 0 offen sc1
    v_mfma_f32_16x16x32_bf16 v[0:3], a[132:135], a[116:119], v[0:3]
    ds_read_b64_tr_b16 a[162:163], v68 offset:6144
    v_mfma_f32_16x16x32_bf16 v[32:35], a[132:135], a[124:127], v[32:35]
    ds_read_b64_tr_b16 a[164:165], v68 offset:10240
    v_accvgpr_read_b32 v247, a233
    v_mfma_f32_16x16x32_bf16 v[32:35], a[128:131], a[120:123], v[32:35]
    ds_read_b64_tr_b16 a[166:167], v68 offset:14336
    s_waitcnt lgkmcnt(12)
    v_mfma_f32_16x16x32_bf16 v[4:7], a[136:139], a[112:115], v[4:7]
    ds_read_b64_tr_b16 a[168:169], v69 offset:2048
    buffer_load_dwordx4 a[28:31], v227, s[4:7], 0 offen sc1
    v_mfma_f32_16x16x32_bf16 v[4:7], a[140:143], a[116:119], v[4:7]
    ds_read_b64_tr_b16 a[170:171], v69 offset:6144
    s_add_u32 s4, s68, 15360
    v_mfma_f32_16x16x32_bf16 v[36:39], a[140:143], a[124:127], v[36:39]
    ds_read_b64_tr_b16 a[172:173], v69 offset:10240
    s_addc_u32 s5, s69, 0
    v_mfma_f32_16x16x32_bf16 v[36:39], a[136:139], a[120:123], v[36:39]
    ds_read_b64_tr_b16 a[174:175], v69 offset:14336
    s_waitcnt lgkmcnt(12)
    v_mfma_f32_16x16x32_bf16 v[8:11], a[144:147], a[112:115], v[8:11]
    ds_read_b64_tr_b16 a[176:177], v70 offset:2048
    buffer_load_dwordx4 a[32:35], v224, s[4:7], 0 offen sc1
    v_mfma_f32_16x16x32_bf16 v[8:11], a[148:151], a[116:119], v[8:11]
    ds_read_b64_tr_b16 a[178:179], v70 offset:6144
    v_accvgpr_read_b32 v248, a234
    v_mfma_f32_16x16x32_bf16 v[40:43], a[148:151], a[124:127], v[40:43]
    ds_read_b64_tr_b16 a[180:181], v70 offset:10240
    v_accvgpr_read_b32 v249, a235
    v_mfma_f32_16x16x32_bf16 v[40:43], a[144:147], a[120:123], v[40:43]
    ds_read_b64_tr_b16 a[182:183], v70 offset:14336
    s_waitcnt lgkmcnt(12)
    v_mfma_f32_16x16x32_bf16 v[12:15], a[152:155], a[112:115], v[12:15]
    ds_read_b64_tr_b16 a[128:129], v71 offset:2048
    buffer_load_dwordx4 a[40:43], v225, s[4:7], 0 offen sc1
    v_mfma_f32_16x16x32_bf16 v[12:15], a[156:159], a[116:119], v[12:15]
    ds_read_b64_tr_b16 a[130:131], v71 offset:6144
    s_mov_b32 s8, s78
    v_mfma_f32_16x16x32_bf16 v[44:47], a[156:159], a[124:127], v[44:47]
    ds_read_b64_tr_b16 a[132:133], v71 offset:10240
    s_mov_b32 s9, s79
    v_mfma_f32_16x16x32_bf16 v[44:47], a[152:155], a[120:123], v[44:47]
    ds_read_b64_tr_b16 a[134:135], v71 offset:14336
    s_waitcnt lgkmcnt(12)
    v_mfma_f32_16x16x32_bf16 v[16:19], a[160:163], a[112:115], v[16:19]
    s_waitcnt vmcnt(21)
    s_barrier
    ds_read_b64_tr_b16 a[136:137], v68 offset:16384
    v_mfma_f32_16x16x32_bf16 v[16:19], a[164:167], a[116:119], v[16:19]
    ds_read_b64_tr_b16 a[138:139], v68 offset:20480
    buffer_load_dwordx4 a[36:39], v226, s[4:7], 0 offen sc1
    v_mfma_f32_16x16x32_bf16 v[48:51], a[164:167], a[124:127], v[48:51]
    ds_read_b64_tr_b16 a[140:141], v68 offset:24576
    s_mov_b32 s10, 4194304
    v_mfma_f32_16x16x32_bf16 v[48:51], a[160:163], a[120:123], v[48:51]
    ds_read_b64_tr_b16 a[142:143], v68 offset:28672
    s_waitcnt lgkmcnt(12)
    v_mfma_f32_16x16x32_bf16 v[20:23], a[168:171], a[112:115], v[20:23]
    ds_read_b64_tr_b16 a[144:145], v69 offset:16384
    buffer_load_dwordx4 a[44:47], v227, s[4:7], 0 offen sc1
    v_mfma_f32_16x16x32_bf16 v[20:23], a[172:175], a[116:119], v[20:23]
    ds_read_b64_tr_b16 a[146:147], v69 offset:20480
    s_add_u32 m0, s49, 149504
    v_mfma_f32_16x16x32_bf16 v[52:55], a[172:175], a[124:127], v[52:55]
    ds_read_b64_tr_b16 a[148:149], v69 offset:24576
    s_add_u32 s84, s66, 1441792
    v_mfma_f32_16x16x32_bf16 v[52:55], a[168:171], a[120:123], v[52:55]
    ds_read_b64_tr_b16 a[150:151], v69 offset:28672
    s_waitcnt lgkmcnt(12)
    v_mfma_f32_16x16x32_bf16 v[24:27], a[176:179], a[112:115], v[24:27]
    ds_read_b64_tr_b16 a[152:153], v70 offset:16384
    s_addc_u32 s85, s67, 0
    v_mfma_f32_16x16x32_bf16 v[24:27], a[180:183], a[116:119], v[24:27]
    ds_read_b64_tr_b16 a[154:155], v70 offset:20480
    buffer_load_dwordx4 v242, s[84:87], 0 offen offset:0 sc1 lds
    v_mfma_f32_16x16x32_bf16 v[56:59], a[180:183], a[124:127], v[56:59]
    ds_read_b64_tr_b16 a[156:157], v70 offset:24576
    v_accvgpr_read_b32 v145, a240
    v_mfma_f32_16x16x32_bf16 v[56:59], a[176:179], a[120:123], v[56:59]
    ds_read_b64_tr_b16 a[158:159], v70 offset:28672
    s_waitcnt lgkmcnt(12)
    v_mfma_f32_16x16x32_bf16 v[28:31], a[128:131], a[112:115], v[28:31]
    ds_read_b64_tr_b16 a[160:161], v71 offset:16384
    buffer_load_dwordx4 v243, s[84:87], 0 offen offset:1024 sc1 lds
    v_mfma_f32_16x16x32_bf16 v[28:31], a[132:135], a[116:119], v[28:31]
    ds_read_b64_tr_b16 a[162:163], v71 offset:20480
    s_add_u32 s4, s68, 22528
    v_mfma_f32_16x16x32_bf16 v[60:63], a[132:135], a[124:127], v[60:63]
    ds_read_b64_tr_b16 a[164:165], v71 offset:24576
    s_addc_u32 s5, s69, 0
    v_mfma_f32_16x16x32_bf16 v[60:63], a[128:131], a[120:123], v[60:63]
    ds_read_b64_tr_b16 a[166:167], v71 offset:28672
    s_waitcnt vmcnt(10) lgkmcnt(12)
    v_mfma_f32_16x16x32_bf16 v[0:3], a[136:139], a[0:3], v[0:3]
    ds_read_b64_tr_b16 a[168:169], v68 offset:18432
    buffer_load_dwordx4 a[48:51], v224, s[4:7], 0 offen sc1
    v_mfma_f32_16x16x32_bf16 v[0:3], a[140:143], a[4:7], v[0:3]
    ds_read_b64_tr_b16 a[170:171], v68 offset:22528
    v_lshlrev_b32 v144, 16, v145
    v_mfma_f32_16x16x32_bf16 v[32:35], a[140:143], a[12:15], v[32:35]
    ds_read_b64_tr_b16 a[172:173], v68 offset:26624
    v_mfma_f32_16x16x32_bf16 v[32:35], a[136:139], a[8:11], v[32:35]
    ds_read_b64_tr_b16 a[174:175], v68 offset:30720
    s_waitcnt lgkmcnt(12)
    v_mfma_f32_16x16x32_bf16 v[4:7], a[144:147], a[0:3], v[4:7]
    ds_read_b64_tr_b16 a[176:177], v69 offset:18432
    buffer_load_dwordx4 a[56:59], v225, s[4:7], 0 offen sc1
    v_mfma_f32_16x16x32_bf16 v[4:7], a[148:151], a[4:7], v[4:7]
    ds_read_b64_tr_b16 a[178:179], v69 offset:22528
    v_and_b32 v145, 0xffff0000, v145
    v_mfma_f32_16x16x32_bf16 v[36:39], a[148:151], a[12:15], v[36:39]
    ds_read_b64_tr_b16 a[180:181], v69 offset:26624
    v_accvgpr_read_b32 v147, a241
    v_mfma_f32_16x16x32_bf16 v[36:39], a[144:147], a[8:11], v[36:39]
    ds_read_b64_tr_b16 a[182:183], v69 offset:30720
    s_waitcnt lgkmcnt(12)
    v_mfma_f32_16x16x32_bf16 v[8:11], a[152:155], a[0:3], v[8:11]
    ds_read_b64_tr_b16 a[128:129], v70 offset:18432
    buffer_load_dwordx4 a[52:55], v226, s[4:7], 0 offen sc1
    v_mfma_f32_16x16x32_bf16 v[8:11], a[156:159], a[4:7], v[8:11]
    ds_read_b64_tr_b16 a[130:131], v70 offset:22528
    v_lshlrev_b32 v146, 16, v147
    v_mfma_f32_16x16x32_bf16 v[40:43], a[156:159], a[12:15], v[40:43]
    ds_read_b64_tr_b16 a[132:133], v70 offset:26624
    v_and_b32 v147, 0xffff0000, v147
    v_mfma_f32_16x16x32_bf16 v[40:43], a[152:155], a[8:11], v[40:43]
    ds_read_b64_tr_b16 a[134:135], v70 offset:30720
    s_waitcnt lgkmcnt(12)
    v_mfma_f32_16x16x32_bf16 v[12:15], a[160:163], a[0:3], v[12:15]
    ds_read_b64_tr_b16 a[136:137], v71 offset:18432
    buffer_load_dwordx4 a[60:63], v227, s[4:7], 0 offen sc1
    v_mfma_f32_16x16x32_bf16 v[12:15], a[164:167], a[4:7], v[12:15]
    ds_read_b64_tr_b16 a[138:139], v71 offset:22528
    s_add_u32 m0, s49, 16384
    v_mfma_f32_16x16x32_bf16 v[44:47], a[164:167], a[12:15], v[44:47]
    ds_read_b64_tr_b16 a[140:141], v71 offset:26624
    s_add_u32 s12, s64, 1900544
    v_mfma_f32_16x16x32_bf16 v[44:47], a[160:163], a[8:11], v[44:47]
    ds_read_b64_tr_b16 a[142:143], v71 offset:30720
    s_waitcnt lgkmcnt(12)
    v_mfma_f32_16x16x32_bf16 v[16:19], a[168:171], a[0:3], v[16:19]
    s_waitcnt vmcnt(24)
    s_barrier
    ds_read_b64_tr_b16 a[144:145], v68 offset:32768
    v_mfma_f32_16x16x32_bf16 v[16:19], a[172:175], a[4:7], v[16:19]
    ds_read_b64_tr_b16 a[146:147], v68 offset:36864
    s_addc_u32 s13, s65, 0
    v_mfma_f32_16x16x32_bf16 v[48:51], a[172:175], a[12:15], v[48:51]
    ds_read_b64_tr_b16 a[148:149], v68 offset:40960
    buffer_load_dwordx4 v242, s[12:15], 0 offen offset:0 sc1 lds
    v_mfma_f32_16x16x32_bf16 v[48:51], a[168:171], a[8:11], v[48:51]
    ds_read_b64_tr_b16 a[150:151], v68 offset:45056
    s_waitcnt lgkmcnt(12)
    v_mfma_f32_16x16x32_bf16 v[20:23], a[176:179], a[0:3], v[20:23]
    ds_read_b64_tr_b16 a[152:153], v69 offset:32768
    buffer_load_dwordx4 v243, s[12:15], 0 offen offset:1024 sc1 lds
    v_mfma_f32_16x16x32_bf16 v[20:23], a[180:183], a[4:7], v[20:23]
    ds_read_b64_tr_b16 a[154:155], v69 offset:36864
    s_add_u32 m0, s49, 18432
    v_mfma_f32_16x16x32_bf16 v[52:55], a[180:183], a[12:15], v[52:55]
    ds_read_b64_tr_b16 a[156:157], v69 offset:40960
    s_add_u32 s84, s66, 1900544
    v_mfma_f32_16x16x32_bf16 v[52:55], a[176:179], a[8:11], v[52:55]
    ds_read_b64_tr_b16 a[158:159], v69 offset:45056
    s_waitcnt lgkmcnt(12)
    v_mfma_f32_16x16x32_bf16 v[24:27], a[128:131], a[0:3], v[24:27]
    ds_read_b64_tr_b16 a[160:161], v70 offset:32768
    s_addc_u32 s85, s67, 0
    v_mfma_f32_16x16x32_bf16 v[24:27], a[132:135], a[4:7], v[24:27]
    ds_read_b64_tr_b16 a[162:163], v70 offset:36864
    buffer_load_dwordx4 v242, s[84:87], 0 offen offset:0 sc1 lds
    v_mfma_f32_16x16x32_bf16 v[56:59], a[132:135], a[12:15], v[56:59]
    ds_read_b64_tr_b16 a[164:165], v70 offset:40960
    v_accvgpr_read_b32 v149, a242
    v_mfma_f32_16x16x32_bf16 v[56:59], a[128:131], a[8:11], v[56:59]
    ds_read_b64_tr_b16 a[166:167], v70 offset:45056
    s_waitcnt lgkmcnt(12)
    v_mfma_f32_16x16x32_bf16 v[28:31], a[136:139], a[0:3], v[28:31]
    ds_read_b64_tr_b16 a[168:169], v71 offset:32768
    buffer_load_dwordx4 v243, s[84:87], 0 offen offset:1024 sc1 lds
    v_mfma_f32_16x16x32_bf16 v[28:31], a[140:143], a[4:7], v[28:31]
    ds_read_b64_tr_b16 a[170:171], v71 offset:36864
    s_add_u32 s4, s68, 29696
    v_mfma_f32_16x16x32_bf16 v[60:63], a[140:143], a[12:15], v[60:63]
    ds_read_b64_tr_b16 a[172:173], v71 offset:40960
    s_addc_u32 s5, s69, 0
    v_mfma_f32_16x16x32_bf16 v[60:63], a[136:139], a[8:11], v[60:63]
    ds_read_b64_tr_b16 a[174:175], v71 offset:45056
    s_waitcnt vmcnt(14) lgkmcnt(12)
    v_mfma_f32_16x16x32_bf16 v[0:3], a[144:147], a[16:19], v[0:3]
    ds_read_b64_tr_b16 a[176:177], v68 offset:34816
    buffer_load_dwordx4 a[64:67], v224, s[4:7], 0 offen sc1
    v_mfma_f32_16x16x32_bf16 v[0:3], a[148:151], a[20:23], v[0:3]
    ds_read_b64_tr_b16 a[178:179], v68 offset:38912
    v_lshlrev_b32 v148, 16, v149
    v_mfma_f32_16x16x32_bf16 v[32:35], a[148:151], a[28:31], v[32:35]
    ds_read_b64_tr_b16 a[180:181], v68 offset:43008
    v_and_b32 v149, 0xffff0000, v149
    v_mfma_f32_16x16x32_bf16 v[32:35], a[144:147], a[24:27], v[32:35]
    ds_read_b64_tr_b16 a[182:183], v68 offset:47104
    s_waitcnt lgkmcnt(12)
    v_mfma_f32_16x16x32_bf16 v[4:7], a[152:155], a[16:19], v[4:7]
    ds_read_b64_tr_b16 a[128:129], v69 offset:34816
    buffer_load_dwordx4 a[72:75], v225, s[4:7], 0 offen sc1
    v_mfma_f32_16x16x32_bf16 v[4:7], a[156:159], a[20:23], v[4:7]
    ds_read_b64_tr_b16 a[130:131], v69 offset:38912
    v_accvgpr_read_b32 v151, a243
    v_mfma_f32_16x16x32_bf16 v[36:39], a[156:159], a[28:31], v[36:39]
    ds_read_b64_tr_b16 a[132:133], v69 offset:43008
    v_mfma_f32_16x16x32_bf16 v[36:39], a[152:155], a[24:27], v[36:39]
    ds_read_b64_tr_b16 a[134:135], v69 offset:47104
    s_waitcnt lgkmcnt(12)
    v_mfma_f32_16x16x32_bf16 v[8:11], a[160:163], a[16:19], v[8:11]
    ds_read_b64_tr_b16 a[136:137], v70 offset:34816
    buffer_load_dwordx4 a[68:71], v226, s[4:7], 0 offen sc1
    v_mfma_f32_16x16x32_bf16 v[8:11], a[164:167], a[20:23], v[8:11]
    ds_read_b64_tr_b16 a[138:139], v70 offset:38912
    v_lshlrev_b32 v150, 16, v151
    v_mfma_f32_16x16x32_bf16 v[40:43], a[164:167], a[28:31], v[40:43]
    ds_read_b64_tr_b16 a[140:141], v70 offset:43008
    v_and_b32 v151, 0xffff0000, v151
    v_mfma_f32_16x16x32_bf16 v[40:43], a[160:163], a[24:27], v[40:43]
    ds_read_b64_tr_b16 a[142:143], v70 offset:47104
    s_waitcnt lgkmcnt(12)
    v_mfma_f32_16x16x32_bf16 v[12:15], a[168:171], a[16:19], v[12:15]
    ds_read_b64_tr_b16 a[144:145], v71 offset:34816
    buffer_load_dwordx4 a[76:79], v227, s[4:7], 0 offen sc1
    v_mfma_f32_16x16x32_bf16 v[12:15], a[172:175], a[20:23], v[12:15]
    ds_read_b64_tr_b16 a[146:147], v71 offset:38912
    s_add_u32 m0, s49, 32768
    v_mfma_f32_16x16x32_bf16 v[44:47], a[172:175], a[28:31], v[44:47]
    ds_read_b64_tr_b16 a[148:149], v71 offset:43008
    s_add_u32 s12, s64, 2359296
    v_mfma_f32_16x16x32_bf16 v[44:47], a[168:171], a[24:27], v[44:47]
    ds_read_b64_tr_b16 a[150:151], v71 offset:47104
    s_waitcnt lgkmcnt(12)
    v_mfma_f32_16x16x32_bf16 v[16:19], a[176:179], a[16:19], v[16:19]
    s_waitcnt vmcnt(28)
    s_barrier
    ds_read_b64_tr_b16 a[152:153], v68 offset:49152
    v_mfma_f32_16x16x32_bf16 v[16:19], a[180:183], a[20:23], v[16:19]
    ds_read_b64_tr_b16 a[154:155], v68 offset:53248
    s_addc_u32 s13, s65, 0
    v_mfma_f32_16x16x32_bf16 v[48:51], a[180:183], a[28:31], v[48:51]
    ds_read_b64_tr_b16 a[156:157], v68 offset:57344
    buffer_load_dwordx4 v242, s[12:15], 0 offen offset:0 sc1 lds
    v_mfma_f32_16x16x32_bf16 v[48:51], a[176:179], a[24:27], v[48:51]
    ds_read_b64_tr_b16 a[158:159], v68 offset:61440
    s_waitcnt lgkmcnt(12)
    v_mfma_f32_16x16x32_bf16 v[20:23], a[128:131], a[16:19], v[20:23]
    ds_read_b64_tr_b16 a[160:161], v69 offset:49152
    buffer_load_dwordx4 v243, s[12:15], 0 offen offset:1024 sc1 lds
    v_mfma_f32_16x16x32_bf16 v[20:23], a[132:135], a[20:23], v[20:23]
    ds_read_b64_tr_b16 a[162:163], v69 offset:53248
    s_add_u32 m0, s49, 34816
    v_mfma_f32_16x16x32_bf16 v[52:55], a[132:135], a[28:31], v[52:55]
    ds_read_b64_tr_b16 a[164:165], v69 offset:57344
    s_add_u32 s84, s66, 2359296
    v_mfma_f32_16x16x32_bf16 v[52:55], a[128:131], a[24:27], v[52:55]
    ds_read_b64_tr_b16 a[166:167], v69 offset:61440
    s_waitcnt lgkmcnt(12)
    v_mfma_f32_16x16x32_bf16 v[24:27], a[136:139], a[16:19], v[24:27]
    ds_read_b64_tr_b16 a[168:169], v70 offset:49152
    s_addc_u32 s85, s67, 0
    v_mfma_f32_16x16x32_bf16 v[24:27], a[140:143], a[20:23], v[24:27]
    ds_read_b64_tr_b16 a[170:171], v70 offset:53248
    buffer_load_dwordx4 v242, s[84:87], 0 offen offset:0 sc1 lds
    v_mfma_f32_16x16x32_bf16 v[56:59], a[140:143], a[28:31], v[56:59]
    ds_read_b64_tr_b16 a[172:173], v70 offset:57344
    v_accvgpr_read_b32 v153, a244
    v_mfma_f32_16x16x32_bf16 v[56:59], a[136:139], a[24:27], v[56:59]
    ds_read_b64_tr_b16 a[174:175], v70 offset:61440
    s_waitcnt lgkmcnt(12)
    v_mfma_f32_16x16x32_bf16 v[28:31], a[144:147], a[16:19], v[28:31]
    ds_read_b64_tr_b16 a[176:177], v71 offset:49152
    buffer_load_dwordx4 v243, s[84:87], 0 offen offset:1024 sc1 lds
    v_mfma_f32_16x16x32_bf16 v[28:31], a[148:151], a[20:23], v[28:31]
    ds_read_b64_tr_b16 a[178:179], v71 offset:53248
    s_add_u32 s4, s68, 36864
    v_mfma_f32_16x16x32_bf16 v[60:63], a[148:151], a[28:31], v[60:63]
    ds_read_b64_tr_b16 a[180:181], v71 offset:57344
    s_addc_u32 s5, s69, 0
    v_mfma_f32_16x16x32_bf16 v[60:63], a[144:147], a[24:27], v[60:63]
    ds_read_b64_tr_b16 a[182:183], v71 offset:61440
    s_waitcnt vmcnt(18) lgkmcnt(12)
    v_mfma_f32_16x16x32_bf16 v[0:3], a[152:155], a[32:35], v[0:3]
    ds_read_b64_tr_b16 a[128:129], v68 offset:51200
    buffer_load_dwordx4 a[80:83], v224, s[4:7], 0 offen sc1
    v_mfma_f32_16x16x32_bf16 v[0:3], a[156:159], a[36:39], v[0:3]
    ds_read_b64_tr_b16 a[130:131], v68 offset:55296
    v_lshlrev_b32 v152, 16, v153
    v_mfma_f32_16x16x32_bf16 v[32:35], a[156:159], a[44:47], v[32:35]
    ds_read_b64_tr_b16 a[132:133], v68 offset:59392
    v_and_b32 v153, 0xffff0000, v153
    v_mfma_f32_16x16x32_bf16 v[32:35], a[152:155], a[40:43], v[32:35]
    ds_read_b64_tr_b16 a[134:135], v68 offset:63488
    s_waitcnt lgkmcnt(12)
    v_mfma_f32_16x16x32_bf16 v[4:7], a[160:163], a[32:35], v[4:7]
    ds_read_b64_tr_b16 a[136:137], v69 offset:51200
    buffer_load_dwordx4 a[88:91], v225, s[4:7], 0 offen sc1
    v_mfma_f32_16x16x32_bf16 v[4:7], a[164:167], a[36:39], v[4:7]
    ds_read_b64_tr_b16 a[138:139], v69 offset:55296
    v_accvgpr_read_b32 v155, a245
    v_mfma_f32_16x16x32_bf16 v[36:39], a[164:167], a[44:47], v[36:39]
    ds_read_b64_tr_b16 a[140:141], v69 offset:59392
    v_lshlrev_b32 v154, 16, v155
    v_mfma_f32_16x16x32_bf16 v[36:39], a[160:163], a[40:43], v[36:39]
    ds_read_b64_tr_b16 a[142:143], v69 offset:63488
    s_waitcnt lgkmcnt(12)
    v_mfma_f32_16x16x32_bf16 v[8:11], a[168:171], a[32:35], v[8:11]
    ds_read_b64_tr_b16 a[144:145], v70 offset:51200
    buffer_load_dwordx4 a[84:87], v226, s[4:7], 0 offen sc1
    v_mfma_f32_16x16x32_bf16 v[8:11], a[172:175], a[36:39], v[8:11]
    ds_read_b64_tr_b16 a[146:147], v70 offset:55296
    v_and_b32 v155, 0xffff0000, v155
    v_mfma_f32_16x16x32_bf16 v[40:43], a[172:175], a[44:47], v[40:43]
    ds_read_b64_tr_b16 a[148:149], v70 offset:59392
    v_mfma_f32_16x16x32_bf16 v[40:43], a[168:171], a[40:43], v[40:43]
    ds_read_b64_tr_b16 a[150:151], v70 offset:63488
    s_waitcnt lgkmcnt(12)
    v_mfma_f32_16x16x32_bf16 v[12:15], a[176:179], a[32:35], v[12:15]
    ds_read_b64_tr_b16 a[152:153], v71 offset:51200
    buffer_load_dwordx4 a[92:95], v227, s[4:7], 0 offen sc1
    v_mfma_f32_16x16x32_bf16 v[12:15], a[180:183], a[36:39], v[12:15]
    ds_read_b64_tr_b16 a[154:155], v71 offset:55296
    s_add_u32 m0, s49, 49152
    v_mfma_f32_16x16x32_bf16 v[44:47], a[180:183], a[44:47], v[44:47]
    ds_read_b64_tr_b16 a[156:157], v71 offset:59392
    s_add_u32 s12, s64, 2818048
    v_mfma_f32_16x16x32_bf16 v[44:47], a[176:179], a[40:43], v[44:47]
    ds_read_b64_tr_b16 a[158:159], v71 offset:63488
    s_waitcnt lgkmcnt(12)
    v_mfma_f32_16x16x32_bf16 v[16:19], a[128:131], a[32:35], v[16:19]
    s_waitcnt vmcnt(20)
    s_barrier
    ds_read_b64_tr_b16 a[160:161], v72 offset:0
    v_mfma_f32_16x16x32_bf16 v[16:19], a[132:135], a[36:39], v[16:19]
    ds_read_b64_tr_b16 a[162:163], v72 offset:4096
    s_addc_u32 s13, s65, 0
    v_mfma_f32_16x16x32_bf16 v[48:51], a[132:135], a[44:47], v[48:51]
    ds_read_b64_tr_b16 a[164:165], v72 offset:8192
    buffer_load_dwordx4 v242, s[12:15], 0 offen offset:0 sc1 lds
    v_mfma_f32_16x16x32_bf16 v[48:51], a[128:131], a[40:43], v[48:51]
    ds_read_b64_tr_b16 a[166:167], v72 offset:12288
    s_waitcnt lgkmcnt(12)
    v_mfma_f32_16x16x32_bf16 v[20:23], a[136:139], a[32:35], v[20:23]
    ds_read_b64_tr_b16 a[168:169], v73 offset:0
    buffer_load_dwordx4 v243, s[12:15], 0 offen offset:1024 sc1 lds
    v_mfma_f32_16x16x32_bf16 v[20:23], a[140:143], a[36:39], v[20:23]
    ds_read_b64_tr_b16 a[170:171], v73 offset:4096
    s_add_u32 m0, s49, 51200
    v_mfma_f32_16x16x32_bf16 v[52:55], a[140:143], a[44:47], v[52:55]
    ds_read_b64_tr_b16 a[172:173], v73 offset:8192
    s_add_u32 s84, s66, 2818048
    v_mfma_f32_16x16x32_bf16 v[52:55], a[136:139], a[40:43], v[52:55]
    ds_read_b64_tr_b16 a[174:175], v73 offset:12288
    s_waitcnt lgkmcnt(12)
    v_mfma_f32_16x16x32_bf16 v[24:27], a[144:147], a[32:35], v[24:27]
    ds_read_b64_tr_b16 a[176:177], v74 offset:0
    s_addc_u32 s85, s67, 0
    v_mfma_f32_16x16x32_bf16 v[24:27], a[148:151], a[36:39], v[24:27]
    ds_read_b64_tr_b16 a[178:179], v74 offset:4096
    buffer_load_dwordx4 v242, s[84:87], 0 offen offset:0 sc1 lds
    v_mfma_f32_16x16x32_bf16 v[56:59], a[148:151], a[44:47], v[56:59]
    ds_read_b64_tr_b16 a[180:181], v74 offset:8192
    v_accvgpr_read_b32 v157, a246
    v_mfma_f32_16x16x32_bf16 v[56:59], a[144:147], a[40:43], v[56:59]
    ds_read_b64_tr_b16 a[182:183], v74 offset:12288
    s_waitcnt lgkmcnt(12)
    v_mfma_f32_16x16x32_bf16 v[28:31], a[152:155], a[32:35], v[28:31]
    ds_read_b64_tr_b16 a[128:129], v75 offset:0
    buffer_load_dwordx4 v243, s[84:87], 0 offen offset:1024 sc1 lds
    v_mfma_f32_16x16x32_bf16 v[28:31], a[156:159], a[36:39], v[28:31]
    ds_read_b64_tr_b16 a[130:131], v75 offset:4096
    s_add_u32 s4, s68, 44032
    v_mfma_f32_16x16x32_bf16 v[60:63], a[156:159], a[44:47], v[60:63]
    ds_read_b64_tr_b16 a[132:133], v75 offset:8192
    s_addc_u32 s5, s69, 0
    v_mfma_f32_16x16x32_bf16 v[60:63], a[152:155], a[40:43], v[60:63]
    ds_read_b64_tr_b16 a[134:135], v75 offset:12288
    s_waitcnt vmcnt(20) lgkmcnt(12)
    v_mfma_f32_16x16x32_bf16 v[0:3], a[160:163], a[48:51], v[0:3]
    ds_read_b64_tr_b16 a[136:137], v72 offset:2048
    buffer_load_dwordx4 a[96:99], v224, s[4:7], 0 offen sc1
    v_mfma_f32_16x16x32_bf16 v[0:3], a[164:167], a[52:55], v[0:3]
    ds_read_b64_tr_b16 a[138:139], v72 offset:6144
    v_lshlrev_b32 v156, 16, v157
    v_mfma_f32_16x16x32_bf16 v[32:35], a[164:167], a[60:63], v[32:35]
    ds_read_b64_tr_b16 a[140:141], v72 offset:10240
    v_and_b32 v157, 0xffff0000, v157
    v_mfma_f32_16x16x32_bf16 v[32:35], a[160:163], a[56:59], v[32:35]
    ds_read_b64_tr_b16 a[142:143], v72 offset:14336
    s_waitcnt lgkmcnt(12)
    v_mfma_f32_16x16x32_bf16 v[4:7], a[168:171], a[48:51], v[4:7]
    ds_read_b64_tr_b16 a[144:145], v73 offset:2048
    buffer_load_dwordx4 a[104:107], v225, s[4:7], 0 offen sc1
    v_mfma_f32_16x16x32_bf16 v[4:7], a[172:175], a[52:55], v[4:7]
    ds_read_b64_tr_b16 a[146:147], v73 offset:6144
    v_accvgpr_read_b32 v159, a247
    v_mfma_f32_16x16x32_bf16 v[36:39], a[172:175], a[60:63], v[36:39]
    ds_read_b64_tr_b16 a[148:149], v73 offset:10240
    v_lshlrev_b32 v158, 16, v159
    v_mfma_f32_16x16x32_bf16 v[36:39], a[168:171], a[56:59], v[36:39]
    ds_read_b64_tr_b16 a[150:151], v73 offset:14336
    s_waitcnt lgkmcnt(12)
    v_mfma_f32_16x16x32_bf16 v[8:11], a[176:179], a[48:51], v[8:11]
    ds_read_b64_tr_b16 a[152:153], v74 offset:2048
    buffer_load_dwordx4 a[100:103], v226, s[4:7], 0 offen sc1
    v_mfma_f32_16x16x32_bf16 v[8:11], a[180:183], a[52:55], v[8:11]
    ds_read_b64_tr_b16 a[154:155], v74 offset:6144
    v_and_b32 v159, 0xffff0000, v159
    v_mfma_f32_16x16x32_bf16 v[40:43], a[180:183], a[60:63], v[40:43]
    ds_read_b64_tr_b16 a[156:157], v74 offset:10240
    v_accvgpr_read_b32 v161, a248
    v_mfma_f32_16x16x32_bf16 v[40:43], a[176:179], a[56:59], v[40:43]
    ds_read_b64_tr_b16 a[158:159], v74 offset:14336
    s_waitcnt lgkmcnt(12)
    v_mfma_f32_16x16x32_bf16 v[12:15], a[128:131], a[48:51], v[12:15]
    ds_read_b64_tr_b16 a[160:161], v75 offset:2048
    buffer_load_dwordx4 a[108:111], v227, s[4:7], 0 offen sc1
    v_mfma_f32_16x16x32_bf16 v[12:15], a[132:135], a[52:55], v[12:15]
    ds_read_b64_tr_b16 a[162:163], v75 offset:6144
    s_add_u32 m0, s49, 65536
    v_mfma_f32_16x16x32_bf16 v[44:47], a[132:135], a[60:63], v[44:47]
    ds_read_b64_tr_b16 a[164:165], v75 offset:10240
    s_add_u32 s12, s64, 3276800
    v_mfma_f32_16x16x32_bf16 v[44:47], a[128:131], a[56:59], v[44:47]
    ds_read_b64_tr_b16 a[166:167], v75 offset:14336
    s_waitcnt lgkmcnt(12)
    v_mfma_f32_16x16x32_bf16 v[16:19], a[136:139], a[48:51], v[16:19]
    s_waitcnt vmcnt(20)
    s_barrier
    ds_read_b64_tr_b16 a[168:169], v64 offset:0
    v_mfma_f32_16x16x32_bf16 v[16:19], a[140:143], a[52:55], v[16:19]
    ds_read_b64_tr_b16 a[170:171], v64 offset:4096
    s_addc_u32 s13, s65, 0
    v_mfma_f32_16x16x32_bf16 v[48:51], a[140:143], a[60:63], v[48:51]
    ds_read_b64_tr_b16 a[172:173], v64 offset:8192
    buffer_load_dwordx4 v242, s[12:15], 0 offen offset:0 sc1 lds
    v_mfma_f32_16x16x32_bf16 v[48:51], a[136:139], a[56:59], v[48:51]
    ds_read_b64_tr_b16 a[174:175], v64 offset:12288
    s_waitcnt lgkmcnt(12)
    v_mfma_f32_16x16x32_bf16 v[20:23], a[144:147], a[48:51], v[20:23]
    ds_read_b64_tr_b16 a[176:177], v65 offset:0
    buffer_load_dwordx4 v243, s[12:15], 0 offen offset:1024 sc1 lds
    v_mfma_f32_16x16x32_bf16 v[20:23], a[148:151], a[52:55], v[20:23]
    ds_read_b64_tr_b16 a[178:179], v65 offset:4096
    s_add_u32 m0, s49, 67584
    v_mfma_f32_16x16x32_bf16 v[52:55], a[148:151], a[60:63], v[52:55]
    ds_read_b64_tr_b16 a[180:181], v65 offset:8192
    s_add_u32 s84, s66, 3276800
    v_mfma_f32_16x16x32_bf16 v[52:55], a[144:147], a[56:59], v[52:55]
    ds_read_b64_tr_b16 a[182:183], v65 offset:12288
    s_waitcnt lgkmcnt(12)
    v_mfma_f32_16x16x32_bf16 v[24:27], a[152:155], a[48:51], v[24:27]
    ds_read_b64_tr_b16 a[128:129], v66 offset:0
    s_addc_u32 s85, s67, 0
    v_mfma_f32_16x16x32_bf16 v[24:27], a[156:159], a[52:55], v[24:27]
    ds_read_b64_tr_b16 a[130:131], v66 offset:4096
    buffer_load_dwordx4 v242, s[84:87], 0 offen offset:0 sc1 lds
    v_mfma_f32_16x16x32_bf16 v[56:59], a[156:159], a[60:63], v[56:59]
    ds_read_b64_tr_b16 a[132:133], v66 offset:8192
    v_lshlrev_b32 v160, 16, v161
    v_mfma_f32_16x16x32_bf16 v[56:59], a[152:155], a[56:59], v[56:59]
    ds_read_b64_tr_b16 a[134:135], v66 offset:12288
    s_waitcnt lgkmcnt(12)
    v_mfma_f32_16x16x32_bf16 v[28:31], a[160:163], a[48:51], v[28:31]
    ds_read_b64_tr_b16 a[136:137], v67 offset:0
    buffer_load_dwordx4 v243, s[84:87], 0 offen offset:1024 sc1 lds
    v_mfma_f32_16x16x32_bf16 v[28:31], a[164:167], a[52:55], v[28:31]
    ds_read_b64_tr_b16 a[138:139], v67 offset:4096
    s_add_u32 s4, s68, 51200
    v_mfma_f32_16x16x32_bf16 v[60:63], a[164:167], a[60:63], v[60:63]
    ds_read_b64_tr_b16 a[140:141], v67 offset:8192
    s_addc_u32 s5, s69, 0
    v_mfma_f32_16x16x32_bf16 v[60:63], a[160:163], a[56:59], v[60:63]
    ds_read_b64_tr_b16 a[142:143], v67 offset:12288
    s_waitcnt vmcnt(20) lgkmcnt(12)
    v_mfma_f32_16x16x32_bf16 v[0:3], a[168:171], a[64:67], v[0:3]
    ds_read_b64_tr_b16 a[144:145], v64 offset:2048
    buffer_load_dwordx4 a[112:115], v224, s[4:7], 0 offen sc1
    v_mfma_f32_16x16x32_bf16 v[0:3], a[172:175], a[68:71], v[0:3]
    ds_read_b64_tr_b16 a[146:147], v64 offset:6144
    v_mfma_f32_16x16x32_bf16 v[32:35], a[172:175], a[76:79], v[32:35]
    ds_read_b64_tr_b16 a[148:149], v64 offset:10240
    v_and_b32 v161, 0xffff0000, v161
    v_mfma_f32_16x16x32_bf16 v[32:35], a[168:171], a[72:75], v[32:35]
    ds_read_b64_tr_b16 a[150:151], v64 offset:14336
    s_waitcnt lgkmcnt(12)
    v_mfma_f32_16x16x32_bf16 v[4:7], a[176:179], a[64:67], v[4:7]
    ds_read_b64_tr_b16 a[152:153], v65 offset:2048
    buffer_load_dwordx4 a[120:123], v225, s[4:7], 0 offen sc1
    v_mfma_f32_16x16x32_bf16 v[4:7], a[180:183], a[68:71], v[4:7]
    ds_read_b64_tr_b16 a[154:155], v65 offset:6144
    v_accvgpr_read_b32 v163, a249
    v_mfma_f32_16x16x32_bf16 v[36:39], a[180:183], a[76:79], v[36:39]
    ds_read_b64_tr_b16 a[156:157], v65 offset:10240
    v_lshlrev_b32 v162, 16, v163
    v_mfma_f32_16x16x32_bf16 v[36:39], a[176:179], a[72:75], v[36:39]
    ds_read_b64_tr_b16 a[158:159], v65 offset:14336
    s_waitcnt lgkmcnt(12)
    v_mfma_f32_16x16x32_bf16 v[8:11], a[128:131], a[64:67], v[8:11]
    ds_read_b64_tr_b16 a[160:161], v66 offset:2048
    buffer_load_dwordx4 a[116:119], v226, s[4:7], 0 offen sc1
    v_mfma_f32_16x16x32_bf16 v[8:11], a[132:135], a[68:71], v[8:11]
    ds_read_b64_tr_b16 a[162:163], v66 offset:6144
    v_and_b32 v163, 0xffff0000, v163
    v_mfma_f32_16x16x32_bf16 v[40:43], a[132:135], a[76:79], v[40:43]
    ds_read_b64_tr_b16 a[164:165], v66 offset:10240
    v_accvgpr_read_b32 v165, a250
    v_mfma_f32_16x16x32_bf16 v[40:43], a[128:131], a[72:75], v[40:43]
    ds_read_b64_tr_b16 a[166:167], v66 offset:14336
    s_waitcnt lgkmcnt(12)
    v_mfma_f32_16x16x32_bf16 v[12:15], a[136:139], a[64:67], v[12:15]
    ds_read_b64_tr_b16 a[168:169], v67 offset:2048
    buffer_load_dwordx4 a[124:127], v227, s[4:7], 0 offen sc1
    v_mfma_f32_16x16x32_bf16 v[12:15], a[140:143], a[68:71], v[12:15]
    ds_read_b64_tr_b16 a[170:171], v67 offset:6144
    s_add_u32 m0, s49, 81920
    v_mfma_f32_16x16x32_bf16 v[44:47], a[140:143], a[76:79], v[44:47]
    ds_read_b64_tr_b16 a[172:173], v67 offset:10240
    s_add_u32 s12, s64, 131072
    v_mfma_f32_16x16x32_bf16 v[44:47], a[136:139], a[72:75], v[44:47]
    ds_read_b64_tr_b16 a[174:175], v67 offset:14336
    s_waitcnt lgkmcnt(12)
    v_mfma_f32_16x16x32_bf16 v[16:19], a[144:147], a[64:67], v[16:19]
    s_waitcnt vmcnt(20)
    s_barrier
    ds_read_b64_tr_b16 a[176:177], v64 offset:16384
    v_mfma_f32_16x16x32_bf16 v[16:19], a[148:151], a[68:71], v[16:19]
    ds_read_b64_tr_b16 a[178:179], v64 offset:20480
    s_addc_u32 s13, s65, 0
    v_mfma_f32_16x16x32_bf16 v[48:51], a[148:151], a[76:79], v[48:51]
    ds_read_b64_tr_b16 a[180:181], v64 offset:24576
    buffer_load_dwordx4 v242, s[12:15], 0 offen offset:0 sc1 lds
    v_mfma_f32_16x16x32_bf16 v[48:51], a[144:147], a[72:75], v[48:51]
    ds_read_b64_tr_b16 a[182:183], v64 offset:28672
    s_waitcnt lgkmcnt(12)
    v_mfma_f32_16x16x32_bf16 v[20:23], a[152:155], a[64:67], v[20:23]
    ds_read_b64_tr_b16 a[128:129], v65 offset:16384
    buffer_load_dwordx4 v243, s[12:15], 0 offen offset:1024 sc1 lds
    v_mfma_f32_16x16x32_bf16 v[20:23], a[156:159], a[68:71], v[20:23]
    ds_read_b64_tr_b16 a[130:131], v65 offset:20480
    s_add_u32 m0, s49, 83968
    v_mfma_f32_16x16x32_bf16 v[52:55], a[156:159], a[76:79], v[52:55]
    ds_read_b64_tr_b16 a[132:133], v65 offset:24576
    s_add_u32 s84, s66, 131072
    v_mfma_f32_16x16x32_bf16 v[52:55], a[152:155], a[72:75], v[52:55]
    ds_read_b64_tr_b16 a[134:135], v65 offset:28672
    s_waitcnt lgkmcnt(12)
    v_mfma_f32_16x16x32_bf16 v[24:27], a[160:163], a[64:67], v[24:27]
    ds_read_b64_tr_b16 a[136:137], v66 offset:16384
    s_addc_u32 s85, s67, 0
    v_mfma_f32_16x16x32_bf16 v[24:27], a[164:167], a[68:71], v[24:27]
    ds_read_b64_tr_b16 a[138:139], v66 offset:20480
    buffer_load_dwordx4 v242, s[84:87], 0 offen offset:0 sc1 lds
    v_mfma_f32_16x16x32_bf16 v[56:59], a[164:167], a[76:79], v[56:59]
    ds_read_b64_tr_b16 a[140:141], v66 offset:24576
    v_lshlrev_b32 v164, 16, v165
    v_mfma_f32_16x16x32_bf16 v[56:59], a[160:163], a[72:75], v[56:59]
    ds_read_b64_tr_b16 a[142:143], v66 offset:28672
    s_waitcnt lgkmcnt(12)
    v_mfma_f32_16x16x32_bf16 v[28:31], a[168:171], a[64:67], v[28:31]
    ds_read_b64_tr_b16 a[144:145], v67 offset:16384
    buffer_load_dwordx4 v243, s[84:87], 0 offen offset:1024 sc1 lds
    v_mfma_f32_16x16x32_bf16 v[28:31], a[172:175], a[68:71], v[28:31]
    ds_read_b64_tr_b16 a[146:147], v67 offset:20480
    s_add_u32 s4, s68, 2048
    v_mfma_f32_16x16x32_bf16 v[60:63], a[172:175], a[76:79], v[60:63]
    ds_read_b64_tr_b16 a[148:149], v67 offset:24576
    s_addc_u32 s5, s69, 0
    v_mfma_f32_16x16x32_bf16 v[60:63], a[168:171], a[72:75], v[60:63]
    ds_read_b64_tr_b16 a[150:151], v67 offset:28672
    s_waitcnt vmcnt(20) lgkmcnt(12)
    v_mfma_f32_16x16x32_bf16 v[0:3], a[176:179], a[80:83], v[0:3]
    ds_read_b64_tr_b16 a[152:153], v64 offset:18432
    buffer_load_dwordx4 a[0:3], v224, s[4:7], 0 offen sc1
    v_mfma_f32_16x16x32_bf16 v[0:3], a[180:183], a[84:87], v[0:3]
    ds_read_b64_tr_b16 a[154:155], v64 offset:22528
    v_and_b32 v165, 0xffff0000, v165
    v_mfma_f32_16x16x32_bf16 v[32:35], a[180:183], a[92:95], v[32:35]
    ds_read_b64_tr_b16 a[156:157], v64 offset:26624
    v_accvgpr_read_b32 v167, a251
    v_mfma_f32_16x16x32_bf16 v[32:35], a[176:179], a[88:91], v[32:35]
    ds_read_b64_tr_b16 a[158:159], v64 offset:30720
    s_waitcnt lgkmcnt(12)
    v_mfma_f32_16x16x32_bf16 v[4:7], a[128:131], a[80:83], v[4:7]
    ds_read_b64_tr_b16 a[160:161], v65 offset:18432
    buffer_load_dwordx4 a[8:11], v225, s[4:7], 0 offen sc1
    v_mfma_f32_16x16x32_bf16 v[4:7], a[132:135], a[84:87], v[4:7]
    ds_read_b64_tr_b16 a[162:163], v65 offset:22528
    v_mfma_f32_16x16x32_bf16 v[36:39], a[132:135], a[92:95], v[36:39]
    ds_read_b64_tr_b16 a[164:165], v65 offset:26624
    v_lshlrev_b32 v166, 16, v167
    v_mfma_f32_16x16x32_bf16 v[36:39], a[128:131], a[88:91], v[36:39]
    ds_read_b64_tr_b16 a[166:167], v65 offset:30720
    s_waitcnt lgkmcnt(12)
    v_mfma_f32_16x16x32_bf16 v[8:11], a[136:139], a[80:83], v[8:11]
    ds_read_b64_tr_b16 a[168:169], v66 offset:18432
    buffer_load_dwordx4 a[4:7], v226, s[4:7], 0 offen sc1
    v_mfma_f32_16x16x32_bf16 v[8:11], a[140:143], a[84:87], v[8:11]
    ds_read_b64_tr_b16 a[170:171], v66 offset:22528
    v_and_b32 v167, 0xffff0000, v167
    v_mfma_f32_16x16x32_bf16 v[40:43], a[140:143], a[92:95], v[40:43]
    ds_read_b64_tr_b16 a[172:173], v66 offset:26624
    v_accvgpr_read_b32 v169, a252
    v_mfma_f32_16x16x32_bf16 v[40:43], a[136:139], a[88:91], v[40:43]
    ds_read_b64_tr_b16 a[174:175], v66 offset:30720
    s_waitcnt lgkmcnt(12)
    v_mfma_f32_16x16x32_bf16 v[12:15], a[144:147], a[80:83], v[12:15]
    ds_read_b64_tr_b16 a[176:177], v67 offset:18432
    buffer_load_dwordx4 a[12:15], v227, s[4:7], 0 offen sc1
    v_mfma_f32_16x16x32_bf16 v[12:15], a[148:151], a[84:87], v[12:15]
    ds_read_b64_tr_b16 a[178:179], v67 offset:22528
    s_add_u32 m0, s49, 98304
    v_mfma_f32_16x16x32_bf16 v[44:47], a[148:151], a[92:95], v[44:47]
    ds_read_b64_tr_b16 a[180:181], v67 offset:26624
    s_add_u32 s12, s64, 589824
    v_mfma_f32_16x16x32_bf16 v[44:47], a[144:147], a[88:91], v[44:47]
    ds_read_b64_tr_b16 a[182:183], v67 offset:30720
    s_waitcnt lgkmcnt(12)
    v_mfma_f32_16x16x32_bf16 v[16:19], a[152:155], a[80:83], v[16:19]
    s_waitcnt vmcnt(20)
    s_barrier
    ds_read_b64_tr_b16 a[128:129], v64 offset:32768
    v_mfma_f32_16x16x32_bf16 v[16:19], a[156:159], a[84:87], v[16:19]
    ds_read_b64_tr_b16 a[130:131], v64 offset:36864
    s_addc_u32 s13, s65, 0
    v_mfma_f32_16x16x32_bf16 v[48:51], a[156:159], a[92:95], v[48:51]
    ds_read_b64_tr_b16 a[132:133], v64 offset:40960
    buffer_load_dwordx4 v242, s[12:15], 0 offen offset:0 sc1 lds
    v_mfma_f32_16x16x32_bf16 v[48:51], a[152:155], a[88:91], v[48:51]
    ds_read_b64_tr_b16 a[134:135], v64 offset:45056
    s_waitcnt lgkmcnt(12)
    v_mfma_f32_16x16x32_bf16 v[20:23], a[160:163], a[80:83], v[20:23]
    ds_read_b64_tr_b16 a[136:137], v65 offset:32768
    buffer_load_dwordx4 v243, s[12:15], 0 offen offset:1024 sc1 lds
    v_mfma_f32_16x16x32_bf16 v[20:23], a[164:167], a[84:87], v[20:23]
    ds_read_b64_tr_b16 a[138:139], v65 offset:36864
    s_add_u32 m0, s49, 100352
    v_mfma_f32_16x16x32_bf16 v[52:55], a[164:167], a[92:95], v[52:55]
    ds_read_b64_tr_b16 a[140:141], v65 offset:40960
    s_add_u32 s84, s66, 589824
    v_mfma_f32_16x16x32_bf16 v[52:55], a[160:163], a[88:91], v[52:55]
    ds_read_b64_tr_b16 a[142:143], v65 offset:45056
    s_waitcnt lgkmcnt(12)
    v_mfma_f32_16x16x32_bf16 v[24:27], a[168:171], a[80:83], v[24:27]
    ds_read_b64_tr_b16 a[144:145], v66 offset:32768
    s_addc_u32 s85, s67, 0
    v_mfma_f32_16x16x32_bf16 v[24:27], a[172:175], a[84:87], v[24:27]
    ds_read_b64_tr_b16 a[146:147], v66 offset:36864
    buffer_load_dwordx4 v242, s[84:87], 0 offen offset:0 sc1 lds
    v_mfma_f32_16x16x32_bf16 v[56:59], a[172:175], a[92:95], v[56:59]
    ds_read_b64_tr_b16 a[148:149], v66 offset:40960
    v_lshlrev_b32 v168, 16, v169
    v_mfma_f32_16x16x32_bf16 v[56:59], a[168:171], a[88:91], v[56:59]
    ds_read_b64_tr_b16 a[150:151], v66 offset:45056
    s_waitcnt lgkmcnt(12)
    v_mfma_f32_16x16x32_bf16 v[28:31], a[176:179], a[80:83], v[28:31]
    ds_read_b64_tr_b16 a[152:153], v67 offset:32768
    buffer_load_dwordx4 v243, s[84:87], 0 offen offset:1024 sc1 lds
    v_mfma_f32_16x16x32_bf16 v[28:31], a[180:183], a[84:87], v[28:31]
    ds_read_b64_tr_b16 a[154:155], v67 offset:36864
    s_add_u32 s4, s68, 9216
    v_mfma_f32_16x16x32_bf16 v[60:63], a[180:183], a[92:95], v[60:63]
    ds_read_b64_tr_b16 a[156:157], v67 offset:40960
    s_addc_u32 s5, s69, 0
    v_mfma_f32_16x16x32_bf16 v[60:63], a[176:179], a[88:91], v[60:63]
    ds_read_b64_tr_b16 a[158:159], v67 offset:45056
    s_waitcnt vmcnt(20) lgkmcnt(12)
    v_mfma_f32_16x16x32_bf16 v[0:3], a[128:131], a[96:99], v[0:3]
    ds_read_b64_tr_b16 a[160:161], v64 offset:34816
    buffer_load_dwordx4 a[16:19], v224, s[4:7], 0 offen sc1
    v_mfma_f32_16x16x32_bf16 v[0:3], a[132:135], a[100:103], v[0:3]
    ds_read_b64_tr_b16 a[162:163], v64 offset:38912
    v_and_b32 v169, 0xffff0000, v169
    v_mfma_f32_16x16x32_bf16 v[32:35], a[132:135], a[108:111], v[32:35]
    ds_read_b64_tr_b16 a[164:165], v64 offset:43008
    v_accvgpr_read_b32 v171, a253
    v_mfma_f32_16x16x32_bf16 v[32:35], a[128:131], a[104:107], v[32:35]
    ds_read_b64_tr_b16 a[166:167], v64 offset:47104
    s_waitcnt lgkmcnt(12)
    v_mfma_f32_16x16x32_bf16 v[4:7], a[136:139], a[96:99], v[4:7]
    ds_read_b64_tr_b16 a[168:169], v65 offset:34816
    buffer_load_dwordx4 a[24:27], v225, s[4:7], 0 offen sc1
    v_mfma_f32_16x16x32_bf16 v[4:7], a[140:143], a[100:103], v[4:7]
    ds_read_b64_tr_b16 a[170:171], v65 offset:38912
    v_lshlrev_b32 v170, 16, v171
    v_mfma_f32_16x16x32_bf16 v[36:39], a[140:143], a[108:111], v[36:39]
    ds_read_b64_tr_b16 a[172:173], v65 offset:43008
    v_and_b32 v171, 0xffff0000, v171
    v_mfma_f32_16x16x32_bf16 v[36:39], a[136:139], a[104:107], v[36:39]
    ds_read_b64_tr_b16 a[174:175], v65 offset:47104
    s_waitcnt lgkmcnt(12)
    v_mfma_f32_16x16x32_bf16 v[8:11], a[144:147], a[96:99], v[8:11]
    ds_read_b64_tr_b16 a[176:177], v66 offset:34816
    buffer_load_dwordx4 a[20:23], v226, s[4:7], 0 offen sc1
    v_mfma_f32_16x16x32_bf16 v[8:11], a[148:151], a[100:103], v[8:11]
    ds_read_b64_tr_b16 a[178:179], v66 offset:38912
    v_mfma_f32_16x16x32_bf16 v[40:43], a[148:151], a[108:111], v[40:43]
    ds_read_b64_tr_b16 a[180:181], v66 offset:43008
    v_accvgpr_read_b32 v173, a254
    v_mfma_f32_16x16x32_bf16 v[40:43], a[144:147], a[104:107], v[40:43]
    ds_read_b64_tr_b16 a[182:183], v66 offset:47104
    s_waitcnt lgkmcnt(12)
    v_mfma_f32_16x16x32_bf16 v[12:15], a[152:155], a[96:99], v[12:15]
    ds_read_b64_tr_b16 a[128:129], v67 offset:34816
    buffer_load_dwordx4 a[28:31], v227, s[4:7], 0 offen sc1
    v_mfma_f32_16x16x32_bf16 v[12:15], a[156:159], a[100:103], v[12:15]
    ds_read_b64_tr_b16 a[130:131], v67 offset:38912
    s_add_u32 m0, s49, 114688
    v_mfma_f32_16x16x32_bf16 v[44:47], a[156:159], a[108:111], v[44:47]
    ds_read_b64_tr_b16 a[132:133], v67 offset:43008
    s_add_u32 s12, s64, 1048576
    v_mfma_f32_16x16x32_bf16 v[44:47], a[152:155], a[104:107], v[44:47]
    ds_read_b64_tr_b16 a[134:135], v67 offset:47104
    s_waitcnt lgkmcnt(12)
    v_mfma_f32_16x16x32_bf16 v[16:19], a[160:163], a[96:99], v[16:19]
    s_waitcnt vmcnt(20)
    s_barrier
    ds_read_b64_tr_b16 a[136:137], v64 offset:49152
    v_mfma_f32_16x16x32_bf16 v[16:19], a[164:167], a[100:103], v[16:19]
    ds_read_b64_tr_b16 a[138:139], v64 offset:53248
    s_addc_u32 s13, s65, 0
    v_mfma_f32_16x16x32_bf16 v[48:51], a[164:167], a[108:111], v[48:51]
    ds_read_b64_tr_b16 a[140:141], v64 offset:57344
    buffer_load_dwordx4 v242, s[12:15], 0 offen offset:0 sc1 lds
    v_mfma_f32_16x16x32_bf16 v[48:51], a[160:163], a[104:107], v[48:51]
    ds_read_b64_tr_b16 a[142:143], v64 offset:61440
    s_waitcnt lgkmcnt(12)
    v_mfma_f32_16x16x32_bf16 v[20:23], a[168:171], a[96:99], v[20:23]
    ds_read_b64_tr_b16 a[144:145], v65 offset:49152
    buffer_load_dwordx4 v243, s[12:15], 0 offen offset:1024 sc1 lds
    v_mfma_f32_16x16x32_bf16 v[20:23], a[172:175], a[100:103], v[20:23]
    ds_read_b64_tr_b16 a[146:147], v65 offset:53248
    s_add_u32 m0, s49, 116736
    v_mfma_f32_16x16x32_bf16 v[52:55], a[172:175], a[108:111], v[52:55]
    ds_read_b64_tr_b16 a[148:149], v65 offset:57344
    s_add_u32 s84, s66, 1048576
    v_mfma_f32_16x16x32_bf16 v[52:55], a[168:171], a[104:107], v[52:55]
    ds_read_b64_tr_b16 a[150:151], v65 offset:61440
    s_waitcnt lgkmcnt(12)
    v_mfma_f32_16x16x32_bf16 v[24:27], a[176:179], a[96:99], v[24:27]
    ds_read_b64_tr_b16 a[152:153], v66 offset:49152
    s_addc_u32 s85, s67, 0
    v_mfma_f32_16x16x32_bf16 v[24:27], a[180:183], a[100:103], v[24:27]
    ds_read_b64_tr_b16 a[154:155], v66 offset:53248
    buffer_load_dwordx4 v242, s[84:87], 0 offen offset:0 sc1 lds
    v_mfma_f32_16x16x32_bf16 v[56:59], a[180:183], a[108:111], v[56:59]
    ds_read_b64_tr_b16 a[156:157], v66 offset:57344
    v_lshlrev_b32 v172, 16, v173
    v_mfma_f32_16x16x32_bf16 v[56:59], a[176:179], a[104:107], v[56:59]
    ds_read_b64_tr_b16 a[158:159], v66 offset:61440
    s_waitcnt lgkmcnt(12)
    v_mfma_f32_16x16x32_bf16 v[28:31], a[128:131], a[96:99], v[28:31]
    ds_read_b64_tr_b16 a[160:161], v67 offset:49152
    buffer_load_dwordx4 v243, s[84:87], 0 offen offset:1024 sc1 lds
    v_mfma_f32_16x16x32_bf16 v[28:31], a[132:135], a[100:103], v[28:31]
    ds_read_b64_tr_b16 a[162:163], v67 offset:53248
    s_add_u32 s4, s68, 16384
    v_mfma_f32_16x16x32_bf16 v[60:63], a[132:135], a[108:111], v[60:63]
    ds_read_b64_tr_b16 a[164:165], v67 offset:57344
    s_addc_u32 s5, s69, 0
    v_mfma_f32_16x16x32_bf16 v[60:63], a[128:131], a[104:107], v[60:63]
    ds_read_b64_tr_b16 a[166:167], v67 offset:61440
    s_waitcnt vmcnt(20) lgkmcnt(12)
    v_mfma_f32_16x16x32_bf16 v[0:3], a[136:139], a[112:115], v[0:3]
    ds_read_b64_tr_b16 a[168:169], v64 offset:51200
    buffer_load_dwordx4 a[32:35], v224, s[4:7], 0 offen sc1
    v_mfma_f32_16x16x32_bf16 v[0:3], a[140:143], a[116:119], v[0:3]
    ds_read_b64_tr_b16 a[170:171], v64 offset:55296
    v_and_b32 v173, 0xffff0000, v173
    v_mfma_f32_16x16x32_bf16 v[32:35], a[140:143], a[124:127], v[32:35]
    ds_read_b64_tr_b16 a[172:173], v64 offset:59392
    v_accvgpr_read_b32 v175, a255
    v_mfma_f32_16x16x32_bf16 v[32:35], a[136:139], a[120:123], v[32:35]
    ds_read_b64_tr_b16 a[174:175], v64 offset:63488
    s_waitcnt lgkmcnt(12)
    v_mfma_f32_16x16x32_bf16 v[4:7], a[144:147], a[112:115], v[4:7]
    ds_read_b64_tr_b16 a[176:177], v65 offset:51200
    buffer_load_dwordx4 a[40:43], v225, s[4:7], 0 offen sc1
    v_mfma_f32_16x16x32_bf16 v[4:7], a[148:151], a[116:119], v[4:7]
    ds_read_b64_tr_b16 a[178:179], v65 offset:55296
    v_lshlrev_b32 v174, 16, v175
    v_mfma_f32_16x16x32_bf16 v[36:39], a[148:151], a[124:127], v[36:39]
    ds_read_b64_tr_b16 a[180:181], v65 offset:59392
    v_and_b32 v175, 0xffff0000, v175
    v_mfma_f32_16x16x32_bf16 v[36:39], a[144:147], a[120:123], v[36:39]
    ds_read_b64_tr_b16 a[182:183], v65 offset:63488
    s_waitcnt lgkmcnt(12)
    v_mfma_f32_16x16x32_bf16 v[8:11], a[152:155], a[112:115], v[8:11]
    ds_read_b64_tr_b16 a[128:129], v66 offset:51200
    buffer_load_dwordx4 a[36:39], v226, s[4:7], 0 offen sc1
    v_mfma_f32_16x16x32_bf16 v[8:11], a[156:159], a[116:119], v[8:11]
    ds_read_b64_tr_b16 a[130:131], v66 offset:55296
    v_add_u32 v176, s49, v254
    v_mfma_f32_16x16x32_bf16 v[40:43], a[156:159], a[124:127], v[40:43]
    ds_read_b64_tr_b16 a[132:133], v66 offset:59392
    v_add_u32 v176, 147456, v176
    v_mfma_f32_16x16x32_bf16 v[40:43], a[152:155], a[120:123], v[40:43]
    ds_read_b64_tr_b16 a[134:135], v66 offset:63488
    s_waitcnt lgkmcnt(12)
    v_mfma_f32_16x16x32_bf16 v[12:15], a[160:163], a[112:115], v[12:15]
    ds_read_b64_tr_b16 a[136:137], v67 offset:51200
    buffer_load_dwordx4 a[44:47], v227, s[4:7], 0 offen sc1
    v_mfma_f32_16x16x32_bf16 v[12:15], a[164:167], a[116:119], v[12:15]
    ds_read_b64_tr_b16 a[138:139], v67 offset:55296
    s_add_u32 m0, s49, 131072
    v_mfma_f32_16x16x32_bf16 v[44:47], a[164:167], a[124:127], v[44:47]
    ds_read_b64_tr_b16 a[140:141], v67 offset:59392
    s_add_u32 s12, s64, 1507328
    v_mfma_f32_16x16x32_bf16 v[44:47], a[160:163], a[120:123], v[44:47]
    ds_read_b64_tr_b16 a[142:143], v67 offset:63488
    s_waitcnt lgkmcnt(12)
    v_mfma_f32_16x16x32_bf16 v[16:19], a[168:171], a[112:115], v[16:19]
    s_waitcnt vmcnt(20)
    s_barrier
    ds_read_b64_tr_b16 a[144:145], v68 offset:0
    v_mfma_f32_16x16x32_bf16 v[16:19], a[172:175], a[116:119], v[16:19]
    ds_read_b64_tr_b16 a[146:147], v68 offset:4096
    s_addc_u32 s13, s65, 0
    v_mfma_f32_16x16x32_bf16 v[48:51], a[172:175], a[124:127], v[48:51]
    ds_read_b64_tr_b16 a[148:149], v68 offset:8192
    buffer_load_dwordx4 v242, s[12:15], 0 offen offset:0 sc1 lds
    v_mfma_f32_16x16x32_bf16 v[48:51], a[168:171], a[120:123], v[48:51]
    ds_read_b64_tr_b16 a[150:151], v68 offset:12288
    s_waitcnt lgkmcnt(12)
    v_mfma_f32_16x16x32_bf16 v[20:23], a[176:179], a[112:115], v[20:23]
    ds_read_b64_tr_b16 a[152:153], v69 offset:0
    buffer_load_dwordx4 v243, s[12:15], 0 offen offset:1024 sc1 lds
    v_mfma_f32_16x16x32_bf16 v[20:23], a[180:183], a[116:119], v[20:23]
    ds_read_b64_tr_b16 a[154:155], v69 offset:4096
    s_add_u32 m0, s49, 133120
    v_mfma_f32_16x16x32_bf16 v[52:55], a[180:183], a[124:127], v[52:55]
    ds_read_b64_tr_b16 a[156:157], v69 offset:8192
    s_add_u32 s84, s66, 1507328
    v_mfma_f32_16x16x32_bf16 v[52:55], a[176:179], a[120:123], v[52:55]
    ds_read_b64_tr_b16 a[158:159], v69 offset:12288
    s_waitcnt lgkmcnt(12)
    v_mfma_f32_16x16x32_bf16 v[24:27], a[128:131], a[112:115], v[24:27]
    ds_read_b64_tr_b16 a[160:161], v70 offset:0
    s_addc_u32 s85, s67, 0
    v_mfma_f32_16x16x32_bf16 v[24:27], a[132:135], a[116:119], v[24:27]
    ds_read_b64_tr_b16 a[162:163], v70 offset:4096
    buffer_load_dwordx4 v242, s[84:87], 0 offen offset:0 sc1 lds
    v_mfma_f32_16x16x32_bf16 v[56:59], a[132:135], a[124:127], v[56:59]
    ds_read_b64_tr_b16 a[164:165], v70 offset:8192
    v_mfma_f32_16x16x32_bf16 v[56:59], a[128:131], a[120:123], v[56:59]
    ds_read_b64_tr_b16 a[166:167], v70 offset:12288
    s_waitcnt lgkmcnt(12)
    v_mfma_f32_16x16x32_bf16 v[28:31], a[136:139], a[112:115], v[28:31]
    ds_read_b64_tr_b16 a[168:169], v71 offset:0
    buffer_load_dwordx4 v243, s[84:87], 0 offen offset:1024 sc1 lds
    v_mfma_f32_16x16x32_bf16 v[28:31], a[140:143], a[116:119], v[28:31]
    ds_read_b64_tr_b16 a[170:171], v71 offset:4096
    s_add_u32 s4, s68, 23552
    v_mfma_f32_16x16x32_bf16 v[60:63], a[140:143], a[124:127], v[60:63]
    ds_read_b64_tr_b16 a[172:173], v71 offset:8192
    s_addc_u32 s5, s69, 0
    v_mfma_f32_16x16x32_bf16 v[60:63], a[136:139], a[120:123], v[60:63]
    ds_read_b64_tr_b16 a[174:175], v71 offset:12288
    s_waitcnt vmcnt(20) lgkmcnt(12)
    v_mfma_f32_16x16x32_bf16 v[0:3], a[144:147], a[0:3], v[0:3]
    ds_read_b64_tr_b16 a[176:177], v68 offset:2048
    buffer_load_dwordx4 a[48:51], v224, s[4:7], 0 offen sc1
    v_mfma_f32_16x16x32_bf16 v[0:3], a[148:151], a[4:7], v[0:3]
    ds_read_b64_tr_b16 a[178:179], v68 offset:6144
    v_mfma_f32_16x16x32_bf16 v[32:35], a[148:151], a[12:15], v[32:35]
    ds_read_b64_tr_b16 a[180:181], v68 offset:10240
    v_mfma_f32_16x16x32_bf16 v[32:35], a[144:147], a[8:11], v[32:35]
    ds_read_b64_tr_b16 a[182:183], v68 offset:14336
    s_waitcnt lgkmcnt(12)
    v_mfma_f32_16x16x32_bf16 v[4:7], a[152:155], a[0:3], v[4:7]
    ds_read_b64_tr_b16 a[128:129], v69 offset:2048
    buffer_load_dwordx4 a[56:59], v225, s[4:7], 0 offen sc1
    v_mfma_f32_16x16x32_bf16 v[4:7], a[156:159], a[4:7], v[4:7]
    ds_read_b64_tr_b16 a[130:131], v69 offset:6144
    v_mfma_f32_16x16x32_bf16 v[36:39], a[156:159], a[12:15], v[36:39]
    ds_read_b64_tr_b16 a[132:133], v69 offset:10240
    v_mfma_f32_16x16x32_bf16 v[36:39], a[152:155], a[8:11], v[36:39]
    ds_read_b64_tr_b16 a[134:135], v69 offset:14336
    s_waitcnt lgkmcnt(12)
    v_mfma_f32_16x16x32_bf16 v[8:11], a[160:163], a[0:3], v[8:11]
    ds_read_b64_tr_b16 a[136:137], v70 offset:2048
    buffer_load_dwordx4 a[52:55], v226, s[4:7], 0 offen sc1
    v_mfma_f32_16x16x32_bf16 v[8:11], a[164:167], a[4:7], v[8:11]
    ds_read_b64_tr_b16 a[138:139], v70 offset:6144
    v_mfma_f32_16x16x32_bf16 v[40:43], a[164:167], a[12:15], v[40:43]
    ds_read_b64_tr_b16 a[140:141], v70 offset:10240
    v_mfma_f32_16x16x32_bf16 v[40:43], a[160:163], a[8:11], v[40:43]
    ds_read_b64_tr_b16 a[142:143], v70 offset:14336
    s_waitcnt lgkmcnt(12)
    v_mfma_f32_16x16x32_bf16 v[12:15], a[168:171], a[0:3], v[12:15]
    ds_read_b64_tr_b16 a[144:145], v71 offset:2048
    buffer_load_dwordx4 a[60:63], v227, s[4:7], 0 offen sc1
    v_mfma_f32_16x16x32_bf16 v[12:15], a[172:175], a[4:7], v[12:15]
    ds_read_b64_tr_b16 a[146:147], v71 offset:6144
    s_add_u32 m0, s49, 147456
    v_mfma_f32_16x16x32_bf16 v[44:47], a[172:175], a[12:15], v[44:47]
    ds_read_b64_tr_b16 a[148:149], v71 offset:10240
    s_add_u32 s12, s64, 1966080
    v_mfma_f32_16x16x32_bf16 v[44:47], a[168:171], a[8:11], v[44:47]
    ds_read_b64_tr_b16 a[150:151], v71 offset:14336
    s_waitcnt lgkmcnt(12)
    v_mfma_f32_16x16x32_bf16 v[16:19], a[176:179], a[0:3], v[16:19]
    s_waitcnt vmcnt(20)
    s_barrier
    ds_read_b64_tr_b16 a[152:153], v68 offset:16384
    v_mfma_f32_16x16x32_bf16 v[16:19], a[180:183], a[4:7], v[16:19]
    ds_read_b64_tr_b16 a[154:155], v68 offset:20480
    s_addc_u32 s13, s65, 0
    v_mfma_f32_16x16x32_bf16 v[48:51], a[180:183], a[12:15], v[48:51]
    ds_read_b64_tr_b16 a[156:157], v68 offset:24576
    buffer_load_dwordx4 v242, s[12:15], 0 offen offset:0 sc1 lds
    v_mfma_f32_16x16x32_bf16 v[48:51], a[176:179], a[8:11], v[48:51]
    ds_read_b64_tr_b16 a[158:159], v68 offset:28672
    s_waitcnt lgkmcnt(12)
    v_mfma_f32_16x16x32_bf16 v[20:23], a[128:131], a[0:3], v[20:23]
    ds_read_b64_tr_b16 a[160:161], v69 offset:16384
    buffer_load_dwordx4 v243, s[12:15], 0 offen offset:1024 sc1 lds
    v_mfma_f32_16x16x32_bf16 v[20:23], a[132:135], a[4:7], v[20:23]
    ds_read_b64_tr_b16 a[162:163], v69 offset:20480
    s_add_u32 m0, s49, 149504
    v_mfma_f32_16x16x32_bf16 v[52:55], a[132:135], a[12:15], v[52:55]
    ds_read_b64_tr_b16 a[164:165], v69 offset:24576
    s_add_u32 s84, s66, 1966080
    v_mfma_f32_16x16x32_bf16 v[52:55], a[128:131], a[8:11], v[52:55]
    ds_read_b64_tr_b16 a[166:167], v69 offset:28672
    s_waitcnt lgkmcnt(12)
    v_mfma_f32_16x16x32_bf16 v[24:27], a[136:139], a[0:3], v[24:27]
    ds_read_b64_tr_b16 a[168:169], v70 offset:16384
    s_addc_u32 s85, s67, 0
    v_mfma_f32_16x16x32_bf16 v[24:27], a[140:143], a[4:7], v[24:27]
    ds_read_b64_tr_b16 a[170:171], v70 offset:20480
    buffer_load_dwordx4 v242, s[84:87], 0 offen offset:0 sc1 lds
    v_mfma_f32_16x16x32_bf16 v[56:59], a[140:143], a[12:15], v[56:59]
    ds_read_b64_tr_b16 a[172:173], v70 offset:24576
    v_mfma_f32_16x16x32_bf16 v[56:59], a[136:139], a[8:11], v[56:59]
    ds_read_b64_tr_b16 a[174:175], v70 offset:28672
    s_waitcnt lgkmcnt(12)
    v_mfma_f32_16x16x32_bf16 v[28:31], a[144:147], a[0:3], v[28:31]
    ds_read_b64_tr_b16 a[176:177], v71 offset:16384
    buffer_load_dwordx4 v243, s[84:87], 0 offen offset:1024 sc1 lds
    v_mfma_f32_16x16x32_bf16 v[28:31], a[148:151], a[4:7], v[28:31]
    ds_read_b64_tr_b16 a[178:179], v71 offset:20480
    s_add_u32 s4, s68, 30720
    v_mfma_f32_16x16x32_bf16 v[60:63], a[148:151], a[12:15], v[60:63]
    ds_read_b64_tr_b16 a[180:181], v71 offset:24576
    s_addc_u32 s5, s69, 0
    v_mfma_f32_16x16x32_bf16 v[60:63], a[144:147], a[8:11], v[60:63]
    ds_read_b64_tr_b16 a[182:183], v71 offset:28672
    s_waitcnt vmcnt(20) lgkmcnt(12)
    v_mfma_f32_16x16x32_bf16 v[0:3], a[152:155], a[16:19], v[0:3]
    ds_read_b64_tr_b16 a[128:129], v68 offset:18432
    buffer_load_dwordx4 a[64:67], v224, s[4:7], 0 offen sc1
    v_mfma_f32_16x16x32_bf16 v[0:3], a[156:159], a[20:23], v[0:3]
    ds_read_b64_tr_b16 a[130:131], v68 offset:22528
    v_mfma_f32_16x16x32_bf16 v[32:35], a[156:159], a[28:31], v[32:35]
    ds_read_b64_tr_b16 a[132:133], v68 offset:26624
    v_mfma_f32_16x16x32_bf16 v[32:35], a[152:155], a[24:27], v[32:35]
    ds_read_b64_tr_b16 a[134:135], v68 offset:30720
    s_waitcnt lgkmcnt(12)
    v_mfma_f32_16x16x32_bf16 v[4:7], a[160:163], a[16:19], v[4:7]
    ds_read_b64_tr_b16 a[136:137], v69 offset:18432
    buffer_load_dwordx4 a[72:75], v225, s[4:7], 0 offen sc1
    v_mfma_f32_16x16x32_bf16 v[4:7], a[164:167], a[20:23], v[4:7]
    ds_read_b64_tr_b16 a[138:139], v69 offset:22528
    v_mfma_f32_16x16x32_bf16 v[36:39], a[164:167], a[28:31], v[36:39]
    ds_read_b64_tr_b16 a[140:141], v69 offset:26624
    v_mfma_f32_16x16x32_bf16 v[36:39], a[160:163], a[24:27], v[36:39]
    ds_read_b64_tr_b16 a[142:143], v69 offset:30720
    s_waitcnt lgkmcnt(12)
    v_mfma_f32_16x16x32_bf16 v[8:11], a[168:171], a[16:19], v[8:11]
    ds_read_b64_tr_b16 a[144:145], v70 offset:18432
    buffer_load_dwordx4 a[68:71], v226, s[4:7], 0 offen sc1
    v_mfma_f32_16x16x32_bf16 v[8:11], a[172:175], a[20:23], v[8:11]
    ds_read_b64_tr_b16 a[146:147], v70 offset:22528
    v_mfma_f32_16x16x32_bf16 v[40:43], a[172:175], a[28:31], v[40:43]
    ds_read_b64_tr_b16 a[148:149], v70 offset:26624
    v_mfma_f32_16x16x32_bf16 v[40:43], a[168:171], a[24:27], v[40:43]
    ds_read_b64_tr_b16 a[150:151], v70 offset:30720
    s_waitcnt lgkmcnt(12)
    v_mfma_f32_16x16x32_bf16 v[12:15], a[176:179], a[16:19], v[12:15]
    ds_read_b64_tr_b16 a[152:153], v71 offset:18432
    buffer_load_dwordx4 a[76:79], v227, s[4:7], 0 offen sc1
    v_mfma_f32_16x16x32_bf16 v[12:15], a[180:183], a[20:23], v[12:15]
    ds_read_b64_tr_b16 a[154:155], v71 offset:22528
    s_add_u32 m0, s49, 16384
    v_mfma_f32_16x16x32_bf16 v[44:47], a[180:183], a[28:31], v[44:47]
    ds_read_b64_tr_b16 a[156:157], v71 offset:26624
    s_add_u32 s12, s64, 2424832
    v_mfma_f32_16x16x32_bf16 v[44:47], a[176:179], a[24:27], v[44:47]
    ds_read_b64_tr_b16 a[158:159], v71 offset:30720
    s_waitcnt lgkmcnt(12)
    v_mfma_f32_16x16x32_bf16 v[16:19], a[128:131], a[16:19], v[16:19]
    s_waitcnt vmcnt(20)
    s_barrier
    ds_read_b64_tr_b16 a[160:161], v68 offset:32768
    v_mfma_f32_16x16x32_bf16 v[16:19], a[132:135], a[20:23], v[16:19]
    ds_read_b64_tr_b16 a[162:163], v68 offset:36864
    s_addc_u32 s13, s65, 0
    v_mfma_f32_16x16x32_bf16 v[48:51], a[132:135], a[28:31], v[48:51]
    ds_read_b64_tr_b16 a[164:165], v68 offset:40960
    buffer_load_dwordx4 v242, s[12:15], 0 offen offset:0 sc1 lds
    v_mfma_f32_16x16x32_bf16 v[48:51], a[128:131], a[24:27], v[48:51]
    ds_read_b64_tr_b16 a[166:167], v68 offset:45056
    s_waitcnt lgkmcnt(12)
    v_mfma_f32_16x16x32_bf16 v[20:23], a[136:139], a[16:19], v[20:23]
    ds_read_b64_tr_b16 a[168:169], v69 offset:32768
    buffer_load_dwordx4 v243, s[12:15], 0 offen offset:1024 sc1 lds
    v_mfma_f32_16x16x32_bf16 v[20:23], a[140:143], a[20:23], v[20:23]
    ds_read_b64_tr_b16 a[170:171], v69 offset:36864
    s_add_u32 m0, s49, 18432
    v_mfma_f32_16x16x32_bf16 v[52:55], a[140:143], a[28:31], v[52:55]
    ds_read_b64_tr_b16 a[172:173], v69 offset:40960
    s_add_u32 s84, s66, 2424832
    v_mfma_f32_16x16x32_bf16 v[52:55], a[136:139], a[24:27], v[52:55]
    ds_read_b64_tr_b16 a[174:175], v69 offset:45056
    s_waitcnt lgkmcnt(12)
    v_mfma_f32_16x16x32_bf16 v[24:27], a[144:147], a[16:19], v[24:27]
    ds_read_b64_tr_b16 a[176:177], v70 offset:32768
    s_addc_u32 s85, s67, 0
    v_mfma_f32_16x16x32_bf16 v[24:27], a[148:151], a[20:23], v[24:27]
    ds_read_b64_tr_b16 a[178:179], v70 offset:36864
    buffer_load_dwordx4 v242, s[84:87], 0 offen offset:0 sc1 lds
    v_mfma_f32_16x16x32_bf16 v[56:59], a[148:151], a[28:31], v[56:59]
    ds_read_b64_tr_b16 a[180:181], v70 offset:40960
    v_mfma_f32_16x16x32_bf16 v[56:59], a[144:147], a[24:27], v[56:59]
    ds_read_b64_tr_b16 a[182:183], v70 offset:45056
    s_waitcnt lgkmcnt(12)
    v_mfma_f32_16x16x32_bf16 v[28:31], a[152:155], a[16:19], v[28:31]
    ds_read_b64_tr_b16 a[128:129], v71 offset:32768
    buffer_load_dwordx4 v243, s[84:87], 0 offen offset:1024 sc1 lds
    v_mfma_f32_16x16x32_bf16 v[28:31], a[156:159], a[20:23], v[28:31]
    ds_read_b64_tr_b16 a[130:131], v71 offset:36864
    s_add_u32 s4, s68, 37888
    v_mfma_f32_16x16x32_bf16 v[60:63], a[156:159], a[28:31], v[60:63]
    ds_read_b64_tr_b16 a[132:133], v71 offset:40960
    s_addc_u32 s5, s69, 0
    v_mfma_f32_16x16x32_bf16 v[60:63], a[152:155], a[24:27], v[60:63]
    ds_read_b64_tr_b16 a[134:135], v71 offset:45056
    s_waitcnt vmcnt(20) lgkmcnt(12)
    v_mfma_f32_16x16x32_bf16 v[0:3], a[160:163], a[32:35], v[0:3]
    ds_read_b64_tr_b16 a[136:137], v68 offset:34816
    buffer_load_dwordx4 a[80:83], v224, s[4:7], 0 offen sc1
    v_mfma_f32_16x16x32_bf16 v[0:3], a[164:167], a[36:39], v[0:3]
    ds_read_b64_tr_b16 a[138:139], v68 offset:38912
    v_mfma_f32_16x16x32_bf16 v[32:35], a[164:167], a[44:47], v[32:35]
    ds_read_b64_tr_b16 a[140:141], v68 offset:43008
    v_mfma_f32_16x16x32_bf16 v[32:35], a[160:163], a[40:43], v[32:35]
    ds_read_b64_tr_b16 a[142:143], v68 offset:47104
    s_waitcnt lgkmcnt(12)
    v_mfma_f32_16x16x32_bf16 v[4:7], a[168:171], a[32:35], v[4:7]
    ds_read_b64_tr_b16 a[144:145], v69 offset:34816
    buffer_load_dwordx4 a[88:91], v225, s[4:7], 0 offen sc1
    v_mfma_f32_16x16x32_bf16 v[4:7], a[172:175], a[36:39], v[4:7]
    ds_read_b64_tr_b16 a[146:147], v69 offset:38912
    v_mfma_f32_16x16x32_bf16 v[36:39], a[172:175], a[44:47], v[36:39]
    ds_read_b64_tr_b16 a[148:149], v69 offset:43008
    v_mfma_f32_16x16x32_bf16 v[36:39], a[168:171], a[40:43], v[36:39]
    ds_read_b64_tr_b16 a[150:151], v69 offset:47104
    s_waitcnt lgkmcnt(12)
    v_mfma_f32_16x16x32_bf16 v[8:11], a[176:179], a[32:35], v[8:11]
    ds_read_b64_tr_b16 a[152:153], v70 offset:34816
    buffer_load_dwordx4 a[84:87], v226, s[4:7], 0 offen sc1
    v_mfma_f32_16x16x32_bf16 v[8:11], a[180:183], a[36:39], v[8:11]
    ds_read_b64_tr_b16 a[154:155], v70 offset:38912
    v_mfma_f32_16x16x32_bf16 v[40:43], a[180:183], a[44:47], v[40:43]
    ds_read_b64_tr_b16 a[156:157], v70 offset:43008
    v_mfma_f32_16x16x32_bf16 v[40:43], a[176:179], a[40:43], v[40:43]
    ds_read_b64_tr_b16 a[158:159], v70 offset:47104
    s_waitcnt lgkmcnt(12)
    v_mfma_f32_16x16x32_bf16 v[12:15], a[128:131], a[32:35], v[12:15]
    ds_read_b64_tr_b16 a[160:161], v71 offset:34816
    buffer_load_dwordx4 a[92:95], v227, s[4:7], 0 offen sc1
    v_mfma_f32_16x16x32_bf16 v[12:15], a[132:135], a[36:39], v[12:15]
    ds_read_b64_tr_b16 a[162:163], v71 offset:38912
    s_add_u32 m0, s49, 32768
    v_mfma_f32_16x16x32_bf16 v[44:47], a[132:135], a[44:47], v[44:47]
    ds_read_b64_tr_b16 a[164:165], v71 offset:43008
    s_add_u32 s12, s64, 2883584
    v_mfma_f32_16x16x32_bf16 v[44:47], a[128:131], a[40:43], v[44:47]
    ds_read_b64_tr_b16 a[166:167], v71 offset:47104
    s_waitcnt lgkmcnt(12)
    v_mfma_f32_16x16x32_bf16 v[16:19], a[136:139], a[32:35], v[16:19]
    s_waitcnt vmcnt(20)
    s_barrier
    ds_read_b64_tr_b16 a[168:169], v68 offset:49152
    v_mfma_f32_16x16x32_bf16 v[16:19], a[140:143], a[36:39], v[16:19]
    ds_read_b64_tr_b16 a[170:171], v68 offset:53248
    s_addc_u32 s13, s65, 0
    v_mfma_f32_16x16x32_bf16 v[48:51], a[140:143], a[44:47], v[48:51]
    ds_read_b64_tr_b16 a[172:173], v68 offset:57344
    buffer_load_dwordx4 v242, s[12:15], 0 offen offset:0 sc1 lds
    v_mfma_f32_16x16x32_bf16 v[48:51], a[136:139], a[40:43], v[48:51]
    ds_read_b64_tr_b16 a[174:175], v68 offset:61440
    s_waitcnt lgkmcnt(12)
    v_mfma_f32_16x16x32_bf16 v[20:23], a[144:147], a[32:35], v[20:23]
    ds_read_b64_tr_b16 a[176:177], v69 offset:49152
    buffer_load_dwordx4 v243, s[12:15], 0 offen offset:1024 sc1 lds
    v_mfma_f32_16x16x32_bf16 v[20:23], a[148:151], a[36:39], v[20:23]
    ds_read_b64_tr_b16 a[178:179], v69 offset:53248
    s_add_u32 s4, s68, 45056
    v_mfma_f32_16x16x32_bf16 v[52:55], a[148:151], a[44:47], v[52:55]
    ds_read_b64_tr_b16 a[180:181], v69 offset:57344
    s_addc_u32 s5, s69, 0
    v_mfma_f32_16x16x32_bf16 v[52:55], a[144:147], a[40:43], v[52:55]
    ds_read_b64_tr_b16 a[182:183], v69 offset:61440
    s_waitcnt lgkmcnt(12)
    v_mfma_f32_16x16x32_bf16 v[24:27], a[152:155], a[32:35], v[24:27]
    ds_read_b64_tr_b16 a[128:129], v70 offset:49152
    buffer_load_dwordx4 a[96:99], v224, s[4:7], 0 offen sc1
    v_mfma_f32_16x16x32_bf16 v[24:27], a[156:159], a[36:39], v[24:27]
    ds_read_b64_tr_b16 a[130:131], v70 offset:53248
    v_mfma_f32_16x16x32_bf16 v[56:59], a[156:159], a[44:47], v[56:59]
    ds_read_b64_tr_b16 a[132:133], v70 offset:57344
    v_mfma_f32_16x16x32_bf16 v[56:59], a[152:155], a[40:43], v[56:59]
    ds_read_b64_tr_b16 a[134:135], v70 offset:61440
    s_waitcnt lgkmcnt(12)
    v_mfma_f32_16x16x32_bf16 v[28:31], a[160:163], a[32:35], v[28:31]
    ds_read_b64_tr_b16 a[136:137], v71 offset:49152
    buffer_load_dwordx4 a[104:107], v225, s[4:7], 0 offen sc1
    v_mfma_f32_16x16x32_bf16 v[28:31], a[164:167], a[36:39], v[28:31]
    ds_read_b64_tr_b16 a[138:139], v71 offset:53248
    v_mfma_f32_16x16x32_bf16 v[60:63], a[164:167], a[44:47], v[60:63]
    ds_read_b64_tr_b16 a[140:141], v71 offset:57344
    v_mfma_f32_16x16x32_bf16 v[60:63], a[160:163], a[40:43], v[60:63]
    ds_read_b64_tr_b16 a[142:143], v71 offset:61440
    s_waitcnt vmcnt(20) lgkmcnt(12)
    v_mfma_f32_16x16x32_bf16 v[0:3], a[168:171], a[48:51], v[0:3]
    ds_read_b64_tr_b16 a[144:145], v68 offset:51200
    buffer_load_dwordx4 a[100:103], v226, s[4:7], 0 offen sc1
    v_mfma_f32_16x16x32_bf16 v[0:3], a[172:175], a[52:55], v[0:3]
    ds_read_b64_tr_b16 a[146:147], v68 offset:55296
    v_mfma_f32_16x16x32_bf16 v[32:35], a[172:175], a[60:63], v[32:35]
    ds_read_b64_tr_b16 a[148:149], v68 offset:59392
    v_mfma_f32_16x16x32_bf16 v[32:35], a[168:171], a[56:59], v[32:35]
    ds_read_b64_tr_b16 a[150:151], v68 offset:63488
    s_waitcnt lgkmcnt(12)
    v_mfma_f32_16x16x32_bf16 v[4:7], a[176:179], a[48:51], v[4:7]
    ds_read_b64_tr_b16 a[152:153], v69 offset:51200
    buffer_load_dwordx4 a[108:111], v227, s[4:7], 0 offen sc1
    v_mfma_f32_16x16x32_bf16 v[4:7], a[180:183], a[52:55], v[4:7]
    ds_read_b64_tr_b16 a[154:155], v69 offset:55296
    s_add_u32 m0, s49, 49152
    v_mfma_f32_16x16x32_bf16 v[36:39], a[180:183], a[60:63], v[36:39]
    ds_read_b64_tr_b16 a[156:157], v69 offset:59392
    s_add_u32 s12, s64, 3342336
    v_mfma_f32_16x16x32_bf16 v[36:39], a[176:179], a[56:59], v[36:39]
    ds_read_b64_tr_b16 a[158:159], v69 offset:63488
    s_waitcnt lgkmcnt(12)
    v_mfma_f32_16x16x32_bf16 v[8:11], a[128:131], a[48:51], v[8:11]
    ds_read_b64_tr_b16 a[160:161], v70 offset:51200
    s_addc_u32 s13, s65, 0
    v_mfma_f32_16x16x32_bf16 v[8:11], a[132:135], a[52:55], v[8:11]
    ds_read_b64_tr_b16 a[162:163], v70 offset:55296
    buffer_load_dwordx4 v242, s[12:15], 0 offen offset:0 sc1 lds
    v_mfma_f32_16x16x32_bf16 v[40:43], a[132:135], a[60:63], v[40:43]
    ds_read_b64_tr_b16 a[164:165], v70 offset:59392
    v_mfma_f32_16x16x32_bf16 v[40:43], a[128:131], a[56:59], v[40:43]
    ds_read_b64_tr_b16 a[166:167], v70 offset:63488
    s_waitcnt lgkmcnt(12)
    v_mfma_f32_16x16x32_bf16 v[12:15], a[136:139], a[48:51], v[12:15]
    ds_read_b64_tr_b16 a[168:169], v71 offset:51200
    buffer_load_dwordx4 v243, s[12:15], 0 offen offset:1024 sc1 lds
    v_mfma_f32_16x16x32_bf16 v[12:15], a[140:143], a[52:55], v[12:15]
    ds_read_b64_tr_b16 a[170:171], v71 offset:55296
    s_add_u32 s4, s68, 52224
    v_mfma_f32_16x16x32_bf16 v[44:47], a[140:143], a[60:63], v[44:47]
    ds_read_b64_tr_b16 a[172:173], v71 offset:59392
    s_addc_u32 s5, s69, 0
    v_mfma_f32_16x16x32_bf16 v[44:47], a[136:139], a[56:59], v[44:47]
    ds_read_b64_tr_b16 a[174:175], v71 offset:63488
    s_waitcnt lgkmcnt(12)
    v_mfma_f32_16x16x32_bf16 v[16:19], a[144:147], a[48:51], v[16:19]
    s_waitcnt vmcnt(20)
    s_barrier
    ds_read_b64_tr_b16 a[176:177], v72 offset:0
    v_mfma_f32_16x16x32_bf16 v[16:19], a[148:151], a[52:55], v[16:19]
    ds_read_b64_tr_b16 a[178:179], v72 offset:4096
    buffer_load_dwordx4 a[112:115], v224, s[4:7], 0 offen sc1
    v_mfma_f32_16x16x32_bf16 v[48:51], a[148:151], a[60:63], v[48:51]
    ds_read_b64_tr_b16 a[180:181], v72 offset:8192
    v_mfma_f32_16x16x32_bf16 v[48:51], a[144:147], a[56:59], v[48:51]
    ds_read_b64_tr_b16 a[182:183], v72 offset:12288
    s_waitcnt lgkmcnt(12)
    v_mfma_f32_16x16x32_bf16 v[20:23], a[152:155], a[48:51], v[20:23]
    ds_read_b64_tr_b16 a[128:129], v73 offset:0
    buffer_load_dwordx4 a[120:123], v225, s[4:7], 0 offen sc1
    v_mfma_f32_16x16x32_bf16 v[20:23], a[156:159], a[52:55], v[20:23]
    ds_read_b64_tr_b16 a[130:131], v73 offset:4096
    v_mfma_f32_16x16x32_bf16 v[52:55], a[156:159], a[60:63], v[52:55]
    ds_read_b64_tr_b16 a[132:133], v73 offset:8192
    v_mfma_f32_16x16x32_bf16 v[52:55], a[152:155], a[56:59], v[52:55]
    ds_read_b64_tr_b16 a[134:135], v73 offset:12288
    s_waitcnt lgkmcnt(12)
    v_mfma_f32_16x16x32_bf16 v[24:27], a[160:163], a[48:51], v[24:27]
    ds_read_b64_tr_b16 a[136:137], v74 offset:0
    buffer_load_dwordx4 a[116:119], v226, s[4:7], 0 offen sc1
    v_mfma_f32_16x16x32_bf16 v[24:27], a[164:167], a[52:55], v[24:27]
    ds_read_b64_tr_b16 a[138:139], v74 offset:4096
    v_mfma_f32_16x16x32_bf16 v[56:59], a[164:167], a[60:63], v[56:59]
    ds_read_b64_tr_b16 a[140:141], v74 offset:8192
    v_mfma_f32_16x16x32_bf16 v[56:59], a[160:163], a[56:59], v[56:59]
    ds_read_b64_tr_b16 a[142:143], v74 offset:12288
    s_waitcnt lgkmcnt(12)
    v_mfma_f32_16x16x32_bf16 v[28:31], a[168:171], a[48:51], v[28:31]
    ds_read_b64_tr_b16 a[144:145], v75 offset:0
    buffer_load_dwordx4 a[124:127], v227, s[4:7], 0 offen sc1
    v_mfma_f32_16x16x32_bf16 v[28:31], a[172:175], a[52:55], v[28:31]
    ds_read_b64_tr_b16 a[146:147], v75 offset:4096
    s_add_u32 m0, s49, 65536
    v_mfma_f32_16x16x32_bf16 v[60:63], a[172:175], a[60:63], v[60:63]
    ds_read_b64_tr_b16 a[148:149], v75 offset:8192
    s_add_u32 s64, s64, s47
    v_mfma_f32_16x16x32_bf16 v[60:63], a[168:171], a[56:59], v[60:63]
    ds_read_b64_tr_b16 a[150:151], v75 offset:12288
    s_waitcnt vmcnt(20) lgkmcnt(12)
    v_mfma_f32_16x16x32_bf16 v[0:3], a[176:179], a[64:67], v[0:3]
    ds_read_b64_tr_b16 a[152:153], v72 offset:2048
    s_addc_u32 s65, s65, 0
    v_mfma_f32_16x16x32_bf16 v[0:3], a[180:183], a[68:71], v[0:3]
    ds_read_b64_tr_b16 a[154:155], v72 offset:6144
    s_add_u32 s12, s64, 196608
    v_mfma_f32_16x16x32_bf16 v[32:35], a[180:183], a[76:79], v[32:35]
    ds_read_b64_tr_b16 a[156:157], v72 offset:10240
    s_addc_u32 s13, s65, 0
    v_mfma_f32_16x16x32_bf16 v[32:35], a[176:179], a[72:75], v[32:35]
    ds_read_b64_tr_b16 a[158:159], v72 offset:14336
    s_waitcnt lgkmcnt(12)
    v_mfma_f32_16x16x32_bf16 v[4:7], a[128:131], a[64:67], v[4:7]
    ds_read_b64_tr_b16 a[160:161], v73 offset:2048
    buffer_load_dwordx4 v242, s[12:15], 0 offen offset:0 sc1 lds
    v_mfma_f32_16x16x32_bf16 v[4:7], a[132:135], a[68:71], v[4:7]
    ds_read_b64_tr_b16 a[162:163], v73 offset:6144
    buffer_load_dwordx4 v243, s[12:15], 0 offen offset:1024 sc1 lds
    v_mfma_f32_16x16x32_bf16 v[36:39], a[132:135], a[76:79], v[36:39]
    ds_read_b64_tr_b16 a[164:165], v73 offset:10240
    s_add_u32 s4, s68, 3072
    v_mfma_f32_16x16x32_bf16 v[36:39], a[128:131], a[72:75], v[36:39]
    ds_read_b64_tr_b16 a[166:167], v73 offset:14336
    s_waitcnt lgkmcnt(12)
    v_mfma_f32_16x16x32_bf16 v[8:11], a[136:139], a[64:67], v[8:11]
    ds_read_b64_tr_b16 a[168:169], v74 offset:2048
    s_addc_u32 s5, s69, 0
    v_mfma_f32_16x16x32_bf16 v[8:11], a[140:143], a[68:71], v[8:11]
    ds_read_b64_tr_b16 a[170:171], v74 offset:6144
    buffer_load_dwordx2 a[0:1], v76, s[4:7], 0 offen sc1
    v_mfma_f32_16x16x32_bf16 v[40:43], a[140:143], a[76:79], v[40:43]
    ds_read_b64_tr_b16 a[172:173], v74 offset:10240
    buffer_load_dwordx2 a[2:3], v78, s[4:7], 0 offen offset:512 sc1
    v_mfma_f32_16x16x32_bf16 v[40:43], a[136:139], a[72:75], v[40:43]
    ds_read_b64_tr_b16 a[174:175], v74 offset:14336
    s_waitcnt lgkmcnt(12)
    v_mfma_f32_16x16x32_bf16 v[12:15], a[144:147], a[64:67], v[12:15]
    ds_read_b64_tr_b16 a[176:177], v75 offset:2048
    buffer_load_dwordx2 a[8:9], v77, s[4:7], 0 offen sc1
    v_mfma_f32_16x16x32_bf16 v[12:15], a[148:151], a[68:71], v[12:15]
    ds_read_b64_tr_b16 a[178:179], v75 offset:6144
    buffer_load_dwordx2 a[10:11], v79, s[4:7], 0 offen offset:512 sc1
    v_mfma_f32_16x16x32_bf16 v[44:47], a[148:151], a[76:79], v[44:47]
    ds_read_b64_tr_b16 a[180:181], v75 offset:10240
    s_add_u32 s4, s68, 10240
    v_mfma_f32_16x16x32_bf16 v[44:47], a[144:147], a[72:75], v[44:47]
    ds_read_b64_tr_b16 a[182:183], v75 offset:14336
    s_waitcnt lgkmcnt(12)
    v_mfma_f32_16x16x32_bf16 v[16:19], a[152:155], a[64:67], v[16:19]
    s_waitcnt vmcnt(22)
    s_barrier
    ds_read_b64_tr_b16 a[128:129], v64 offset:0
    v_mfma_f32_16x16x32_bf16 v[16:19], a[156:159], a[68:71], v[16:19]
    ds_read_b64_tr_b16 a[130:131], v64 offset:4096
    s_addc_u32 s5, s69, 0
    v_mfma_f32_16x16x32_bf16 v[48:51], a[156:159], a[76:79], v[48:51]
    ds_read_b64_tr_b16 a[132:133], v64 offset:8192
    buffer_load_dwordx2 a[4:5], v76, s[4:7], 0 offen sc1
    v_mfma_f32_16x16x32_bf16 v[48:51], a[152:155], a[72:75], v[48:51]
    ds_read_b64_tr_b16 a[134:135], v64 offset:12288
    s_waitcnt lgkmcnt(12)
    v_mfma_f32_16x16x32_bf16 v[20:23], a[160:163], a[64:67], v[20:23]
    ds_read_b64_tr_b16 a[136:137], v65 offset:0
    buffer_load_dwordx2 a[6:7], v78, s[4:7], 0 offen offset:512 sc1
    v_mfma_f32_16x16x32_bf16 v[20:23], a[164:167], a[68:71], v[20:23]
    ds_read_b64_tr_b16 a[138:139], v65 offset:4096
    buffer_load_dwordx2 a[12:13], v77, s[4:7], 0 offen sc1
    v_mfma_f32_16x16x32_bf16 v[52:55], a[164:167], a[76:79], v[52:55]
    ds_read_b64_tr_b16 a[140:141], v65 offset:8192
    buffer_load_dwordx2 a[14:15], v79, s[4:7], 0 offen offset:512 sc1
    v_mfma_f32_16x16x32_bf16 v[52:55], a[160:163], a[72:75], v[52:55]
    ds_read_b64_tr_b16 a[142:143], v65 offset:12288
    s_waitcnt lgkmcnt(12)
    v_mfma_f32_16x16x32_bf16 v[24:27], a[168:171], a[64:67], v[24:27]
    ds_read_b64_tr_b16 a[144:145], v66 offset:0
    s_add_u32 m0, s49, 81920
    v_mfma_f32_16x16x32_bf16 v[24:27], a[172:175], a[68:71], v[24:27]
    ds_read_b64_tr_b16 a[146:147], v66 offset:4096
    s_add_u32 s12, s64, 1114112
    v_mfma_f32_16x16x32_bf16 v[56:59], a[172:175], a[76:79], v[56:59]
    ds_read_b64_tr_b16 a[148:149], v66 offset:8192
    s_addc_u32 s13, s65, 0
    v_mfma_f32_16x16x32_bf16 v[56:59], a[168:171], a[72:75], v[56:59]
    ds_read_b64_tr_b16 a[150:151], v66 offset:12288
    s_waitcnt lgkmcnt(12)
    v_mfma_f32_16x16x32_bf16 v[28:31], a[176:179], a[64:67], v[28:31]
    ds_read_b64_tr_b16 a[152:153], v67 offset:0
    buffer_load_dwordx4 v242, s[12:15], 0 offen offset:0 sc1 lds
    v_mfma_f32_16x16x32_bf16 v[28:31], a[180:183], a[68:71], v[28:31]
    ds_read_b64_tr_b16 a[154:155], v67 offset:4096
    buffer_load_dwordx4 v243, s[12:15], 0 offen offset:1024 sc1 lds
    v_mfma_f32_16x16x32_bf16 v[60:63], a[180:183], a[76:79], v[60:63]
    ds_read_b64_tr_b16 a[156:157], v67 offset:8192
    s_add_u32 s4, s68, 17408
    v_mfma_f32_16x16x32_bf16 v[60:63], a[176:179], a[72:75], v[60:63]
    ds_read_b64_tr_b16 a[158:159], v67 offset:12288
    s_waitcnt vmcnt(24) lgkmcnt(12)
    v_mfma_f32_16x16x32_bf16 v[0:3], a[128:131], a[80:83], v[0:3]
    ds_read_b64_tr_b16 a[160:161], v64 offset:2048
    s_addc_u32 s5, s69, 0
    v_mfma_f32_16x16x32_bf16 v[0:3], a[132:135], a[84:87], v[0:3]
    ds_read_b64_tr_b16 a[162:163], v64 offset:6144
    buffer_load_dwordx2 a[16:17], v76, s[4:7], 0 offen sc1
    v_mfma_f32_16x16x32_bf16 v[32:35], a[132:135], a[92:95], v[32:35]
    ds_read_b64_tr_b16 a[164:165], v64 offset:10240
    buffer_load_dwordx2 a[18:19], v78, s[4:7], 0 offen offset:512 sc1
    v_mfma_f32_16x16x32_bf16 v[32:35], a[128:131], a[88:91], v[32:35]
    ds_read_b64_tr_b16 a[166:167], v64 offset:14336
    s_waitcnt lgkmcnt(12)
    v_mfma_f32_16x16x32_bf16 v[4:7], a[136:139], a[80:83], v[4:7]
    ds_read_b64_tr_b16 a[168:169], v65 offset:2048
    buffer_load_dwordx2 a[24:25], v77, s[4:7], 0 offen sc1
    v_mfma_f32_16x16x32_bf16 v[4:7], a[140:143], a[84:87], v[4:7]
    ds_read_b64_tr_b16 a[170:171], v65 offset:6144
    buffer_load_dwordx2 a[26:27], v79, s[4:7], 0 offen offset:512 sc1
    v_mfma_f32_16x16x32_bf16 v[36:39], a[140:143], a[92:95], v[36:39]
    ds_read_b64_tr_b16 a[172:173], v65 offset:10240
    s_add_u32 s4, s68, 24576
    v_mfma_f32_16x16x32_bf16 v[36:39], a[136:139], a[88:91], v[36:39]
    ds_read_b64_tr_b16 a[174:175], v65 offset:14336
    s_waitcnt lgkmcnt(12)
    v_mfma_f32_16x16x32_bf16 v[8:11], a[144:147], a[80:83], v[8:11]
    ds_read_b64_tr_b16 a[176:177], v66 offset:2048
    s_addc_u32 s5, s69, 0
    v_mfma_f32_16x16x32_bf16 v[8:11], a[148:151], a[84:87], v[8:11]
    ds_read_b64_tr_b16 a[178:179], v66 offset:6144
    buffer_load_dwordx2 a[20:21], v76, s[4:7], 0 offen sc1
    v_mfma_f32_16x16x32_bf16 v[40:43], a[148:151], a[92:95], v[40:43]
    ds_read_b64_tr_b16 a[180:181], v66 offset:10240
    buffer_load_dwordx2 a[22:23], v78, s[4:7], 0 offen offset:512 sc1
    v_mfma_f32_16x16x32_bf16 v[40:43], a[144:147], a[88:91], v[40:43]
    ds_read_b64_tr_b16 a[182:183], v66 offset:14336
    s_waitcnt lgkmcnt(12)
    v_mfma_f32_16x16x32_bf16 v[12:15], a[152:155], a[80:83], v[12:15]
    ds_read_b64_tr_b16 a[128:129], v67 offset:2048
    buffer_load_dwordx2 a[28:29], v77, s[4:7], 0 offen sc1
    v_mfma_f32_16x16x32_bf16 v[12:15], a[156:159], a[84:87], v[12:15]
    ds_read_b64_tr_b16 a[130:131], v67 offset:6144
    buffer_load_dwordx2 a[30:31], v79, s[4:7], 0 offen offset:512 sc1
    v_mfma_f32_16x16x32_bf16 v[44:47], a[156:159], a[92:95], v[44:47]
    ds_read_b64_tr_b16 a[132:133], v67 offset:10240
    s_add_u32 m0, s49, 98304
    v_mfma_f32_16x16x32_bf16 v[44:47], a[152:155], a[88:91], v[44:47]
    ds_read_b64_tr_b16 a[134:135], v67 offset:14336
    s_waitcnt lgkmcnt(12)
    v_mfma_f32_16x16x32_bf16 v[16:19], a[160:163], a[80:83], v[16:19]
    s_waitcnt vmcnt(30)
    s_barrier
    ds_read_b64_tr_b16 a[136:137], v64 offset:16384
    v_mfma_f32_16x16x32_bf16 v[16:19], a[164:167], a[84:87], v[16:19]
    ds_read_b64_tr_b16 a[138:139], v64 offset:20480
    s_add_u32 s12, s64, 2031616
    v_mfma_f32_16x16x32_bf16 v[48:51], a[164:167], a[92:95], v[48:51]
    ds_read_b64_tr_b16 a[140:141], v64 offset:24576
    s_addc_u32 s13, s65, 0
    v_mfma_f32_16x16x32_bf16 v[48:51], a[160:163], a[88:91], v[48:51]
    ds_read_b64_tr_b16 a[142:143], v64 offset:28672
    s_waitcnt lgkmcnt(12)
    v_mfma_f32_16x16x32_bf16 v[20:23], a[168:171], a[80:83], v[20:23]
    ds_read_b64_tr_b16 a[144:145], v65 offset:16384
    buffer_load_dwordx4 v242, s[12:15], 0 offen offset:0 sc1 lds
    v_mfma_f32_16x16x32_bf16 v[20:23], a[172:175], a[84:87], v[20:23]
    ds_read_b64_tr_b16 a[146:147], v65 offset:20480
    buffer_load_dwordx4 v243, s[12:15], 0 offen offset:1024 sc1 lds
    v_mfma_f32_16x16x32_bf16 v[52:55], a[172:175], a[92:95], v[52:55]
    ds_read_b64_tr_b16 a[148:149], v65 offset:24576
    s_add_u32 s4, s68, 31744
    v_mfma_f32_16x16x32_bf16 v[52:55], a[168:171], a[88:91], v[52:55]
    ds_read_b64_tr_b16 a[150:151], v65 offset:28672
    s_waitcnt lgkmcnt(12)
    v_mfma_f32_16x16x32_bf16 v[24:27], a[176:179], a[80:83], v[24:27]
    ds_read_b64_tr_b16 a[152:153], v66 offset:16384
    s_addc_u32 s5, s69, 0
    v_mfma_f32_16x16x32_bf16 v[24:27], a[180:183], a[84:87], v[24:27]
    ds_read_b64_tr_b16 a[154:155], v66 offset:20480
    buffer_load_dwordx2 a[32:33], v76, s[4:7], 0 offen sc1
    v_mfma_f32_16x16x32_bf16 v[56:59], a[180:183], a[92:95], v[56:59]
    ds_read_b64_tr_b16 a[156:157], v66 offset:24576
    buffer_load_dwordx2 a[34:35], v78, s[4:7], 0 offen offset:512 sc1
    v_mfma_f32_16x16x32_bf16 v[56:59], a[176:179], a[88:91], v[56:59]
    ds_read_b64_tr_b16 a[158:159], v66 offset:28672
    s_waitcnt lgkmcnt(12)
    v_mfma_f32_16x16x32_bf16 v[28:31], a[128:131], a[80:83], v[28:31]
    ds_read_b64_tr_b16 a[160:161], v67 offset:16384
    buffer_load_dwordx2 a[40:41], v77, s[4:7], 0 offen sc1
    v_mfma_f32_16x16x32_bf16 v[28:31], a[132:135], a[84:87], v[28:31]
    ds_read_b64_tr_b16 a[162:163], v67 offset:20480
    buffer_load_dwordx2 a[42:43], v79, s[4:7], 0 offen offset:512 sc1
    v_mfma_f32_16x16x32_bf16 v[60:63], a[132:135], a[92:95], v[60:63]
    ds_read_b64_tr_b16 a[164:165], v67 offset:24576
    s_add_u32 s4, s68, 38912
    v_mfma_f32_16x16x32_bf16 v[60:63], a[128:131], a[88:91], v[60:63]
    ds_read_b64_tr_b16 a[166:167], v67 offset:28672
    s_waitcnt vmcnt(32) lgkmcnt(12)
    v_mfma_f32_16x16x32_bf16 v[0:3], a[136:139], a[96:99], v[0:3]
    s_waitcnt vmcnt(30)
    s_barrier
    ds_read_b64_tr_b16 a[168:169], v64 offset:32768
    v_mfma_f32_16x16x32_bf16 v[0:3], a[140:143], a[100:103], v[0:3]
    ds_read_b64_tr_b16 a[170:171], v64 offset:36864
    s_addc_u32 s5, s69, 0
    v_mfma_f32_16x16x32_bf16 v[32:35], a[140:143], a[108:111], v[32:35]
    ds_read_b64_tr_b16 a[172:173], v64 offset:40960
    buffer_load_dwordx2 a[36:37], v76, s[4:7], 0 offen sc1
    v_mfma_f32_16x16x32_bf16 v[32:35], a[136:139], a[104:107], v[32:35]
    ds_read_b64_tr_b16 a[174:175], v64 offset:45056
    s_waitcnt lgkmcnt(12)
    v_mfma_f32_16x16x32_bf16 v[4:7], a[144:147], a[96:99], v[4:7]
    ds_read_b64_tr_b16 a[176:177], v65 offset:32768
    buffer_load_dwordx2 a[38:39], v78, s[4:7], 0 offen offset:512 sc1
    v_mfma_f32_16x16x32_bf16 v[4:7], a[148:151], a[100:103], v[4:7]
    ds_read_b64_tr_b16 a[178:179], v65 offset:36864
    buffer_load_dwordx2 a[44:45], v77, s[4:7], 0 offen sc1
    v_mfma_f32_16x16x32_bf16 v[36:39], a[148:151], a[108:111], v[36:39]
    ds_read_b64_tr_b16 a[180:181], v65 offset:40960
    buffer_load_dwordx2 a[46:47], v79, s[4:7], 0 offen offset:512 sc1
    v_mfma_f32_16x16x32_bf16 v[36:39], a[144:147], a[104:107], v[36:39]
    ds_read_b64_tr_b16 a[182:183], v65 offset:45056
    s_waitcnt lgkmcnt(12)
    v_mfma_f32_16x16x32_bf16 v[8:11], a[152:155], a[96:99], v[8:11]
    ds_read_b64_tr_b16 a[128:129], v66 offset:32768
    s_add_u32 m0, s49, 114688
    v_mfma_f32_16x16x32_bf16 v[8:11], a[156:159], a[100:103], v[8:11]
    ds_read_b64_tr_b16 a[130:131], v66 offset:36864
    s_add_u32 s12, s64, 2949120
    v_mfma_f32_16x16x32_bf16 v[40:43], a[156:159], a[108:111], v[40:43]
    ds_read_b64_tr_b16 a[132:133], v66 offset:40960
    s_addc_u32 s13, s65, 0
    v_mfma_f32_16x16x32_bf16 v[40:43], a[152:155], a[104:107], v[40:43]
    ds_read_b64_tr_b16 a[134:135], v66 offset:45056
    s_waitcnt lgkmcnt(12)
    v_mfma_f32_16x16x32_bf16 v[12:15], a[160:163], a[96:99], v[12:15]
    ds_read_b64_tr_b16 a[136:137], v67 offset:32768
    buffer_load_dwordx4 v242, s[12:15], 0 offen offset:0 sc1 lds
    v_mfma_f32_16x16x32_bf16 v[12:15], a[164:167], a[100:103], v[12:15]
    ds_read_b64_tr_b16 a[138:139], v67 offset:36864
    buffer_load_dwordx4 v243, s[12:15], 0 offen offset:1024 sc1 lds
    v_mfma_f32_16x16x32_bf16 v[44:47], a[164:167], a[108:111], v[44:47]
    ds_read_b64_tr_b16 a[140:141], v67 offset:40960
    s_add_u32 s4, s68, 46080
    v_mfma_f32_16x16x32_bf16 v[44:47], a[160:163], a[104:107], v[44:47]
    ds_read_b64_tr_b16 a[142:143], v67 offset:45056
    s_waitcnt vmcnt(32) lgkmcnt(12)
    v_mfma_f32_16x16x32_bf16 v[0:3], a[168:171], a[112:115], v[0:3]
    s_waitcnt vmcnt(30)
    s_barrier
    ds_read_b64_tr_b16 a[144:145], v64 offset:49152
    v_mfma_f32_16x16x32_bf16 v[0:3], a[172:175], a[116:119], v[0:3]
    ds_read_b64_tr_b16 a[146:147], v64 offset:53248
    s_addc_u32 s5, s69, 0
    v_mfma_f32_16x16x32_bf16 v[32:35], a[172:175], a[124:127], v[32:35]
    ds_read_b64_tr_b16 a[148:149], v64 offset:57344
    buffer_load_dwordx2 a[48:49], v76, s[4:7], 0 offen sc1
    v_mfma_f32_16x16x32_bf16 v[32:35], a[168:171], a[120:123], v[32:35]
    ds_read_b64_tr_b16 a[150:151], v64 offset:61440
    s_waitcnt lgkmcnt(12)
    v_mfma_f32_16x16x32_bf16 v[4:7], a[176:179], a[112:115], v[4:7]
    ds_read_b64_tr_b16 a[152:153], v65 offset:49152
    buffer_load_dwordx2 a[50:51], v78, s[4:7], 0 offen offset:512 sc1
    v_mfma_f32_16x16x32_bf16 v[4:7], a[180:183], a[116:119], v[4:7]
    ds_read_b64_tr_b16 a[154:155], v65 offset:53248
    buffer_load_dwordx2 a[56:57], v77, s[4:7], 0 offen sc1
    v_mfma_f32_16x16x32_bf16 v[36:39], a[180:183], a[124:127], v[36:39]
    ds_read_b64_tr_b16 a[156:157], v65 offset:57344
    buffer_load_dwordx2 a[58:59], v79, s[4:7], 0 offen offset:512 sc1
    v_mfma_f32_16x16x32_bf16 v[36:39], a[176:179], a[120:123], v[36:39]
    ds_read_b64_tr_b16 a[158:159], v65 offset:61440
    s_waitcnt lgkmcnt(12)
    v_mfma_f32_16x16x32_bf16 v[8:11], a[128:131], a[112:115], v[8:11]
    ds_read_b64_tr_b16 a[160:161], v66 offset:49152
    s_add_u32 s4, s68, 53248
    v_mfma_f32_16x16x32_bf16 v[8:11], a[132:135], a[116:119], v[8:11]
    ds_read_b64_tr_b16 a[162:163], v66 offset:53248
    s_addc_u32 s5, s69, 0
    v_mfma_f32_16x16x32_bf16 v[40:43], a[132:135], a[124:127], v[40:43]
    ds_read_b64_tr_b16 a[164:165], v66 offset:57344
    buffer_load_dwordx2 a[52:53], v76, s[4:7], 0 offen sc1
    v_mfma_f32_16x16x32_bf16 v[40:43], a[128:131], a[120:123], v[40:43]
    ds_read_b64_tr_b16 a[166:167], v66 offset:61440
    s_waitcnt lgkmcnt(12)
    v_mfma_f32_16x16x32_bf16 v[12:15], a[136:139], a[112:115], v[12:15]
    ds_read_b64_tr_b16 a[168:169], v67 offset:49152
    buffer_load_dwordx2 a[54:55], v78, s[4:7], 0 offen offset:512 sc1
    v_mfma_f32_16x16x32_bf16 v[12:15], a[140:143], a[116:119], v[12:15]
    ds_read_b64_tr_b16 a[170:171], v67 offset:53248
    buffer_load_dwordx2 a[60:61], v77, s[4:7], 0 offen sc1
    v_mfma_f32_16x16x32_bf16 v[44:47], a[140:143], a[124:127], v[44:47]
    ds_read_b64_tr_b16 a[172:173], v67 offset:57344
    buffer_load_dwordx2 a[62:63], v79, s[4:7], 0 offen offset:512 sc1
    v_mfma_f32_16x16x32_bf16 v[44:47], a[136:139], a[120:123], v[44:47]
    ds_read_b64_tr_b16 a[174:175], v67 offset:61440
    s_waitcnt vmcnt(30) lgkmcnt(12)
    v_mfma_f32_16x16x32_bf16 v[0:3], a[144:147], a[0:3], v[0:3]
    s_waitcnt vmcnt(28)
    s_barrier
    ds_read_b64_tr_b16 a[176:177], v68 offset:0
    v_mfma_f32_16x16x32_bf16 v[0:3], a[148:151], a[4:7], v[0:3]
    ds_read_b64_tr_b16 a[178:179], v68 offset:4096
    s_add_u32 m0, s49, 34816
    v_mfma_f32_16x16x32_bf16 v[32:35], a[148:151], a[12:15], v[32:35]
    ds_read_b64_tr_b16 a[180:181], v68 offset:8192
    s_add_u32 s84, s66, 2883584
    v_mfma_f32_16x16x32_bf16 v[32:35], a[144:147], a[8:11], v[32:35]
    ds_read_b64_tr_b16 a[182:183], v68 offset:12288
    s_waitcnt lgkmcnt(12)
    v_mfma_f32_16x16x32_bf16 v[4:7], a[152:155], a[0:3], v[4:7]
    ds_read_b64_tr_b16 a[128:129], v69 offset:0
    s_addc_u32 s85, s67, 0
    v_mfma_f32_16x16x32_bf16 v[4:7], a[156:159], a[4:7], v[4:7]
    ds_read_b64_tr_b16 a[130:131], v69 offset:4096
    buffer_load_dwordx4 v242, s[84:87], 0 offen offset:0 sc1 lds
    v_mfma_f32_16x16x32_bf16 v[36:39], a[156:159], a[12:15], v[36:39]
    ds_read_b64_tr_b16 a[132:133], v69 offset:8192
    buffer_load_dwordx4 v243, s[84:87], 0 offen offset:1024 sc1 lds
    v_mfma_f32_16x16x32_bf16 v[36:39], a[152:155], a[8:11], v[36:39]
    ds_read_b64_tr_b16 a[134:135], v69 offset:12288
    s_waitcnt lgkmcnt(12)
    v_mfma_f32_16x16x32_bf16 v[8:11], a[160:163], a[0:3], v[8:11]
    ds_read_b64_tr_b16 a[136:137], v70 offset:0
    s_add_u32 m0, s49, 51200
    v_mfma_f32_16x16x32_bf16 v[8:11], a[164:167], a[4:7], v[8:11]
    ds_read_b64_tr_b16 a[138:139], v70 offset:4096
    s_add_u32 s84, s66, 3342336
    v_mfma_f32_16x16x32_bf16 v[40:43], a[164:167], a[12:15], v[40:43]
    ds_read_b64_tr_b16 a[140:141], v70 offset:8192
    s_addc_u32 s85, s67, 0
    v_mfma_f32_16x16x32_bf16 v[40:43], a[160:163], a[8:11], v[40:43]
    ds_read_b64_tr_b16 a[142:143], v70 offset:12288
    s_waitcnt lgkmcnt(12)
    v_mfma_f32_16x16x32_bf16 v[12:15], a[168:171], a[0:3], v[12:15]
    ds_read_b64_tr_b16 a[144:145], v71 offset:0
    buffer_load_dwordx4 v242, s[84:87], 0 offen offset:0 sc1 lds
    v_mfma_f32_16x16x32_bf16 v[12:15], a[172:175], a[4:7], v[12:15]
    ds_read_b64_tr_b16 a[146:147], v71 offset:4096
    buffer_load_dwordx4 v243, s[84:87], 0 offen offset:1024 sc1 lds
    v_mfma_f32_16x16x32_bf16 v[44:47], a[172:175], a[12:15], v[44:47]
    ds_read_b64_tr_b16 a[148:149], v71 offset:8192
    s_add_u32 m0, s49, 67584
    v_mfma_f32_16x16x32_bf16 v[44:47], a[168:171], a[8:11], v[44:47]
    ds_read_b64_tr_b16 a[150:151], v71 offset:12288
    s_waitcnt vmcnt(24) lgkmcnt(12)
    v_mfma_f32_16x16x32_bf16 v[0:3], a[176:179], a[16:19], v[0:3]
    s_waitcnt vmcnt(22)
    s_barrier
    ds_read_b64_tr_b16 a[152:153], v68 offset:16384
    v_mfma_f32_16x16x32_bf16 v[0:3], a[180:183], a[20:23], v[0:3]
    ds_read_b64_tr_b16 a[154:155], v68 offset:20480
    s_add_u32 s66, s66, s47
    v_mfma_f32_16x16x32_bf16 v[32:35], a[180:183], a[28:31], v[32:35]
    ds_read_b64_tr_b16 a[156:157], v68 offset:24576
    s_addc_u32 s67, s67, 0
    v_mfma_f32_16x16x32_bf16 v[32:35], a[176:179], a[24:27], v[32:35]
    ds_read_b64_tr_b16 a[158:159], v68 offset:28672
    s_waitcnt lgkmcnt(12)
    v_mfma_f32_16x16x32_bf16 v[4:7], a[128:131], a[16:19], v[4:7]
    ds_read_b64_tr_b16 a[160:161], v69 offset:16384
    s_add_u32 s84, s66, 196608
    v_mfma_f32_16x16x32_bf16 v[4:7], a[132:135], a[20:23], v[4:7]
    ds_read_b64_tr_b16 a[162:163], v69 offset:20480
    s_addc_u32 s85, s67, 0
    v_mfma_f32_16x16x32_bf16 v[36:39], a[132:135], a[28:31], v[36:39]
    ds_read_b64_tr_b16 a[164:165], v69 offset:24576
    buffer_load_dwordx4 v242, s[84:87], 0 offen offset:0 sc1 lds
    v_mfma_f32_16x16x32_bf16 v[36:39], a[128:131], a[24:27], v[36:39]
    ds_read_b64_tr_b16 a[166:167], v69 offset:28672
    s_waitcnt lgkmcnt(12)
    v_mfma_f32_16x16x32_bf16 v[8:11], a[136:139], a[16:19], v[8:11]
    ds_read_b64_tr_b16 a[168:169], v70 offset:16384
    buffer_load_dwordx4 v243, s[84:87], 0 offen offset:1024 sc1 lds
    v_mfma_f32_16x16x32_bf16 v[8:11], a[140:143], a[20:23], v[8:11]
    ds_read_b64_tr_b16 a[170:171], v70 offset:20480
    s_add_u32 m0, s49, 83968
    v_mfma_f32_16x16x32_bf16 v[40:43], a[140:143], a[28:31], v[40:43]
    ds_read_b64_tr_b16 a[172:173], v70 offset:24576
    s_add_u32 s84, s66, 1114112
    v_mfma_f32_16x16x32_bf16 v[40:43], a[136:139], a[24:27], v[40:43]
    ds_read_b64_tr_b16 a[174:175], v70 offset:28672
    s_waitcnt lgkmcnt(12)
    v_mfma_f32_16x16x32_bf16 v[12:15], a[144:147], a[16:19], v[12:15]
    ds_read_b64_tr_b16 a[176:177], v71 offset:16384
    s_addc_u32 s85, s67, 0
    v_mfma_f32_16x16x32_bf16 v[12:15], a[148:151], a[20:23], v[12:15]
    ds_read_b64_tr_b16 a[178:179], v71 offset:20480
    buffer_load_dwordx4 v242, s[84:87], 0 offen offset:0 sc1 lds
    v_mfma_f32_16x16x32_bf16 v[44:47], a[148:151], a[28:31], v[44:47]
    ds_read_b64_tr_b16 a[180:181], v71 offset:24576
    buffer_load_dwordx4 v243, s[84:87], 0 offen offset:1024 sc1 lds
    v_mfma_f32_16x16x32_bf16 v[44:47], a[144:147], a[24:27], v[44:47]
    ds_read_b64_tr_b16 a[182:183], v71 offset:28672
    s_waitcnt vmcnt(18) lgkmcnt(12)
    v_mfma_f32_16x16x32_bf16 v[0:3], a[152:155], a[32:35], v[0:3]
    s_waitcnt vmcnt(16)
    s_barrier
    ds_read_b64_tr_b16 a[128:129], v68 offset:32768
    v_mfma_f32_16x16x32_bf16 v[0:3], a[156:159], a[36:39], v[0:3]
    ds_read_b64_tr_b16 a[130:131], v68 offset:36864
    s_add_u32 m0, s49, 100352
    v_mfma_f32_16x16x32_bf16 v[32:35], a[156:159], a[44:47], v[32:35]
    ds_read_b64_tr_b16 a[132:133], v68 offset:40960
    s_add_u32 s84, s66, 2031616
    v_mfma_f32_16x16x32_bf16 v[32:35], a[152:155], a[40:43], v[32:35]
    ds_read_b64_tr_b16 a[134:135], v68 offset:45056
    s_waitcnt lgkmcnt(12)
    v_mfma_f32_16x16x32_bf16 v[4:7], a[160:163], a[32:35], v[4:7]
    ds_read_b64_tr_b16 a[136:137], v69 offset:32768
    s_addc_u32 s85, s67, 0
    v_mfma_f32_16x16x32_bf16 v[4:7], a[164:167], a[36:39], v[4:7]
    ds_read_b64_tr_b16 a[138:139], v69 offset:36864
    buffer_load_dwordx4 v242, s[84:87], 0 offen offset:0 sc1 lds
    v_mfma_f32_16x16x32_bf16 v[36:39], a[164:167], a[44:47], v[36:39]
    ds_read_b64_tr_b16 a[140:141], v69 offset:40960
    buffer_load_dwordx4 v243, s[84:87], 0 offen offset:1024 sc1 lds
    v_mfma_f32_16x16x32_bf16 v[36:39], a[160:163], a[40:43], v[36:39]
    ds_read_b64_tr_b16 a[142:143], v69 offset:45056
    s_waitcnt lgkmcnt(12)
    v_mfma_f32_16x16x32_bf16 v[8:11], a[168:171], a[32:35], v[8:11]
    ds_read_b64_tr_b16 a[144:145], v70 offset:32768
    s_add_u32 m0, s49, 116736
    v_mfma_f32_16x16x32_bf16 v[8:11], a[172:175], a[36:39], v[8:11]
    ds_read_b64_tr_b16 a[146:147], v70 offset:36864
    s_add_u32 s84, s66, 2949120
    v_mfma_f32_16x16x32_bf16 v[40:43], a[172:175], a[44:47], v[40:43]
    ds_read_b64_tr_b16 a[148:149], v70 offset:40960
    s_addc_u32 s85, s67, 0
    v_mfma_f32_16x16x32_bf16 v[40:43], a[168:171], a[40:43], v[40:43]
    ds_read_b64_tr_b16 a[150:151], v70 offset:45056
    s_waitcnt lgkmcnt(12)
    v_mfma_f32_16x16x32_bf16 v[12:15], a[176:179], a[32:35], v[12:15]
    ds_read_b64_tr_b16 a[152:153], v71 offset:32768
    buffer_load_dwordx4 v242, s[84:87], 0 offen offset:0 sc1 lds
    v_mfma_f32_16x16x32_bf16 v[12:15], a[180:183], a[36:39], v[12:15]
    ds_read_b64_tr_b16 a[154:155], v71 offset:36864
    buffer_load_dwordx4 v243, s[84:87], 0 offen offset:1024 sc1 lds
    v_mfma_f32_16x16x32_bf16 v[44:47], a[180:183], a[44:47], v[44:47]
    ds_read_b64_tr_b16 a[156:157], v71 offset:40960
    v_mfma_f32_16x16x32_bf16 v[44:47], a[176:179], a[40:43], v[44:47]
    ds_read_b64_tr_b16 a[158:159], v71 offset:45056
    s_waitcnt vmcnt(12) lgkmcnt(12)
    v_mfma_f32_16x16x32_bf16 v[0:3], a[128:131], a[48:51], v[0:3]
    s_waitcnt vmcnt(10)
    s_barrier
    ds_read_b64_tr_b16 a[160:161], v64 offset:18432
    v_mfma_f32_16x16x32_bf16 v[0:3], a[132:135], a[52:55], v[0:3]
    ds_read_b64_tr_b16 a[162:163], v64 offset:22528
    v_mfma_f32_16x16x32_bf16 v[32:35], a[132:135], a[60:63], v[32:35]
    ds_read_b64_tr_b16 a[164:165], v64 offset:26624
    v_mfma_f32_16x16x32_bf16 v[32:35], a[128:131], a[56:59], v[32:35]
    ds_read_b64_tr_b16 a[166:167], v64 offset:30720
    s_waitcnt lgkmcnt(12)
    v_mfma_f32_16x16x32_bf16 v[4:7], a[136:139], a[48:51], v[4:7]
    ds_read_b64_tr_b16 a[168:169], v65 offset:18432
    v_mfma_f32_16x16x32_bf16 v[4:7], a[140:143], a[52:55], v[4:7]
    ds_read_b64_tr_b16 a[170:171], v65 offset:22528
    v_mfma_f32_16x16x32_bf16 v[36:39], a[140:143], a[60:63], v[36:39]
    ds_read_b64_tr_b16 a[172:173], v65 offset:26624
    v_mfma_f32_16x16x32_bf16 v[36:39], a[136:139], a[56:59], v[36:39]
    ds_read_b64_tr_b16 a[174:175], v65 offset:30720
    s_waitcnt lgkmcnt(12)
    v_mfma_f32_16x16x32_bf16 v[8:11], a[144:147], a[48:51], v[8:11]
    ds_read_b64_tr_b16 a[176:177], v66 offset:18432
    v_mfma_f32_16x16x32_bf16 v[8:11], a[148:151], a[52:55], v[8:11]
    ds_read_b64_tr_b16 a[178:179], v66 offset:22528
    v_mfma_f32_16x16x32_bf16 v[40:43], a[148:151], a[60:63], v[40:43]
    ds_read_b64_tr_b16 a[180:181], v66 offset:26624
    v_mfma_f32_16x16x32_bf16 v[40:43], a[144:147], a[56:59], v[40:43]
    ds_read_b64_tr_b16 a[182:183], v66 offset:30720
    s_waitcnt lgkmcnt(12)
    v_mfma_f32_16x16x32_bf16 v[12:15], a[152:155], a[48:51], v[12:15]
    ds_read_b64_tr_b16 a[128:129], v67 offset:18432
    v_mfma_f32_16x16x32_bf16 v[12:15], a[156:159], a[52:55], v[12:15]
    ds_read_b64_tr_b16 a[130:131], v67 offset:22528
    v_mfma_f32_16x16x32_bf16 v[44:47], a[156:159], a[60:63], v[44:47]
    ds_read_b64_tr_b16 a[132:133], v67 offset:26624
    v_mfma_f32_16x16x32_bf16 v[44:47], a[152:155], a[56:59], v[44:47]
    ds_read_b64_tr_b16 a[134:135], v67 offset:30720
    s_waitcnt lgkmcnt(12)
    v_mfma_f32_16x16x32_bf16 v[16:19], a[160:163], a[96:99], v[16:19]
    s_waitcnt vmcnt(8)
    s_barrier
    ds_read_b64_tr_b16 a[136:137], v64 offset:34816
    v_mfma_f32_16x16x32_bf16 v[16:19], a[164:167], a[100:103], v[16:19]
    ds_read_b64_tr_b16 a[138:139], v64 offset:38912
    v_cvt_pk_bf16_f32 v80, v0, v1
    v_mfma_f32_16x16x32_bf16 v[48:51], a[164:167], a[108:111], v[48:51]
    ds_read_b64_tr_b16 a[140:141], v64 offset:43008
    v_cvt_pk_bf16_f32 v81, v2, v3
    v_mfma_f32_16x16x32_bf16 v[48:51], a[160:163], a[104:107], v[48:51]
    ds_read_b64_tr_b16 a[142:143], v64 offset:47104
    s_waitcnt lgkmcnt(12)
    v_mfma_f32_16x16x32_bf16 v[20:23], a[168:171], a[96:99], v[20:23]
    ds_read_b64_tr_b16 a[144:145], v65 offset:34816
    v_cvt_pk_bf16_f32 v82, v4, v5
    v_mfma_f32_16x16x32_bf16 v[20:23], a[172:175], a[100:103], v[20:23]
    ds_read_b64_tr_b16 a[146:147], v65 offset:38912
    v_cvt_pk_bf16_f32 v83, v6, v7
    v_mfma_f32_16x16x32_bf16 v[52:55], a[172:175], a[108:111], v[52:55]
    ds_read_b64_tr_b16 a[148:149], v65 offset:43008
    buffer_store_dwordx4 v[80:83], v240, s[16:19], s42 offen offset:0 sc1
    v_mfma_f32_16x16x32_bf16 v[52:55], a[168:171], a[104:107], v[52:55]
    ds_read_b64_tr_b16 a[150:151], v65 offset:47104
    s_waitcnt lgkmcnt(12)
    v_mfma_f32_16x16x32_bf16 v[24:27], a[176:179], a[96:99], v[24:27]
    ds_read_b64_tr_b16 a[152:153], v66 offset:34816
    v_cvt_pk_bf16_f32 v84, v8, v9
    v_mfma_f32_16x16x32_bf16 v[24:27], a[180:183], a[100:103], v[24:27]
    ds_read_b64_tr_b16 a[154:155], v66 offset:38912
    v_cvt_pk_bf16_f32 v85, v10, v11
    v_mfma_f32_16x16x32_bf16 v[56:59], a[180:183], a[108:111], v[56:59]
    ds_read_b64_tr_b16 a[156:157], v66 offset:43008
    v_cvt_pk_bf16_f32 v86, v12, v13
    v_mfma_f32_16x16x32_bf16 v[56:59], a[176:179], a[104:107], v[56:59]
    ds_read_b64_tr_b16 a[158:159], v66 offset:47104
    s_waitcnt lgkmcnt(12)
    v_mfma_f32_16x16x32_bf16 v[28:31], a[128:131], a[96:99], v[28:31]
    ds_read_b64_tr_b16 a[160:161], v67 offset:34816
    v_cvt_pk_bf16_f32 v87, v14, v15
    v_mfma_f32_16x16x32_bf16 v[28:31], a[132:135], a[100:103], v[28:31]
    ds_read_b64_tr_b16 a[162:163], v67 offset:38912
    buffer_store_dwordx4 v[84:87], v240, s[16:19], s42 offen offset:1024 sc1
    v_mfma_f32_16x16x32_bf16 v[60:63], a[132:135], a[108:111], v[60:63]
    ds_read_b64_tr_b16 a[164:165], v67 offset:43008
    v_cvt_pk_bf16_f32 v88, v32, v33
    v_mfma_f32_16x16x32_bf16 v[60:63], a[128:131], a[104:107], v[60:63]
    ds_read_b64_tr_b16 a[166:167], v67 offset:47104
    s_waitcnt lgkmcnt(12)
    v_mfma_f32_16x16x32_bf16 v[16:19], a[136:139], a[112:115], v[16:19]
    s_waitcnt vmcnt(8)
    s_barrier
    ds_read_b64_tr_b16 a[168:169], v64 offset:51200
    v_mfma_f32_16x16x32_bf16 v[16:19], a[140:143], a[116:119], v[16:19]
    ds_read_b64_tr_b16 a[170:171], v64 offset:55296
    v_cvt_pk_bf16_f32 v89, v34, v35
    v_mfma_f32_16x16x32_bf16 v[48:51], a[140:143], a[124:127], v[48:51]
    ds_read_b64_tr_b16 a[172:173], v64 offset:59392
    v_cvt_pk_bf16_f32 v90, v36, v37
    v_mfma_f32_16x16x32_bf16 v[48:51], a[136:139], a[120:123], v[48:51]
    ds_read_b64_tr_b16 a[174:175], v64 offset:63488
    s_waitcnt lgkmcnt(12)
    v_mfma_f32_16x16x32_bf16 v[20:23], a[144:147], a[112:115], v[20:23]
    ds_read_b64_tr_b16 a[176:177], v65 offset:51200
    v_cvt_pk_bf16_f32 v91, v38, v39
    v_mfma_f32_16x16x32_bf16 v[20:23], a[148:151], a[116:119], v[20:23]
    ds_read_b64_tr_b16 a[178:179], v65 offset:55296
    buffer_store_dwordx4 v[88:91], v240, s[16:19], s42 offen offset:2048 sc1
    v_mfma_f32_16x16x32_bf16 v[52:55], a[148:151], a[124:127], v[52:55]
    ds_read_b64_tr_b16 a[180:181], v65 offset:59392
    v_cvt_pk_bf16_f32 v92, v40, v41
    v_mfma_f32_16x16x32_bf16 v[52:55], a[144:147], a[120:123], v[52:55]
    ds_read_b64_tr_b16 a[182:183], v65 offset:63488
    s_waitcnt lgkmcnt(12)
    v_mfma_f32_16x16x32_bf16 v[24:27], a[152:155], a[112:115], v[24:27]
    ds_read_b64_tr_b16 a[128:129], v66 offset:51200
    v_cvt_pk_bf16_f32 v93, v42, v43
    v_mfma_f32_16x16x32_bf16 v[24:27], a[156:159], a[116:119], v[24:27]
    ds_read_b64_tr_b16 a[130:131], v66 offset:55296
    v_cvt_pk_bf16_f32 v94, v44, v45
    v_mfma_f32_16x16x32_bf16 v[56:59], a[156:159], a[124:127], v[56:59]
    ds_read_b64_tr_b16 a[132:133], v66 offset:59392
    v_cvt_pk_bf16_f32 v95, v46, v47
    v_mfma_f32_16x16x32_bf16 v[56:59], a[152:155], a[120:123], v[56:59]
    ds_read_b64_tr_b16 a[134:135], v66 offset:63488
    s_waitcnt lgkmcnt(12)
    v_mfma_f32_16x16x32_bf16 v[28:31], a[160:163], a[112:115], v[28:31]
    ds_read_b64_tr_b16 a[136:137], v67 offset:51200
    buffer_store_dwordx4 v[92:95], v240, s[16:19], s42 offen offset:3072 sc1
    v_mfma_f32_16x16x32_bf16 v[28:31], a[164:167], a[116:119], v[28:31]
    ds_read_b64_tr_b16 a[138:139], v67 offset:55296
    s_xor_b32 s42, s42, 0x4000
    v_mfma_f32_16x16x32_bf16 v[60:63], a[164:167], a[124:127], v[60:63]
    ds_read_b64_tr_b16 a[140:141], v67 offset:59392
    s_mov_b32 s59, 0x20000
    v_mfma_f32_16x16x32_bf16 v[60:63], a[160:163], a[120:123], v[60:63]
    ds_read_b64_tr_b16 a[142:143], v67 offset:63488
    s_waitcnt lgkmcnt(12)
    v_mfma_f32_16x16x32_bf16 v[16:19], a[168:171], a[0:3], v[16:19]
    s_waitcnt vmcnt(8)
    s_barrier
    ds_read_b64_tr_b16 a[144:145], v68 offset:2048
    v_mfma_f32_16x16x32_bf16 v[16:19], a[172:175], a[4:7], v[16:19]
    ds_read_b64_tr_b16 a[146:147], v68 offset:6144
    v_mfma_f32_16x16x32_bf16 v[48:51], a[172:175], a[12:15], v[48:51]
    ds_read_b64_tr_b16 a[148:149], v68 offset:10240
    v_mfma_f32_16x16x32_bf16 v[48:51], a[168:171], a[8:11], v[48:51]
    ds_read_b64_tr_b16 a[150:151], v68 offset:14336
    s_waitcnt lgkmcnt(12)
    v_mfma_f32_16x16x32_bf16 v[20:23], a[176:179], a[0:3], v[20:23]
    ds_read_b64_tr_b16 a[152:153], v69 offset:2048
    v_mfma_f32_16x16x32_bf16 v[20:23], a[180:183], a[4:7], v[20:23]
    ds_read_b64_tr_b16 a[154:155], v69 offset:6144
    v_mfma_f32_16x16x32_bf16 v[52:55], a[180:183], a[12:15], v[52:55]
    ds_read_b64_tr_b16 a[156:157], v69 offset:10240
    v_mfma_f32_16x16x32_bf16 v[52:55], a[176:179], a[8:11], v[52:55]
    ds_read_b64_tr_b16 a[158:159], v69 offset:14336
    s_waitcnt lgkmcnt(12)
    v_mfma_f32_16x16x32_bf16 v[24:27], a[128:131], a[0:3], v[24:27]
    ds_read_b64_tr_b16 a[160:161], v70 offset:2048
    v_mfma_f32_16x16x32_bf16 v[24:27], a[132:135], a[4:7], v[24:27]
    ds_read_b64_tr_b16 a[162:163], v70 offset:6144
    v_mfma_f32_16x16x32_bf16 v[56:59], a[132:135], a[12:15], v[56:59]
    ds_read_b64_tr_b16 a[164:165], v70 offset:10240
    v_mfma_f32_16x16x32_bf16 v[56:59], a[128:131], a[8:11], v[56:59]
    ds_read_b64_tr_b16 a[166:167], v70 offset:14336
    s_waitcnt lgkmcnt(12)
    v_mfma_f32_16x16x32_bf16 v[28:31], a[136:139], a[0:3], v[28:31]
    ds_read_b64_tr_b16 a[168:169], v71 offset:2048
    v_mfma_f32_16x16x32_bf16 v[28:31], a[140:143], a[4:7], v[28:31]
    ds_read_b64_tr_b16 a[170:171], v71 offset:6144
    v_mfma_f32_16x16x32_bf16 v[60:63], a[140:143], a[12:15], v[60:63]
    ds_read_b64_tr_b16 a[172:173], v71 offset:10240
    v_mfma_f32_16x16x32_bf16 v[60:63], a[136:139], a[8:11], v[60:63]
    ds_read_b64_tr_b16 a[174:175], v71 offset:14336
    s_waitcnt lgkmcnt(12)
    v_mfma_f32_16x16x32_bf16 v[16:19], a[144:147], a[16:19], v[16:19]
    s_waitcnt vmcnt(6)
    s_barrier
    ds_read_b64_tr_b16 a[176:177], v68 offset:18432
    v_mfma_f32_16x16x32_bf16 v[16:19], a[148:151], a[20:23], v[16:19]
    ds_read_b64_tr_b16 a[178:179], v68 offset:22528
    v_mfma_f32_16x16x32_bf16 v[48:51], a[148:151], a[28:31], v[48:51]
    ds_read_b64_tr_b16 a[180:181], v68 offset:26624
    v_mfma_f32_16x16x32_bf16 v[48:51], a[144:147], a[24:27], v[48:51]
    ds_read_b64_tr_b16 a[182:183], v68 offset:30720
    s_waitcnt lgkmcnt(12)
    v_mfma_f32_16x16x32_bf16 v[20:23], a[152:155], a[16:19], v[20:23]
    ds_read_b64_tr_b16 a[128:129], v69 offset:18432
    v_mfma_f32_16x16x32_bf16 v[20:23], a[156:159], a[20:23], v[20:23]
    ds_read_b64_tr_b16 a[130:131], v69 offset:22528
    v_mfma_f32_16x16x32_bf16 v[52:55], a[156:159], a[28:31], v[52:55]
    ds_read_b64_tr_b16 a[132:133], v69 offset:26624
    v_mfma_f32_16x16x32_bf16 v[52:55], a[152:155], a[24:27], v[52:55]
    ds_read_b64_tr_b16 a[134:135], v69 offset:30720
    s_waitcnt lgkmcnt(12)
    v_mfma_f32_16x16x32_bf16 v[24:27], a[160:163], a[16:19], v[24:27]
    ds_read_b64_tr_b16 a[136:137], v70 offset:18432
    v_mfma_f32_16x16x32_bf16 v[24:27], a[164:167], a[20:23], v[24:27]
    ds_read_b64_tr_b16 a[138:139], v70 offset:22528
    v_mfma_f32_16x16x32_bf16 v[56:59], a[164:167], a[28:31], v[56:59]
    ds_read_b64_tr_b16 a[140:141], v70 offset:26624
    v_mfma_f32_16x16x32_bf16 v[56:59], a[160:163], a[24:27], v[56:59]
    ds_read_b64_tr_b16 a[142:143], v70 offset:30720
    s_waitcnt lgkmcnt(12)
    v_mfma_f32_16x16x32_bf16 v[28:31], a[168:171], a[16:19], v[28:31]
    ds_read_b64_tr_b16 a[144:145], v71 offset:18432
    buffer_load_dwordx4 v[96:99], v240, s[16:19], s42 offen offset:0 sc1
    v_mfma_f32_16x16x32_bf16 v[28:31], a[172:175], a[20:23], v[28:31]
    ds_read_b64_tr_b16 a[146:147], v71 offset:22528
    v_mfma_f32_16x16x32_bf16 v[60:63], a[172:175], a[28:31], v[60:63]
    ds_read_b64_tr_b16 a[148:149], v71 offset:26624
    buffer_load_dwordx4 v[100:103], v240, s[16:19], s42 offen offset:1024 sc1
    v_mfma_f32_16x16x32_bf16 v[60:63], a[168:171], a[24:27], v[60:63]
    ds_read_b64_tr_b16 a[150:151], v71 offset:30720
    s_waitcnt lgkmcnt(12)
    v_mfma_f32_16x16x32_bf16 v[16:19], a[176:179], a[32:35], v[16:19]
    s_waitcnt vmcnt(6)
    s_barrier
    ds_read_b64_tr_b16 a[152:153], v68 offset:34816
    v_mfma_f32_16x16x32_bf16 v[16:19], a[180:183], a[36:39], v[16:19]
    ds_read_b64_tr_b16 a[154:155], v68 offset:38912
    v_mfma_f32_16x16x32_bf16 v[48:51], a[180:183], a[44:47], v[48:51]
    ds_read_b64_tr_b16 a[156:157], v68 offset:43008
    buffer_load_dwordx4 v[104:107], v240, s[16:19], s42 offen offset:2048 sc1
    v_mfma_f32_16x16x32_bf16 v[48:51], a[176:179], a[40:43], v[48:51]
    ds_read_b64_tr_b16 a[158:159], v68 offset:47104
    s_waitcnt lgkmcnt(12)
    v_mfma_f32_16x16x32_bf16 v[20:23], a[128:131], a[32:35], v[20:23]
    ds_read_b64_tr_b16 a[160:161], v69 offset:34816
    v_mfma_f32_16x16x32_bf16 v[20:23], a[132:135], a[36:39], v[20:23]
    ds_read_b64_tr_b16 a[162:163], v69 offset:38912
    buffer_load_dwordx4 v[108:111], v240, s[16:19], s42 offen offset:3072 sc1
    v_mfma_f32_16x16x32_bf16 v[52:55], a[132:135], a[44:47], v[52:55]
    ds_read_b64_tr_b16 a[164:165], v69 offset:43008
    v_mfma_f32_16x16x32_bf16 v[52:55], a[128:131], a[40:43], v[52:55]
    ds_read_b64_tr_b16 a[166:167], v69 offset:47104
    s_waitcnt lgkmcnt(12)
    v_mfma_f32_16x16x32_bf16 v[24:27], a[136:139], a[32:35], v[24:27]
    ds_read_b64_tr_b16 a[168:169], v70 offset:34816
    v_mfma_f32_16x16x32_bf16 v[24:27], a[140:143], a[36:39], v[24:27]
    ds_read_b64_tr_b16 a[170:171], v70 offset:38912
    v_mfma_f32_16x16x32_bf16 v[56:59], a[140:143], a[44:47], v[56:59]
    ds_read_b64_tr_b16 a[172:173], v70 offset:43008
    v_mfma_f32_16x16x32_bf16 v[56:59], a[136:139], a[40:43], v[56:59]
    ds_read_b64_tr_b16 a[174:175], v70 offset:47104
    s_waitcnt lgkmcnt(12)
    v_mfma_f32_16x16x32_bf16 v[28:31], a[144:147], a[32:35], v[28:31]
    ds_read_b64_tr_b16 a[176:177], v71 offset:34816
    v_mfma_f32_16x16x32_bf16 v[28:31], a[148:151], a[36:39], v[28:31]
    ds_read_b64_tr_b16 a[178:179], v71 offset:38912
    v_mfma_f32_16x16x32_bf16 v[60:63], a[148:151], a[44:47], v[60:63]
    ds_read_b64_tr_b16 a[180:181], v71 offset:43008
    v_mfma_f32_16x16x32_bf16 v[60:63], a[144:147], a[40:43], v[60:63]
    ds_read_b64_tr_b16 a[182:183], v71 offset:47104
    s_waitcnt lgkmcnt(12)
    v_mfma_f32_16x16x32_bf16 v[16:19], a[152:155], a[48:51], v[16:19]
    v_mfma_f32_16x16x32_bf16 v[16:19], a[156:159], a[52:55], v[16:19]
    v_mfma_f32_16x16x32_bf16 v[48:51], a[156:159], a[60:63], v[48:51]
    v_mfma_f32_16x16x32_bf16 v[48:51], a[152:155], a[56:59], v[48:51]
    s_waitcnt lgkmcnt(8)
    v_mfma_f32_16x16x32_bf16 v[20:23], a[160:163], a[48:51], v[20:23]
    v_mfma_f32_16x16x32_bf16 v[20:23], a[164:167], a[52:55], v[20:23]
    v_mfma_f32_16x16x32_bf16 v[52:55], a[164:167], a[60:63], v[52:55]
    v_mfma_f32_16x16x32_bf16 v[52:55], a[160:163], a[56:59], v[52:55]
    s_waitcnt lgkmcnt(4)
    v_mfma_f32_16x16x32_bf16 v[24:27], a[168:171], a[48:51], v[24:27]
    v_mfma_f32_16x16x32_bf16 v[24:27], a[172:175], a[52:55], v[24:27]
    v_mfma_f32_16x16x32_bf16 v[56:59], a[172:175], a[60:63], v[56:59]
    v_mfma_f32_16x16x32_bf16 v[56:59], a[168:171], a[56:59], v[56:59]
    s_waitcnt lgkmcnt(0)
    v_mfma_f32_16x16x32_bf16 v[28:31], a[176:179], a[48:51], v[28:31]
    v_mfma_f32_16x16x32_bf16 v[28:31], a[180:183], a[52:55], v[28:31]
    v_mfma_f32_16x16x32_bf16 v[60:63], a[180:183], a[60:63], v[60:63]
    v_mfma_f32_16x16x32_bf16 v[60:63], a[176:179], a[56:59], v[60:63]
    s_nop 1
    v_pk_add_f32 v[16:17], v[16:17], v[144:145]
    v_pk_add_f32 v[18:19], v[18:19], v[146:147]
    v_pk_add_f32 v[48:49], v[48:49], v[160:161]
    v_pk_add_f32 v[50:51], v[50:51], v[162:163]
    v_pk_add_f32 v[20:21], v[20:21], v[148:149]
    v_pk_add_f32 v[22:23], v[22:23], v[150:151]
    v_pk_add_f32 v[52:53], v[52:53], v[164:165]
    v_pk_add_f32 v[54:55], v[54:55], v[166:167]
    v_pk_add_f32 v[24:25], v[24:25], v[152:153]
    v_pk_add_f32 v[26:27], v[26:27], v[154:155]
    v_pk_add_f32 v[56:57], v[56:57], v[168:169]
    v_pk_add_f32 v[58:59], v[58:59], v[170:171]
    v_pk_add_f32 v[28:29], v[28:29], v[156:157]
    v_pk_add_f32 v[30:31], v[30:31], v[158:159]
    v_pk_add_f32 v[60:61], v[60:61], v[172:173]
    v_pk_add_f32 v[62:63], v[62:63], v[174:175]
L_rx:
    s_waitcnt vmcnt(0)
    v_max3_u32 v128, v96, v97, v98
    v_max3_u32 v128, v128, v99, v100
    v_max3_u32 v128, v128, v101, v102
    v_max3_u32 v128, v128, v103, v104
    v_max3_u32 v128, v128, v105, v106
    v_max3_u32 v128, v128, v107, v108
    v_max3_u32 v128, v128, v109, v110
    v_max_u32 v128, v128, v111
    v_cmp_eq_u32 vcc, -1, v128
    s_cmp_eq_u64 vcc, 0
    s_cbranch_scc1 L_rxdone
    s_sub_u32 s59, s59, 1
    s_cbranch_scc1 L_rxdone
    buffer_load_dwordx4 v[96:99], v240, s[16:19], s42 offen offset:0 sc1
    buffer_load_dwordx4 v[100:103], v240, s[16:19], s42 offen offset:1024 sc1
    buffer_load_dwordx4 v[104:107], v240, s[16:19], s42 offen offset:2048 sc1
    buffer_load_dwordx4 v[108:111], v240, s[16:19], s42 offen offset:3072 sc1
    s_branch L_rx
L_rxdone:
    v_lshlrev_b32 v128, 16, v96
    v_and_b32 v129, 0xffff0000, v96
    v_pk_add_f32 v[16:17], v[16:17], v[128:129]
    v_cvt_pk_bf16_f32 v112, v16, v17
    v_lshlrev_b32 v128, 16, v97
    v_and_b32 v129, 0xffff0000, v97
    v_pk_add_f32 v[18:19], v[18:19], v[128:129]
    v_cvt_pk_bf16_f32 v113, v18, v19
    ds_write_b64 v246, v[112:113] offset:0
    v_lshlrev_b32 v128, 16, v98
    v_and_b32 v129, 0xffff0000, v98
    v_pk_add_f32 v[20:21], v[20:21], v[128:129]
    v_cvt_pk_bf16_f32 v114, v20, v21
    v_lshlrev_b32 v128, 16, v99
    v_and_b32 v129, 0xffff0000, v99
    v_pk_add_f32 v[22:23], v[22:23], v[128:129]
    v_cvt_pk_bf16_f32 v115, v22, v23
    ds_write_b64 v247, v[114:115] offset:0
    v_lshlrev_b32 v128, 16, v100
    v_and_b32 v129, 0xffff0000, v100
    v_pk_add_f32 v[24:25], v[24:25], v[128:129]
    v_cvt_pk_bf16_f32 v116, v24, v25
    v_lshlrev_b32 v128, 16, v101
    v_and_b32 v129, 0xffff0000, v101
    v_pk_add_f32 v[26:27], v[26:27], v[128:129]
    v_cvt_pk_bf16_f32 v117, v26, v27
    ds_write_b64 v248, v[116:117] offset:0
    v_lshlrev_b32 v128, 16, v102
    v_and_b32 v129, 0xffff0000, v102
    v_pk_add_f32 v[28:29], v[28:29], v[128:129]
    v_cvt_pk_bf16_f32 v118, v28, v29
    v_lshlrev_b32 v128, 16, v103
    v_and_b32 v129, 0xffff0000, v103
    v_pk_add_f32 v[30:31], v[30:31], v[128:129]
    v_cvt_pk_bf16_f32 v119, v30, v31
    ds_write_b64 v249, v[118:119] offset:0
    ds_read_b128 v[0:3], v176 offset:0
    ds_read_b128 v[4:7], v176 offset:1024
    v_lshlrev_b32 v128, 16, v104
    v_and_b32 v129, 0xffff0000, v104
    v_pk_add_f32 v[48:49], v[48:49], v[128:129]
    v_cvt_pk_bf16_f32 v120, v48, v49
    v_lshlrev_b32 v128, 16, v105
    v_and_b32 v129, 0xffff0000, v105
    v_pk_add_f32 v[50:51], v[50:51], v[128:129]
    v_cvt_pk_bf16_f32 v121, v50, v51
    ds_write_b64 v246, v[120:121] offset:2048
    v_lshlrev_b32 v128, 16, v106
    v_and_b32 v129, 0xffff0000, v106
    v_pk_add_f32 v[52:53], v[52:53], v[128:129]
    v_cvt_pk_bf16_f32 v122, v52, v53
    v_lshlrev_b32 v128, 16, v107
    v_and_b32 v129, 0xffff0000, v107
    v_pk_add_f32 v[54:55], v[54:55], v[128:129]
    v_cvt_pk_bf16_f32 v123, v54, v55
    ds_write_b64 v247, v[122:123] offset:2048
    v_lshlrev_b32 v128, 16, v108
    v_and_b32 v129, 0xffff0000, v108
    v_pk_add_f32 v[56:57], v[56:57], v[128:129]
    v_cvt_pk_bf16_f32 v124, v56, v57
    s_waitcnt lgkmcnt(2)
    s_mov_b32 s51, 0
    buffer_store_dwordx4 v[0:3], v244, s[8:11], s51 offen nt
    s_mov_b32 s51, 16384
    buffer_store_dwordx4 v[4:7], v245, s[8:11], s51 offen nt
    v_lshlrev_b32 v128, 16, v109
    v_and_b32 v129, 0xffff0000, v109
    v_pk_add_f32 v[58:59], v[58:59], v[128:129]
    v_cvt_pk_bf16_f32 v125, v58, v59
    ds_write_b64 v248, v[124:125] offset:2048
    v_lshlrev_b32 v128, 16, v110
    v_and_b32 v129, 0xffff0000, v110
    v_pk_add_f32 v[60:61], v[60:61], v[128:129]
    v_cvt_pk_bf16_f32 v126, v60, v61
    v_lshlrev_b32 v128, 16, v111
    v_and_b32 v129, 0xffff0000, v111
    v_pk_add_f32 v[62:63], v[62:63], v[128:129]
    v_cvt_pk_bf16_f32 v127, v62, v63
    ds_write_b64 v249, v[126:127] offset:2048
    ds_read_b128 v[8:11], v176 offset:2048
    ds_read_b128 v[12:15], v176 offset:3072
    s_waitcnt lgkmcnt(1)
    s_mov_b32 s51, 32768
    buffer_store_dwordx4 v[8:11], v244, s[8:11], s51 offen nt
    s_waitcnt lgkmcnt(0)
    s_mov_b32 s51, 49152
    buffer_store_dwordx4 v[12:15], v245, s[8:11], s51 offen nt
L_end:
    s_endpgm
.section .rodata,"a"
.p2align 6
.amdhsa_kernel sequential_preLN__linear_attn_block__glu_gated_glu__prompt_kernel
  .amdhsa_next_free_vgpr 512
  .amdhsa_next_free_sgpr 102
  .amdhsa_accum_offset 256
  .amdhsa_group_segment_fixed_size 0
  .amdhsa_kernarg_size 80
  .amdhsa_user_sgpr_count 2
  .amdhsa_user_sgpr_kernarg_segment_ptr 1
  .amdhsa_system_sgpr_workgroup_id_x 1
  .amdhsa_float_denorm_mode_32 3
  .amdhsa_float_denorm_mode_16_64 3
.end_amdhsa_kernel
```
